```python
import torch

def _softmax(x, axis=-1):
    return torch.softmax(x, dim=axis)
def _gelu(x):
    return torch.nn.functional.gelu(x, approximate="tanh")
def _silu(x):
    return torch.nn.functional.silu(x)
def _sigmoid(x):
    return torch.sigmoid(x)
def _layernorm(x, axis=-1, eps=1e-5):
    m = x.mean(dim=axis, keepdim=True)
    v = x.var(dim=axis, keepdim=True, unbiased=False)
    return (x - m) / torch.sqrt(v + eps)
def _scatter_add(tgt, idx, src, axis=0):
    return tgt.clone().index_add_(axis, idx, src)
def _segment_sum(src, seg, n):
    out = torch.zeros((n,) + src.shape[1:], dtype=src.dtype)
    return out.index_add_(0, seg, src)
def _pad(x, pw):
    flat = tuple(v for pair in reversed(pw) for v in pair)
    return torch.nn.functional.pad(x, flat)

kernel_name = 'standalone__sequential_behavior_din__recsys'

def setup_inputs():

    _w = (lambda a: (lambda t: t.to(torch.bfloat16) if t.is_floating_point() else t)(torch.as_tensor(a)))
    B, L, D = 16384, 200, 64
    H = D
    return {
        "target": _w((lambda *s: torch.randn(*s, dtype=torch.bfloat16) * 1.6)(B, D)),
        "hist": _w((lambda *s: torch.randn(*s, dtype=torch.bfloat16) * 1.6)(B, L, D)),
        "mask": _w((lambda lo, hi, *s: torch.randint(lo, hi, s))(0, 2, B, L).to(float)),
        "w1": _w((lambda *s: torch.randn(*s, dtype=torch.bfloat16) * 1.6)(4 * D, H) * (4 * D) ** -0.5),
        "b1": _w((lambda *s: torch.randn(*s, dtype=torch.bfloat16) * 1.6)(H) * 0.1),
        "w2": _w((lambda *s: torch.randn(*s, dtype=torch.bfloat16) * 0.05)(H, 1) * H ** -0.5),
        "b2": _w((lambda *s: torch.randn(*s, dtype=torch.bfloat16) * 0.05)(1) * 0.1),
    }

def reference(target, hist, mask, w1, b1, w2, b2):
    L = hist.shape[1]
    tgt = (lambda x, n, axis: torch.repeat_interleave(x, n, dim=axis))(target[:, None, :], L, axis=1)
    feat = torch.concatenate([hist, tgt, hist - tgt, hist * tgt], axis=-1)
    h = _sigmoid(feat @ w1 + b1)
    scores = (h @ w2 + b2)[..., 0] * mask
    return torch.einsum('bl,bld->bd', scores, hist)
```

```asm
; @launch grid=(256,1,1) block=(512,1,1) lds=157184
.amdgcn_target "amdgcn-amd-amdhsa--gfx950"
.text
.globl standalone__sequential_behavior_din__recsys_kernel
.p2align 8
.type standalone__sequential_behavior_din__recsys_kernel,@function
standalone__sequential_behavior_din__recsys_kernel:
    s_cmp_ge_u32 s2, 256
    s_cbranch_scc1 L_END
    s_load_dwordx16 s[4:19], s[0:1], 0
    s_setprio 3
    v_lshrrev_b32 v1, 6, v0
    v_and_b32 v160, 63, v0
    v_readfirstlane_b32 s48, v1
    s_getpc_b64 s[40:41]
L_PC:
    s_cmp_lt_u32 s48, 5
    s_cbranch_scc1 P_NC
    s_sub_u32 s40, s40, L_PC-standalone__sequential_behavior_din__recsys_kernel
    s_subb_u32 s41, s41, 0
    s_mov_b32 s42, L_END-standalone__sequential_behavior_din__recsys_kernel
    s_mov_b32 s43, 0x20000
    v_subrev_u32 v150, 320, v0
    v_lshlrev_b32 v150, 6, v150
    buffer_load_dword v150, v150, s[40:43], 0 offen
P_NC:
    v_and_b32 v2, 31, v0
    v_bfe_u32 v3, v0, 5, 1
    v_cmp_gt_u32 vcc, 25, v2
    v_mul_u32_u24 v4, 400, v3
    v_lshl_add_u32 v163, v2, 4, v4
    v_bfrev_b32 v4, 8
    v_cndmask_b32 v163, v4, v163, vcc
    s_mul_i32 s57, s2, 25600
    s_mul_i32 s71, s48, 800
    s_mov_b32 s26, 25600
    s_mov_b32 s27, 0x20000
    s_lshl_b32 s69, s48, 12
    s_lshl_b32 s53, s2, 13
    v_lshlrev_b32 v251, 4, v160
    v_lshlrev_b32 v120, 1, v160
    v_and_b32 v120, 32, v120
    v_xor_b32 v120, v120, v251
    v_xor_b32 v121, 64, v120
    s_mov_b32 s38, 32768
    s_mov_b32 s39, 0x20000
    s_lshl_b32 s58, s48, 10
    s_mov_b32 s34, 8192
    s_mov_b32 s35, 0x20000
    s_lshl1_add_u32 s54, s69, 16384
    s_add_u32 m0, s54, 4096
    v_and_b32 v162, 15, v160
    v_lshrrev_b32 v161, 4, v160
    v_lshlrev_b32 v252, 4, v161
    v_mul_u32_u24 v224, 0x80008, v2
    v_lshrrev_b32 v236, 3, v160
    v_add_u32 v224, 0x10000, v224
    v_cmp_gt_u32 vcc, 32, v160
    s_waitcnt lgkmcnt(0)
    s_add_u32 s24, s8, s57
    s_addc_u32 s25, s9, 0
    s_mov_b64 s[36:37], s[10:11]
    buffer_load_dwordx4 v[220:223], v163, s[24:27], s71 offen offset:0 nt
    s_setprio 0
    s_add_u32 s32, s4, s53
    s_addc_u32 s33, s5, 0
    s_load_dword s63, s[16:17], 0
    s_cmp_lg_u32 s48, 0
    s_cbranch_scc1 P_LJ
    v_mov_b32 v146, s12
    v_mov_b32 v147, s13
    v_mov_b32 v148, s14
    v_mov_b32 v149, s15
    v_lshlrev_b32 v4, 2, v2
    v_cndmask_b32 v146, v146, v148, vcc
    v_cndmask_b32 v147, v147, v149, vcc
    v_add_co_u32 v146, vcc, v146, v4
    s_nop 1
    v_addc_co_u32 v147, vcc, 0, v147, vcc
    global_load_dword v146, v[146:147], off
P_LJ:
    buffer_load_dwordx4 v[124:127], v251, s[32:35], s58 offen nt
    buffer_load_dwordx4 v120, s[36:39], s69 offen offset:0 lds
    buffer_load_dwordx4 v121, s[36:39], s69 offen offset:1024 lds
    s_mul_i32 s49, s2, 1638400
    s_lshl_b32 s57, s48, 9
    v_add_u32 v247, 115712, v236
    v_add_u32 v246, s57, v247
    v_add_u32 v225, 0x20002, v224
    v_add_u32 v226, 0x40004, v224
    v_add_u32 v227, 0x60006, v224
    s_mul_i32 s56, s48, 3072
    s_add_u32 s56, s56, 132608
    v_add_u32 v4, s56, v251
    v_mov_b64 v[104:105], 0
    v_mov_b64 v[106:107], 0
    ds_write_b128 v4, v[104:107] offset:0
    ds_write_b128 v4, v[104:107] offset:1024
    ds_write_b128 v4, v[104:107] offset:2048
    s_mov_b32 s20, s6
    s_or_b32 s21, s7, 0x800000
    s_mov_b32 s22, 200
    s_mov_b32 s23, 0x20000
    s_mov_b32 s62, 0xffff
    s_mov_b32 s61, 0x3f80
    v_lshlrev_b32 v250, 2, v160
    v_and_b32 v2, 6, v236
    v_xor_b32 v2, v2, v160
    v_and_b32 v2, 7, v2
    v_mul_u32_u24 v143, 528, v236
    v_lshlrev_b32 v237, 4, v2
    v_lshlrev_b32 v239, 4, v2
    v_lshlrev_b32 v181, 4, v2
    v_lshlrev_b32 v183, 4, v2
    s_add_u32 s28, s18, s53
    s_addc_u32 s29, s19, 0
    s_mov_b32 s30, 8192
    s_mov_b32 s31, 0x20000
    s_mov_b32 s60, 0xbfb8aa3b
    s_mov_b32 s46, 0x2b800000
    s_mul_i32 s51, s48, 51200
    s_add_u32 s51, s51, s49
    v_and_b32 v2, 6, v162
    v_xor_b32 v2, v2, v161
    v_lshl_add_u32 v2, v2, 4, s54
    v_lshl_add_u32 v240, v162, 7, v2
    v_xor_b32 v241, 64, v240
    v_lshrrev_b32 v2, 2, v160
    v_and_b32 v3, 3, v160
    v_lshlrev_b32 v7, 3, v3
    v_and_b32 v6, 0x60, v250
    v_or_b32 v6, v6, v7
    v_lshl_add_u32 v242, v2, 7, v6
    v_add_u32 v242, s54, v242
    v_xor_b32 v243, 32, v242
    v_xor_b32 v244, 64, v242
    v_xor_b32 v245, 96, v242
    s_add_u32 s56, s57, 115712
    s_add_u32 s57, s57, 152064
    v_lshl_add_u32 v249, v161, 2, s57
    v_lshl_add_u32 v249, v162, 4, v249
    v_lshl_add_u32 v248, v2, 4, v7
    v_cmp_gt_u32 vcc, 2, v3
    v_add_u32 v248, s57, v248
    v_mov_b32 v152, 132608
    v_cndmask_b32 v248, v152, v248, vcc
    v_and_b32 v2, 3, v2
    v_lshl_add_u32 v6, v2, 7, v6
    v_lshl_add_u32 v136, v161, 10, v6
    v_add_u32 v136, 20480, v136
    v_xor_b32 v137, 32, v136
    v_xor_b32 v138, 64, v136
    v_xor_b32 v139, 96, v136
    v_add_u32 v151, 132096, v252
    s_and_b32 s52, s48, 4
    s_lshl_b32 s52, s52, 4
    v_xor_b32 v140, s52, v136
    v_xor_b32 v141, 32, v140
    s_mul_i32 s57, s48, 0x2010
    s_and_b32 s57, s57, 0x2060
    v_xor_b32 v144, s57, v136
    s_and_b32 s57, s48, 3
    s_mul_i32 s57, s57, 8448
    s_lshl1_add_u32 s57, s52, s57
    s_add_u32 s57, s57, 81920
    v_mul_u32_u24 v145, 528, v162
    v_add3_u32 v145, v145, v252, s57
    v_lshl_add_u32 v142, s52, 1, v151
    s_mul_i32 s57, s48, 4224
    s_add_u32 s57, s57, 81920
    v_and_b32 v3, 0x70, v251
    v_add3_u32 v143, v143, v3, s57
    v_add_u32 v3, v143, v3
    s_lshl_b32 s57, s48, 11
    v_add_u32 v1, s57, v251
    s_mov_b32 s66, 0x1b0a0100
    s_mov_b32 s67, 0x966d4c33
    s_lshl_b32 s57, s48, 3
    s_lshr_b64 s[66:67], s[66:67], s57
    s_and_b32 s47, s66, 7
    s_bfe_u32 s70, s66, 0x50003
    s_lshl1_add_u32 s70, s70, 16
    s_mul_i32 s71, s70, 400
    buffer_load_dwordx4 v120, s[36:39], s69 offen offset:2048 lds
    buffer_load_dwordx4 v121, s[36:39], s69 offen offset:3072 lds
    s_cmp_eq_u32 s48, 0
    s_waitcnt vmcnt(6) lgkmcnt(0)
    s_cbranch_scc1 P_M0
    s_waitcnt vmcnt(5)
P_M0:
    s_call_b64 s[36:37], CMP
    ds_read_u8 v236, v246 offset:0
    ds_read_u8 v238, v246 offset:8
    ds_read_u8 v180, v246 offset:16
    ds_read_u8 v182, v246 offset:24
    s_add_u32 m0, s54, 0
    v_add_u32 v246, 32, v246
    s_waitcnt lgkmcnt(3)
    buffer_load_dwordx4 v[236:237], s[20:23], s51 idxen offen nt lds
    s_add_u32 m0, s54, 1024
    s_waitcnt lgkmcnt(2)
    buffer_load_dwordx4 v[238:239], s[20:23], s51 idxen offen nt lds
    s_add_u32 m0, s54, 2048
    s_waitcnt lgkmcnt(1)
    buffer_load_dwordx4 v[180:181], s[20:23], s51 idxen offen nt lds
    s_add_u32 m0, s54, 3072
    s_waitcnt lgkmcnt(0)
    buffer_load_dwordx4 v[182:183], s[20:23], s51 idxen offen nt lds
    s_call_b64 s[36:37], CHK
    s_and_b32 s59, s57, 0xff
    s_lshr_b32 s57, s57, 8
    s_max_u32 s59, s59, 1
    s_add_u32 s59, s59, 15
    s_lshr_b32 s59, s59, 4
    s_mul_i32 s50, s59, 0x11000000
    s_or_b32 s50, s50, s57
    s_mul_i32 s59, s48, 0x202
    s_or_b32 s50, s50, s59
    s_and_b32 s59, s58, 0xff
    s_lshr_b32 s58, s58, 8
    s_max_u32 s59, s59, 1
    s_add_u32 s59, s59, 15
    s_lshr_b32 s59, s59, 4
    s_mul_i32 s68, s59, 0x11000000
    s_or_b32 s68, s68, s58
    s_mul_i32 s59, s48, 0x202
    s_or_b32 s68, s68, s59
    s_or_b32 s68, s68, 0x101
    s_mov_b32 s53, s50
    s_lshl_b32 s63, s63, 16
    s_cmp_lg_u32 s48, 0
    s_waitcnt vmcnt(8)
    s_cbranch_scc1 P_SW_J
    v_lshlrev_b32 v148, 16, v146
    v_and_b32 v149, 0xffff0000, v146
    v_mov_b32 v4, 133184
    v_mov_b32 v6, 0x20e00040
    v_add_u32 v7, v250, v152
    v_lshl_add_u32 v0, v250, 1, v152
    s_mov_b32 exec_hi, 0
    v_max3_f32 v2, abs(v148), abs(v149), abs(s63)
    v_ldexp_f32 v148, v148, 40
    v_ldexp_f32 v149, v149, 40
    v_cmp_le_f32 vcc, 0x33800000, v2
    s_mov_b64 exec, 255
    ds_write_b32 v7, v6 offset:800
    s_mov_b64 exec, -1
    s_movk_i32 s56, 0x3ff
    s_cmp_lg_u64 vcc, 0
    s_cmovk_i32 s56, 0x207
    v_subrev_u32 v0, 512, v0
    v_mov_b32 v2, s56
    ds_write_b64 v0, v[148:149]
    ds_write2_b32 v152, v4, v2 offset0:4 offset1:8
P_SW_J:
    ds_write_b128 v143, v[124:127] offset:256
    ds_write_b128 v143, v[124:127] offset:384
    v_lshlrev_b32 v196, 16, v124
    v_and_b32 v197, 0xffff0000, v124
    v_lshlrev_b32 v198, 16, v125
    v_and_b32 v199, 0xffff0000, v125
    v_lshlrev_b32 v200, 16, v126
    v_and_b32 v201, 0xffff0000, v126
    v_lshlrev_b32 v202, 16, v127
    v_and_b32 v203, 0xffff0000, v127
    v_mul_f32 v196, s60, v196
    v_mul_f32 v197, s60, v197
    v_mul_f32 v198, s60, v198
    v_mul_f32 v199, s60, v199
    v_mul_f32 v200, s60, v200
    v_mul_f32 v201, s60, v201
    v_mul_f32 v202, s60, v202
    v_mul_f32 v203, s60, v203
    ds_write_b128 v3, v[196:199] offset:0
    ds_write_b128 v3, v[200:203] offset:16
    v_ldexp_f32 v2, s63, 37
    v_add_u32 v250, 133632, v250
    v_readfirstlane_b32 s44, v2
    s_waitcnt vmcnt(4) lgkmcnt(2)
    s_barrier
    ds_read_b64_tr_b16 v[184:185], v144 offset:0
    ds_read_b64_tr_b16 v[186:187], v144 offset:512
    ds_read_b64_tr_b16 v[188:189], v144 offset:32768
    ds_read_b64_tr_b16 v[190:191], v144 offset:33280
    ds_read_b128 v[164:167], v145 offset:256
    ds_read_b128 v[168:171], v145 offset:320
    ds_read_b128 v[104:107], v142 offset:256
    ds_read_b128 v[108:111], v142 offset:320
    ds_read_b64_tr_b16 v[40:41], v140 offset:16384
    ds_read_b64_tr_b16 v[42:43], v140 offset:16896
    ds_read_b64_tr_b16 v[44:45], v141 offset:16384
    ds_read_b64_tr_b16 v[46:47], v141 offset:16896
    ds_read_b64_tr_b16 v[48:49], v140 offset:24576
    ds_read_b64_tr_b16 v[50:51], v140 offset:25088
    ds_read_b64_tr_b16 v[52:53], v141 offset:24576
    ds_read_b64_tr_b16 v[54:55], v141 offset:25088
    ds_read_b64_tr_b16 v[56:57], v140 offset:32768
    ds_read_b64_tr_b16 v[58:59], v140 offset:33280
    ds_read_b64_tr_b16 v[60:61], v141 offset:32768
    ds_read_b64_tr_b16 v[62:63], v141 offset:33280
    ds_read_b64_tr_b16 v[64:65], v140 offset:40960
    ds_read_b64_tr_b16 v[66:67], v140 offset:41472
    ds_read_b64_tr_b16 v[68:69], v141 offset:40960
    ds_read_b64_tr_b16 v[70:71], v141 offset:41472
    s_waitcnt lgkmcnt(15)
    v_lshlrev_b32 v8, 16, v184
    v_and_b32 v9, 0xffff0000, v184
    v_lshlrev_b32 v16, 16, v188
    v_and_b32 v17, 0xffff0000, v188
    v_lshlrev_b32 v10, 16, v185
    v_and_b32 v11, 0xffff0000, v185
    v_lshlrev_b32 v18, 16, v189
    v_and_b32 v19, 0xffff0000, v189
    v_lshlrev_b32 v12, 16, v186
    v_and_b32 v13, 0xffff0000, v186
    v_lshlrev_b32 v20, 16, v190
    v_and_b32 v21, 0xffff0000, v190
    v_lshlrev_b32 v14, 16, v187
    v_and_b32 v15, 0xffff0000, v187
    v_lshlrev_b32 v22, 16, v191
    v_and_b32 v23, 0xffff0000, v191
    v_xor_b32 v172, 0x80008000, v164
    v_xor_b32 v173, 0x80008000, v165
    v_xor_b32 v174, 0x80008000, v166
    v_xor_b32 v175, 0x80008000, v167
    v_xor_b32 v176, 0x80008000, v168
    v_xor_b32 v177, 0x80008000, v169
    v_xor_b32 v178, 0x80008000, v170
    v_xor_b32 v179, 0x80008000, v171
    s_waitcnt lgkmcnt(12)
    v_mfma_f32_16x16x32_bf16 v[104:107], v[40:43], v[164:167], v[104:107]
    v_mfma_f32_16x16x32_bf16 v[108:111], v[44:47], v[164:167], v[108:111]
    v_add_f32 v112, v8, v16
    v_add_f32 v113, v9, v17
    s_waitcnt lgkmcnt(8)
    v_mfma_f32_16x16x32_bf16 v[104:107], v[48:51], v[168:171], v[104:107]
    v_mfma_f32_16x16x32_bf16 v[108:111], v[52:55], v[168:171], v[108:111]
    v_add_f32 v114, v10, v18
    v_add_f32 v115, v11, v19
    s_waitcnt lgkmcnt(4)
    v_mfma_f32_16x16x32_bf16 v[104:107], v[56:59], v[172:175], v[104:107]
    v_mfma_f32_16x16x32_bf16 v[108:111], v[60:63], v[172:175], v[108:111]
    v_add_f32 v116, v12, v20
    v_add_f32 v117, v13, v21
    s_waitcnt lgkmcnt(0)
    v_mfma_f32_16x16x32_bf16 v[104:107], v[64:67], v[176:179], v[104:107]
    v_mfma_f32_16x16x32_bf16 v[108:111], v[68:71], v[176:179], v[108:111]
    v_add_f32 v118, v14, v22
    v_add_f32 v119, v15, v23
    ds_read_b64_tr_b16 v[72:73], v136 offset:49152
    ds_read_b64_tr_b16 v[74:75], v136 offset:49664
    ds_read_b64_tr_b16 v[76:77], v136 offset:57344
    ds_read_b64_tr_b16 v[78:79], v136 offset:57856
    ds_read_b64_tr_b16 v[80:81], v137 offset:49152
    ds_read_b64_tr_b16 v[82:83], v137 offset:49664
    ds_read_b64_tr_b16 v[84:85], v137 offset:57344
    ds_read_b64_tr_b16 v[86:87], v137 offset:57856
    ds_read_b64_tr_b16 v[88:89], v138 offset:49152
    ds_read_b64_tr_b16 v[90:91], v138 offset:49664
    ds_read_b64_tr_b16 v[92:93], v138 offset:57344
    ds_read_b64_tr_b16 v[94:95], v138 offset:57856
    ds_read_b64_tr_b16 v[96:97], v139 offset:49152
    ds_read_b64_tr_b16 v[98:99], v139 offset:49664
    ds_read_b64_tr_b16 v[100:101], v139 offset:57344
    ds_read_b64_tr_b16 v[102:103], v139 offset:57856
    v_mul_f32 v112, s60, v112
    v_mul_f32 v113, s60, v113
    v_mul_f32 v114, s60, v114
    v_mul_f32 v115, s60, v115
    v_mul_f32 v116, s60, v116
    v_mul_f32 v117, s60, v117
    v_mul_f32 v118, s60, v118
    v_mul_f32 v119, s60, v119
    ds_write_b128 v1, v[112:115] offset:0
    ds_write_b128 v1, v[116:119] offset:1024
    v_mul_f32 v104, s60, v104
    v_mul_f32 v105, s60, v105
    v_mul_f32 v106, s60, v106
    v_mul_f32 v107, s60, v107
    v_mul_f32 v108, s60, v108
    v_mul_f32 v109, s60, v109
    v_mul_f32 v110, s60, v110
    v_mul_f32 v111, s60, v111
    ds_write_b128 v145, v[104:107] offset:256
    ds_write_b128 v145, v[108:111] offset:320
    ds_read_b128 v[120:123], v151 offset:0
    ds_read_b128 v[124:127], v151 offset:64
    ds_read_b128 v[128:131], v151 offset:128
    ds_read_b128 v[132:135], v151 offset:192
    ds_read_b32 v3, v152 offset:32
    s_cmp_le_u32 s47, 0
    s_cbranch_scc1 P_MJ
    buffer_load_dwordx4 v[196:199], v163, s[24:27], s71 offen offset:0 nt
    s_cmp_le_u32 s47, 1
    s_cbranch_scc1 P_MJ
    buffer_load_dwordx4 v[200:203], v163, s[24:27], s71 offen offset:800 nt
    s_cmp_le_u32 s47, 2
    s_cbranch_scc1 P_MJ
    buffer_load_dwordx4 v[204:207], v163, s[24:27], s71 offen offset:1600 nt
    s_cmp_le_u32 s47, 3
    s_cbranch_scc1 P_MJ
    buffer_load_dwordx4 v[208:211], v163, s[24:27], s71 offen offset:2400 nt
    s_cmp_le_u32 s47, 4
    s_cbranch_scc1 P_MJ
    buffer_load_dwordx4 v[212:215], v163, s[24:27], s71 offen offset:3200 nt
    s_cmp_le_u32 s47, 5
    s_cbranch_scc1 P_MJ
    buffer_load_dwordx4 v[216:219], v163, s[24:27], s71 offen offset:4000 nt
P_MJ:
    v_mov_b64 v[166:167], 0
    v_mov_b64 v[170:171], 0
    v_mov_b64 v[174:175], 0
    v_mov_b64 v[178:179], 0
    s_waitcnt lgkmcnt(15)
    v_lshlrev_b32 v8, 16, v72
    v_and_b32 v9, 0xffff0000, v72
    v_lshlrev_b32 v10, 16, v73
    v_and_b32 v11, 0xffff0000, v73
    v_lshlrev_b32 v12, 16, v74
    v_and_b32 v13, 0xffff0000, v74
    v_lshlrev_b32 v14, 16, v75
    v_and_b32 v15, 0xffff0000, v75
    v_lshlrev_b32 v16, 16, v76
    v_and_b32 v17, 0xffff0000, v76
    v_lshlrev_b32 v18, 16, v77
    v_and_b32 v19, 0xffff0000, v77
    v_lshlrev_b32 v20, 16, v78
    v_and_b32 v21, 0xffff0000, v78
    v_lshlrev_b32 v22, 16, v79
    v_and_b32 v23, 0xffff0000, v79
    v_lshlrev_b32 v24, 16, v80
    v_and_b32 v25, 0xffff0000, v80
    v_lshlrev_b32 v26, 16, v81
    v_and_b32 v27, 0xffff0000, v81
    v_lshlrev_b32 v28, 16, v82
    v_and_b32 v29, 0xffff0000, v82
    v_lshlrev_b32 v30, 16, v83
    v_and_b32 v31, 0xffff0000, v83
    v_lshlrev_b32 v32, 16, v84
    v_and_b32 v33, 0xffff0000, v84
    v_lshlrev_b32 v34, 16, v85
    v_and_b32 v35, 0xffff0000, v85
    v_lshlrev_b32 v36, 16, v86
    v_and_b32 v37, 0xffff0000, v86
    v_lshlrev_b32 v38, 16, v87
    v_and_b32 v39, 0xffff0000, v87
    s_cmp_lt_u32 s50, 805306368
    s_waitcnt lgkmcnt(0)
    s_barrier
    v_readfirstlane_b32 s45, v3
    s_cbranch_scc1 ADV_P
    s_sub_u32 s50, s50, 536870912
RET_P:
    ds_read_u8 v236, v246 offset:0
    ds_read_u8 v238, v246 offset:8
    ds_read_u8 v180, v246 offset:16
    ds_read_u8 v182, v246 offset:24
    s_add_u32 m0, s54, 4096
    v_add_u32 v246, 32, v246
    s_waitcnt lgkmcnt(3)
    buffer_load_dwordx4 v[236:237], s[20:23], s51 idxen offen nt lds
    s_add_u32 m0, s54, 5120
    s_waitcnt lgkmcnt(2)
    buffer_load_dwordx4 v[238:239], s[20:23], s51 idxen offen nt lds
    s_add_u32 m0, s54, 6144
    s_waitcnt lgkmcnt(1)
    buffer_load_dwordx4 v[180:181], s[20:23], s51 idxen offen nt lds
    s_add_u32 m0, s54, 7168
    s_waitcnt lgkmcnt(0)
    buffer_load_dwordx4 v[182:183], s[20:23], s51 idxen offen nt lds
    s_mov_b32 s69, s50
    s_cmp_lg_u32 s47, 0
    s_cbranch_scc1 LATE
LATE_R:
    s_and_b32 s57, s53, 63
    s_mul_i32 s57, s57, 528
    s_add_u32 s57, s57, 81920
    v_lshl_add_u32 v6, v252, 1, s57
    v_add_u32 v7, s57, v252
    ds_read_b128 v[104:107], v6 offset:0
    ds_read_b128 v[108:111], v6 offset:16
    ds_read_b128 v[196:199], v251 offset:0
    ds_read_b128 v[200:203], v251 offset:1024
    ds_read_b128 v[112:115], v6 offset:128
    ds_read_b128 v[116:119], v6 offset:144
    ds_read_b128 v[204:207], v251 offset:2048
    ds_read_b128 v[208:211], v251 offset:3072
    ds_read_b128 v[212:215], v251 offset:4096
    ds_read_b128 v[216:219], v251 offset:5120
    ds_read_b128 v[220:223], v251 offset:12288
    ds_read_b128 v[224:227], v251 offset:13312
    ds_read_b128 v[228:231], v251 offset:14336
    ds_read_b128 v[232:235], v251 offset:15360
    v_lshlrev_b32 v40, 16, v88
    v_and_b32 v41, 0xffff0000, v88
    v_lshlrev_b32 v42, 16, v89
    v_and_b32 v43, 0xffff0000, v89
    v_lshlrev_b32 v44, 16, v90
    v_and_b32 v45, 0xffff0000, v90
    v_lshlrev_b32 v46, 16, v91
    v_and_b32 v47, 0xffff0000, v91
    v_lshlrev_b32 v48, 16, v92
    v_and_b32 v49, 0xffff0000, v92
    v_lshlrev_b32 v50, 16, v93
    v_and_b32 v51, 0xffff0000, v93
    v_lshlrev_b32 v52, 16, v94
    v_and_b32 v53, 0xffff0000, v94
    v_lshlrev_b32 v54, 16, v95
    v_and_b32 v55, 0xffff0000, v95
    v_lshlrev_b32 v56, 16, v96
    v_and_b32 v57, 0xffff0000, v96
    v_lshlrev_b32 v58, 16, v97
    v_and_b32 v59, 0xffff0000, v97
    v_lshlrev_b32 v60, 16, v98
    v_and_b32 v61, 0xffff0000, v98
    v_lshlrev_b32 v62, 16, v99
    v_and_b32 v63, 0xffff0000, v99
    v_lshlrev_b32 v64, 16, v100
    v_and_b32 v65, 0xffff0000, v100
    v_lshlrev_b32 v66, 16, v101
    v_and_b32 v67, 0xffff0000, v101
    v_lshlrev_b32 v68, 16, v102
    v_and_b32 v69, 0xffff0000, v102
    v_lshlrev_b32 v70, 16, v103
    v_and_b32 v71, 0xffff0000, v103
    s_waitcnt vmcnt(6)
    ds_read_b128 v[152:155], v240
    ds_read_b128 v[156:159], v241
    s_call_b64 s[34:35], BP_C
    s_cmp_lt_u32 s50, 805306368
    s_cbranch_scc1 ADV_Q
    s_sub_u32 s50, s50, 536870912
RET_Q:
    ds_read_u8 v236, v246 offset:0
    ds_read_u8 v238, v246 offset:8
U0_0:
    s_waitcnt lgkmcnt(2)
    v_mfma_f32_16x16x32_bf16 v[104:107], v[72:75], v[152:155], v[136:139]
    v_mfma_f32_16x16x32_bf16 v[104:107], v[76:79], v[156:159], v[104:107]
    s_mov_b32 s52, s53
    s_mov_b32 s53, s69
    v_mfma_f32_16x16x32_bf16 v[108:111], v[80:83], v[152:155], v[140:143]
    s_mov_b32 s69, s50
    s_cmp_lg_u32 s55, 0
    v_mfma_f32_16x16x32_bf16 v[108:111], v[84:87], v[156:159], v[108:111]
    s_nop 1
    v_exp_f32 v104, v104
    v_mfma_f32_16x16x32_bf16 v[112:115], v[88:91], v[152:155], v[144:147]
    v_exp_f32 v105, v105
    v_mfma_f32_16x16x32_bf16 v[112:115], v[92:95], v[156:159], v[112:115]
    v_exp_f32 v106, v106
    v_mfma_f32_16x16x32_bf16 v[116:119], v[96:99], v[152:155], v[148:151]
    v_exp_f32 v107, v107
    v_mfma_f32_16x16x32_bf16 v[116:119], v[100:103], v[156:159], v[116:119]
    s_waitcnt lgkmcnt(0)
    s_cbranch_scc1 PX_0
    v_exp_f32 v108, v108
    v_mfma_f32_16x16x32_bf16 v[180:183], v[160:163], v[164:167], v[180:183]
    v_exp_f32 v109, v109
    v_mfma_f32_16x16x32_bf16 v[184:187], v[160:163], v[168:171], v[184:187]
    v_exp_f32 v110, v110
    v_mfma_f32_16x16x32_bf16 v[188:191], v[160:163], v[172:175], v[188:191]
    v_exp_f32 v111, v111
    v_mfma_f32_16x16x32_bf16 v[192:195], v[160:163], v[176:179], v[192:195]
PR_0:
    ds_read_b64_tr_b16 v[164:165], v242 offset:0
    ds_read_b64_tr_b16 v[168:169], v243 offset:0
    ds_read_b64_tr_b16 v[172:173], v244 offset:0
    ds_read_b64_tr_b16 v[176:177], v245 offset:0
    v_exp_f32 v112, v112
    v_exp_f32 v113, v113
    v_exp_f32 v114, v114
    v_exp_f32 v115, v115
    v_exp_f32 v116, v116
    v_exp_f32 v117, v117
    v_exp_f32 v118, v118
    v_exp_f32 v119, v119
    s_add_u32 m0, s54, 0
    s_cmp_lt_u32 s52, 536870912
    s_waitcnt vmcnt(4)
    s_cbranch_scc1 HALF_0
    ds_read_b128 v[152:155], v240 offset:2048
    ds_read_b128 v[156:159], v241 offset:2048
    s_waitcnt lgkmcnt(2)
    buffer_load_dwordx4 v[236:237], s[20:23], s51 idxen offen nt lds
    s_add_u32 m0, s54, 1024
    s_nop 0
    buffer_load_dwordx4 v[238:239], s[20:23], s51 idxen offen nt lds
    ds_read_u8 v236, v246 offset:16
    ds_read_u8 v238, v246 offset:24
    v_add_u32 v246, 32, v246
CH_0:
    s_setprio 1
    v_pk_add_f32 v[2:3], v[104:105], 1.0 op_sel_hi:[1,0]
    v_pk_fma_f32 v[0:1], v[120:121], v[106:107], v[120:121]
    v_pk_fma_f32 v[0:1], v[122:123], v[2:3], v[0:1]
    v_pk_fma_f32 v[2:3], v[106:107], v[2:3], v[2:3]
    v_pk_fma_f32 v[0:1], v[108:109], v[0:1], v[0:1]
    v_pk_fma_f32 v[0:1], v[124:125], v[2:3], v[0:1]
    v_pk_fma_f32 v[2:3], v[108:109], v[2:3], v[2:3]
    v_pk_fma_f32 v[0:1], v[110:111], v[0:1], v[0:1]
    v_pk_fma_f32 v[0:1], v[126:127], v[2:3], v[0:1]
    v_pk_fma_f32 v[2:3], v[110:111], v[2:3], v[2:3]
    v_pk_fma_f32 v[0:1], v[112:113], v[0:1], v[0:1]
    v_pk_fma_f32 v[0:1], v[128:129], v[2:3], v[0:1]
    v_pk_fma_f32 v[2:3], v[112:113], v[2:3], v[2:3]
    v_pk_fma_f32 v[0:1], v[114:115], v[0:1], v[0:1]
    v_pk_fma_f32 v[0:1], v[130:131], v[2:3], v[0:1]
    v_pk_fma_f32 v[2:3], v[114:115], v[2:3], v[2:3]
    v_pk_fma_f32 v[0:1], v[116:117], v[0:1], v[0:1]
    v_pk_fma_f32 v[0:1], v[132:133], v[2:3], v[0:1]
    v_pk_fma_f32 v[2:3], v[116:117], v[2:3], v[2:3]
    v_pk_fma_f32 v[0:1], v[118:119], v[0:1], v[0:1]
    v_pk_fma_f32 v[0:1], v[134:135], v[2:3], v[0:1]
    v_pk_fma_f32 v[2:3], v[118:119], v[2:3], v[2:3]
    v_rcp_f32 v2, v2
    v_rcp_f32 v3, v3
    s_cmp_lt_u32 s52, 536870912
    v_pk_fma_f32 v[0:1], v[0:1], v[2:3], s[44:45] op_sel_hi:[1,1,0]
    v_cvt_pk_bf16_f32 v0, v0, v1
    s_setprio 0
    ds_write_b32 v249, v0 offset:0
    ds_read_b64_tr_b16 v[160:161], v248 offset:0
    s_cbranch_scc1 HEND_0
    s_waitcnt lgkmcnt(2)
    v_mfma_f32_16x16x32_bf16 v[104:107], v[72:75], v[152:155], v[136:139]
    v_mfma_f32_16x16x32_bf16 v[104:107], v[76:79], v[156:159], v[104:107]
    ds_read_b64_tr_b16 v[166:167], v242 offset:2048
    ds_read_b64_tr_b16 v[170:171], v243 offset:2048
    v_mfma_f32_16x16x32_bf16 v[108:111], v[80:83], v[152:155], v[140:143]
    ds_read_b64_tr_b16 v[174:175], v244 offset:2048
    ds_read_b64_tr_b16 v[178:179], v245 offset:2048
    v_mfma_f32_16x16x32_bf16 v[108:111], v[84:87], v[156:159], v[108:111]
    s_nop 1
    v_exp_f32 v104, v104
    v_mfma_f32_16x16x32_bf16 v[112:115], v[88:91], v[152:155], v[144:147]
    v_exp_f32 v105, v105
    v_mfma_f32_16x16x32_bf16 v[112:115], v[92:95], v[156:159], v[112:115]
    v_exp_f32 v106, v106
    v_mfma_f32_16x16x32_bf16 v[116:119], v[96:99], v[152:155], v[148:151]
    v_exp_f32 v107, v107
    v_mfma_f32_16x16x32_bf16 v[116:119], v[100:103], v[156:159], v[116:119]
    v_exp_f32 v108, v108
    v_exp_f32 v109, v109
    v_exp_f32 v110, v110
    v_exp_f32 v111, v111
    v_exp_f32 v112, v112
    v_exp_f32 v113, v113
    v_exp_f32 v114, v114
    v_exp_f32 v115, v115
    v_exp_f32 v116, v116
    v_exp_f32 v117, v117
    v_exp_f32 v118, v118
    v_exp_f32 v119, v119
    s_add_u32 m0, s54, 2048
    s_waitcnt vmcnt(4)
    ds_read_b128 v[152:155], v240 offset:4096
    ds_read_b128 v[156:159], v241 offset:4096
    s_waitcnt lgkmcnt(2)
    buffer_load_dwordx4 v[236:237], s[20:23], s51 idxen offen nt lds
    s_add_u32 m0, s54, 3072
    s_nop 0
    buffer_load_dwordx4 v[238:239], s[20:23], s51 idxen offen nt lds
    s_cmp_lt_u32 s50, 805306368
    s_cbranch_scc1 ADV_0
    s_sub_u32 s50, s50, 536870912
RET_0:
    ds_read_u8 v236, v246 offset:0
    ds_read_u8 v238, v246 offset:8
    s_setprio 1
    v_pk_add_f32 v[2:3], v[104:105], 1.0 op_sel_hi:[1,0]
    v_pk_fma_f32 v[0:1], v[120:121], v[106:107], v[120:121]
    v_pk_fma_f32 v[0:1], v[122:123], v[2:3], v[0:1]
    v_pk_fma_f32 v[2:3], v[106:107], v[2:3], v[2:3]
    v_pk_fma_f32 v[0:1], v[108:109], v[0:1], v[0:1]
    v_pk_fma_f32 v[0:1], v[124:125], v[2:3], v[0:1]
    v_pk_fma_f32 v[2:3], v[108:109], v[2:3], v[2:3]
    v_pk_fma_f32 v[0:1], v[110:111], v[0:1], v[0:1]
    v_pk_fma_f32 v[0:1], v[126:127], v[2:3], v[0:1]
    v_pk_fma_f32 v[2:3], v[110:111], v[2:3], v[2:3]
    v_pk_fma_f32 v[0:1], v[112:113], v[0:1], v[0:1]
    v_pk_fma_f32 v[0:1], v[128:129], v[2:3], v[0:1]
    v_pk_fma_f32 v[2:3], v[112:113], v[2:3], v[2:3]
    v_pk_fma_f32 v[0:1], v[114:115], v[0:1], v[0:1]
    v_pk_fma_f32 v[0:1], v[130:131], v[2:3], v[0:1]
    v_pk_fma_f32 v[2:3], v[114:115], v[2:3], v[2:3]
    v_pk_fma_f32 v[0:1], v[116:117], v[0:1], v[0:1]
    v_pk_fma_f32 v[0:1], v[132:133], v[2:3], v[0:1]
    v_pk_fma_f32 v[2:3], v[116:117], v[2:3], v[2:3]
    v_pk_fma_f32 v[0:1], v[118:119], v[0:1], v[0:1]
    v_pk_fma_f32 v[0:1], v[134:135], v[2:3], v[0:1]
    v_pk_fma_f32 v[2:3], v[118:119], v[2:3], v[2:3]
    v_rcp_f32 v2, v2
    v_rcp_f32 v3, v3
    s_cmp_lt_u32 s52, 805306368
    v_pk_fma_f32 v[0:1], v[0:1], v[2:3], s[44:45] op_sel_hi:[1,1,0]
    v_cvt_pk_bf16_f32 v0, v0, v1
    s_setprio 0
    ds_write_b32 v249, v0 offset:256
    ds_read_b64_tr_b16 v[162:163], v248 offset:256
    s_cbranch_scc1 LAST_0
U0_1:
    s_waitcnt lgkmcnt(2)
    v_mfma_f32_16x16x32_bf16 v[104:107], v[72:75], v[152:155], v[136:139]
    v_mfma_f32_16x16x32_bf16 v[104:107], v[76:79], v[156:159], v[104:107]
    s_mov_b32 s52, s53
    s_mov_b32 s53, s69
    v_mfma_f32_16x16x32_bf16 v[108:111], v[80:83], v[152:155], v[140:143]
    s_mov_b32 s69, s50
    s_cmp_lg_u32 s55, 0
    v_mfma_f32_16x16x32_bf16 v[108:111], v[84:87], v[156:159], v[108:111]
    s_nop 1
    v_exp_f32 v104, v104
    v_mfma_f32_16x16x32_bf16 v[112:115], v[88:91], v[152:155], v[144:147]
    v_exp_f32 v105, v105
    v_mfma_f32_16x16x32_bf16 v[112:115], v[92:95], v[156:159], v[112:115]
    v_exp_f32 v106, v106
    v_mfma_f32_16x16x32_bf16 v[116:119], v[96:99], v[152:155], v[148:151]
    v_exp_f32 v107, v107
    v_mfma_f32_16x16x32_bf16 v[116:119], v[100:103], v[156:159], v[116:119]
    s_waitcnt lgkmcnt(0)
    s_cbranch_scc1 PX_1
    v_exp_f32 v108, v108
    v_mfma_f32_16x16x32_bf16 v[180:183], v[160:163], v[164:167], v[180:183]
    v_exp_f32 v109, v109
    v_mfma_f32_16x16x32_bf16 v[184:187], v[160:163], v[168:171], v[184:187]
    v_exp_f32 v110, v110
    v_mfma_f32_16x16x32_bf16 v[188:191], v[160:163], v[172:175], v[188:191]
    v_exp_f32 v111, v111
    v_mfma_f32_16x16x32_bf16 v[192:195], v[160:163], v[176:179], v[192:195]
PR_1:
    ds_read_b64_tr_b16 v[164:165], v242 offset:4096
    ds_read_b64_tr_b16 v[168:169], v243 offset:4096
    ds_read_b64_tr_b16 v[172:173], v244 offset:4096
    ds_read_b64_tr_b16 v[176:177], v245 offset:4096
    v_exp_f32 v112, v112
    v_exp_f32 v113, v113
    v_exp_f32 v114, v114
    v_exp_f32 v115, v115
    v_exp_f32 v116, v116
    v_exp_f32 v117, v117
    v_exp_f32 v118, v118
    v_exp_f32 v119, v119
    s_add_u32 m0, s54, 4096
    s_cmp_lt_u32 s52, 536870912
    s_waitcnt vmcnt(4)
    s_cbranch_scc1 HALF_1
    ds_read_b128 v[152:155], v240 offset:6144
    ds_read_b128 v[156:159], v241 offset:6144
    s_waitcnt lgkmcnt(2)
    buffer_load_dwordx4 v[236:237], s[20:23], s51 idxen offen nt lds
    s_add_u32 m0, s54, 5120
    s_nop 0
    buffer_load_dwordx4 v[238:239], s[20:23], s51 idxen offen nt lds
    ds_read_u8 v236, v246 offset:16
    ds_read_u8 v238, v246 offset:24
    v_add_u32 v246, 32, v246
CH_1:
    s_setprio 1
    v_pk_add_f32 v[2:3], v[104:105], 1.0 op_sel_hi:[1,0]
    v_pk_fma_f32 v[0:1], v[120:121], v[106:107], v[120:121]
    v_pk_fma_f32 v[0:1], v[122:123], v[2:3], v[0:1]
    v_pk_fma_f32 v[2:3], v[106:107], v[2:3], v[2:3]
    v_pk_fma_f32 v[0:1], v[108:109], v[0:1], v[0:1]
    v_pk_fma_f32 v[0:1], v[124:125], v[2:3], v[0:1]
    v_pk_fma_f32 v[2:3], v[108:109], v[2:3], v[2:3]
    v_pk_fma_f32 v[0:1], v[110:111], v[0:1], v[0:1]
    v_pk_fma_f32 v[0:1], v[126:127], v[2:3], v[0:1]
    v_pk_fma_f32 v[2:3], v[110:111], v[2:3], v[2:3]
    v_pk_fma_f32 v[0:1], v[112:113], v[0:1], v[0:1]
    v_pk_fma_f32 v[0:1], v[128:129], v[2:3], v[0:1]
    v_pk_fma_f32 v[2:3], v[112:113], v[2:3], v[2:3]
    v_pk_fma_f32 v[0:1], v[114:115], v[0:1], v[0:1]
    v_pk_fma_f32 v[0:1], v[130:131], v[2:3], v[0:1]
    v_pk_fma_f32 v[2:3], v[114:115], v[2:3], v[2:3]
    v_pk_fma_f32 v[0:1], v[116:117], v[0:1], v[0:1]
    v_pk_fma_f32 v[0:1], v[132:133], v[2:3], v[0:1]
    v_pk_fma_f32 v[2:3], v[116:117], v[2:3], v[2:3]
    v_pk_fma_f32 v[0:1], v[118:119], v[0:1], v[0:1]
    v_pk_fma_f32 v[0:1], v[134:135], v[2:3], v[0:1]
    v_pk_fma_f32 v[2:3], v[118:119], v[2:3], v[2:3]
    v_rcp_f32 v2, v2
    v_rcp_f32 v3, v3
    s_cmp_lt_u32 s52, 536870912
    v_pk_fma_f32 v[0:1], v[0:1], v[2:3], s[44:45] op_sel_hi:[1,1,0]
    v_cvt_pk_bf16_f32 v0, v0, v1
    s_setprio 0
    ds_write_b32 v249, v0 offset:0
    ds_read_b64_tr_b16 v[160:161], v248 offset:0
    s_cbranch_scc1 HEND_1
    s_waitcnt lgkmcnt(2)
    v_mfma_f32_16x16x32_bf16 v[104:107], v[72:75], v[152:155], v[136:139]
    v_mfma_f32_16x16x32_bf16 v[104:107], v[76:79], v[156:159], v[104:107]
    ds_read_b64_tr_b16 v[166:167], v242 offset:6144
    ds_read_b64_tr_b16 v[170:171], v243 offset:6144
    v_mfma_f32_16x16x32_bf16 v[108:111], v[80:83], v[152:155], v[140:143]
    ds_read_b64_tr_b16 v[174:175], v244 offset:6144
    ds_read_b64_tr_b16 v[178:179], v245 offset:6144
    v_mfma_f32_16x16x32_bf16 v[108:111], v[84:87], v[156:159], v[108:111]
    s_nop 1
    v_exp_f32 v104, v104
    v_mfma_f32_16x16x32_bf16 v[112:115], v[88:91], v[152:155], v[144:147]
    v_exp_f32 v105, v105
    v_mfma_f32_16x16x32_bf16 v[112:115], v[92:95], v[156:159], v[112:115]
    v_exp_f32 v106, v106
    v_mfma_f32_16x16x32_bf16 v[116:119], v[96:99], v[152:155], v[148:151]
    v_exp_f32 v107, v107
    v_mfma_f32_16x16x32_bf16 v[116:119], v[100:103], v[156:159], v[116:119]
    v_exp_f32 v108, v108
    v_exp_f32 v109, v109
    v_exp_f32 v110, v110
    v_exp_f32 v111, v111
    v_exp_f32 v112, v112
    v_exp_f32 v113, v113
    v_exp_f32 v114, v114
    v_exp_f32 v115, v115
    v_exp_f32 v116, v116
    v_exp_f32 v117, v117
    v_exp_f32 v118, v118
    v_exp_f32 v119, v119
    s_add_u32 m0, s54, 6144
    s_waitcnt vmcnt(4)
    ds_read_b128 v[152:155], v240 offset:0
    ds_read_b128 v[156:159], v241 offset:0
    s_waitcnt lgkmcnt(2)
    buffer_load_dwordx4 v[236:237], s[20:23], s51 idxen offen nt lds
    s_add_u32 m0, s54, 7168
    s_nop 0
    buffer_load_dwordx4 v[238:239], s[20:23], s51 idxen offen nt lds
    s_cmp_lt_u32 s50, 805306368
    s_cbranch_scc1 ADV_1
    s_sub_u32 s50, s50, 536870912
RET_1:
    ds_read_u8 v236, v246 offset:0
    ds_read_u8 v238, v246 offset:8
    s_setprio 1
    v_pk_add_f32 v[2:3], v[104:105], 1.0 op_sel_hi:[1,0]
    v_pk_fma_f32 v[0:1], v[120:121], v[106:107], v[120:121]
    v_pk_fma_f32 v[0:1], v[122:123], v[2:3], v[0:1]
    v_pk_fma_f32 v[2:3], v[106:107], v[2:3], v[2:3]
    v_pk_fma_f32 v[0:1], v[108:109], v[0:1], v[0:1]
    v_pk_fma_f32 v[0:1], v[124:125], v[2:3], v[0:1]
    v_pk_fma_f32 v[2:3], v[108:109], v[2:3], v[2:3]
    v_pk_fma_f32 v[0:1], v[110:111], v[0:1], v[0:1]
    v_pk_fma_f32 v[0:1], v[126:127], v[2:3], v[0:1]
    v_pk_fma_f32 v[2:3], v[110:111], v[2:3], v[2:3]
    v_pk_fma_f32 v[0:1], v[112:113], v[0:1], v[0:1]
    v_pk_fma_f32 v[0:1], v[128:129], v[2:3], v[0:1]
    v_pk_fma_f32 v[2:3], v[112:113], v[2:3], v[2:3]
    v_pk_fma_f32 v[0:1], v[114:115], v[0:1], v[0:1]
    v_pk_fma_f32 v[0:1], v[130:131], v[2:3], v[0:1]
    v_pk_fma_f32 v[2:3], v[114:115], v[2:3], v[2:3]
    v_pk_fma_f32 v[0:1], v[116:117], v[0:1], v[0:1]
    v_pk_fma_f32 v[0:1], v[132:133], v[2:3], v[0:1]
    v_pk_fma_f32 v[2:3], v[116:117], v[2:3], v[2:3]
    v_pk_fma_f32 v[0:1], v[118:119], v[0:1], v[0:1]
    v_pk_fma_f32 v[0:1], v[134:135], v[2:3], v[0:1]
    v_pk_fma_f32 v[2:3], v[118:119], v[2:3], v[2:3]
    v_rcp_f32 v2, v2
    v_rcp_f32 v3, v3
    s_cmp_lt_u32 s52, 805306368
    v_pk_fma_f32 v[0:1], v[0:1], v[2:3], s[44:45] op_sel_hi:[1,1,0]
    v_cvt_pk_bf16_f32 v0, v0, v1
    s_setprio 0
    ds_write_b32 v249, v0 offset:256
    ds_read_b64_tr_b16 v[162:163], v248 offset:256
    s_cbranch_scc0 U0_0
LAST_1:
    s_call_b64 s[34:35], IEND
    s_branch U0_0
HEND_0:
    v_mov_b64 v[162:163], 0
LAST_0:
    s_call_b64 s[34:35], IEND
    s_branch U0_1
HEND_1:
    v_mov_b64 v[162:163], 0
    s_branch LAST_1
PX_0:
    s_sub_u32 s55, s55, 1
    s_cmp_lg_u32 s55, 0
    s_cbranch_scc1 PS_0
    v_exp_f32 v108, v108
    v_mfma_f32_16x16x32_bf16 v[180:183], v[160:163], v[164:167], 0
    v_exp_f32 v109, v109
    v_mfma_f32_16x16x32_bf16 v[184:187], v[160:163], v[168:171], 0
    v_exp_f32 v110, v110
    v_mfma_f32_16x16x32_bf16 v[188:191], v[160:163], v[172:175], 0
    v_exp_f32 v111, v111
    v_mfma_f32_16x16x32_bf16 v[192:195], v[160:163], v[176:179], 0
    s_branch PR_0
PS_0:
    v_exp_f32 v108, v108
    v_exp_f32 v109, v109
    v_exp_f32 v110, v110
    v_exp_f32 v111, v111
    s_branch PR_0
HALF_0:
    s_waitcnt lgkmcnt(0)
    buffer_load_dwordx4 v[236:237], s[20:23], s51 idxen offen nt lds
    s_add_u32 m0, s54, 1024
    s_nop 0
    buffer_load_dwordx4 v[238:239], s[20:23], s51 idxen offen nt lds
    ds_read_u8 v236, v246 offset:16
    ds_read_u8 v238, v246 offset:24
    v_add_u32 v246, 32, v246
    s_add_u32 m0, s54, 2048
    s_waitcnt vmcnt(4)
    ds_read_b128 v[152:155], v240 offset:4096
    ds_read_b128 v[156:159], v241 offset:4096
    s_waitcnt lgkmcnt(2)
    buffer_load_dwordx4 v[236:237], s[20:23], s51 idxen offen nt lds
    s_add_u32 m0, s54, 3072
    s_nop 0
    buffer_load_dwordx4 v[238:239], s[20:23], s51 idxen offen nt lds
    s_cmp_lt_u32 s50, 805306368
    s_cbranch_scc1 ADV_H0
    s_sub_u32 s50, s50, 536870912
RET_H0:
    ds_read_u8 v236, v246 offset:0
    ds_read_u8 v238, v246 offset:8
    s_branch CH_0
PX_1:
    s_sub_u32 s55, s55, 1
    s_cmp_lg_u32 s55, 0
    s_cbranch_scc1 PS_1
    v_exp_f32 v108, v108
    v_mfma_f32_16x16x32_bf16 v[180:183], v[160:163], v[164:167], 0
    v_exp_f32 v109, v109
    v_mfma_f32_16x16x32_bf16 v[184:187], v[160:163], v[168:171], 0
    v_exp_f32 v110, v110
    v_mfma_f32_16x16x32_bf16 v[188:191], v[160:163], v[172:175], 0
    v_exp_f32 v111, v111
    v_mfma_f32_16x16x32_bf16 v[192:195], v[160:163], v[176:179], 0
    s_branch PR_1
PS_1:
    v_exp_f32 v108, v108
    v_exp_f32 v109, v109
    v_exp_f32 v110, v110
    v_exp_f32 v111, v111
    s_branch PR_1
HALF_1:
    s_waitcnt lgkmcnt(0)
    buffer_load_dwordx4 v[236:237], s[20:23], s51 idxen offen nt lds
    s_add_u32 m0, s54, 5120
    s_nop 0
    buffer_load_dwordx4 v[238:239], s[20:23], s51 idxen offen nt lds
    ds_read_u8 v236, v246 offset:16
    ds_read_u8 v238, v246 offset:24
    v_add_u32 v246, 32, v246
    s_add_u32 m0, s54, 6144
    s_waitcnt vmcnt(4)
    ds_read_b128 v[152:155], v240 offset:0
    ds_read_b128 v[156:159], v241 offset:0
    s_waitcnt lgkmcnt(2)
    buffer_load_dwordx4 v[236:237], s[20:23], s51 idxen offen nt lds
    s_add_u32 m0, s54, 7168
    s_nop 0
    buffer_load_dwordx4 v[238:239], s[20:23], s51 idxen offen nt lds
    s_cmp_lt_u32 s50, 805306368
    s_cbranch_scc1 ADV_H1
    s_sub_u32 s50, s50, 536870912
RET_H1:
    ds_read_u8 v236, v246 offset:0
    ds_read_u8 v238, v246 offset:8
    s_branch CH_1
ADV_0:
    s_call_b64 s[32:33], PROD
    s_branch RET_0
ADV_1:
    s_call_b64 s[32:33], PROD
    s_branch RET_1
ADV_H0:
    s_call_b64 s[32:33], PROD
    s_branch RET_H0
ADV_H1:
    s_call_b64 s[32:33], PROD
    s_branch RET_H1
ADV_P:
    s_call_b64 s[32:33], PROD
    s_branch RET_P
ADV_Q:
    s_call_b64 s[32:33], PROD
    s_branch RET_Q
IZ:
    v_mfma_f32_16x16x32_bf16 v[180:183], v[160:163], v[164:167], 0
    v_mfma_f32_16x16x32_bf16 v[184:187], v[160:163], v[168:171], 0
    v_mfma_f32_16x16x32_bf16 v[188:191], v[160:163], v[172:175], 0
    v_mfma_f32_16x16x32_bf16 v[192:195], v[160:163], v[176:179], 0
    s_branch IP
IEND:
    s_and_b32 s57, s53, 63
    s_mul_i32 s57, s57, 528
    s_add_u32 s57, s57, 81920
    v_lshl_add_u32 v6, v252, 1, s57
    v_add_u32 v7, s57, v252
    ds_read_b128 v[104:107], v6 offset:0
    ds_read_b128 v[108:111], v6 offset:16
    ds_read_b128 v[196:199], v251 offset:0
    ds_read_b128 v[200:203], v251 offset:1024
    ds_read_b128 v[112:115], v6 offset:128
    ds_read_b128 v[116:119], v6 offset:144
    ds_read_b128 v[204:207], v251 offset:2048
    ds_read_b128 v[208:211], v251 offset:3072
    ds_read_b128 v[212:215], v251 offset:4096
    ds_read_b128 v[216:219], v251 offset:5120
    s_cmp_lg_u32 s55, 0
    s_waitcnt lgkmcnt(10)
    s_cbranch_scc1 IZ
    v_mfma_f32_16x16x32_bf16 v[180:183], v[160:163], v[164:167], v[180:183]
    v_mfma_f32_16x16x32_bf16 v[184:187], v[160:163], v[168:171], v[184:187]
    v_mfma_f32_16x16x32_bf16 v[188:191], v[160:163], v[172:175], v[188:191]
    v_mfma_f32_16x16x32_bf16 v[192:195], v[160:163], v[176:179], v[192:195]
IP:
    s_and_b32 s56, s52, 0x7f00
    s_mov_b32 exec_hi, 0
    s_nop 2
    v_pk_add_f32 v[180:181], v[180:181], v[182:183]
    v_pk_add_f32 v[184:185], v[184:185], v[186:187]
    v_pk_add_f32 v[188:189], v[188:189], v[190:191]
    v_pk_add_f32 v[192:193], v[192:193], v[194:195]
    v_add_f32 v0, v180, v181
    v_add_f32 v2, v184, v185
    v_add_f32 v1, v188, v189
    v_add_f32 v3, v192, v193
    v_add_u32 v5, s56, v250
    v_permlane16_swap_b32 v0, v2
    v_permlane16_swap_b32 v1, v3
    v_pk_add_f32 v[0:1], v[0:1], v[2:3]
    v_pk_mul_f32 v[0:1], v[0:1], s[46:47] op_sel_hi:[1,0]
    v_add_f32 v4, v0, v1
    v_cmp_class_f32_e64 vcc, v4, s45
    s_bitcmp1_b32 s52, 7
    s_cbranch_scc1 SLOW
    s_cbranch_vccnz SLOW
    ds_write2_b32 v5, v0, v1 offset0:0 offset1:32
    s_mov_b32 exec_hi, -1
    s_bitcmp1_b32 s53, 6
    s_cbranch_scc1 L_DONE
BP_C:
    s_setprio 1
    s_waitcnt lgkmcnt(6)
    v_pk_fma_f32 v[196:197], v[8:9], v[104:105], v[196:197]
    v_pk_fma_f32 v[198:199], v[10:11], v[106:107], v[198:199]
    v_pk_fma_f32 v[200:201], v[12:13], v[108:109], v[200:201]
    v_pk_fma_f32 v[202:203], v[14:15], v[110:111], v[202:203]
    v_cvt_pk_bf16_f32 v72, v196, v197
    v_cvt_pk_bf16_f32 v73, v198, v199
    v_cvt_pk_bf16_f32 v74, v200, v201
    v_cvt_pk_bf16_f32 v75, v202, v203
    ds_read_b128 v[196:199], v251 offset:6144
    ds_read_b128 v[200:203], v251 offset:7168
    s_waitcnt lgkmcnt(4)
    v_pk_fma_f32 v[204:205], v[16:17], v[112:113], v[204:205]
    v_pk_fma_f32 v[206:207], v[18:19], v[114:115], v[206:207]
    v_pk_fma_f32 v[208:209], v[20:21], v[116:117], v[208:209]
    v_pk_fma_f32 v[210:211], v[22:23], v[118:119], v[210:211]
    v_cvt_pk_bf16_f32 v76, v204, v205
    v_cvt_pk_bf16_f32 v77, v206, v207
    v_cvt_pk_bf16_f32 v78, v208, v209
    v_cvt_pk_bf16_f32 v79, v210, v211
    ds_read_b128 v[204:207], v251 offset:8192
    ds_read_b128 v[208:211], v251 offset:9216
    s_waitcnt lgkmcnt(4)
    v_pk_fma_f32 v[212:213], v[24:25], v[104:105], v[212:213]
    v_pk_fma_f32 v[214:215], v[26:27], v[106:107], v[214:215]
    v_pk_fma_f32 v[216:217], v[28:29], v[108:109], v[216:217]
    v_pk_fma_f32 v[218:219], v[30:31], v[110:111], v[218:219]
    v_cvt_pk_bf16_f32 v80, v212, v213
    v_cvt_pk_bf16_f32 v81, v214, v215
    v_cvt_pk_bf16_f32 v82, v216, v217
    v_cvt_pk_bf16_f32 v83, v218, v219
    ds_read_b128 v[212:215], v251 offset:10240
    ds_read_b128 v[216:219], v251 offset:11264
    s_waitcnt lgkmcnt(4)
    v_pk_fma_f32 v[196:197], v[32:33], v[112:113], v[196:197]
    v_pk_fma_f32 v[198:199], v[34:35], v[114:115], v[198:199]
    v_pk_fma_f32 v[200:201], v[36:37], v[116:117], v[200:201]
    v_pk_fma_f32 v[202:203], v[38:39], v[118:119], v[202:203]
    v_cvt_pk_bf16_f32 v84, v196, v197
    v_cvt_pk_bf16_f32 v85, v198, v199
    v_cvt_pk_bf16_f32 v86, v200, v201
    v_cvt_pk_bf16_f32 v87, v202, v203
    ds_read_b128 v[136:139], v7 offset:256
    ds_read_b128 v[140:143], v7 offset:320
    ds_read_b128 v[144:147], v7 offset:384
    ds_read_b128 v[148:151], v7 offset:448
    s_waitcnt lgkmcnt(6)
    v_pk_fma_f32 v[204:205], v[40:41], v[104:105], v[204:205]
    v_pk_fma_f32 v[206:207], v[42:43], v[106:107], v[206:207]
    v_pk_fma_f32 v[208:209], v[44:45], v[108:109], v[208:209]
    v_pk_fma_f32 v[210:211], v[46:47], v[110:111], v[210:211]
    v_cvt_pk_bf16_f32 v88, v204, v205
    v_cvt_pk_bf16_f32 v89, v206, v207
    v_cvt_pk_bf16_f32 v90, v208, v209
    v_cvt_pk_bf16_f32 v91, v210, v211
    s_waitcnt lgkmcnt(4)
    v_pk_fma_f32 v[212:213], v[48:49], v[112:113], v[212:213]
    v_pk_fma_f32 v[214:215], v[50:51], v[114:115], v[214:215]
    v_pk_fma_f32 v[216:217], v[52:53], v[116:117], v[216:217]
    v_pk_fma_f32 v[218:219], v[54:55], v[118:119], v[218:219]
    v_cvt_pk_bf16_f32 v92, v212, v213
    v_cvt_pk_bf16_f32 v93, v214, v215
    v_cvt_pk_bf16_f32 v94, v216, v217
    v_cvt_pk_bf16_f32 v95, v218, v219
    v_pk_fma_f32 v[196:197], v[56:57], v[104:105], v[220:221]
    v_pk_fma_f32 v[198:199], v[58:59], v[106:107], v[222:223]
    v_pk_fma_f32 v[200:201], v[60:61], v[108:109], v[224:225]
    v_pk_fma_f32 v[202:203], v[62:63], v[110:111], v[226:227]
    v_cvt_pk_bf16_f32 v96, v196, v197
    v_cvt_pk_bf16_f32 v97, v198, v199
    v_cvt_pk_bf16_f32 v98, v200, v201
    v_cvt_pk_bf16_f32 v99, v202, v203
    v_pk_fma_f32 v[204:205], v[64:65], v[112:113], v[228:229]
    v_pk_fma_f32 v[206:207], v[66:67], v[114:115], v[230:231]
    v_pk_fma_f32 v[208:209], v[68:69], v[116:117], v[232:233]
    v_pk_fma_f32 v[210:211], v[70:71], v[118:119], v[234:235]
    v_cvt_pk_bf16_f32 v100, v204, v205
    v_cvt_pk_bf16_f32 v101, v206, v207
    v_cvt_pk_bf16_f32 v102, v208, v209
    v_cvt_pk_bf16_f32 v103, v210, v211
    s_setprio 0
    s_mov_b32 s55, 2
    s_waitcnt lgkmcnt(0)
    s_setpc_b64 s[34:35]
PROD:
    s_cmp_lg_u32 s68, 0
    s_cbranch_scc1 PSEC
    s_bitcmp1_b32 s50, 6
    s_cbranch_scc1 PSET
    v_mov_b32 v6, 132624
    s_mov_b64 exec, 1
PDRAW:
    v_mov_b32 v7, 4
    ds_add_rtn_u32 v7, v6, v7
    s_waitcnt lgkmcnt(0)
PREAD:
    ds_read_b32 v5, v7
    s_waitcnt lgkmcnt(0)
    v_readfirstlane_b32 s50, v5
    s_cmp_lt_u32 s50, 268435456
    s_cbranch_scc1 PODD
    s_mov_b64 exec, -1
PSET:
    s_and_b32 s56, s50, 63
    s_bfe_u32 s57, s50, 0x40014
    s_lshl4_add_u32 s57, s56, s57
    s_mul_i32 s51, s56, 25600
    v_lshl_add_u32 v246, s57, 4, v247
    s_add_u32 s51, s51, s49
    s_setpc_b64 s[32:33]
L_DONE:
    s_lshl_b32 s56, s48, 11
    s_add_u32 s56, s56, 133632
    v_lshl_add_u32 v0, v251, 1, s56
    s_lshl_b32 s56, s48, 10
    s_cmp_lt_u32 s48, 7
    s_waitcnt lgkmcnt(0)
    s_barrier
    ds_read_b128 v[104:107], v0 offset:0
    ds_read_b128 v[108:111], v0 offset:16
    s_cbranch_scc1 L_ST
    ds_read_b128 v[112:115], v0 offset:2048
    ds_read_b128 v[116:119], v0 offset:2064
    s_waitcnt lgkmcnt(0)
    v_pk_add_f32 v[104:105], v[104:105], v[112:113]
    v_pk_add_f32 v[106:107], v[106:107], v[114:115]
    v_pk_add_f32 v[108:109], v[108:109], v[116:117]
    v_pk_add_f32 v[110:111], v[110:111], v[118:119]
L_ST:
    s_waitcnt lgkmcnt(0)
    v_cvt_pk_bf16_f32 v152, v104, v105
    v_cvt_pk_bf16_f32 v153, v106, v107
    v_cvt_pk_bf16_f32 v154, v108, v109
    v_cvt_pk_bf16_f32 v155, v110, v111
    buffer_store_dwordx4 v[152:155], v251, s[28:31], s56 offen nt
L_FIN:
    s_endpgm
CMP:
    v_cmp_ne_u16_e64 s[4:5], 0, v220
    v_cmp_lt_u32_e64 s[6:7], s62, v220
    v_cmp_ne_u16_e64 s[8:9], 0, v221
    v_cmp_lt_u32_e64 s[10:11], s62, v221
    v_cmp_ne_u16_e64 s[12:13], 0, v222
    v_cmp_lt_u32_e64 s[14:15], s62, v222
    v_cmp_ne_u16_e64 s[16:17], 0, v223
    v_cmp_lt_u32_e64 s[18:19], s62, v223
    v_lshrrev_b32 v7, 1, v251
    v_add_u32 v7, s56, v7
    v_mov_b64 v[4:5], -1
    ds_write_b64 v7, v[4:5]
    v_mbcnt_lo_u32_b32 v6, s4, 0
    v_mbcnt_hi_u32_b32 v6, s5, v6
    v_mbcnt_lo_u32_b32 v6, s6, v6
    v_mbcnt_hi_u32_b32 v6, s7, v6
    v_mbcnt_lo_u32_b32 v6, s8, v6
    v_mbcnt_hi_u32_b32 v6, s9, v6
    v_mbcnt_lo_u32_b32 v6, s10, v6
    v_mbcnt_hi_u32_b32 v6, s11, v6
    v_mbcnt_lo_u32_b32 v6, s12, v6
    v_mbcnt_hi_u32_b32 v6, s13, v6
    v_mbcnt_lo_u32_b32 v6, s14, v6
    v_mbcnt_hi_u32_b32 v6, s15, v6
    v_mbcnt_lo_u32_b32 v6, s16, v6
    v_mbcnt_hi_u32_b32 v6, s17, v6
    v_mbcnt_lo_u32_b32 v6, s18, v6
    v_mbcnt_hi_u32_b32 v6, s19, v6
    s_mov_b64 s[64:65], 0
    v_readlane_b32 s59, v6, 31
    v_readlane_b32 s58, v6, 63
    v_add_u32 v6, s56, v6
    s_mov_b32 exec_lo, 0
    s_sub_u32 s57, 256, s59
    v_add_u32 v6, s57, v6
    s_sub_u32 s58, s58, s59
    s_mov_b64 exec, s[4:5]
    ds_write_b8 v6, v224
    v_add_u32 v6, 1, v6
    s_mov_b64 exec, s[6:7]
    ds_write_b8_d16_hi v6, v224
    v_add_u32 v6, 1, v6
    s_mov_b64 exec, s[8:9]
    ds_write_b8 v6, v225
    v_add_u32 v6, 1, v6
    s_mov_b64 exec, s[10:11]
    ds_write_b8_d16_hi v6, v225
    v_add_u32 v6, 1, v6
    s_mov_b64 exec, s[12:13]
    ds_write_b8 v6, v226
    v_add_u32 v6, 1, v6
    s_mov_b64 exec, s[14:15]
    ds_write_b8_d16_hi v6, v226
    v_add_u32 v6, 1, v6
    s_mov_b64 exec, s[16:17]
    ds_write_b8 v6, v227
    v_add_u32 v6, 1, v6
    s_mov_b64 exec, s[18:19]
    ds_write_b8_d16_hi v6, v227
    s_mov_b64 exec, -1
    s_setpc_b64 s[36:37]
CHK:
    v_cmp_eq_u16_e64 s[66:67], s61, v220
    s_xor_b64 s[66:67], s[66:67], s[4:5]
    s_or_b64 s[64:65], s[64:65], s[66:67]
    v_cmp_eq_u16_sdwa s[66:67], v220, s61 src0_sel:WORD_1 src1_sel:WORD_0
    s_xor_b64 s[66:67], s[66:67], s[6:7]
    s_or_b64 s[64:65], s[64:65], s[66:67]
    v_cmp_eq_u16_e64 s[66:67], s61, v221
    s_xor_b64 s[66:67], s[66:67], s[8:9]
    s_or_b64 s[64:65], s[64:65], s[66:67]
    v_cmp_eq_u16_sdwa s[66:67], v221, s61 src0_sel:WORD_1 src1_sel:WORD_0
    s_xor_b64 s[66:67], s[66:67], s[10:11]
    s_or_b64 s[64:65], s[64:65], s[66:67]
    v_cmp_eq_u16_e64 s[66:67], s61, v222
    s_xor_b64 s[66:67], s[66:67], s[12:13]
    s_or_b64 s[64:65], s[64:65], s[66:67]
    v_cmp_eq_u16_sdwa s[66:67], v222, s61 src0_sel:WORD_1 src1_sel:WORD_0
    s_xor_b64 s[66:67], s[66:67], s[14:15]
    s_or_b64 s[64:65], s[64:65], s[66:67]
    v_cmp_eq_u16_e64 s[66:67], s61, v223
    s_xor_b64 s[66:67], s[66:67], s[16:17]
    s_or_b64 s[64:65], s[64:65], s[66:67]
    v_cmp_eq_u16_sdwa s[66:67], v223, s61 src0_sel:WORD_1 src1_sel:WORD_0
    s_xor_b64 s[66:67], s[66:67], s[18:19]
    s_or_b64 s[64:65], s[64:65], s[66:67]
    s_min_u32 s64, s64, 1
    s_min_u32 s65, s65, 1
    s_lshl_b64 s[64:65], s[64:65], 15
    s_or_b32 s57, s59, s64
    s_or_b32 s58, s58, s65
    s_setpc_b64 s[36:37]
LATE:
    s_lshl_b32 s56, s70, 8
    s_add_u32 s56, s56, 115712
    s_waitcnt vmcnt(4)
    v_mov_b64 v[220:221], v[196:197]
    v_mov_b64 v[222:223], v[198:199]
    s_call_b64 s[36:37], CMP
    s_call_b64 s[36:37], CHK
    v_writelane_b32 v228, s57, 0
    v_writelane_b32 v228, s58, 1
    s_cmp_le_u32 s47, 1
    s_cbranch_scc1 LATE_D
    s_add_u32 s56, s56, 512
    v_mov_b64 v[220:221], v[200:201]
    v_mov_b64 v[222:223], v[202:203]
    s_call_b64 s[36:37], CMP
    s_call_b64 s[36:37], CHK
    v_writelane_b32 v228, s57, 2
    v_writelane_b32 v228, s58, 3
    s_cmp_le_u32 s47, 2
    s_cbranch_scc1 LATE_D
    s_add_u32 s56, s56, 512
    v_mov_b64 v[220:221], v[204:205]
    v_mov_b64 v[222:223], v[206:207]
    s_call_b64 s[36:37], CMP
    s_call_b64 s[36:37], CHK
    v_writelane_b32 v228, s57, 4
    v_writelane_b32 v228, s58, 5
    s_cmp_le_u32 s47, 3
    s_cbranch_scc1 LATE_D
    s_add_u32 s56, s56, 512
    v_mov_b64 v[220:221], v[208:209]
    v_mov_b64 v[222:223], v[210:211]
    s_call_b64 s[36:37], CMP
    s_call_b64 s[36:37], CHK
    v_writelane_b32 v228, s57, 6
    v_writelane_b32 v228, s58, 7
    s_cmp_le_u32 s47, 4
    s_cbranch_scc1 LATE_D
    s_add_u32 s56, s56, 512
    v_mov_b64 v[220:221], v[212:213]
    v_mov_b64 v[222:223], v[214:215]
    s_call_b64 s[36:37], CMP
    s_call_b64 s[36:37], CHK
    v_writelane_b32 v228, s57, 8
    v_writelane_b32 v228, s58, 9
    s_cmp_le_u32 s47, 5
    s_cbranch_scc1 LATE_D
    s_add_u32 s56, s56, 512
    v_mov_b64 v[220:221], v[216:217]
    v_mov_b64 v[222:223], v[218:219]
    s_call_b64 s[36:37], CMP
    s_call_b64 s[36:37], CHK
    v_writelane_b32 v228, s57, 10
    v_writelane_b32 v228, s58, 11
LATE_D:
    v_lshrrev_b32 v230, 4, v251
    v_add_u32 v230, s70, v230
    s_lshl_b32 s56, s47, 1
    s_bfm_b64 s[66:67], s56, 0
    v_and_b32 v231, 0xff, v228
    v_max_u32 v231, 1, v231
    v_add_u32 v231, 15, v231
    v_lshrrev_b32 v231, 4, v231
    v_add_u32 v232, 2, v231
    v_cmp_gt_u32 vcc, 56, v230
    v_lshrrev_b32 v232, 2, v232
    v_lshlrev_b32 v232, 1, v232
    v_cndmask_b32 v232, v232, v231, vcc
    v_lshrrev_b32 v233, 8, v228
    v_mul_u32_u24 v234, 0x101, v230
    v_and_or_b32 v233, v233, s61, v234
    v_mul_u32_u24 v234, 0x11, v232
    v_lshl_or_b32 v234, v234, 24, v233
    v_sub_u32 v231, v231, v232
    v_mul_u32_u24 v231, 0x110, v231
    v_or_b32 v231, v231, v232
    v_add_u32 v233, 2048, v233
    v_lshl_or_b32 v235, v231, 20, v233
    v_lshlrev_b32 v231, 2, v230
    v_add_u32 v231, 133120, v231
    v_lshlrev_b32 v232, 3, v230
    v_add_u32 v232, 132896, v232
    s_and_b64 exec, s[66:67], vcc
    ds_write_b32 v231, v234
    s_andn2_b64 exec, s[66:67], vcc
    ds_write_b64 v232, v[234:235]
    s_mov_b64 exec, -1
    s_branch LATE_R
PSEC:
    s_mov_b32 s50, s68
    s_mov_b32 s68, 0
    s_branch PSET
PODD:
    s_cmp_lg_u32 s50, 0
    s_cbranch_scc1 PDRAW
    s_sleep 2
    s_branch PREAD
SLOW:
    s_mov_b64 exec, -1
    s_waitcnt lgkmcnt(0)
    s_and_b32 s56, s52, 63
    s_bfe_u32 s57, s52, 0x40014
    s_bfe_u32 s59, s52, 0x40018
    s_lshl4_add_u32 s57, s56, s57
    s_lshl_b32 s57, s57, 4
    s_add_u32 s57, s57, 115712
    v_bfe_u32 v196, v251, 4, 4
    v_add_u32 v196, s57, v196
    v_mov_b32 v199, v252
    s_mul_i32 s57, s56, 25600
    s_add_u32 s57, s57, s49
    s_mul_i32 s58, s56, 400
    v_mov_b32 v164, 0
    v_mov_b32 v165, 0
    v_mov_b32 v166, 0
    v_mov_b32 v167, 0
    v_mov_b32 v168, 0
    v_mov_b32 v169, 0
    v_mov_b32 v170, 0
    v_mov_b32 v171, 0
    v_mov_b32 v172, 0
    v_mov_b32 v173, 0
    v_mov_b32 v174, 0
    v_mov_b32 v175, 0
    v_mov_b32 v176, 0
    v_mov_b32 v177, 0
    v_mov_b32 v178, 0
    v_mov_b32 v179, 0
SLOW_L:
    ds_read_u8 v198, v196
    v_add_u32 v196, 16, v196
    s_waitcnt lgkmcnt(0)
    v_lshlrev_b32 v197, 1, v198
    buffer_load_dwordx4 v[200:203], v[198:199], s[20:23], s57 idxen offen offset:0
    buffer_load_dwordx4 v[204:207], v[198:199], s[20:23], s57 idxen offen offset:64
    buffer_load_ushort v197, v197, s[24:27], s58 offen
    v_cmp_gt_u32 vcc, 200, v198
    s_waitcnt vmcnt(0)
    v_mfma_f32_16x16x32_bf16 v[104:107], v[72:75], v[200:203], v[136:139]
    v_mfma_f32_16x16x32_bf16 v[104:107], v[76:79], v[204:207], v[104:107]
    v_mfma_f32_16x16x32_bf16 v[108:111], v[80:83], v[200:203], v[140:143]
    v_mfma_f32_16x16x32_bf16 v[108:111], v[84:87], v[204:207], v[108:111]
    v_mfma_f32_16x16x32_bf16 v[112:115], v[88:91], v[200:203], v[144:147]
    v_mfma_f32_16x16x32_bf16 v[112:115], v[92:95], v[204:207], v[112:115]
    v_mfma_f32_16x16x32_bf16 v[116:119], v[96:99], v[200:203], v[148:151]
    v_mfma_f32_16x16x32_bf16 v[116:119], v[100:103], v[204:207], v[116:119]
    v_lshlrev_b32 v197, 16, v197
    v_cndmask_b32 v197, 0, v197, vcc
    s_nop 7
    v_exp_f32 v104, v104
    v_exp_f32 v105, v105
    v_exp_f32 v106, v106
    v_exp_f32 v107, v107
    v_exp_f32 v108, v108
    v_exp_f32 v109, v109
    v_exp_f32 v110, v110
    v_exp_f32 v111, v111
    v_exp_f32 v112, v112
    v_exp_f32 v113, v113
    v_exp_f32 v114, v114
    v_exp_f32 v115, v115
    v_exp_f32 v116, v116
    v_exp_f32 v117, v117
    v_exp_f32 v118, v118
    v_exp_f32 v119, v119
    v_add_f32 v104, 1.0, v104
    v_add_f32 v105, 1.0, v105
    v_add_f32 v106, 1.0, v106
    v_add_f32 v107, 1.0, v107
    v_add_f32 v108, 1.0, v108
    v_add_f32 v109, 1.0, v109
    v_add_f32 v110, 1.0, v110
    v_add_f32 v111, 1.0, v111
    v_add_f32 v112, 1.0, v112
    v_add_f32 v113, 1.0, v113
    v_add_f32 v114, 1.0, v114
    v_add_f32 v115, 1.0, v115
    v_add_f32 v116, 1.0, v116
    v_add_f32 v117, 1.0, v117
    v_add_f32 v118, 1.0, v118
    v_add_f32 v119, 1.0, v119
    v_rcp_f32 v104, v104
    v_rcp_f32 v105, v105
    v_rcp_f32 v106, v106
    v_rcp_f32 v107, v107
    v_rcp_f32 v108, v108
    v_rcp_f32 v109, v109
    v_rcp_f32 v110, v110
    v_rcp_f32 v111, v111
    v_rcp_f32 v112, v112
    v_rcp_f32 v113, v113
    v_rcp_f32 v114, v114
    v_rcp_f32 v115, v115
    v_rcp_f32 v116, v116
    v_rcp_f32 v117, v117
    v_rcp_f32 v118, v118
    v_rcp_f32 v119, v119
    v_mul_f32 v0, v104, v120
    v_fmac_f32 v0, v105, v121
    v_fmac_f32 v0, v106, v122
    v_fmac_f32 v0, v107, v123
    v_fmac_f32 v0, v108, v124
    v_fmac_f32 v0, v109, v125
    v_fmac_f32 v0, v110, v126
    v_fmac_f32 v0, v111, v127
    v_fmac_f32 v0, v112, v128
    v_fmac_f32 v0, v113, v129
    v_fmac_f32 v0, v114, v130
    v_fmac_f32 v0, v115, v131
    v_fmac_f32 v0, v116, v132
    v_fmac_f32 v0, v117, v133
    v_fmac_f32 v0, v118, v134
    v_fmac_f32 v0, v119, v135
    v_mov_b32 v1, v0
    s_nop 1
    v_permlane32_swap_b32 v0, v1
    v_add_f32 v0, v0, v1
    v_mov_b32 v1, v0
    s_nop 1
    v_permlane16_swap_b32 v0, v1
    v_add_f32 v0, v0, v1
    v_mul_f32 v0, s46, v0
    v_add_f32 v0, s63, v0
    v_mul_f32 v0, v0, v197
    v_lshlrev_b32 v1, 16, v200
    v_and_b32 v2, 0xffff0000, v200
    v_fmac_f32 v164, v0, v1
    v_fmac_f32 v165, v0, v2
    v_lshlrev_b32 v1, 16, v201
    v_and_b32 v2, 0xffff0000, v201
    v_fmac_f32 v166, v0, v1
    v_fmac_f32 v167, v0, v2
    v_lshlrev_b32 v1, 16, v202
    v_and_b32 v2, 0xffff0000, v202
    v_fmac_f32 v168, v0, v1
    v_fmac_f32 v169, v0, v2
    v_lshlrev_b32 v1, 16, v203
    v_and_b32 v2, 0xffff0000, v203
    v_fmac_f32 v170, v0, v1
    v_fmac_f32 v171, v0, v2
    v_lshlrev_b32 v1, 16, v204
    v_and_b32 v2, 0xffff0000, v204
    v_fmac_f32 v172, v0, v1
    v_fmac_f32 v173, v0, v2
    v_lshlrev_b32 v1, 16, v205
    v_and_b32 v2, 0xffff0000, v205
    v_fmac_f32 v174, v0, v1
    v_fmac_f32 v175, v0, v2
    v_lshlrev_b32 v1, 16, v206
    v_and_b32 v2, 0xffff0000, v206
    v_fmac_f32 v176, v0, v1
    v_fmac_f32 v177, v0, v2
    v_lshlrev_b32 v1, 16, v207
    v_and_b32 v2, 0xffff0000, v207
    v_fmac_f32 v178, v0, v1
    v_fmac_f32 v179, v0, v2
    s_sub_u32 s59, s59, 1
    s_cmp_lg_u32 s59, 0
    s_cbranch_scc1 SLOW_L
    s_and_b32 s56, s52, 0x7f00
    s_add_u32 s56, s56, 133632
    v_lshl_add_u32 v0, v252, 1, s56
    ds_add_f32 v0, v164 offset:0
    ds_add_f32 v0, v165 offset:4
    ds_add_f32 v0, v166 offset:8
    ds_add_f32 v0, v167 offset:12
    ds_add_f32 v0, v168 offset:16
    ds_add_f32 v0, v169 offset:20
    ds_add_f32 v0, v170 offset:24
    ds_add_f32 v0, v171 offset:28
    ds_add_f32 v0, v172 offset:128
    ds_add_f32 v0, v173 offset:132
    ds_add_f32 v0, v174 offset:136
    ds_add_f32 v0, v175 offset:140
    ds_add_f32 v0, v176 offset:144
    ds_add_f32 v0, v177 offset:148
    ds_add_f32 v0, v178 offset:152
    ds_add_f32 v0, v179 offset:156
    s_waitcnt lgkmcnt(0)
    v_mov_b64 v[166:167], 0
    v_mov_b64 v[170:171], 0
    v_mov_b64 v[174:175], 0
    v_mov_b64 v[178:179], 0
    s_bitcmp1_b32 s53, 6
    s_cbranch_scc1 L_DONE
    s_and_b32 s57, s53, 63
    s_mul_i32 s57, s57, 528
    s_add_u32 s57, s57, 81920
    v_lshl_add_u32 v6, v252, 1, s57
    v_add_u32 v7, s57, v252
    ds_read_b128 v[104:107], v6 offset:0
    ds_read_b128 v[108:111], v6 offset:16
    ds_read_b128 v[196:199], v251 offset:0
    ds_read_b128 v[200:203], v251 offset:1024
    ds_read_b128 v[112:115], v6 offset:128
    ds_read_b128 v[116:119], v6 offset:144
    ds_read_b128 v[204:207], v251 offset:2048
    ds_read_b128 v[208:211], v251 offset:3072
    ds_read_b128 v[212:215], v251 offset:4096
    ds_read_b128 v[216:219], v251 offset:5120
    s_branch BP_C
L_END:
    s_endpgm
.section .rodata,"a"
.p2align 6
.amdhsa_kernel standalone__sequential_behavior_din__recsys_kernel
  .amdhsa_next_free_vgpr 253
  .amdhsa_next_free_sgpr 72
  .amdhsa_accum_offset 256
  .amdhsa_group_segment_fixed_size 0
  .amdhsa_kernarg_size 80
  .amdhsa_user_sgpr_count 2
  .amdhsa_user_sgpr_kernarg_segment_ptr 1
  .amdhsa_system_sgpr_workgroup_id_x 1
.end_amdhsa_kernel
```

```asm
; @launch grid=(256,1,1) block=(512,1,1) lds=157184
.amdgcn_target "amdgcn-amd-amdhsa--gfx950"
.text
.globl standalone__sequential_behavior_din__recsys_kernel
.p2align 8
.type standalone__sequential_behavior_din__recsys_kernel,@function
standalone__sequential_behavior_din__recsys_kernel:
    s_cmp_ge_u32 s2, 256
    s_cbranch_scc1 L_END
    s_load_dwordx16 s[4:19], s[0:1], 0
    s_setprio 3
    v_lshrrev_b32 v1, 6, v0
    v_and_b32 v160, 63, v0
    v_readfirstlane_b32 s48, v1
    s_getpc_b64 s[40:41]
L_PC:
    s_cmp_lt_u32 s48, 5
    s_cbranch_scc1 P_NC
    s_sub_u32 s40, s40, L_PC-standalone__sequential_behavior_din__recsys_kernel
    s_subb_u32 s41, s41, 0
    s_mov_b32 s42, L_END-standalone__sequential_behavior_din__recsys_kernel
    s_mov_b32 s43, 0x20000
    v_subrev_u32 v150, 320, v0
    v_lshlrev_b32 v150, 6, v150
    buffer_load_dword v150, v150, s[40:43], 0 offen
P_NC:
    v_and_b32 v2, 31, v0
    v_bfe_u32 v3, v0, 5, 1
    v_cmp_gt_u32 vcc, 25, v2
    v_mul_u32_u24 v4, 400, v3
    v_lshl_add_u32 v163, v2, 4, v4
    v_bfrev_b32 v4, 8
    v_cndmask_b32 v163, v4, v163, vcc
    s_mul_i32 s57, s2, 25600
    s_mul_i32 s71, s48, 800
    s_mov_b32 s26, 25600
    s_mov_b32 s27, 0x20000
    s_lshl_b32 s69, s48, 12
    s_lshl_b32 s53, s2, 13
    v_lshlrev_b32 v251, 4, v160
    v_lshlrev_b32 v120, 1, v160
    v_and_b32 v120, 32, v120
    v_xor_b32 v120, v120, v251
    v_xor_b32 v121, 64, v120
    s_mov_b32 s38, 32768
    s_mov_b32 s39, 0x20000
    s_lshl_b32 s58, s48, 10
    s_mov_b32 s34, 8192
    s_mov_b32 s35, 0x20000
    s_lshl1_add_u32 s54, s69, 16384
    s_add_u32 m0, s54, 4096
    v_and_b32 v162, 15, v160
    v_lshrrev_b32 v161, 4, v160
    v_lshlrev_b32 v252, 4, v161
    v_mul_u32_u24 v184, 0x80008, v2
    v_lshrrev_b32 v236, 3, v160
    v_add_u32 v184, 0x10000, v184
    v_cmp_gt_u32 vcc, 32, v160
    s_waitcnt lgkmcnt(0)
    s_add_u32 s24, s8, s57
    s_addc_u32 s25, s9, 0
    s_mov_b64 s[36:37], s[10:11]
    buffer_load_dwordx4 v[180:183], v163, s[24:27], s71 offen offset:0 nt
    s_setprio 0
    s_add_u32 s32, s4, s53
    s_addc_u32 s33, s5, 0
    s_load_dword s63, s[16:17], 0
    s_cmp_lg_u32 s48, 0
    s_cbranch_scc1 P_LJ
    v_mov_b32 v146, s12
    v_mov_b32 v147, s13
    v_mov_b32 v148, s14
    v_mov_b32 v149, s15
    v_lshlrev_b32 v4, 2, v2
    v_cndmask_b32 v146, v146, v148, vcc
    v_cndmask_b32 v147, v147, v149, vcc
    v_add_co_u32 v146, vcc, v146, v4
    s_nop 1
    v_addc_co_u32 v147, vcc, 0, v147, vcc
    global_load_dword v146, v[146:147], off
P_LJ:
    buffer_load_dwordx4 v[124:127], v251, s[32:35], s58 offen nt
    buffer_load_dwordx4 v120, s[36:39], s69 offen offset:0 lds
    buffer_load_dwordx4 v121, s[36:39], s69 offen offset:1024 lds
    s_mul_i32 s49, s2, 1638400
    s_lshl_b32 s57, s48, 9
    v_add_u32 v247, 115712, v236
    v_add_u32 v246, s57, v247
    v_add_u32 v185, 0x20002, v184
    v_add_u32 v186, 0x40004, v184
    v_add_u32 v187, 0x60006, v184
    s_mul_i32 s56, s48, 3072
    s_add_u32 s56, s56, 132608
    v_add_u32 v4, s56, v251
    v_mov_b64 v[104:105], 0
    v_mov_b64 v[106:107], 0
    ds_write_b128 v4, v[104:107] offset:0
    ds_write_b128 v4, v[104:107] offset:1024
    ds_write_b128 v4, v[104:107] offset:2048
    s_sub_u32 s20, s6, 1024
    s_subb_u32 s21, s7, 0
    s_or_b32 s21, s21, 0x800000
    s_mov_b32 s22, 200
    s_mov_b32 s23, 0x20000
    s_mov_b32 s62, 0xffff
    s_mov_b32 s61, 0x3f80
    v_lshlrev_b32 v250, 2, v160
    v_and_b32 v2, 6, v236
    v_xor_b32 v2, v2, v160
    v_and_b32 v2, 7, v2
    v_mul_u32_u24 v143, 528, v236
    v_lshlrev_b32 v237, 4, v2
    v_lshlrev_b32 v239, 4, v2
    v_lshlrev_b32 v197, 4, v2
    v_lshlrev_b32 v199, 4, v2
    s_add_u32 s28, s18, s53
    s_addc_u32 s29, s19, 0
    s_mov_b32 s30, 8192
    s_mov_b32 s31, 0x20000
    s_mov_b32 s60, 0xbfb8aa3b
    s_mov_b32 s46, 0x2b800000
    s_mul_i32 s51, s48, 51200
    s_add_u32 s51, s51, s49
    s_add_u32 s72, s51, 1024
    v_and_b32 v2, 6, v162
    v_xor_b32 v2, v2, v161
    v_lshl_add_u32 v2, v2, 4, s54
    v_lshl_add_u32 v240, v162, 7, v2
    v_xor_b32 v241, 64, v240
    v_lshrrev_b32 v2, 2, v160
    v_and_b32 v3, 3, v160
    v_lshlrev_b32 v7, 3, v3
    v_and_b32 v6, 0x60, v250
    v_or_b32 v6, v6, v7
    v_lshl_add_u32 v242, v2, 7, v6
    v_add_u32 v242, s54, v242
    v_xor_b32 v243, 32, v242
    v_xor_b32 v244, 64, v242
    v_xor_b32 v245, 96, v242
    s_add_u32 s56, s57, 115712
    s_add_u32 s57, s57, 150016
    v_lshl_add_u32 v249, v161, 2, s57
    v_lshl_add_u32 v249, v162, 4, v249
    v_lshl_add_u32 v248, v2, 4, v7
    v_cmp_gt_u32 vcc, 2, v3
    v_add_u32 v248, s57, v248
    v_mov_b32 v152, 132608
    v_cndmask_b32 v248, v152, v248, vcc
    v_and_b32 v2, 3, v2
    v_lshl_add_u32 v6, v2, 7, v6
    v_lshl_add_u32 v136, v161, 10, v6
    v_add_u32 v136, 20480, v136
    v_xor_b32 v137, 32, v136
    v_xor_b32 v138, 64, v136
    v_xor_b32 v139, 96, v136
    v_add_u32 v151, 132096, v252
    s_and_b32 s52, s48, 4
    s_lshl_b32 s52, s52, 4
    v_xor_b32 v140, s52, v136
    v_xor_b32 v141, 32, v140
    s_mul_i32 s57, s48, 0x2010
    s_and_b32 s57, s57, 0x2060
    v_xor_b32 v144, s57, v136
    s_and_b32 s57, s48, 3
    s_mul_i32 s57, s57, 8448
    s_lshl1_add_u32 s57, s52, s57
    s_add_u32 s57, s57, 81920
    v_mul_u32_u24 v145, 528, v162
    v_add3_u32 v145, v145, v252, s57
    v_lshl_add_u32 v142, s52, 1, v151
    s_mul_i32 s57, s48, 4224
    s_add_u32 s57, s57, 81920
    v_and_b32 v3, 0x70, v251
    v_add3_u32 v143, v143, v3, s57
    v_add_u32 v3, v143, v3
    s_lshl_b32 s57, s48, 11
    v_add_u32 v1, s57, v251
    s_mov_b32 s66, 0x1b0a0100
    s_mov_b32 s67, 0x966d4c33
    s_lshl_b32 s57, s48, 3
    s_lshr_b64 s[66:67], s[66:67], s57
    s_and_b32 s47, s66, 7
    s_bfe_u32 s70, s66, 0x50003
    s_lshl1_add_u32 s70, s70, 16
    s_mul_i32 s71, s70, 400
    buffer_load_dwordx4 v120, s[36:39], s69 offen offset:2048 lds
    buffer_load_dwordx4 v121, s[36:39], s69 offen offset:3072 lds
    s_cmp_eq_u32 s48, 0
    s_waitcnt vmcnt(6) lgkmcnt(0)
    s_cbranch_scc1 P_M0
    s_waitcnt vmcnt(5)
P_M0:
    s_call_b64 s[36:37], CMP
    ds_read_u8 v236, v246 offset:0
    ds_read_u8 v238, v246 offset:8
    ds_read_u8 v196, v246 offset:16
    ds_read_u8 v198, v246 offset:24
    s_add_u32 m0, s54, 0
    v_add_u32 v246, 32, v246
    s_waitcnt lgkmcnt(3)
    buffer_load_dwordx4 v[236:237], s[20:23], s72 idxen offen nt lds
    s_waitcnt lgkmcnt(2)
    buffer_load_dwordx4 v[238:239], s[20:23], s51 idxen offen offset:1024 nt lds
    s_add_u32 m0, s54, 2048
    s_waitcnt lgkmcnt(1)
    buffer_load_dwordx4 v[196:197], s[20:23], s72 idxen offen nt lds
    s_waitcnt lgkmcnt(0)
    buffer_load_dwordx4 v[198:199], s[20:23], s51 idxen offen offset:1024 nt lds
    s_call_b64 s[36:37], CHK
    s_and_b32 s59, s57, 0xff
    s_lshr_b32 s57, s57, 8
    s_max_u32 s59, s59, 1
    s_add_u32 s59, s59, 15
    s_lshr_b32 s59, s59, 4
    s_mul_i32 s50, s59, 0x11000000
    s_or_b32 s50, s50, s57
    s_mul_i32 s59, s48, 0x202
    s_or_b32 s50, s50, s59
    s_and_b32 s59, s58, 0xff
    s_lshr_b32 s58, s58, 8
    s_max_u32 s59, s59, 1
    s_add_u32 s59, s59, 15
    s_lshr_b32 s59, s59, 4
    s_mul_i32 s68, s59, 0x11000000
    s_or_b32 s68, s68, s58
    s_mul_i32 s59, s48, 0x202
    s_or_b32 s68, s68, s59
    s_or_b32 s68, s68, 0x101
    s_mov_b32 s53, s50
    s_lshl_b32 s63, s63, 16
    s_cmp_lg_u32 s48, 0
    s_waitcnt vmcnt(8)
    s_cbranch_scc1 P_SW_J
    v_lshlrev_b32 v148, 16, v146
    v_and_b32 v149, 0xffff0000, v146
    v_mov_b32 v4, 133184
    v_mov_b32 v6, 0x20e00040
    v_add_u32 v7, v250, v152
    v_lshl_add_u32 v0, v250, 1, v152
    s_mov_b32 exec_hi, 0
    v_max3_f32 v2, abs(v148), abs(v149), abs(s63)
    v_ldexp_f32 v148, v148, 40
    v_ldexp_f32 v149, v149, 40
    v_cmp_le_f32 vcc, 0x33800000, v2
    s_mov_b64 exec, 255
    ds_write_b32 v7, v6 offset:768
    s_mov_b64 exec, -1
    s_movk_i32 s56, 0x3ff
    s_cmp_lg_u64 vcc, 0
    s_cmovk_i32 s56, 0x207
    v_subrev_u32 v0, 512, v0
    v_mov_b32 v2, s56
    ds_write_b64 v0, v[148:149]
    ds_write2_b32 v152, v4, v2 offset0:4 offset1:8
P_SW_J:
    ds_write_b128 v143, v[124:127] offset:256
    ds_write_b128 v143, v[124:127] offset:384
    v_lshlrev_b32 v212, 16, v124
    v_and_b32 v213, 0xffff0000, v124
    v_lshlrev_b32 v214, 16, v125
    v_and_b32 v215, 0xffff0000, v125
    v_lshlrev_b32 v216, 16, v126
    v_and_b32 v217, 0xffff0000, v126
    v_lshlrev_b32 v218, 16, v127
    v_and_b32 v219, 0xffff0000, v127
    v_mul_f32 v212, s60, v212
    v_mul_f32 v213, s60, v213
    v_mul_f32 v214, s60, v214
    v_mul_f32 v215, s60, v215
    v_mul_f32 v216, s60, v216
    v_mul_f32 v217, s60, v217
    v_mul_f32 v218, s60, v218
    v_mul_f32 v219, s60, v219
    ds_write_b128 v3, v[212:215] offset:0
    ds_write_b128 v3, v[216:219] offset:16
    v_ldexp_f32 v2, s63, 37
    v_add_u32 v250, 133632, v250
    v_readfirstlane_b32 s44, v2
    s_waitcnt vmcnt(4) lgkmcnt(2)
    s_barrier
    ds_read_b64_tr_b16 v[200:201], v144 offset:0
    ds_read_b64_tr_b16 v[202:203], v144 offset:512
    ds_read_b64_tr_b16 v[204:205], v144 offset:32768
    ds_read_b64_tr_b16 v[206:207], v144 offset:33280
    ds_read_b128 v[164:167], v145 offset:256
    ds_read_b128 v[168:171], v145 offset:320
    ds_read_b128 v[104:107], v142 offset:256
    ds_read_b128 v[108:111], v142 offset:320
    ds_read_b64_tr_b16 v[40:41], v140 offset:16384
    ds_read_b64_tr_b16 v[42:43], v140 offset:16896
    ds_read_b64_tr_b16 v[44:45], v141 offset:16384
    ds_read_b64_tr_b16 v[46:47], v141 offset:16896
    ds_read_b64_tr_b16 v[48:49], v140 offset:24576
    ds_read_b64_tr_b16 v[50:51], v140 offset:25088
    ds_read_b64_tr_b16 v[52:53], v141 offset:24576
    ds_read_b64_tr_b16 v[54:55], v141 offset:25088
    ds_read_b64_tr_b16 v[56:57], v140 offset:32768
    ds_read_b64_tr_b16 v[58:59], v140 offset:33280
    ds_read_b64_tr_b16 v[60:61], v141 offset:32768
    ds_read_b64_tr_b16 v[62:63], v141 offset:33280
    ds_read_b64_tr_b16 v[64:65], v140 offset:40960
    ds_read_b64_tr_b16 v[66:67], v140 offset:41472
    ds_read_b64_tr_b16 v[68:69], v141 offset:40960
    ds_read_b64_tr_b16 v[70:71], v141 offset:41472
    s_waitcnt lgkmcnt(15)
    v_lshlrev_b32 v8, 16, v200
    v_and_b32 v9, 0xffff0000, v200
    v_lshlrev_b32 v16, 16, v204
    v_and_b32 v17, 0xffff0000, v204
    v_lshlrev_b32 v10, 16, v201
    v_and_b32 v11, 0xffff0000, v201
    v_lshlrev_b32 v18, 16, v205
    v_and_b32 v19, 0xffff0000, v205
    v_lshlrev_b32 v12, 16, v202
    v_and_b32 v13, 0xffff0000, v202
    v_lshlrev_b32 v20, 16, v206
    v_and_b32 v21, 0xffff0000, v206
    v_lshlrev_b32 v14, 16, v203
    v_and_b32 v15, 0xffff0000, v203
    v_lshlrev_b32 v22, 16, v207
    v_and_b32 v23, 0xffff0000, v207
    v_xor_b32 v172, 0x80008000, v164
    v_xor_b32 v173, 0x80008000, v165
    v_xor_b32 v174, 0x80008000, v166
    v_xor_b32 v175, 0x80008000, v167
    v_xor_b32 v176, 0x80008000, v168
    v_xor_b32 v177, 0x80008000, v169
    v_xor_b32 v178, 0x80008000, v170
    v_xor_b32 v179, 0x80008000, v171
    s_waitcnt lgkmcnt(12)
    v_mfma_f32_16x16x32_bf16 v[104:107], v[40:43], v[164:167], v[104:107]
    v_mfma_f32_16x16x32_bf16 v[108:111], v[44:47], v[164:167], v[108:111]
    v_add_f32 v112, v8, v16
    v_add_f32 v113, v9, v17
    s_waitcnt lgkmcnt(8)
    v_mfma_f32_16x16x32_bf16 v[104:107], v[48:51], v[168:171], v[104:107]
    v_mfma_f32_16x16x32_bf16 v[108:111], v[52:55], v[168:171], v[108:111]
    v_add_f32 v114, v10, v18
    v_add_f32 v115, v11, v19
    s_waitcnt lgkmcnt(4)
    v_mfma_f32_16x16x32_bf16 v[104:107], v[56:59], v[172:175], v[104:107]
    v_mfma_f32_16x16x32_bf16 v[108:111], v[60:63], v[172:175], v[108:111]
    v_add_f32 v116, v12, v20
    v_add_f32 v117, v13, v21
    s_waitcnt lgkmcnt(0)
    v_mfma_f32_16x16x32_bf16 v[104:107], v[64:67], v[176:179], v[104:107]
    v_mfma_f32_16x16x32_bf16 v[108:111], v[68:71], v[176:179], v[108:111]
    v_add_f32 v118, v14, v22
    v_add_f32 v119, v15, v23
    ds_read_b64_tr_b16 v[72:73], v136 offset:49152
    ds_read_b64_tr_b16 v[74:75], v136 offset:49664
    ds_read_b64_tr_b16 v[76:77], v136 offset:57344
    ds_read_b64_tr_b16 v[78:79], v136 offset:57856
    ds_read_b64_tr_b16 v[80:81], v137 offset:49152
    ds_read_b64_tr_b16 v[82:83], v137 offset:49664
    ds_read_b64_tr_b16 v[84:85], v137 offset:57344
    ds_read_b64_tr_b16 v[86:87], v137 offset:57856
    ds_read_b64_tr_b16 v[88:89], v138 offset:49152
    ds_read_b64_tr_b16 v[90:91], v138 offset:49664
    ds_read_b64_tr_b16 v[92:93], v138 offset:57344
    ds_read_b64_tr_b16 v[94:95], v138 offset:57856
    ds_read_b64_tr_b16 v[96:97], v139 offset:49152
    ds_read_b64_tr_b16 v[98:99], v139 offset:49664
    ds_read_b64_tr_b16 v[100:101], v139 offset:57344
    ds_read_b64_tr_b16 v[102:103], v139 offset:57856
    v_mul_f32 v112, s60, v112
    v_mul_f32 v113, s60, v113
    v_mul_f32 v114, s60, v114
    v_mul_f32 v115, s60, v115
    v_mul_f32 v116, s60, v116
    v_mul_f32 v117, s60, v117
    v_mul_f32 v118, s60, v118
    v_mul_f32 v119, s60, v119
    ds_write_b128 v1, v[112:115] offset:0
    ds_write_b128 v1, v[116:119] offset:1024
    v_mul_f32 v104, s60, v104
    v_mul_f32 v105, s60, v105
    v_mul_f32 v106, s60, v106
    v_mul_f32 v107, s60, v107
    v_mul_f32 v108, s60, v108
    v_mul_f32 v109, s60, v109
    v_mul_f32 v110, s60, v110
    v_mul_f32 v111, s60, v111
    ds_write_b128 v145, v[104:107] offset:256
    ds_write_b128 v145, v[108:111] offset:320
    ds_read_b128 v[120:123], v151 offset:0
    ds_read_b128 v[124:127], v151 offset:64
    ds_read_b128 v[128:131], v151 offset:128
    ds_read_b128 v[132:135], v151 offset:192
    ds_read_b32 v3, v152 offset:32
    s_cmp_le_u32 s47, 0
    s_cbranch_scc1 P_MJ
    buffer_load_dwordx4 v[212:215], v163, s[24:27], s71 offen offset:0 nt
    s_cmp_le_u32 s47, 1
    s_cbranch_scc1 P_MJ
    buffer_load_dwordx4 v[216:219], v163, s[24:27], s71 offen offset:800 nt
    s_cmp_le_u32 s47, 2
    s_cbranch_scc1 P_MJ
    buffer_load_dwordx4 v[220:223], v163, s[24:27], s71 offen offset:1600 nt
    s_cmp_le_u32 s47, 3
    s_cbranch_scc1 P_MJ
    buffer_load_dwordx4 v[224:227], v163, s[24:27], s71 offen offset:2400 nt
    s_cmp_le_u32 s47, 4
    s_cbranch_scc1 P_MJ
    buffer_load_dwordx4 v[228:231], v163, s[24:27], s71 offen offset:3200 nt
    s_cmp_le_u32 s47, 5
    s_cbranch_scc1 P_MJ
    buffer_load_dwordx4 v[232:235], v163, s[24:27], s71 offen offset:4000 nt
P_MJ:
    v_mov_b64 v[166:167], 0
    v_mov_b64 v[170:171], 0
    v_mov_b64 v[174:175], 0
    v_mov_b64 v[178:179], 0
    s_waitcnt lgkmcnt(15)
    v_lshlrev_b32 v8, 16, v72
    v_and_b32 v9, 0xffff0000, v72
    v_lshlrev_b32 v10, 16, v73
    v_and_b32 v11, 0xffff0000, v73
    v_lshlrev_b32 v12, 16, v74
    v_and_b32 v13, 0xffff0000, v74
    v_lshlrev_b32 v14, 16, v75
    v_and_b32 v15, 0xffff0000, v75
    v_lshlrev_b32 v16, 16, v76
    v_and_b32 v17, 0xffff0000, v76
    v_lshlrev_b32 v18, 16, v77
    v_and_b32 v19, 0xffff0000, v77
    v_lshlrev_b32 v20, 16, v78
    v_and_b32 v21, 0xffff0000, v78
    v_lshlrev_b32 v22, 16, v79
    v_and_b32 v23, 0xffff0000, v79
    v_lshlrev_b32 v24, 16, v80
    v_and_b32 v25, 0xffff0000, v80
    v_lshlrev_b32 v26, 16, v81
    v_and_b32 v27, 0xffff0000, v81
    v_lshlrev_b32 v28, 16, v82
    v_and_b32 v29, 0xffff0000, v82
    v_lshlrev_b32 v30, 16, v83
    v_and_b32 v31, 0xffff0000, v83
    v_lshlrev_b32 v32, 16, v84
    v_and_b32 v33, 0xffff0000, v84
    v_lshlrev_b32 v34, 16, v85
    v_and_b32 v35, 0xffff0000, v85
    v_lshlrev_b32 v36, 16, v86
    v_and_b32 v37, 0xffff0000, v86
    v_lshlrev_b32 v38, 16, v87
    v_and_b32 v39, 0xffff0000, v87
    s_cmp_lt_u32 s50, 805306368
    s_waitcnt lgkmcnt(0)
    s_barrier
    v_readfirstlane_b32 s45, v3
    s_cbranch_scc1 ADV_P
    s_sub_u32 s50, s50, 536870912
RET_P:
    ds_read_u8 v236, v246 offset:0
    ds_read_u8 v238, v246 offset:8
    ds_read_u8 v196, v246 offset:16
    ds_read_u8 v198, v246 offset:24
    s_add_u32 m0, s54, 4096
    s_waitcnt lgkmcnt(3)
    buffer_load_dwordx4 v[236:237], s[20:23], s72 idxen offen nt lds
    s_waitcnt lgkmcnt(2)
    buffer_load_dwordx4 v[238:239], s[20:23], s51 idxen offen offset:1024 nt lds
    s_add_u32 m0, s54, 6144
    s_waitcnt lgkmcnt(1)
    buffer_load_dwordx4 v[196:197], s[20:23], s72 idxen offen nt lds
    s_waitcnt lgkmcnt(0)
    buffer_load_dwordx4 v[198:199], s[20:23], s51 idxen offen offset:1024 nt lds
    s_mov_b32 s69, s50
    s_cmp_lg_u32 s47, 0
    s_cbranch_scc1 LATE
LATE_R:
    v_lshlrev_b32 v40, 16, v88
    v_and_b32 v41, 0xffff0000, v88
    v_lshlrev_b32 v42, 16, v89
    v_and_b32 v43, 0xffff0000, v89
    v_lshlrev_b32 v44, 16, v90
    v_and_b32 v45, 0xffff0000, v90
    v_lshlrev_b32 v46, 16, v91
    v_and_b32 v47, 0xffff0000, v91
    v_lshlrev_b32 v48, 16, v92
    v_and_b32 v49, 0xffff0000, v92
    v_lshlrev_b32 v50, 16, v93
    v_and_b32 v51, 0xffff0000, v93
    v_lshlrev_b32 v52, 16, v94
    v_and_b32 v53, 0xffff0000, v94
    v_lshlrev_b32 v54, 16, v95
    v_and_b32 v55, 0xffff0000, v95
    v_lshlrev_b32 v56, 16, v96
    v_and_b32 v57, 0xffff0000, v96
    v_lshlrev_b32 v58, 16, v97
    v_and_b32 v59, 0xffff0000, v97
    v_lshlrev_b32 v60, 16, v98
    v_and_b32 v61, 0xffff0000, v98
    v_lshlrev_b32 v62, 16, v99
    v_and_b32 v63, 0xffff0000, v99
    v_lshlrev_b32 v64, 16, v100
    v_and_b32 v65, 0xffff0000, v100
    v_lshlrev_b32 v66, 16, v101
    v_and_b32 v67, 0xffff0000, v101
    v_lshlrev_b32 v68, 16, v102
    v_and_b32 v69, 0xffff0000, v102
    v_lshlrev_b32 v70, 16, v103
    v_and_b32 v71, 0xffff0000, v103
    v_mov_b64 v[182:183], 0
    v_mov_b64 v[186:187], 0
    v_mov_b64 v[190:191], 0
    v_mov_b64 v[194:195], 0
    s_waitcnt vmcnt(6)
    ds_read_b128 v[152:155], v240
    ds_read_b128 v[156:159], v241
    s_call_b64 s[34:35], BPF
U0_0:
    v_mfma_f32_16x16x32_bf16 v[104:107], v[72:75], v[152:155], v[136:139]
    s_add_u32 m0, s54, 0
    v_rcp_f32 v2, v2
    v_mfma_f32_16x16x32_bf16 v[104:107], v[76:79], v[156:159], v[104:107]
    s_mov_b32 s52, s53
    v_rcp_f32 v3, v3
    v_mfma_f32_16x16x32_bf16 v[108:111], v[80:83], v[152:155], v[140:143]
    s_mov_b32 s53, s69
    v_fma_f32 v0, v0, v2, s44
    v_fma_f32 v1, v1, v3, s44
    v_mfma_f32_16x16x32_bf16 v[108:111], v[84:87], v[156:159], v[108:111]
    s_cmp_lt_u32 s50, 805306368
    v_cvt_pk_bf16_f32 v0, v0, v1
    v_add_u32 v246, 32, v246
    v_mfma_f32_16x16x32_bf16 v[112:115], v[88:91], v[152:155], v[144:147]
    s_cbranch_scc1 ADV_0
    s_sub_u32 s50, s50, 536870912
RET_0:
    v_exp_f32 v104, v104
    v_mfma_f32_16x16x32_bf16 v[112:115], v[92:95], v[156:159], v[112:115]
    s_mov_b32 s69, s50
    v_exp_f32 v105, v105
    v_mfma_f32_16x16x32_bf16 v[116:119], v[96:99], v[152:155], v[148:151]
    s_cmp_lt_u32 s52, 536870912
    v_exp_f32 v106, v106
    v_mfma_f32_16x16x32_bf16 v[116:119], v[100:103], v[156:159], v[116:119]
    s_waitcnt vmcnt(4)
    v_exp_f32 v107, v107
    ds_write_b32 v249, v0 offset:256
    ds_read_b64_tr_b16 v[162:163], v248 offset:256
    ds_read_b64_tr_b16 v[164:165], v242 offset:0
    ds_read_b64_tr_b16 v[168:169], v243 offset:0
    ds_read_b64_tr_b16 v[172:173], v244 offset:0
    ds_read_b64_tr_b16 v[176:177], v245 offset:0
    ds_read_u8 v236, v246 offset:0
    ds_read_u8 v238, v246 offset:8
    ds_read_b128 v[152:155], v240 offset:2048
    ds_read_b128 v[156:159], v241 offset:2048
    v_exp_f32 v108, v108
    v_exp_f32 v109, v109
    v_exp_f32 v110, v110
    v_exp_f32 v111, v111
    v_exp_f32 v112, v112
    v_exp_f32 v113, v113
    v_exp_f32 v114, v114
    v_exp_f32 v115, v115
    v_exp_f32 v116, v116
    v_exp_f32 v117, v117
    v_exp_f32 v118, v118
    v_exp_f32 v119, v119
    .p2align 3
    v_pk_add_f32 v[2:3], v[104:105], 1.0 op_sel_hi:[1,0]
    v_pk_fma_f32 v[0:1], v[120:121], v[106:107], v[120:121]
    v_pk_fma_f32 v[0:1], v[122:123], v[2:3], v[0:1]
    v_pk_fma_f32 v[2:3], v[106:107], v[2:3], v[2:3]
    v_pk_fma_f32 v[0:1], v[108:109], v[0:1], v[0:1]
    v_pk_fma_f32 v[0:1], v[124:125], v[2:3], v[0:1]
    v_pk_fma_f32 v[2:3], v[108:109], v[2:3], v[2:3]
    v_pk_fma_f32 v[0:1], v[110:111], v[0:1], v[0:1]
    v_pk_fma_f32 v[0:1], v[126:127], v[2:3], v[0:1]
    v_pk_fma_f32 v[2:3], v[110:111], v[2:3], v[2:3]
    v_pk_fma_f32 v[0:1], v[112:113], v[0:1], v[0:1]
    v_pk_fma_f32 v[0:1], v[128:129], v[2:3], v[0:1]
    v_pk_fma_f32 v[2:3], v[112:113], v[2:3], v[2:3]
    v_pk_fma_f32 v[0:1], v[114:115], v[0:1], v[0:1]
    v_pk_fma_f32 v[0:1], v[130:131], v[2:3], v[0:1]
    v_pk_fma_f32 v[2:3], v[114:115], v[2:3], v[2:3]
    v_pk_fma_f32 v[0:1], v[116:117], v[0:1], v[0:1]
    v_pk_fma_f32 v[0:1], v[132:133], v[2:3], v[0:1]
    v_pk_fma_f32 v[2:3], v[116:117], v[2:3], v[2:3]
    v_pk_fma_f32 v[0:1], v[118:119], v[0:1], v[0:1]
    v_pk_fma_f32 v[0:1], v[134:135], v[2:3], v[0:1]
    v_pk_fma_f32 v[2:3], v[118:119], v[2:3], v[2:3]
    s_waitcnt lgkmcnt(0)
    buffer_load_dwordx4 v[236:237], s[20:23], s72 idxen offen nt lds
    buffer_load_dwordx4 v[238:239], s[20:23], s51 idxen offen offset:1024 nt lds
    s_cbranch_scc1 HALF_0
    v_mfma_f32_16x16x32_bf16 v[104:107], v[72:75], v[152:155], v[136:139]
    s_add_u32 m0, s54, 2048
    v_rcp_f32 v2, v2
    v_mfma_f32_16x16x32_bf16 v[104:107], v[76:79], v[156:159], v[104:107]
    s_nop 0
    v_rcp_f32 v3, v3
    v_mfma_f32_16x16x32_bf16 v[108:111], v[80:83], v[152:155], v[140:143]
    s_nop 0
    v_fma_f32 v0, v0, v2, s44
    v_fma_f32 v1, v1, v3, s44
    v_mfma_f32_16x16x32_bf16 v[108:111], v[84:87], v[156:159], v[108:111]
    s_nop 0
    v_cvt_pk_bf16_f32 v0, v0, v1
    v_mfma_f32_16x16x32_bf16 v[112:115], v[88:91], v[152:155], v[144:147]
    v_exp_f32 v104, v104
    v_mfma_f32_16x16x32_bf16 v[112:115], v[92:95], v[156:159], v[112:115]
    v_exp_f32 v105, v105
    v_mfma_f32_16x16x32_bf16 v[116:119], v[96:99], v[152:155], v[148:151]
    s_cmp_eq_u32 s55, 0
    v_exp_f32 v106, v106
    v_mfma_f32_16x16x32_bf16 v[116:119], v[100:103], v[156:159], v[116:119]
    s_cbranch_scc1 PS_0
    v_exp_f32 v107, v107
    v_mfma_f32_16x16x32_bf16 v[196:199], v[160:163], v[180:183], v[196:199]
    v_exp_f32 v108, v108
    v_mfma_f32_16x16x32_bf16 v[200:203], v[160:163], v[184:187], v[200:203]
    v_exp_f32 v109, v109
    v_mfma_f32_16x16x32_bf16 v[204:207], v[160:163], v[188:191], v[204:207]
    v_exp_f32 v110, v110
    v_mfma_f32_16x16x32_bf16 v[208:211], v[160:163], v[192:195], v[208:211]
PR_0:
    s_waitcnt vmcnt(4)
    v_exp_f32 v111, v111
    ds_write_b32 v249, v0 offset:0
    ds_read_b64_tr_b16 v[160:161], v248 offset:0
    ds_read_b64_tr_b16 v[166:167], v242 offset:2048
    ds_read_b64_tr_b16 v[170:171], v243 offset:2048
    ds_read_b64_tr_b16 v[174:175], v244 offset:2048
    ds_read_b64_tr_b16 v[178:179], v245 offset:2048
    ds_read_u8 v236, v246 offset:16
    ds_read_u8 v238, v246 offset:24
    ds_read_b128 v[152:155], v240 offset:4096
    ds_read_b128 v[156:159], v241 offset:4096
    v_exp_f32 v112, v112
    v_exp_f32 v113, v113
    v_exp_f32 v114, v114
    v_exp_f32 v115, v115
    v_exp_f32 v116, v116
    v_exp_f32 v117, v117
    v_exp_f32 v118, v118
    v_exp_f32 v119, v119
    .p2align 3
    v_pk_add_f32 v[2:3], v[104:105], 1.0 op_sel_hi:[1,0]
    v_pk_fma_f32 v[0:1], v[120:121], v[106:107], v[120:121]
    v_pk_fma_f32 v[0:1], v[122:123], v[2:3], v[0:1]
    v_pk_fma_f32 v[2:3], v[106:107], v[2:3], v[2:3]
    v_pk_fma_f32 v[0:1], v[108:109], v[0:1], v[0:1]
    v_pk_fma_f32 v[0:1], v[124:125], v[2:3], v[0:1]
    v_pk_fma_f32 v[2:3], v[108:109], v[2:3], v[2:3]
    v_pk_fma_f32 v[0:1], v[110:111], v[0:1], v[0:1]
    v_pk_fma_f32 v[0:1], v[126:127], v[2:3], v[0:1]
    v_pk_fma_f32 v[2:3], v[110:111], v[2:3], v[2:3]
    v_pk_fma_f32 v[0:1], v[112:113], v[0:1], v[0:1]
    v_pk_fma_f32 v[0:1], v[128:129], v[2:3], v[0:1]
    v_pk_fma_f32 v[2:3], v[112:113], v[2:3], v[2:3]
    v_pk_fma_f32 v[0:1], v[114:115], v[0:1], v[0:1]
    v_pk_fma_f32 v[0:1], v[130:131], v[2:3], v[0:1]
    v_pk_fma_f32 v[2:3], v[114:115], v[2:3], v[2:3]
    v_pk_fma_f32 v[0:1], v[116:117], v[0:1], v[0:1]
    v_pk_fma_f32 v[0:1], v[132:133], v[2:3], v[0:1]
    v_pk_fma_f32 v[2:3], v[116:117], v[2:3], v[2:3]
    v_pk_fma_f32 v[0:1], v[118:119], v[0:1], v[0:1]
    v_pk_fma_f32 v[0:1], v[134:135], v[2:3], v[0:1]
    v_pk_fma_f32 v[2:3], v[118:119], v[2:3], v[2:3]
    s_cmp_lt_u32 s52, 805306368
    s_waitcnt lgkmcnt(0)
    buffer_load_dwordx4 v[236:237], s[20:23], s72 idxen offen nt lds
    buffer_load_dwordx4 v[238:239], s[20:23], s51 idxen offen offset:1024 nt lds
    s_cbranch_scc1 LAST_0
U0_1:
    v_mfma_f32_16x16x32_bf16 v[104:107], v[72:75], v[152:155], v[136:139]
    s_add_u32 m0, s54, 4096
    v_rcp_f32 v2, v2
    v_mfma_f32_16x16x32_bf16 v[104:107], v[76:79], v[156:159], v[104:107]
    s_mov_b32 s52, s53
    v_rcp_f32 v3, v3
    v_mfma_f32_16x16x32_bf16 v[108:111], v[80:83], v[152:155], v[140:143]
    s_mov_b32 s53, s69
    v_fma_f32 v0, v0, v2, s44
    v_fma_f32 v1, v1, v3, s44
    v_mfma_f32_16x16x32_bf16 v[108:111], v[84:87], v[156:159], v[108:111]
    s_cmp_lt_u32 s50, 805306368
    v_cvt_pk_bf16_f32 v0, v0, v1
    v_add_u32 v246, 32, v246
    v_mfma_f32_16x16x32_bf16 v[112:115], v[88:91], v[152:155], v[144:147]
    s_cbranch_scc1 ADV_1
    s_sub_u32 s50, s50, 536870912
RET_1:
    v_exp_f32 v104, v104
    v_mfma_f32_16x16x32_bf16 v[112:115], v[92:95], v[156:159], v[112:115]
    s_mov_b32 s69, s50
    v_exp_f32 v105, v105
    v_mfma_f32_16x16x32_bf16 v[116:119], v[96:99], v[152:155], v[148:151]
    s_cmp_lt_u32 s52, 536870912
    v_exp_f32 v106, v106
    v_mfma_f32_16x16x32_bf16 v[116:119], v[100:103], v[156:159], v[116:119]
    s_waitcnt vmcnt(4)
    v_exp_f32 v107, v107
    ds_write_b32 v249, v0 offset:256
    ds_read_b64_tr_b16 v[162:163], v248 offset:256
    ds_read_b64_tr_b16 v[180:181], v242 offset:4096
    ds_read_b64_tr_b16 v[184:185], v243 offset:4096
    ds_read_b64_tr_b16 v[188:189], v244 offset:4096
    ds_read_b64_tr_b16 v[192:193], v245 offset:4096
    ds_read_u8 v236, v246 offset:0
    ds_read_u8 v238, v246 offset:8
    ds_read_b128 v[152:155], v240 offset:6144
    ds_read_b128 v[156:159], v241 offset:6144
    v_exp_f32 v108, v108
    v_exp_f32 v109, v109
    v_exp_f32 v110, v110
    v_exp_f32 v111, v111
    v_exp_f32 v112, v112
    v_exp_f32 v113, v113
    v_exp_f32 v114, v114
    v_exp_f32 v115, v115
    v_exp_f32 v116, v116
    v_exp_f32 v117, v117
    v_exp_f32 v118, v118
    v_exp_f32 v119, v119
    .p2align 3
    v_pk_add_f32 v[2:3], v[104:105], 1.0 op_sel_hi:[1,0]
    v_pk_fma_f32 v[0:1], v[120:121], v[106:107], v[120:121]
    v_pk_fma_f32 v[0:1], v[122:123], v[2:3], v[0:1]
    v_pk_fma_f32 v[2:3], v[106:107], v[2:3], v[2:3]
    v_pk_fma_f32 v[0:1], v[108:109], v[0:1], v[0:1]
    v_pk_fma_f32 v[0:1], v[124:125], v[2:3], v[0:1]
    v_pk_fma_f32 v[2:3], v[108:109], v[2:3], v[2:3]
    v_pk_fma_f32 v[0:1], v[110:111], v[0:1], v[0:1]
    v_pk_fma_f32 v[0:1], v[126:127], v[2:3], v[0:1]
    v_pk_fma_f32 v[2:3], v[110:111], v[2:3], v[2:3]
    v_pk_fma_f32 v[0:1], v[112:113], v[0:1], v[0:1]
    v_pk_fma_f32 v[0:1], v[128:129], v[2:3], v[0:1]
    v_pk_fma_f32 v[2:3], v[112:113], v[2:3], v[2:3]
    v_pk_fma_f32 v[0:1], v[114:115], v[0:1], v[0:1]
    v_pk_fma_f32 v[0:1], v[130:131], v[2:3], v[0:1]
    v_pk_fma_f32 v[2:3], v[114:115], v[2:3], v[2:3]
    v_pk_fma_f32 v[0:1], v[116:117], v[0:1], v[0:1]
    v_pk_fma_f32 v[0:1], v[132:133], v[2:3], v[0:1]
    v_pk_fma_f32 v[2:3], v[116:117], v[2:3], v[2:3]
    v_pk_fma_f32 v[0:1], v[118:119], v[0:1], v[0:1]
    v_pk_fma_f32 v[0:1], v[134:135], v[2:3], v[0:1]
    v_pk_fma_f32 v[2:3], v[118:119], v[2:3], v[2:3]
    s_waitcnt lgkmcnt(0)
    buffer_load_dwordx4 v[236:237], s[20:23], s72 idxen offen nt lds
    buffer_load_dwordx4 v[238:239], s[20:23], s51 idxen offen offset:1024 nt lds
    s_cbranch_scc1 HALF_1
    v_mfma_f32_16x16x32_bf16 v[104:107], v[72:75], v[152:155], v[136:139]
    s_add_u32 m0, s54, 6144
    v_rcp_f32 v2, v2
    v_mfma_f32_16x16x32_bf16 v[104:107], v[76:79], v[156:159], v[104:107]
    s_nop 0
    v_rcp_f32 v3, v3
    v_mfma_f32_16x16x32_bf16 v[108:111], v[80:83], v[152:155], v[140:143]
    s_nop 0
    v_fma_f32 v0, v0, v2, s44
    v_fma_f32 v1, v1, v3, s44
    v_mfma_f32_16x16x32_bf16 v[108:111], v[84:87], v[156:159], v[108:111]
    s_nop 0
    v_cvt_pk_bf16_f32 v0, v0, v1
    v_mfma_f32_16x16x32_bf16 v[112:115], v[88:91], v[152:155], v[144:147]
    v_exp_f32 v104, v104
    v_mfma_f32_16x16x32_bf16 v[112:115], v[92:95], v[156:159], v[112:115]
    v_exp_f32 v105, v105
    v_mfma_f32_16x16x32_bf16 v[116:119], v[96:99], v[152:155], v[148:151]
    s_cmp_eq_u32 s55, 0
    v_exp_f32 v106, v106
    v_mfma_f32_16x16x32_bf16 v[116:119], v[100:103], v[156:159], v[116:119]
    s_cbranch_scc1 PS_1
    v_exp_f32 v107, v107
    v_mfma_f32_16x16x32_bf16 v[196:199], v[160:163], v[164:167], v[196:199]
    v_exp_f32 v108, v108
    v_mfma_f32_16x16x32_bf16 v[200:203], v[160:163], v[168:171], v[200:203]
    v_exp_f32 v109, v109
    v_mfma_f32_16x16x32_bf16 v[204:207], v[160:163], v[172:175], v[204:207]
    v_exp_f32 v110, v110
    v_mfma_f32_16x16x32_bf16 v[208:211], v[160:163], v[176:179], v[208:211]
PR_1:
    s_waitcnt vmcnt(4)
    v_exp_f32 v111, v111
    ds_write_b32 v249, v0 offset:0
    ds_read_b64_tr_b16 v[160:161], v248 offset:0
    ds_read_b64_tr_b16 v[182:183], v242 offset:6144
    ds_read_b64_tr_b16 v[186:187], v243 offset:6144
    ds_read_b64_tr_b16 v[190:191], v244 offset:6144
    ds_read_b64_tr_b16 v[194:195], v245 offset:6144
    ds_read_u8 v236, v246 offset:16
    ds_read_u8 v238, v246 offset:24
    ds_read_b128 v[152:155], v240 offset:0
    ds_read_b128 v[156:159], v241 offset:0
    v_exp_f32 v112, v112
    v_exp_f32 v113, v113
    v_exp_f32 v114, v114
    v_exp_f32 v115, v115
    v_exp_f32 v116, v116
    v_exp_f32 v117, v117
    v_exp_f32 v118, v118
    v_exp_f32 v119, v119
    .p2align 3
    v_pk_add_f32 v[2:3], v[104:105], 1.0 op_sel_hi:[1,0]
    v_pk_fma_f32 v[0:1], v[120:121], v[106:107], v[120:121]
    v_pk_fma_f32 v[0:1], v[122:123], v[2:3], v[0:1]
    v_pk_fma_f32 v[2:3], v[106:107], v[2:3], v[2:3]
    v_pk_fma_f32 v[0:1], v[108:109], v[0:1], v[0:1]
    v_pk_fma_f32 v[0:1], v[124:125], v[2:3], v[0:1]
    v_pk_fma_f32 v[2:3], v[108:109], v[2:3], v[2:3]
    v_pk_fma_f32 v[0:1], v[110:111], v[0:1], v[0:1]
    v_pk_fma_f32 v[0:1], v[126:127], v[2:3], v[0:1]
    v_pk_fma_f32 v[2:3], v[110:111], v[2:3], v[2:3]
    v_pk_fma_f32 v[0:1], v[112:113], v[0:1], v[0:1]
    v_pk_fma_f32 v[0:1], v[128:129], v[2:3], v[0:1]
    v_pk_fma_f32 v[2:3], v[112:113], v[2:3], v[2:3]
    v_pk_fma_f32 v[0:1], v[114:115], v[0:1], v[0:1]
    v_pk_fma_f32 v[0:1], v[130:131], v[2:3], v[0:1]
    v_pk_fma_f32 v[2:3], v[114:115], v[2:3], v[2:3]
    v_pk_fma_f32 v[0:1], v[116:117], v[0:1], v[0:1]
    v_pk_fma_f32 v[0:1], v[132:133], v[2:3], v[0:1]
    v_pk_fma_f32 v[2:3], v[116:117], v[2:3], v[2:3]
    v_pk_fma_f32 v[0:1], v[118:119], v[0:1], v[0:1]
    v_pk_fma_f32 v[0:1], v[134:135], v[2:3], v[0:1]
    v_pk_fma_f32 v[2:3], v[118:119], v[2:3], v[2:3]
    s_cmp_lt_u32 s52, 805306368
    s_waitcnt lgkmcnt(0)
    buffer_load_dwordx4 v[236:237], s[20:23], s72 idxen offen nt lds
    buffer_load_dwordx4 v[238:239], s[20:23], s51 idxen offen offset:1024 nt lds
    s_cbranch_scc0 U0_0
    s_mov_b32 s73, 1
    s_call_b64 s[34:35], IEND1
    s_branch U0_0
LAST_0:
    s_mov_b32 s73, 0
    s_call_b64 s[34:35], IEND1
    s_branch U0_1
PS_0:
    s_mov_b32 s55, 1
    v_exp_f32 v107, v107
    v_exp_f32 v108, v108
    v_exp_f32 v109, v109
    v_exp_f32 v110, v110
    s_branch PR_0
HALF_0:
    ds_read_u8 v236, v246 offset:16
    ds_read_u8 v238, v246 offset:24
    s_cmp_eq_u32 s55, 0
    s_cbranch_scc1 HS_0
    v_mfma_f32_16x16x32_bf16 v[196:199], v[160:163], v[180:183], v[196:199]
    v_mfma_f32_16x16x32_bf16 v[200:203], v[160:163], v[184:187], v[200:203]
    v_mfma_f32_16x16x32_bf16 v[204:207], v[160:163], v[188:191], v[204:207]
    v_mfma_f32_16x16x32_bf16 v[208:211], v[160:163], v[192:195], v[208:211]
HS_0:
    v_rcp_f32 v2, v2
    v_rcp_f32 v3, v3
    v_fma_f32 v0, v0, v2, s44
    v_fma_f32 v1, v1, v3, s44
    v_cvt_pk_bf16_f32 v0, v0, v1
    s_add_u32 m0, s54, 2048
    s_mov_b32 s73, 0
    s_waitcnt vmcnt(4) lgkmcnt(0)
    buffer_load_dwordx4 v[236:237], s[20:23], s72 idxen offen nt lds
    buffer_load_dwordx4 v[238:239], s[20:23], s51 idxen offen offset:1024 nt lds
    v_mov_b64 v[162:163], 0
    ds_write_b32 v249, v0 offset:0
    ds_read_b64_tr_b16 v[160:161], v248 offset:0
    ds_read_b128 v[152:155], v240 offset:4096
    ds_read_b128 v[156:159], v241 offset:4096
    s_call_b64 s[34:35], IEND0
    s_branch U0_1
PS_1:
    s_mov_b32 s55, 1
    v_exp_f32 v107, v107
    v_exp_f32 v108, v108
    v_exp_f32 v109, v109
    v_exp_f32 v110, v110
    s_branch PR_1
HALF_1:
    ds_read_u8 v236, v246 offset:16
    ds_read_u8 v238, v246 offset:24
    s_cmp_eq_u32 s55, 0
    s_cbranch_scc1 HS_1
    v_mfma_f32_16x16x32_bf16 v[196:199], v[160:163], v[164:167], v[196:199]
    v_mfma_f32_16x16x32_bf16 v[200:203], v[160:163], v[168:171], v[200:203]
    v_mfma_f32_16x16x32_bf16 v[204:207], v[160:163], v[172:175], v[204:207]
    v_mfma_f32_16x16x32_bf16 v[208:211], v[160:163], v[176:179], v[208:211]
HS_1:
    v_rcp_f32 v2, v2
    v_rcp_f32 v3, v3
    v_fma_f32 v0, v0, v2, s44
    v_fma_f32 v1, v1, v3, s44
    v_cvt_pk_bf16_f32 v0, v0, v1
    s_add_u32 m0, s54, 6144
    s_mov_b32 s73, 1
    s_waitcnt vmcnt(4) lgkmcnt(0)
    buffer_load_dwordx4 v[236:237], s[20:23], s72 idxen offen nt lds
    buffer_load_dwordx4 v[238:239], s[20:23], s51 idxen offen offset:1024 nt lds
    v_mov_b64 v[162:163], 0
    ds_write_b32 v249, v0 offset:0
    ds_read_b64_tr_b16 v[160:161], v248 offset:0
    ds_read_b128 v[152:155], v240 offset:0
    ds_read_b128 v[156:159], v241 offset:0
    s_call_b64 s[34:35], IEND0
    s_branch U0_0
ADV_0:
    s_call_b64 s[32:33], PROD
    s_branch RET_0
ADV_1:
    s_call_b64 s[32:33], PROD
    s_branch RET_1
ADV_P:
    s_call_b64 s[32:33], PROD
    s_branch RET_P
BPF:
    s_and_b32 s57, s53, 63
    s_mul_i32 s57, s57, 528
    s_add_u32 s57, s57, 81920
    v_lshl_add_u32 v6, v252, 1, s57
    v_add_u32 v7, s57, v252
    ds_read_b128 v[104:107], v6 offset:0
    ds_read_b128 v[108:111], v6 offset:16
    ds_read_b128 v[212:215], v251 offset:0
    ds_read_b128 v[216:219], v251 offset:1024
    ds_read_b128 v[112:115], v6 offset:128
    ds_read_b128 v[116:119], v6 offset:144
    ds_read_b128 v[220:223], v251 offset:2048
    ds_read_b128 v[224:227], v251 offset:3072
    ds_read_b128 v[228:231], v251 offset:4096
    ds_read_b128 v[232:235], v251 offset:5120
    s_waitcnt lgkmcnt(2)
    .p2align 3
    v_pk_fma_f32 v[212:213], v[8:9], v[104:105], v[212:213]
    v_pk_fma_f32 v[214:215], v[10:11], v[106:107], v[214:215]
    v_pk_fma_f32 v[216:217], v[12:13], v[108:109], v[216:217]
    v_pk_fma_f32 v[218:219], v[14:15], v[110:111], v[218:219]
    v_pk_fma_f32 v[220:221], v[16:17], v[112:113], v[220:221]
    v_pk_fma_f32 v[222:223], v[18:19], v[114:115], v[222:223]
    v_pk_fma_f32 v[224:225], v[20:21], v[116:117], v[224:225]
    v_pk_fma_f32 v[226:227], v[22:23], v[118:119], v[226:227]
    v_cvt_pk_bf16_f32 v72, v212, v213
    v_cvt_pk_bf16_f32 v73, v214, v215
    v_cvt_pk_bf16_f32 v74, v216, v217
    v_cvt_pk_bf16_f32 v75, v218, v219
    v_cvt_pk_bf16_f32 v76, v220, v221
    v_cvt_pk_bf16_f32 v77, v222, v223
    v_cvt_pk_bf16_f32 v78, v224, v225
    v_cvt_pk_bf16_f32 v79, v226, v227
    ds_read_b128 v[212:215], v251 offset:6144
    ds_read_b128 v[216:219], v251 offset:7168
    ds_read_b128 v[220:223], v251 offset:8192
    ds_read_b128 v[224:227], v251 offset:9216
    s_branch BP_C
IEND0:
    s_and_b32 s57, s53, 63
    s_mul_i32 s57, s57, 528
    s_add_u32 s57, s57, 81920
    v_lshl_add_u32 v6, v252, 1, s57
    v_add_u32 v7, s57, v252
    ds_read_b128 v[104:107], v6 offset:0
    ds_read_b128 v[108:111], v6 offset:16
    ds_read_b128 v[212:215], v251 offset:0
    ds_read_b128 v[216:219], v251 offset:1024
    ds_read_b128 v[112:115], v6 offset:128
    ds_read_b128 v[116:119], v6 offset:144
    ds_read_b128 v[220:223], v251 offset:2048
    ds_read_b128 v[224:227], v251 offset:3072
    ds_read_b128 v[228:231], v251 offset:4096
    ds_read_b128 v[232:235], v251 offset:5120
    s_waitcnt lgkmcnt(2)
    s_branch IE_J
IEND1:
    s_and_b32 s57, s53, 63
    s_mul_i32 s57, s57, 528
    s_add_u32 s57, s57, 81920
    v_lshl_add_u32 v6, v252, 1, s57
    v_add_u32 v7, s57, v252
    ds_read_b128 v[104:107], v6 offset:0
    ds_read_b128 v[108:111], v6 offset:16
    ds_read_b128 v[212:215], v251 offset:0
    ds_read_b128 v[216:219], v251 offset:1024
    ds_read_b128 v[112:115], v6 offset:128
    ds_read_b128 v[116:119], v6 offset:144
    ds_read_b128 v[220:223], v251 offset:2048
    ds_read_b128 v[224:227], v251 offset:3072
    ds_read_b128 v[228:231], v251 offset:4096
    ds_read_b128 v[232:235], v251 offset:5120
    v_rcp_f32 v2, v2
    v_rcp_f32 v3, v3
    v_fma_f32 v0, v0, v2, s44
    v_fma_f32 v1, v1, v3, s44
    v_cvt_pk_bf16_f32 v0, v0, v1
    ds_write_b32 v249, v0 offset:256
    ds_read_b64_tr_b16 v[162:163], v248 offset:256
    s_waitcnt lgkmcnt(4)
IE_J:
    s_cmp_lg_u32 s73, 0
    .p2align 3
    v_pk_fma_f32 v[212:213], v[8:9], v[104:105], v[212:213]
    v_pk_fma_f32 v[214:215], v[10:11], v[106:107], v[214:215]
    v_pk_fma_f32 v[216:217], v[12:13], v[108:109], v[216:217]
    v_pk_fma_f32 v[218:219], v[14:15], v[110:111], v[218:219]
    v_pk_fma_f32 v[220:221], v[16:17], v[112:113], v[220:221]
    v_pk_fma_f32 v[222:223], v[18:19], v[114:115], v[222:223]
    v_pk_fma_f32 v[224:225], v[20:21], v[116:117], v[224:225]
    v_pk_fma_f32 v[226:227], v[22:23], v[118:119], v[226:227]
    s_waitcnt lgkmcnt(0)
    s_cbranch_scc1 IK1
    v_mfma_f32_16x16x32_bf16 v[196:199], v[160:163], v[164:167], v[196:199]
    v_cvt_pk_bf16_f32 v72, v212, v213
    v_cvt_pk_bf16_f32 v73, v214, v215
    v_mfma_f32_16x16x32_bf16 v[200:203], v[160:163], v[168:171], v[200:203]
    v_cvt_pk_bf16_f32 v74, v216, v217
    v_cvt_pk_bf16_f32 v75, v218, v219
    v_mfma_f32_16x16x32_bf16 v[204:207], v[160:163], v[172:175], v[204:207]
    v_cvt_pk_bf16_f32 v76, v220, v221
    v_cvt_pk_bf16_f32 v77, v222, v223
    v_mfma_f32_16x16x32_bf16 v[208:211], v[160:163], v[176:179], v[208:211]
    v_cvt_pk_bf16_f32 v78, v224, v225
    v_cvt_pk_bf16_f32 v79, v226, v227
IK_J:
    ds_read_b128 v[212:215], v251 offset:6144
    ds_read_b128 v[216:219], v251 offset:7168
    ds_read_b128 v[220:223], v251 offset:8192
    ds_read_b128 v[224:227], v251 offset:9216
    s_and_b32 s56, s52, 0x7f00
    s_mov_b32 exec_hi, 0
    .p2align 3
    v_pk_add_f32 v[196:197], v[196:197], v[198:199]
    v_pk_add_f32 v[200:201], v[200:201], v[202:203]
    v_pk_add_f32 v[204:205], v[204:205], v[206:207]
    v_pk_add_f32 v[208:209], v[208:209], v[210:211]
    v_add_f32 v0, v196, v197
    v_add_f32 v2, v200, v201
    v_add_f32 v1, v204, v205
    v_add_f32 v3, v208, v209
    v_add_u32 v5, s56, v250
    v_permlane16_swap_b32 v0, v2
    v_permlane16_swap_b32 v1, v3
    v_pk_add_f32 v[0:1], v[0:1], v[2:3]
    v_pk_mul_f32 v[0:1], v[0:1], s[46:47] op_sel_hi:[1,0]
    v_add_f32 v4, v0, v1
    v_cmp_class_f32_e64 vcc, v4, s45
    s_bitcmp1_b32 s52, 7
    s_cbranch_scc1 SLOW
    s_cbranch_vccnz SLOW
    ds_write2_b32 v5, v0, v1 offset0:0 offset1:32
    s_mov_b32 exec_hi, -1
    s_bitcmp1_b32 s53, 6
    s_cbranch_scc1 L_DONE
BP_C:
    v_mov_b64 v[196:197], 0
    v_mov_b64 v[198:199], 0
    v_mov_b64 v[200:201], 0
    v_mov_b64 v[202:203], 0
    v_mov_b64 v[204:205], 0
    v_mov_b64 v[206:207], 0
    v_mov_b64 v[208:209], 0
    v_mov_b64 v[210:211], 0
    s_waitcnt lgkmcnt(4)
    .p2align 3
    v_pk_fma_f32 v[228:229], v[24:25], v[104:105], v[228:229]
    v_pk_fma_f32 v[230:231], v[26:27], v[106:107], v[230:231]
    v_pk_fma_f32 v[232:233], v[28:29], v[108:109], v[232:233]
    v_pk_fma_f32 v[234:235], v[30:31], v[110:111], v[234:235]
    v_cvt_pk_bf16_f32 v80, v228, v229
    v_cvt_pk_bf16_f32 v81, v230, v231
    v_cvt_pk_bf16_f32 v82, v232, v233
    v_cvt_pk_bf16_f32 v83, v234, v235
    ds_read_b128 v[228:231], v251 offset:10240
    ds_read_b128 v[232:235], v251 offset:11264
    s_waitcnt lgkmcnt(4)
    .p2align 3
    v_pk_fma_f32 v[212:213], v[32:33], v[112:113], v[212:213]
    v_pk_fma_f32 v[214:215], v[34:35], v[114:115], v[214:215]
    v_pk_fma_f32 v[216:217], v[36:37], v[116:117], v[216:217]
    v_pk_fma_f32 v[218:219], v[38:39], v[118:119], v[218:219]
    v_cvt_pk_bf16_f32 v84, v212, v213
    v_cvt_pk_bf16_f32 v85, v214, v215
    v_cvt_pk_bf16_f32 v86, v216, v217
    v_cvt_pk_bf16_f32 v87, v218, v219
    ds_read_b128 v[212:215], v251 offset:12288
    ds_read_b128 v[216:219], v251 offset:13312
    s_waitcnt lgkmcnt(4)
    .p2align 3
    v_pk_fma_f32 v[220:221], v[40:41], v[104:105], v[220:221]
    v_pk_fma_f32 v[222:223], v[42:43], v[106:107], v[222:223]
    v_pk_fma_f32 v[224:225], v[44:45], v[108:109], v[224:225]
    v_pk_fma_f32 v[226:227], v[46:47], v[110:111], v[226:227]
    v_cvt_pk_bf16_f32 v88, v220, v221
    v_cvt_pk_bf16_f32 v89, v222, v223
    v_cvt_pk_bf16_f32 v90, v224, v225
    v_cvt_pk_bf16_f32 v91, v226, v227
    ds_read_b128 v[220:223], v251 offset:14336
    ds_read_b128 v[224:227], v251 offset:15360
    ds_read_b128 v[136:139], v7 offset:256
    ds_read_b128 v[140:143], v7 offset:320
    ds_read_b128 v[144:147], v7 offset:384
    ds_read_b128 v[148:151], v7 offset:448
    s_waitcnt lgkmcnt(8)
    .p2align 3
    v_pk_fma_f32 v[228:229], v[48:49], v[112:113], v[228:229]
    v_pk_fma_f32 v[230:231], v[50:51], v[114:115], v[230:231]
    v_pk_fma_f32 v[232:233], v[52:53], v[116:117], v[232:233]
    v_pk_fma_f32 v[234:235], v[54:55], v[118:119], v[234:235]
    v_cvt_pk_bf16_f32 v92, v228, v229
    v_cvt_pk_bf16_f32 v93, v230, v231
    v_cvt_pk_bf16_f32 v94, v232, v233
    v_cvt_pk_bf16_f32 v95, v234, v235
    s_waitcnt lgkmcnt(6)
    .p2align 3
    v_pk_fma_f32 v[212:213], v[56:57], v[104:105], v[212:213]
    v_pk_fma_f32 v[214:215], v[58:59], v[106:107], v[214:215]
    v_pk_fma_f32 v[216:217], v[60:61], v[108:109], v[216:217]
    v_pk_fma_f32 v[218:219], v[62:63], v[110:111], v[218:219]
    v_cvt_pk_bf16_f32 v96, v212, v213
    v_cvt_pk_bf16_f32 v97, v214, v215
    v_cvt_pk_bf16_f32 v98, v216, v217
    v_cvt_pk_bf16_f32 v99, v218, v219
    s_waitcnt lgkmcnt(4)
    .p2align 3
    v_pk_fma_f32 v[220:221], v[64:65], v[112:113], v[220:221]
    v_pk_fma_f32 v[222:223], v[66:67], v[114:115], v[222:223]
    v_pk_fma_f32 v[224:225], v[68:69], v[116:117], v[224:225]
    v_pk_fma_f32 v[226:227], v[70:71], v[118:119], v[226:227]
    v_cvt_pk_bf16_f32 v100, v220, v221
    v_cvt_pk_bf16_f32 v101, v222, v223
    v_cvt_pk_bf16_f32 v102, v224, v225
    v_cvt_pk_bf16_f32 v103, v226, v227
    s_mov_b32 s55, 0
    s_waitcnt lgkmcnt(0)
    s_setpc_b64 s[34:35]
IK1:
    v_mfma_f32_16x16x32_bf16 v[196:199], v[160:163], v[180:183], v[196:199]
    v_cvt_pk_bf16_f32 v72, v212, v213
    v_cvt_pk_bf16_f32 v73, v214, v215
    v_mfma_f32_16x16x32_bf16 v[200:203], v[160:163], v[184:187], v[200:203]
    v_cvt_pk_bf16_f32 v74, v216, v217
    v_cvt_pk_bf16_f32 v75, v218, v219
    v_mfma_f32_16x16x32_bf16 v[204:207], v[160:163], v[188:191], v[204:207]
    v_cvt_pk_bf16_f32 v76, v220, v221
    v_cvt_pk_bf16_f32 v77, v222, v223
    v_mfma_f32_16x16x32_bf16 v[208:211], v[160:163], v[192:195], v[208:211]
    v_cvt_pk_bf16_f32 v78, v224, v225
    v_cvt_pk_bf16_f32 v79, v226, v227
    s_branch IK_J
PROD:
    s_cmp_lg_u32 s68, 0
    s_cbranch_scc1 PSEC
    s_bitcmp1_b32 s50, 6
    s_cbranch_scc1 PSET
    v_mov_b32 v6, 132624
    s_mov_b64 exec, 1
PDRAW:
    v_mov_b32 v7, 4
    ds_add_rtn_u32 v7, v6, v7
    s_waitcnt lgkmcnt(0)
PREAD:
    ds_read_b32 v5, v7
    s_waitcnt lgkmcnt(0)
    v_readfirstlane_b32 s50, v5
    s_cmp_lt_u32 s50, 268435456
    s_cbranch_scc1 PODD
    s_mov_b64 exec, -1
PSET:
    s_and_b32 s56, s50, 63
    s_bfe_u32 s57, s50, 0x40014
    s_lshl4_add_u32 s57, s56, s57
    s_mul_i32 s51, s56, 25600
    v_lshl_add_u32 v246, s57, 4, v247
    s_add_u32 s51, s51, s49
    s_add_u32 s72, s51, 1024
    s_setpc_b64 s[32:33]
L_DONE:
    s_lshl_b32 s56, s48, 11
    s_add_u32 s56, s56, 133632
    v_lshl_add_u32 v0, v251, 1, s56
    s_lshl_b32 s56, s48, 10
    s_cmp_lt_u32 s48, 8
    s_waitcnt lgkmcnt(0)
    s_barrier
    ds_read_b128 v[104:107], v0 offset:0
    ds_read_b128 v[108:111], v0 offset:16
    s_cbranch_scc1 L_ST
    ds_read_b128 v[112:115], v0 offset:0
    ds_read_b128 v[116:119], v0 offset:16
    s_waitcnt lgkmcnt(0)
    v_pk_add_f32 v[104:105], v[104:105], v[112:113]
    v_pk_add_f32 v[106:107], v[106:107], v[114:115]
    v_pk_add_f32 v[108:109], v[108:109], v[116:117]
    v_pk_add_f32 v[110:111], v[110:111], v[118:119]
L_ST:
    s_waitcnt lgkmcnt(0)
    v_cvt_pk_bf16_f32 v152, v104, v105
    v_cvt_pk_bf16_f32 v153, v106, v107
    v_cvt_pk_bf16_f32 v154, v108, v109
    v_cvt_pk_bf16_f32 v155, v110, v111
    buffer_store_dwordx4 v[152:155], v251, s[28:31], s56 offen nt
L_FIN:
    s_endpgm
    .p2align 3
CMP:
    v_cmp_ne_u16_e64 s[4:5], 0, v180
    v_cmp_lt_u32_e64 s[6:7], s62, v180
    v_cmp_ne_u16_e64 s[8:9], 0, v181
    v_cmp_lt_u32_e64 s[10:11], s62, v181
    v_cmp_ne_u16_e64 s[12:13], 0, v182
    v_cmp_lt_u32_e64 s[14:15], s62, v182
    v_cmp_ne_u16_e64 s[16:17], 0, v183
    v_cmp_lt_u32_e64 s[18:19], s62, v183
    v_lshrrev_b32 v7, 1, v251
    v_add_u32 v7, s56, v7
    v_mov_b64 v[4:5], -1
    ds_write_b64 v7, v[4:5]
    v_mbcnt_lo_u32_b32 v6, s4, 0
    v_mbcnt_hi_u32_b32 v6, s5, v6
    v_mbcnt_lo_u32_b32 v6, s6, v6
    v_mbcnt_hi_u32_b32 v6, s7, v6
    v_mbcnt_lo_u32_b32 v6, s8, v6
    v_mbcnt_hi_u32_b32 v6, s9, v6
    v_mbcnt_lo_u32_b32 v6, s10, v6
    v_mbcnt_hi_u32_b32 v6, s11, v6
    v_mbcnt_lo_u32_b32 v6, s12, v6
    v_mbcnt_hi_u32_b32 v6, s13, v6
    v_mbcnt_lo_u32_b32 v6, s14, v6
    v_mbcnt_hi_u32_b32 v6, s15, v6
    v_mbcnt_lo_u32_b32 v6, s16, v6
    v_mbcnt_hi_u32_b32 v6, s17, v6
    v_mbcnt_lo_u32_b32 v6, s18, v6
    v_mbcnt_hi_u32_b32 v6, s19, v6
    s_mov_b64 s[64:65], 0
    v_readlane_b32 s59, v6, 31
    v_readlane_b32 s58, v6, 63
    v_add_u32 v6, s56, v6
    s_mov_b32 exec_lo, 0
    s_sub_u32 s57, 256, s59
    v_add_u32 v6, s57, v6
    s_sub_u32 s58, s58, s59
    s_mov_b64 exec, s[4:5]
    ds_write_b8 v6, v184
    v_add_u32 v6, 1, v6
    s_mov_b64 exec, s[6:7]
    ds_write_b8_d16_hi v6, v184
    v_add_u32 v6, 1, v6
    s_mov_b64 exec, s[8:9]
    ds_write_b8 v6, v185
    v_add_u32 v6, 1, v6
    s_mov_b64 exec, s[10:11]
    ds_write_b8_d16_hi v6, v185
    v_add_u32 v6, 1, v6
    s_mov_b64 exec, s[12:13]
    ds_write_b8 v6, v186
    v_add_u32 v6, 1, v6
    s_mov_b64 exec, s[14:15]
    ds_write_b8_d16_hi v6, v186
    v_add_u32 v6, 1, v6
    s_mov_b64 exec, s[16:17]
    ds_write_b8 v6, v187
    v_add_u32 v6, 1, v6
    s_mov_b64 exec, s[18:19]
    ds_write_b8_d16_hi v6, v187
    s_mov_b64 exec, -1
    s_setpc_b64 s[36:37]
CHK:
    v_cmp_eq_u16_e64 s[66:67], s61, v180
    s_xor_b64 s[66:67], s[66:67], s[4:5]
    s_or_b64 s[64:65], s[64:65], s[66:67]
    v_cmp_eq_u16_sdwa s[66:67], v180, s61 src0_sel:WORD_1 src1_sel:WORD_0
    s_xor_b64 s[66:67], s[66:67], s[6:7]
    s_or_b64 s[64:65], s[64:65], s[66:67]
    v_cmp_eq_u16_e64 s[66:67], s61, v181
    s_xor_b64 s[66:67], s[66:67], s[8:9]
    s_or_b64 s[64:65], s[64:65], s[66:67]
    v_cmp_eq_u16_sdwa s[66:67], v181, s61 src0_sel:WORD_1 src1_sel:WORD_0
    s_xor_b64 s[66:67], s[66:67], s[10:11]
    s_or_b64 s[64:65], s[64:65], s[66:67]
    v_cmp_eq_u16_e64 s[66:67], s61, v182
    s_xor_b64 s[66:67], s[66:67], s[12:13]
    s_or_b64 s[64:65], s[64:65], s[66:67]
    v_cmp_eq_u16_sdwa s[66:67], v182, s61 src0_sel:WORD_1 src1_sel:WORD_0
    s_xor_b64 s[66:67], s[66:67], s[14:15]
    s_or_b64 s[64:65], s[64:65], s[66:67]
    v_cmp_eq_u16_e64 s[66:67], s61, v183
    s_xor_b64 s[66:67], s[66:67], s[16:17]
    s_or_b64 s[64:65], s[64:65], s[66:67]
    v_cmp_eq_u16_sdwa s[66:67], v183, s61 src0_sel:WORD_1 src1_sel:WORD_0
    s_xor_b64 s[66:67], s[66:67], s[18:19]
    s_or_b64 s[64:65], s[64:65], s[66:67]
    s_min_u32 s64, s64, 1
    s_min_u32 s65, s65, 1
    s_lshl_b64 s[64:65], s[64:65], 15
    s_or_b32 s57, s59, s64
    s_or_b32 s58, s58, s65
    s_setpc_b64 s[36:37]
LATE:
    s_lshl_b32 s56, s70, 8
    s_add_u32 s56, s56, 115712
    s_waitcnt vmcnt(4)
    v_mov_b64 v[180:181], v[212:213]
    v_mov_b64 v[182:183], v[214:215]
    s_call_b64 s[36:37], CMP
    s_call_b64 s[36:37], CHK
    v_writelane_b32 v188, s57, 0
    v_writelane_b32 v188, s58, 1
    s_cmp_le_u32 s47, 1
    s_cbranch_scc1 LATE_D
    s_add_u32 s56, s56, 512
    v_mov_b64 v[180:181], v[216:217]
    v_mov_b64 v[182:183], v[218:219]
    s_call_b64 s[36:37], CMP
    s_call_b64 s[36:37], CHK
    v_writelane_b32 v188, s57, 2
    v_writelane_b32 v188, s58, 3
    s_cmp_le_u32 s47, 2
    s_cbranch_scc1 LATE_D
    s_add_u32 s56, s56, 512
    v_mov_b64 v[180:181], v[220:221]
    v_mov_b64 v[182:183], v[222:223]
    s_call_b64 s[36:37], CMP
    s_call_b64 s[36:37], CHK
    v_writelane_b32 v188, s57, 4
    v_writelane_b32 v188, s58, 5
    s_cmp_le_u32 s47, 3
    s_cbranch_scc1 LATE_D
    s_add_u32 s56, s56, 512
    v_mov_b64 v[180:181], v[224:225]
    v_mov_b64 v[182:183], v[226:227]
    s_call_b64 s[36:37], CMP
    s_call_b64 s[36:37], CHK
    v_writelane_b32 v188, s57, 6
    v_writelane_b32 v188, s58, 7
    s_cmp_le_u32 s47, 4
    s_cbranch_scc1 LATE_D
    s_add_u32 s56, s56, 512
    v_mov_b64 v[180:181], v[228:229]
    v_mov_b64 v[182:183], v[230:231]
    s_call_b64 s[36:37], CMP
    s_call_b64 s[36:37], CHK
    v_writelane_b32 v188, s57, 8
    v_writelane_b32 v188, s58, 9
    s_cmp_le_u32 s47, 5
    s_cbranch_scc1 LATE_D
    s_add_u32 s56, s56, 512
    v_mov_b64 v[180:181], v[232:233]
    v_mov_b64 v[182:183], v[234:235]
    s_call_b64 s[36:37], CMP
    s_call_b64 s[36:37], CHK
    v_writelane_b32 v188, s57, 10
    v_writelane_b32 v188, s58, 11
LATE_D:
    v_lshrrev_b32 v190, 4, v251
    v_add_u32 v190, s70, v190
    s_lshl_b32 s56, s47, 1
    s_bfm_b64 s[66:67], s56, 0
    v_and_b32 v191, 0xff, v188
    v_max_u32 v191, 1, v191
    v_add_u32 v191, 15, v191
    v_lshrrev_b32 v191, 4, v191
    v_add_u32 v192, 2, v191
    v_cmp_gt_u32 vcc, 64, v190
    v_lshrrev_b32 v192, 2, v192
    v_lshlrev_b32 v192, 1, v192
    v_cndmask_b32 v192, v192, v191, vcc
    v_lshrrev_b32 v193, 8, v188
    v_mul_u32_u24 v194, 0x101, v190
    v_and_or_b32 v193, v193, s61, v194
    v_mul_u32_u24 v194, 0x11, v192
    v_lshl_or_b32 v194, v194, 24, v193
    v_sub_u32 v191, v191, v192
    v_mul_u32_u24 v191, 0x110, v191
    v_or_b32 v191, v191, v192
    v_add_u32 v193, 0, v193
    v_lshl_or_b32 v195, v191, 20, v193
    v_lshlrev_b32 v191, 2, v190
    v_add_u32 v191, 133120, v191
    v_lshlrev_b32 v192, 3, v190
    v_add_u32 v192, 132864, v192
    s_and_b64 exec, s[66:67], vcc
    ds_write_b32 v191, v194
    s_andn2_b64 exec, s[66:67], vcc
    ds_write_b64 v192, v[194:195]
    s_mov_b64 exec, -1
    s_branch LATE_R
PSEC:
    s_mov_b32 s50, s68
    s_mov_b32 s68, 0
    s_branch PSET
PODD:
    s_cmp_lg_u32 s50, 0
    s_cbranch_scc1 PDRAW
    s_sleep 2
    s_branch PREAD
SLOW:
    s_mov_b64 exec, -1
    s_waitcnt lgkmcnt(0)
    s_mov_b32 s74, s53
    s_mov_b64 s[76:77], s[34:35]
    s_mov_b32 s53, s52
    s_call_b64 s[34:35], BPF
    s_mov_b32 s53, s74
    s_mov_b64 s[34:35], s[76:77]
    s_and_b32 s56, s52, 63
    s_bfe_u32 s57, s52, 0x40014
    s_bfe_u32 s59, s52, 0x40018
    s_lshl4_add_u32 s57, s56, s57
    s_lshl_b32 s57, s57, 4
    s_add_u32 s57, s57, 115712
    v_bfe_u32 v212, v251, 4, 4
    v_add_u32 v212, s57, v212
    v_mov_b32 v215, v252
    s_mul_i32 s57, s56, 25600
    s_add_u32 s57, s57, s49
    s_mul_i32 s58, s56, 400
SLOW_L:
    ds_read_u8 v214, v212
    v_add_u32 v212, 16, v212
    s_waitcnt lgkmcnt(0)
    v_lshlrev_b32 v213, 1, v214
    buffer_load_dwordx4 v[216:219], v[214:215], s[20:23], s57 idxen offen offset:1024
    buffer_load_dwordx4 v[220:223], v[214:215], s[20:23], s57 idxen offen offset:1088
    buffer_load_ushort v213, v213, s[24:27], s58 offen
    v_cmp_gt_u32 vcc, 200, v214
    s_waitcnt vmcnt(0)
    v_mfma_f32_16x16x32_bf16 v[104:107], v[72:75], v[216:219], v[136:139]
    v_mfma_f32_16x16x32_bf16 v[104:107], v[76:79], v[220:223], v[104:107]
    v_mfma_f32_16x16x32_bf16 v[108:111], v[80:83], v[216:219], v[140:143]
    v_mfma_f32_16x16x32_bf16 v[108:111], v[84:87], v[220:223], v[108:111]
    v_mfma_f32_16x16x32_bf16 v[112:115], v[88:91], v[216:219], v[144:147]
    v_mfma_f32_16x16x32_bf16 v[112:115], v[92:95], v[220:223], v[112:115]
    v_mfma_f32_16x16x32_bf16 v[116:119], v[96:99], v[216:219], v[148:151]
    v_mfma_f32_16x16x32_bf16 v[116:119], v[100:103], v[220:223], v[116:119]
    v_lshlrev_b32 v213, 16, v213
    v_cndmask_b32 v213, 0, v213, vcc
    s_nop 7
    v_exp_f32 v104, v104
    v_exp_f32 v105, v105
    v_exp_f32 v106, v106
    v_exp_f32 v107, v107
    v_exp_f32 v108, v108
    v_exp_f32 v109, v109
    v_exp_f32 v110, v110
    v_exp_f32 v111, v111
    v_exp_f32 v112, v112
    v_exp_f32 v113, v113
    v_exp_f32 v114, v114
    v_exp_f32 v115, v115
    v_exp_f32 v116, v116
    v_exp_f32 v117, v117
    v_exp_f32 v118, v118
    v_exp_f32 v119, v119
    v_add_f32 v104, 1.0, v104
    v_add_f32 v105, 1.0, v105
    v_add_f32 v106, 1.0, v106
    v_add_f32 v107, 1.0, v107
    v_add_f32 v108, 1.0, v108
    v_add_f32 v109, 1.0, v109
    v_add_f32 v110, 1.0, v110
    v_add_f32 v111, 1.0, v111
    v_add_f32 v112, 1.0, v112
    v_add_f32 v113, 1.0, v113
    v_add_f32 v114, 1.0, v114
    v_add_f32 v115, 1.0, v115
    v_add_f32 v116, 1.0, v116
    v_add_f32 v117, 1.0, v117
    v_add_f32 v118, 1.0, v118
    v_add_f32 v119, 1.0, v119
    v_rcp_f32 v104, v104
    v_rcp_f32 v105, v105
    v_rcp_f32 v106, v106
    v_rcp_f32 v107, v107
    v_rcp_f32 v108, v108
    v_rcp_f32 v109, v109
    v_rcp_f32 v110, v110
    v_rcp_f32 v111, v111
    v_rcp_f32 v112, v112
    v_rcp_f32 v113, v113
    v_rcp_f32 v114, v114
    v_rcp_f32 v115, v115
    v_rcp_f32 v116, v116
    v_rcp_f32 v117, v117
    v_rcp_f32 v118, v118
    v_rcp_f32 v119, v119
    v_mul_f32 v0, v104, v120
    v_fmac_f32 v0, v105, v121
    v_fmac_f32 v0, v106, v122
    v_fmac_f32 v0, v107, v123
    v_fmac_f32 v0, v108, v124
    v_fmac_f32 v0, v109, v125
    v_fmac_f32 v0, v110, v126
    v_fmac_f32 v0, v111, v127
    v_fmac_f32 v0, v112, v128
    v_fmac_f32 v0, v113, v129
    v_fmac_f32 v0, v114, v130
    v_fmac_f32 v0, v115, v131
    v_fmac_f32 v0, v116, v132
    v_fmac_f32 v0, v117, v133
    v_fmac_f32 v0, v118, v134
    v_fmac_f32 v0, v119, v135
    v_mov_b32 v1, v0
    s_nop 1
    v_permlane32_swap_b32 v0, v1
    v_add_f32 v0, v0, v1
    v_mov_b32 v1, v0
    s_nop 1
    v_permlane16_swap_b32 v0, v1
    v_add_f32 v0, v0, v1
    v_mul_f32 v0, s46, v0
    v_add_f32 v0, s63, v0
    v_mul_f32 v0, v0, v213
    v_lshlrev_b32 v1, 16, v216
    v_and_b32 v2, 0xffff0000, v216
    v_fmac_f32 v196, v0, v1
    v_fmac_f32 v197, v0, v2
    v_lshlrev_b32 v1, 16, v217
    v_and_b32 v2, 0xffff0000, v217
    v_fmac_f32 v198, v0, v1
    v_fmac_f32 v199, v0, v2
    v_lshlrev_b32 v1, 16, v218
    v_and_b32 v2, 0xffff0000, v218
    v_fmac_f32 v200, v0, v1
    v_fmac_f32 v201, v0, v2
    v_lshlrev_b32 v1, 16, v219
    v_and_b32 v2, 0xffff0000, v219
    v_fmac_f32 v202, v0, v1
    v_fmac_f32 v203, v0, v2
    v_lshlrev_b32 v1, 16, v220
    v_and_b32 v2, 0xffff0000, v220
    v_fmac_f32 v204, v0, v1
    v_fmac_f32 v205, v0, v2
    v_lshlrev_b32 v1, 16, v221
    v_and_b32 v2, 0xffff0000, v221
    v_fmac_f32 v206, v0, v1
    v_fmac_f32 v207, v0, v2
    v_lshlrev_b32 v1, 16, v222
    v_and_b32 v2, 0xffff0000, v222
    v_fmac_f32 v208, v0, v1
    v_fmac_f32 v209, v0, v2
    v_lshlrev_b32 v1, 16, v223
    v_and_b32 v2, 0xffff0000, v223
    v_fmac_f32 v210, v0, v1
    v_fmac_f32 v211, v0, v2
    s_sub_u32 s59, s59, 1
    s_cmp_lg_u32 s59, 0
    s_cbranch_scc1 SLOW_L
    s_and_b32 s56, s52, 0x7f00
    s_add_u32 s56, s56, 133632
    v_lshl_add_u32 v0, v252, 1, s56
    ds_add_f32 v0, v196 offset:0
    ds_add_f32 v0, v197 offset:4
    ds_add_f32 v0, v198 offset:8
    ds_add_f32 v0, v199 offset:12
    ds_add_f32 v0, v200 offset:16
    ds_add_f32 v0, v201 offset:20
    ds_add_f32 v0, v202 offset:24
    ds_add_f32 v0, v203 offset:28
    ds_add_f32 v0, v204 offset:128
    ds_add_f32 v0, v205 offset:132
    ds_add_f32 v0, v206 offset:136
    ds_add_f32 v0, v207 offset:140
    ds_add_f32 v0, v208 offset:144
    ds_add_f32 v0, v209 offset:148
    ds_add_f32 v0, v210 offset:152
    ds_add_f32 v0, v211 offset:156
    s_waitcnt lgkmcnt(0)
    s_bitcmp1_b32 s53, 6
    s_cbranch_scc1 L_DONE
    s_branch BPF
L_END:
    s_endpgm
.section .rodata,"a"
.p2align 6
.amdhsa_kernel standalone__sequential_behavior_din__recsys_kernel
  .amdhsa_next_free_vgpr 253
  .amdhsa_next_free_sgpr 78
  .amdhsa_accum_offset 256
  .amdhsa_group_segment_fixed_size 0
  .amdhsa_kernarg_size 80
  .amdhsa_user_sgpr_count 2
  .amdhsa_user_sgpr_kernarg_segment_ptr 1
  .amdhsa_system_sgpr_workgroup_id_x 1
.end_amdhsa_kernel
```

```asm
; @launch grid=(256,1,1) block=(512,1,1) lds=153856
.amdgcn_target "amdgcn-amd-amdhsa--gfx950"
.text
.globl standalone__sequential_behavior_din__recsys_kernel
.p2align 8
.type standalone__sequential_behavior_din__recsys_kernel,@function
standalone__sequential_behavior_din__recsys_kernel:
    s_cmpk_ge_u32 s2, 256
    s_cbranch_scc1 L_END
    s_load_dwordx16 s[4:19], s[0:1], 0
    s_setprio 3
    v_lshrrev_b32 v1, 6, v0
    v_and_b32 v176, 63, v0
    v_readfirstlane_b32 s48, v1
    s_getpc_b64 s[40:41]
L_PC:
    s_cmp_lt_u32 s48, 5
    s_cbranch_scc1 P_NC
    s_mov_b32 s42, L_END-L_PC
    s_mov_b32 s43, 0x20000
    v_subrev_u32 v150, 320, v0
    v_lshlrev_b32 v150, 6, v150
    buffer_load_dword v150, v150, s[40:43], 0 offen
P_NC:
    v_and_b32 v2, 31, v0
    v_bfe_u32 v3, v0, 5, 1
    v_cmp_gt_u32 vcc, 25, v2
    v_mul_u32_u24 v4, 400, v3
    v_lshl_add_u32 v179, v2, 4, v4
    v_bfrev_b32 v4, 8
    v_cndmask_b32 v179, v4, v179, vcc
    s_movk_i32 s26, 25600
    s_mul_i32 s57, s2, s26
    s_mul_i32 s71, s48, 800
    s_mov_b32 s27, 0x20000
    s_lshl_b32 s74, s48, 12
    s_lshl_b32 s53, s2, 13
    v_lshlrev_b32 v251, 4, v176
    v_lshlrev_b32 v120, 1, v176
    v_and_b32 v120, 32, v120
    v_xor_b32 v120, v120, v251
    v_xor_b32 v121, 64, v120
    s_mov_b32 s38, 32768
    s_mov_b32 s39, s27
    s_lshl_b32 s58, s48, 10
    s_movk_i32 s34, 8192
    s_mov_b32 s35, s27
    s_add_u32 m0, s74, 121088
    v_and_b32 v178, 15, v176
    v_lshrrev_b32 v177, 4, v176
    v_lshlrev_b32 v252, 4, v177
    v_mul_u32_u24 v208, 0x80008, v2
    v_lshrrev_b32 v238, 3, v176
    v_add_u32 v208, 0x10000, v208
    v_cmp_gt_u32 vcc, 32, v176
    s_waitcnt lgkmcnt(0)
    s_add_u32 s24, s8, s57
    s_addc_u32 s25, s9, 0
    s_mov_b64 s[36:37], s[10:11]
    buffer_load_dwordx4 v[204:207], v179, s[24:27], s71 offen offset:0 nt
    s_setprio 0
    s_add_u32 s32, s4, s53
    s_addc_u32 s33, s5, 0
    s_load_dword s63, s[16:17], 0
    s_cmp_lg_u32 s48, 0
    s_cbranch_scc1 P_LJ
    v_mov_b32 v146, s12
    v_mov_b32 v147, s13
    v_mov_b32 v148, s14
    v_mov_b32 v149, s15
    v_lshlrev_b32 v4, 2, v2
    v_cndmask_b32 v146, v146, v148, vcc
    v_cndmask_b32 v147, v147, v149, vcc
    v_add_co_u32 v146, vcc, v146, v4
    s_nop 1
    v_addc_co_u32 v147, vcc, 0, v147, vcc
    global_load_dword v146, v[146:147], off
P_LJ:
    buffer_load_dwordx4 v[124:127], v251, s[32:35], s58 offen nt
    buffer_load_dwordx4 v120, s[36:39], s74 offen offset:0 lds
    buffer_load_dwordx4 v121, s[36:39], s74 offen offset:1024 lds
    s_lshl1_add_u32 s54, s74, 17664
    s_mul_i32 s49, s2, 1638400
    s_lshl_b32 s57, s48, 9
    v_add_u32 v247, 116992, v238
    v_add_u32 v246, s57, v247
    s_add_u32 s56, s57, 116992
    v_add_u32 v209, 0x20002, v208
    v_add_u32 v210, 0x40004, v208
    v_add_u32 v211, 0x60006, v208
    s_sub_u32 s20, s6, 1024
    s_subb_u32 s21, s7, 0
    s_or_b32 s21, s21, 0x800000
    s_movk_i32 s22, 200
    s_mov_b32 s23, s27
    s_movk_i32 s61, 0x3f80
    v_lshlrev_b32 v250, 2, v176
    v_bfrev_b32 v2, v238
    v_lshrrev_b32 v2, 28, v2
    v_and_b32 v2, 6, v2
    v_xor_b32 v2, v2, v176
    v_and_b32 v2, 7, v2
    v_mul_u32_u24 v143, 528, v238
    v_lshlrev_b32 v239, 4, v2
    v_lshlrev_b32 v241, 4, v2
    v_lshlrev_b32 v153, 4, v2
    v_lshlrev_b32 v155, 4, v2
    s_add_u32 s28, s18, s53
    s_addc_u32 s29, s19, 0
    s_movk_i32 s30, 8192
    s_mov_b32 s31, s27
    s_mov_b32 s60, 0xbfb8aa3b
    s_mov_b32 s46, 0x2b800000
    s_mul_i32 s51, s48, 51200
    s_add_u32 s51, s51, s49
    s_add_u32 s72, s51, 1024
    v_bfrev_b32 v2, v178
    v_lshrrev_b32 v2, 28, v2
    v_and_b32 v2, 6, v2
    v_xor_b32 v2, v2, v177
    v_lshl_add_u32 v2, v2, 4, s54
    v_lshl_add_u32 v242, v178, 7, v2
    v_xor_b32 v243, 64, v242
    v_and_b32 v3, 3, v176
    v_bfe_u32 v2, v176, 2, 2
    v_lshlrev_b32 v7, 3, v3
    v_lshl_add_u32 v7, v2, 7, v7
    v_and_b32 v6, 8, v176
    v_lshlrev_b32 v6, 3, v6
    v_lshl_add_u32 v244, v177, 5, v7
    v_xor_b32 v244, v244, v6
    v_add_u32 v244, s54, v244
    v_xor_b32 v245, 32, v244
    s_lshl_b32 s57, s48, 7
    s_add_u32 s57, s57, 150016
    v_lshl_add_u32 v249, v2, 2, v177
    v_lshl_add_u32 v249, v249, 2, v3
    v_lshl_add_u32 v249, v249, 1, s57
    v_lshl_add_u32 v248, v178, 3, s57
    v_and_b32 v6, 0x60, v250
    v_or_b32 v6, v6, v7
    v_lshl_add_u32 v136, v177, 10, v6
    s_mul_i32 s57, s48, 0x1010
    s_and_b32 s57, s57, 0x1060
    v_xor_b32 v144, s57, v136
    v_add_u32 v136, 121088, v136
    v_add_u32 v144, 121088, v144
    v_xor_b32 v137, 32, v136
    v_xor_b32 v138, 64, v136
    v_xor_b32 v139, 96, v136
    s_and_b32 s59, s48, 4
    s_lshl_b32 s59, s59, 4
    v_xor_b32 v140, s59, v136
    v_xor_b32 v141, 32, v140
    s_and_b32 s57, s48, 3
    s_mul_i32 s57, s57, 8448
    s_lshl1_add_u32 s57, s59, s57
    s_add_u32 s57, s57, 83200
    v_mul_u32_u24 v145, 528, v178
    v_add3_u32 v145, v145, v252, s57
    v_lshl_add_u32 v142, s59, 1, v252
    s_mul_i32 s57, s48, 4224
    s_add_u32 s57, s57, 83200
    v_and_b32 v3, 0x70, v251
    v_add3_u32 v143, v143, v3, s57
    v_add_u32 v3, v143, v3
    s_lshl_b32 s57, s48, 11
    v_add_u32 v151, s57, v251
    s_mov_b32 s66, 0x1b0a0100
    s_mov_b32 s67, 0x966d4c33
    s_lshl_b32 s57, s48, 3
    s_lshr_b64 s[66:67], s[66:67], s57
    s_and_b32 s47, s66, 7
    s_bfe_u32 s70, s66, 0x50003
    s_lshl1_add_u32 s70, s70, 16
    s_mul_i32 s71, s70, 400
    buffer_load_dwordx4 v120, s[36:39], s74 offen offset:2048 lds
    buffer_load_dwordx4 v121, s[36:39], s74 offen offset:3072 lds
    s_cmp_eq_u32 s48, 0
    s_waitcnt vmcnt(6) lgkmcnt(0)
    s_cbranch_scc1 P_M0
    s_waitcnt vmcnt(5)
P_M0:
    s_call_b64 s[36:37], CMP
    s_branch P_C
    .p2align 3
CMP:
    v_cmp_eq_u16_e64 s[4:5], s61, v204
    v_cmp_eq_u16_sdwa s[6:7], v204, s61 src0_sel:WORD_1 src1_sel:WORD_0
    v_cmp_eq_u16_e64 s[8:9], s61, v205
    v_cmp_eq_u16_sdwa s[10:11], v205, s61 src0_sel:WORD_1 src1_sel:WORD_0
    v_cmp_eq_u16_e64 s[12:13], s61, v206
    v_cmp_eq_u16_sdwa s[14:15], v206, s61 src0_sel:WORD_1 src1_sel:WORD_0
    v_cmp_eq_u16_e64 s[16:17], s61, v207
    v_cmp_eq_u16_sdwa s[18:19], v207, s61 src0_sel:WORD_1 src1_sel:WORD_0
    v_lshrrev_b32 v7, 1, v251
    v_add_u32 v7, s56, v7
    v_mov_b64 v[4:5], -1
    ds_write_b64 v7, v[4:5]
    .p2align 3
    v_mbcnt_lo_u32_b32 v6, s4, 0
    v_mbcnt_hi_u32_b32 v6, s5, v6
    v_mbcnt_lo_u32_b32 v6, s6, v6
    v_mbcnt_hi_u32_b32 v6, s7, v6
    v_mbcnt_lo_u32_b32 v6, s8, v6
    v_mbcnt_hi_u32_b32 v6, s9, v6
    v_mbcnt_lo_u32_b32 v6, s10, v6
    v_mbcnt_hi_u32_b32 v6, s11, v6
    v_mbcnt_lo_u32_b32 v6, s12, v6
    v_mbcnt_hi_u32_b32 v6, s13, v6
    v_mbcnt_lo_u32_b32 v6, s14, v6
    v_mbcnt_hi_u32_b32 v6, s15, v6
    v_mbcnt_lo_u32_b32 v6, s16, v6
    v_mbcnt_hi_u32_b32 v6, s17, v6
    v_mbcnt_lo_u32_b32 v6, s18, v6
    v_mbcnt_hi_u32_b32 v6, s19, v6
    v_bcnt_u32_b32 v7, v204, 0
    v_readlane_b32 s59, v6, 31
    v_readlane_b32 s58, v6, 63
    v_add_u32 v6, s56, v6
    s_mov_b32 exec_lo, 0
    s_sub_u32 s57, 256, s59
    v_add_u32 v6, s57, v6
    s_mov_b32 exec_lo, -1
    v_mad_u32_u24 v7, v6, 7, v7
    s_sub_u32 s58, s58, s59
    s_mov_b64 exec, s[4:5]
    ds_write_b8 v6, v208
    v_add_u32 v6, 1, v6
    s_mov_b64 exec, s[6:7]
    ds_write_b8_d16_hi v6, v208
    v_add_u32 v6, 1, v6
    s_mov_b64 exec, s[8:9]
    ds_write_b8 v6, v209
    v_add_u32 v6, 1, v6
    s_mov_b64 exec, s[10:11]
    ds_write_b8_d16_hi v6, v209
    v_add_u32 v6, 1, v6
    s_mov_b64 exec, s[12:13]
    ds_write_b8 v6, v210
    v_add_u32 v6, 1, v6
    s_mov_b64 exec, s[14:15]
    ds_write_b8_d16_hi v6, v210
    v_add_u32 v6, 1, v6
    s_mov_b64 exec, s[16:17]
    ds_write_b8 v6, v211
    v_add_u32 v6, 1, v6
    s_mov_b64 exec, s[18:19]
    ds_write_b8_d16_hi v6, v211
    v_add_u32 v6, 1, v6
    s_mov_b64 exec, -1
    v_bcnt_u32_b32 v7, v205, v7
    v_bcnt_u32_b32 v7, v206, v7
    v_bcnt_u32_b32 v7, v207, v7
    v_mul_u32_u24 v6, 7, v6
    v_cmp_ne_u32 vcc, v6, v7
    s_min_u32 s64, vcc_lo, 1
    s_min_u32 s65, vcc_hi, 1
    s_lshl_b64 s[64:65], s[64:65], 15
    s_or_b32 s57, s59, s64
    s_or_b32 s58, s58, s65
    s_setpc_b64 s[36:37]
P_C:
    ds_read_u8 v238, v246 offset:0
    ds_read_u8 v240, v246 offset:8
    ds_read_u8 v152, v246 offset:16
    ds_read_u8 v154, v246 offset:24
    s_add_u32 m0, s54, 0
    s_waitcnt lgkmcnt(3)
    buffer_load_dwordx4 v[238:239], s[20:23], s72 idxen offen nt lds
    s_waitcnt lgkmcnt(2)
    buffer_load_dwordx4 v[240:241], s[20:23], s51 idxen offen offset:1024 nt lds
    s_add_u32 m0, s54, 2048
    s_waitcnt lgkmcnt(1)
    buffer_load_dwordx4 v[152:153], s[20:23], s72 idxen offen nt lds
    s_waitcnt lgkmcnt(0)
    buffer_load_dwordx4 v[154:155], s[20:23], s51 idxen offen offset:1024 nt lds
    s_lshl_b32 s63, s63, 16
    s_cmp_lg_u32 s48, 0
    s_waitcnt vmcnt(8)
    s_cbranch_scc1 P_SW_J
    v_lshlrev_b32 v148, 16, v146
    v_and_b32 v149, 0xffff0000, v146
    v_mov_b32 v4, -1
    v_mov_b32 v5, 0
    v_mov_b32 v6, 0x240
    v_lshrrev_b32 v0, 1, v251
    ds_write2st64_b32 v250, v4, v5 offset0:66 offset1:67
    s_mov_b32 exec_hi, 0
    v_max3_f32 v2, abs(v148), abs(v149), abs(s63)
    v_ldexp_f32 v148, v148, 40
    v_ldexp_f32 v149, v149, 40
    v_cmp_le_f32 vcc, 0x33800000, v2
    ds_write_b32 v250, v6 offset:17408
    s_mov_b32 exec_hi, -1
    s_movk_i32 s56, 0x3ff
    s_cmp_lg_u64 vcc, 0
    s_cmovk_i32 s56, 0x207
    v_mov_b32 v6, 17184
    v_mov_b32 v7, s56
    ds_write_b64 v0, v[148:149] offset:16384
    ds_write_b64 v5, v[6:7] offset:17600
P_SW_J:
    ds_write_b128 v143, v[124:127] offset:256
    ds_write_b128 v143, v[124:127] offset:384
    v_lshlrev_b32 v104, 16, v124
    v_and_b32 v105, 0xffff0000, v124
    v_lshlrev_b32 v106, 16, v125
    v_and_b32 v107, 0xffff0000, v125
    v_lshlrev_b32 v108, 16, v126
    v_and_b32 v109, 0xffff0000, v126
    v_lshlrev_b32 v110, 16, v127
    v_and_b32 v111, 0xffff0000, v127
    v_mul_f32 v104, s60, v104
    v_mul_f32 v105, s60, v105
    v_mul_f32 v106, s60, v106
    v_mul_f32 v107, s60, v107
    v_mul_f32 v108, s60, v108
    v_mul_f32 v109, s60, v109
    v_mul_f32 v110, s60, v110
    v_mul_f32 v111, s60, v111
    ds_write_b128 v3, v[104:107] offset:0
    ds_write_b128 v3, v[108:111] offset:16
    s_waitcnt vmcnt(4) lgkmcnt(2)
    s_barrier
    ds_read_b64_tr_b16 v[220:221], v144 offset:0
    ds_read_b64_tr_b16 v[222:223], v144 offset:512
    ds_read_b64_tr_b16 v[224:225], v144 offset:16384
    ds_read_b64_tr_b16 v[226:227], v144 offset:16896
    ds_read_b128 v[160:163], v145 offset:256
    ds_read_b128 v[164:167], v145 offset:320
    ds_read_b128 v[104:107], v142 offset:16640
    ds_read_b128 v[108:111], v142 offset:16704
    ds_read_b64_tr_b16 v[40:41], v140 offset:8192
    ds_read_b64_tr_b16 v[42:43], v140 offset:8704
    ds_read_b64_tr_b16 v[44:45], v141 offset:8192
    ds_read_b64_tr_b16 v[46:47], v141 offset:8704
    ds_read_b64_tr_b16 v[48:49], v140 offset:12288
    ds_read_b64_tr_b16 v[50:51], v140 offset:12800
    ds_read_b64_tr_b16 v[52:53], v141 offset:12288
    ds_read_b64_tr_b16 v[54:55], v141 offset:12800
    ds_read_b64_tr_b16 v[56:57], v140 offset:16384
    ds_read_b64_tr_b16 v[58:59], v140 offset:16896
    ds_read_b64_tr_b16 v[60:61], v141 offset:16384
    ds_read_b64_tr_b16 v[62:63], v141 offset:16896
    ds_read_b64_tr_b16 v[64:65], v140 offset:20480
    ds_read_b64_tr_b16 v[66:67], v140 offset:20992
    ds_read_b64_tr_b16 v[68:69], v141 offset:20480
    ds_read_b64_tr_b16 v[70:71], v141 offset:20992
    s_and_b32 s59, s57, 0xff
    s_lshr_b32 s57, s57, 8
    s_add_u32 s59, s59, 15
    s_lshr_b32 s59, s59, 4
    s_max_u32 s59, s59, 4
    s_lshl1_add_u32 s52, s48, s57
    s_lshl_b32 s57, s59, 8
    s_or_b32 s52, s52, s57
    s_sub_u32 s50, s59, 4
    s_and_b32 s59, s58, 0xff
    s_lshr_b32 s58, s58, 8
    s_add_u32 s59, s59, 15
    s_lshr_b32 s59, s59, 4
    s_max_u32 s59, s59, 2
    s_lshl1_add_u32 s74, s48, s58
    s_lshl_b32 s58, s59, 8
    s_or_b32 s74, s74, s58
    s_or_b32 s74, s74, 1
    s_waitcnt lgkmcnt(15)
    v_lshlrev_b32 v8, 16, v220
    v_and_b32 v9, 0xffff0000, v220
    v_lshlrev_b32 v16, 16, v224
    v_and_b32 v17, 0xffff0000, v224
    v_lshlrev_b32 v10, 16, v221
    v_and_b32 v11, 0xffff0000, v221
    v_lshlrev_b32 v18, 16, v225
    v_and_b32 v19, 0xffff0000, v225
    v_lshlrev_b32 v12, 16, v222
    v_and_b32 v13, 0xffff0000, v222
    v_lshlrev_b32 v20, 16, v226
    v_and_b32 v21, 0xffff0000, v226
    v_lshlrev_b32 v14, 16, v223
    v_and_b32 v15, 0xffff0000, v223
    v_lshlrev_b32 v22, 16, v227
    v_and_b32 v23, 0xffff0000, v227
    v_xor_b32 v168, 0x80008000, v160
    v_xor_b32 v169, 0x80008000, v161
    v_xor_b32 v170, 0x80008000, v162
    v_xor_b32 v171, 0x80008000, v163
    v_xor_b32 v172, 0x80008000, v164
    v_xor_b32 v173, 0x80008000, v165
    v_xor_b32 v174, 0x80008000, v166
    v_xor_b32 v175, 0x80008000, v167
    s_waitcnt lgkmcnt(12)
    v_mfma_f32_16x16x32_bf16 v[104:107], v[40:43], v[160:163], v[104:107]
    v_mfma_f32_16x16x32_bf16 v[108:111], v[44:47], v[160:163], v[108:111]
    v_add_f32 v112, v8, v16
    v_add_f32 v113, v9, v17
    s_waitcnt lgkmcnt(8)
    v_mfma_f32_16x16x32_bf16 v[104:107], v[48:51], v[164:167], v[104:107]
    v_mfma_f32_16x16x32_bf16 v[108:111], v[52:55], v[164:167], v[108:111]
    v_add_f32 v114, v10, v18
    v_add_f32 v115, v11, v19
    s_waitcnt lgkmcnt(4)
    v_mfma_f32_16x16x32_bf16 v[104:107], v[56:59], v[168:171], v[104:107]
    v_mfma_f32_16x16x32_bf16 v[108:111], v[60:63], v[168:171], v[108:111]
    v_add_f32 v116, v12, v20
    v_add_f32 v117, v13, v21
    s_waitcnt lgkmcnt(0)
    v_mfma_f32_16x16x32_bf16 v[104:107], v[64:67], v[172:175], v[104:107]
    v_mfma_f32_16x16x32_bf16 v[108:111], v[68:71], v[172:175], v[108:111]
    v_add_f32 v118, v14, v22
    v_add_f32 v119, v15, v23
    ds_read_b64_tr_b16 v[72:73], v136 offset:24576
    ds_read_b64_tr_b16 v[74:75], v136 offset:25088
    ds_read_b64_tr_b16 v[76:77], v136 offset:28672
    ds_read_b64_tr_b16 v[78:79], v136 offset:29184
    ds_read_b64_tr_b16 v[80:81], v137 offset:24576
    ds_read_b64_tr_b16 v[82:83], v137 offset:25088
    ds_read_b64_tr_b16 v[84:85], v137 offset:28672
    ds_read_b64_tr_b16 v[86:87], v137 offset:29184
    ds_read_b64_tr_b16 v[88:89], v138 offset:24576
    ds_read_b64_tr_b16 v[90:91], v138 offset:25088
    ds_read_b64_tr_b16 v[92:93], v138 offset:28672
    ds_read_b64_tr_b16 v[94:95], v138 offset:29184
    ds_read_b64_tr_b16 v[96:97], v139 offset:24576
    ds_read_b64_tr_b16 v[98:99], v139 offset:25088
    ds_read_b64_tr_b16 v[100:101], v139 offset:28672
    ds_read_b64_tr_b16 v[102:103], v139 offset:29184
    v_mul_f32 v112, s60, v112
    v_mul_f32 v113, s60, v113
    v_mul_f32 v114, s60, v114
    v_mul_f32 v115, s60, v115
    v_mul_f32 v116, s60, v116
    v_mul_f32 v117, s60, v117
    v_mul_f32 v118, s60, v118
    v_mul_f32 v119, s60, v119
    ds_write_b128 v151, v[112:115] offset:0
    ds_write_b128 v151, v[116:119] offset:1024
    v_mul_f32 v104, s60, v104
    v_mul_f32 v105, s60, v105
    v_mul_f32 v106, s60, v106
    v_mul_f32 v107, s60, v107
    v_mul_f32 v108, s60, v108
    v_mul_f32 v109, s60, v109
    v_mul_f32 v110, s60, v110
    v_mul_f32 v111, s60, v111
    ds_write_b128 v145, v[104:107] offset:256
    ds_write_b128 v145, v[108:111] offset:320
    ds_read_b128 v[120:123], v252 offset:16384
    ds_read_b128 v[124:127], v252 offset:16448
    ds_read_b128 v[128:131], v252 offset:16512
    ds_read_b128 v[132:135], v252 offset:16576
    ds_read_b32 v150, v252 offset:17604
    s_lshl2_add_u32 s56, s48, 17184
    v_mov_b32 v253, s56
    v_mov_b32 v254, s74
    ds_write_b32 v253, v254
    s_cmp_le_u32 s47, 0
    s_cbranch_scc1 P_MJ
    buffer_load_dwordx4 v[180:183], v179, s[24:27], s71 offen offset:0 nt
    s_cmp_le_u32 s47, 1
    s_cbranch_scc1 P_MJ
    buffer_load_dwordx4 v[184:187], v179, s[24:27], s71 offen offset:800 nt
    s_cmp_le_u32 s47, 2
    s_cbranch_scc1 P_MJ
    buffer_load_dwordx4 v[188:191], v179, s[24:27], s71 offen offset:1600 nt
    s_cmp_le_u32 s47, 3
    s_cbranch_scc1 P_MJ
    buffer_load_dwordx4 v[192:195], v179, s[24:27], s71 offen offset:2400 nt
    s_cmp_le_u32 s47, 4
    s_cbranch_scc1 P_MJ
    buffer_load_dwordx4 v[196:199], v179, s[24:27], s71 offen offset:3200 nt
    s_cmp_le_u32 s47, 5
    s_cbranch_scc1 P_MJ
    buffer_load_dwordx4 v[200:203], v179, s[24:27], s71 offen offset:4000 nt
P_MJ:
    v_ldexp_f32 v2, s63, 38
    v_add_u32 v250, 133376, v250
    v_mov_b64 v[168:169], 0
    v_mov_b64 v[170:171], 0
    v_mov_b64 v[172:173], 0
    v_mov_b64 v[174:175], 0
    v_readfirstlane_b32 s44, v2
    s_waitcnt lgkmcnt(15)
    v_lshlrev_b32 v8, 16, v72
    v_and_b32 v9, 0xffff0000, v72
    v_lshlrev_b32 v10, 16, v73
    v_and_b32 v11, 0xffff0000, v73
    v_lshlrev_b32 v12, 16, v74
    v_and_b32 v13, 0xffff0000, v74
    v_lshlrev_b32 v14, 16, v75
    v_and_b32 v15, 0xffff0000, v75
    v_lshlrev_b32 v16, 16, v76
    v_and_b32 v17, 0xffff0000, v76
    v_lshlrev_b32 v18, 16, v77
    v_and_b32 v19, 0xffff0000, v77
    v_lshlrev_b32 v20, 16, v78
    v_and_b32 v21, 0xffff0000, v78
    v_lshlrev_b32 v22, 16, v79
    v_and_b32 v23, 0xffff0000, v79
    v_lshlrev_b32 v24, 16, v80
    v_and_b32 v25, 0xffff0000, v80
    v_lshlrev_b32 v26, 16, v81
    v_and_b32 v27, 0xffff0000, v81
    v_lshlrev_b32 v28, 16, v82
    v_and_b32 v29, 0xffff0000, v82
    v_lshlrev_b32 v30, 16, v83
    v_and_b32 v31, 0xffff0000, v83
    v_lshlrev_b32 v32, 16, v84
    v_and_b32 v33, 0xffff0000, v84
    v_lshlrev_b32 v34, 16, v85
    v_and_b32 v35, 0xffff0000, v85
    v_lshlrev_b32 v36, 16, v86
    v_and_b32 v37, 0xffff0000, v86
    v_lshlrev_b32 v38, 16, v87
    v_and_b32 v39, 0xffff0000, v87
    s_waitcnt lgkmcnt(0)
    s_barrier
    v_readfirstlane_b32 s45, v150
    ds_read_u8 v238, v246 offset:32
    ds_read_u8 v240, v246 offset:40
    ds_read_u8 v152, v246 offset:48
    ds_read_u8 v154, v246 offset:56
    s_add_u32 m0, s54, 4096
    s_waitcnt lgkmcnt(3)
    buffer_load_dwordx4 v[238:239], s[20:23], s72 idxen offen nt lds
    s_waitcnt lgkmcnt(2)
    buffer_load_dwordx4 v[240:241], s[20:23], s51 idxen offen offset:1024 nt lds
    s_add_u32 m0, s54, 6144
    s_waitcnt lgkmcnt(1)
    buffer_load_dwordx4 v[152:153], s[20:23], s72 idxen offen nt lds
    s_waitcnt lgkmcnt(0)
    buffer_load_dwordx4 v[154:155], s[20:23], s51 idxen offen offset:1024 nt lds
    s_cmp_eq_u32 s47, 0
    s_cbranch_scc1 P_GO
    s_lshl_b32 s56, s70, 8
    s_add_u32 s56, s56, 116992
    s_waitcnt vmcnt(4)
    v_mov_b64 v[204:205], v[180:181]
    v_mov_b64 v[206:207], v[182:183]
    s_call_b64 s[36:37], CMP
    v_writelane_b32 v212, s57, 0
    v_writelane_b32 v212, s58, 1
    s_cmp_le_u32 s47, 1
    s_cbranch_scc1 LATE_D
    s_add_u32 s56, s56, 512
    v_mov_b64 v[204:205], v[184:185]
    v_mov_b64 v[206:207], v[186:187]
    s_call_b64 s[36:37], CMP
    v_writelane_b32 v212, s57, 2
    v_writelane_b32 v212, s58, 3
    s_cmp_le_u32 s47, 2
    s_cbranch_scc1 LATE_D
    s_add_u32 s56, s56, 512
    v_mov_b64 v[204:205], v[188:189]
    v_mov_b64 v[206:207], v[190:191]
    s_call_b64 s[36:37], CMP
    v_writelane_b32 v212, s57, 4
    v_writelane_b32 v212, s58, 5
    s_cmp_le_u32 s47, 3
    s_cbranch_scc1 LATE_D
    s_add_u32 s56, s56, 512
    v_mov_b64 v[204:205], v[192:193]
    v_mov_b64 v[206:207], v[194:195]
    s_call_b64 s[36:37], CMP
    v_writelane_b32 v212, s57, 6
    v_writelane_b32 v212, s58, 7
    s_cmp_le_u32 s47, 4
    s_cbranch_scc1 LATE_D
    s_add_u32 s56, s56, 512
    v_mov_b64 v[204:205], v[196:197]
    v_mov_b64 v[206:207], v[198:199]
    s_call_b64 s[36:37], CMP
    v_writelane_b32 v212, s57, 8
    v_writelane_b32 v212, s58, 9
    s_cmp_le_u32 s47, 5
    s_cbranch_scc1 LATE_D
    s_add_u32 s56, s56, 512
    v_mov_b64 v[204:205], v[200:201]
    v_mov_b64 v[206:207], v[202:203]
    s_call_b64 s[36:37], CMP
    v_writelane_b32 v212, s57, 10
    v_writelane_b32 v212, s58, 11
LATE_D:
    v_add_u32 v4, s70, v176
    s_lshl_b32 s56, s47, 1
    v_and_b32 v5, 0xff, v212
    v_add_u32 v5, 15, v5
    v_lshrrev_b32 v5, 4, v5
    v_max_u32 v5, 2, v5
    v_lshrrev_b32 v212, 8, v212
    v_or_b32 v212, v212, v4
    v_cmp_gt_u32 vcc, 64, v4
    v_lshl_or_b32 v6, v5, 8, v212
    v_lshlrev_b32 v4, 2, v4
    s_bfm_b64 s[66:67], s56, 0
    s_and_b64 exec, s[66:67], vcc
    ds_write_b32 v4, v6 offset:17152
    s_mov_b64 exec, -1
P_GO:
    ds_read_b128 v[180:183], v251 offset:0
    ds_read_b128 v[184:187], v251 offset:1024
    ds_read_b128 v[196:199], v251 offset:4096
    ds_read_b128 v[200:203], v251 offset:5120
    ds_read_b128 v[212:215], v251 offset:8192
    ds_read_b128 v[216:219], v251 offset:9216
    ds_read_b128 v[188:191], v251 offset:2048
    ds_read_b128 v[192:195], v251 offset:3072
    ds_read_b128 v[204:207], v251 offset:6144
    ds_read_b128 v[208:211], v251 offset:7168
    ds_read_b128 v[220:223], v251 offset:10240
    ds_read_b128 v[224:227], v251 offset:11264
    ds_read_b128 v[228:231], v251 offset:14336
    ds_read_b128 v[232:235], v251 offset:15360
    v_lshlrev_b32 v40, 16, v88
    v_and_b32 v41, 0xffff0000, v88
    v_lshlrev_b32 v42, 16, v89
    v_and_b32 v43, 0xffff0000, v89
    v_lshlrev_b32 v44, 16, v90
    v_and_b32 v45, 0xffff0000, v90
    v_lshlrev_b32 v46, 16, v91
    v_and_b32 v47, 0xffff0000, v91
    v_lshlrev_b32 v48, 16, v92
    v_and_b32 v49, 0xffff0000, v92
    v_lshlrev_b32 v50, 16, v93
    v_and_b32 v51, 0xffff0000, v93
    v_lshlrev_b32 v52, 16, v94
    v_and_b32 v53, 0xffff0000, v94
    v_lshlrev_b32 v54, 16, v95
    v_and_b32 v55, 0xffff0000, v95
    v_lshlrev_b32 v56, 16, v96
    v_and_b32 v57, 0xffff0000, v96
    v_lshlrev_b32 v58, 16, v97
    v_and_b32 v59, 0xffff0000, v97
    v_lshlrev_b32 v60, 16, v98
    v_and_b32 v61, 0xffff0000, v98
    v_lshlrev_b32 v62, 16, v99
    v_and_b32 v63, 0xffff0000, v99
    v_lshlrev_b32 v64, 16, v100
    v_and_b32 v65, 0xffff0000, v100
    v_lshlrev_b32 v66, 16, v101
    v_and_b32 v67, 0xffff0000, v101
    v_lshlrev_b32 v68, 16, v102
    v_and_b32 v69, 0xffff0000, v102
    v_lshlrev_b32 v70, 16, v103
    v_and_b32 v71, 0xffff0000, v103
    v_add_u32 v246, 48, v246
    v_mov_b64 v[0:1], 0
    v_mov_b32 v2, 1.0
    v_mov_b32 v3, 1.0
    v_mov_b64 v[176:177], 0
    v_mov_b64 v[178:179], 0
    s_mov_b64 s[68:69], 0
    s_mov_b32 s75, 0
    s_movk_i32 s53, 0x1040
    s_mov_b32 s73, 3
    s_mov_b32 s77, 0
    s_mov_b32 s55, 0
    s_sub_u32 s50, s50, 2
    s_cbranch_scc1 DRAW_P
DRET_P:
    s_waitcnt vmcnt(6)
    ds_read_b128 v[152:155], v242
    ds_read_b128 v[156:159], v243
    s_branch BPF
U_0:
    v_mfma_f32_16x16x32_bf16 v[104:107], v[72:75], v[152:155], v[136:139]
    s_add_u32 m0, s54, 0
    v_rcp_f32 v2, v2
    v_mfma_f32_16x16x32_bf16 v[104:107], v[76:79], v[156:159], v[104:107]
    s_mov_b32 s73, 0
    v_rcp_f32 v3, v3
    v_mfma_f32_16x16x32_bf16 v[108:111], v[80:83], v[152:155], v[140:143]
    s_sub_u32 s50, s50, 1
    v_fma_f32 v0, v0, v2, s44
    v_fmac_f32 v0, v1, v3
    v_mfma_f32_16x16x32_bf16 v[108:111], v[84:87], v[156:159], v[108:111]
    s_cbranch_scc1 PEV
    v_add_u32 v246, 16, v246
RET_0:
    v_cvt_pk_bf16_f32 v0, v0, v0
    v_mfma_f32_16x16x32_bf16 v[112:115], v[88:91], v[152:155], v[144:147]
    v_exp_f32 v104, v104
    v_mfma_f32_16x16x32_bf16 v[112:115], v[92:95], v[156:159], v[112:115]
    v_exp_f32 v105, v105
    v_mfma_f32_16x16x32_bf16 v[116:119], v[96:99], v[152:155], v[148:151]
    s_sub_u32 s62, s62, 1
    v_exp_f32 v106, v106
    v_mfma_f32_16x16x32_bf16 v[116:119], v[100:103], v[156:159], v[116:119]
    s_waitcnt vmcnt(3)
    v_exp_f32 v107, v107
    ds_write_b16 v249, v0
    ds_read_b64 v[236:237], v248
    ds_read_b64_tr_b16 v[160:161], v244 offset:0
    ds_read_b64_tr_b16 v[162:163], v245 offset:512
    ds_read_b64_tr_b16 v[164:165], v244 offset:1024
    ds_read_b64_tr_b16 v[166:167], v245 offset:1536
    ds_read_u8 v238, v246 offset:0
    ds_read_u8 v240, v246 offset:8
    ds_read_b32 v254, v253
    ds_read_b128 v[152:155], v242 offset:2048
    ds_read_b128 v[156:159], v243 offset:2048
    v_exp_f32 v108, v108
    v_exp_f32 v109, v109
    v_exp_f32 v110, v110
    v_exp_f32 v111, v111
    s_waitcnt lgkmcnt(9)
    v_mfma_f32_4x4x4_16b_bf16 v[176:179], v[236:237], v[168:169], v[176:179] cbsz:4 abid:0
    v_exp_f32 v112, v112
    v_exp_f32 v113, v113
    v_mfma_f32_4x4x4_16b_bf16 v[176:179], v[236:237], v[170:171], v[176:179] cbsz:4 abid:1
    v_exp_f32 v114, v114
    v_exp_f32 v115, v115
    v_mfma_f32_4x4x4_16b_bf16 v[176:179], v[236:237], v[172:173], v[176:179] cbsz:4 abid:2
    v_exp_f32 v116, v116
    v_exp_f32 v117, v117
    v_mfma_f32_4x4x4_16b_bf16 v[176:179], v[236:237], v[174:175], v[176:179] cbsz:4 abid:3
    v_exp_f32 v118, v118
    v_exp_f32 v119, v119
    .p2align 3
    v_pk_add_f32 v[2:3], v[104:105], 1.0 op_sel_hi:[1,0]
    v_pk_fma_f32 v[0:1], v[120:121], v[106:107], v[120:121]
    v_pk_fma_f32 v[0:1], v[122:123], v[2:3], v[0:1]
    v_pk_fma_f32 v[2:3], v[106:107], v[2:3], v[2:3]
    v_pk_fma_f32 v[0:1], v[108:109], v[0:1], v[0:1]
    v_pk_fma_f32 v[0:1], v[124:125], v[2:3], v[0:1]
    v_pk_fma_f32 v[2:3], v[108:109], v[2:3], v[2:3]
    v_pk_fma_f32 v[0:1], v[110:111], v[0:1], v[0:1]
    v_pk_fma_f32 v[0:1], v[126:127], v[2:3], v[0:1]
    v_pk_fma_f32 v[2:3], v[110:111], v[2:3], v[2:3]
    v_pk_fma_f32 v[0:1], v[112:113], v[0:1], v[0:1]
    v_pk_fma_f32 v[0:1], v[128:129], v[2:3], v[0:1]
    v_pk_fma_f32 v[2:3], v[112:113], v[2:3], v[2:3]
    v_pk_fma_f32 v[0:1], v[114:115], v[0:1], v[0:1]
    v_pk_fma_f32 v[0:1], v[130:131], v[2:3], v[0:1]
    v_pk_fma_f32 v[2:3], v[114:115], v[2:3], v[2:3]
    v_pk_fma_f32 v[0:1], v[116:117], v[0:1], v[0:1]
    v_pk_fma_f32 v[0:1], v[132:133], v[2:3], v[0:1]
    v_pk_fma_f32 v[2:3], v[116:117], v[2:3], v[2:3]
    v_pk_fma_f32 v[0:1], v[118:119], v[0:1], v[0:1]
    v_pk_fma_f32 v[0:1], v[134:135], v[2:3], v[0:1]
    v_pk_fma_f32 v[2:3], v[118:119], v[2:3], v[2:3]
    s_waitcnt lgkmcnt(0)
    buffer_load_dwordx4 v[238:239], s[20:23], s72 idxen offen nt lds
    buffer_load_dwordx4 v[240:241], s[20:23], s51 idxen offen offset:1024 nt lds
    s_cbranch_scc1 CEV
U_1:
    v_mfma_f32_16x16x32_bf16 v[104:107], v[72:75], v[152:155], v[136:139]
    s_add_u32 m0, s54, 2048
    v_rcp_f32 v2, v2
    v_mfma_f32_16x16x32_bf16 v[104:107], v[76:79], v[156:159], v[104:107]
    s_mov_b32 s73, 1
    v_rcp_f32 v3, v3
    v_mfma_f32_16x16x32_bf16 v[108:111], v[80:83], v[152:155], v[140:143]
    s_sub_u32 s50, s50, 1
    v_fma_f32 v0, v0, v2, s44
    v_fmac_f32 v0, v1, v3
    v_mfma_f32_16x16x32_bf16 v[108:111], v[84:87], v[156:159], v[108:111]
    s_cbranch_scc1 PEV
    v_add_u32 v246, 16, v246
RET_1:
    v_cvt_pk_bf16_f32 v0, v0, v0
    v_mfma_f32_16x16x32_bf16 v[112:115], v[88:91], v[152:155], v[144:147]
    v_exp_f32 v104, v104
    v_mfma_f32_16x16x32_bf16 v[112:115], v[92:95], v[156:159], v[112:115]
    v_exp_f32 v105, v105
    v_mfma_f32_16x16x32_bf16 v[116:119], v[96:99], v[152:155], v[148:151]
    s_sub_u32 s62, s62, 1
    v_exp_f32 v106, v106
    v_mfma_f32_16x16x32_bf16 v[116:119], v[100:103], v[156:159], v[116:119]
    s_waitcnt vmcnt(3)
    v_exp_f32 v107, v107
    ds_write_b16 v249, v0
    ds_read_b64 v[236:237], v248
    ds_read_b64_tr_b16 v[168:169], v244 offset:2048
    ds_read_b64_tr_b16 v[170:171], v245 offset:2560
    ds_read_b64_tr_b16 v[172:173], v244 offset:3072
    ds_read_b64_tr_b16 v[174:175], v245 offset:3584
    ds_read_u8 v238, v246 offset:0
    ds_read_u8 v240, v246 offset:8
    ds_read_b32 v254, v253
    ds_read_b128 v[152:155], v242 offset:4096
    ds_read_b128 v[156:159], v243 offset:4096
    v_exp_f32 v108, v108
    v_exp_f32 v109, v109
    v_exp_f32 v110, v110
    v_exp_f32 v111, v111
    s_waitcnt lgkmcnt(9)
    v_mfma_f32_4x4x4_16b_bf16 v[176:179], v[236:237], v[160:161], v[176:179] cbsz:4 abid:0
    v_exp_f32 v112, v112
    v_exp_f32 v113, v113
    v_mfma_f32_4x4x4_16b_bf16 v[176:179], v[236:237], v[162:163], v[176:179] cbsz:4 abid:1
    v_exp_f32 v114, v114
    v_exp_f32 v115, v115
    v_mfma_f32_4x4x4_16b_bf16 v[176:179], v[236:237], v[164:165], v[176:179] cbsz:4 abid:2
    v_exp_f32 v116, v116
    v_exp_f32 v117, v117
    v_mfma_f32_4x4x4_16b_bf16 v[176:179], v[236:237], v[166:167], v[176:179] cbsz:4 abid:3
    v_exp_f32 v118, v118
    v_exp_f32 v119, v119
    .p2align 3
    v_pk_add_f32 v[2:3], v[104:105], 1.0 op_sel_hi:[1,0]
    v_pk_fma_f32 v[0:1], v[120:121], v[106:107], v[120:121]
    v_pk_fma_f32 v[0:1], v[122:123], v[2:3], v[0:1]
    v_pk_fma_f32 v[2:3], v[106:107], v[2:3], v[2:3]
    v_pk_fma_f32 v[0:1], v[108:109], v[0:1], v[0:1]
    v_pk_fma_f32 v[0:1], v[124:125], v[2:3], v[0:1]
    v_pk_fma_f32 v[2:3], v[108:109], v[2:3], v[2:3]
    v_pk_fma_f32 v[0:1], v[110:111], v[0:1], v[0:1]
    v_pk_fma_f32 v[0:1], v[126:127], v[2:3], v[0:1]
    v_pk_fma_f32 v[2:3], v[110:111], v[2:3], v[2:3]
    v_pk_fma_f32 v[0:1], v[112:113], v[0:1], v[0:1]
    v_pk_fma_f32 v[0:1], v[128:129], v[2:3], v[0:1]
    v_pk_fma_f32 v[2:3], v[112:113], v[2:3], v[2:3]
    v_pk_fma_f32 v[0:1], v[114:115], v[0:1], v[0:1]
    v_pk_fma_f32 v[0:1], v[130:131], v[2:3], v[0:1]
    v_pk_fma_f32 v[2:3], v[114:115], v[2:3], v[2:3]
    v_pk_fma_f32 v[0:1], v[116:117], v[0:1], v[0:1]
    v_pk_fma_f32 v[0:1], v[132:133], v[2:3], v[0:1]
    v_pk_fma_f32 v[2:3], v[116:117], v[2:3], v[2:3]
    v_pk_fma_f32 v[0:1], v[118:119], v[0:1], v[0:1]
    v_pk_fma_f32 v[0:1], v[134:135], v[2:3], v[0:1]
    v_pk_fma_f32 v[2:3], v[118:119], v[2:3], v[2:3]
    s_waitcnt lgkmcnt(0)
    buffer_load_dwordx4 v[238:239], s[20:23], s72 idxen offen nt lds
    buffer_load_dwordx4 v[240:241], s[20:23], s51 idxen offen offset:1024 nt lds
    s_cbranch_scc1 CEV
U_2:
    v_mfma_f32_16x16x32_bf16 v[104:107], v[72:75], v[152:155], v[136:139]
    s_add_u32 m0, s54, 4096
    v_rcp_f32 v2, v2
    v_mfma_f32_16x16x32_bf16 v[104:107], v[76:79], v[156:159], v[104:107]
    s_mov_b32 s73, 2
    v_rcp_f32 v3, v3
    v_mfma_f32_16x16x32_bf16 v[108:111], v[80:83], v[152:155], v[140:143]
    s_sub_u32 s50, s50, 1
    v_fma_f32 v0, v0, v2, s44
    v_fmac_f32 v0, v1, v3
    v_mfma_f32_16x16x32_bf16 v[108:111], v[84:87], v[156:159], v[108:111]
    s_cbranch_scc1 PEV
    v_add_u32 v246, 16, v246
RET_2:
    v_cvt_pk_bf16_f32 v0, v0, v0
    v_mfma_f32_16x16x32_bf16 v[112:115], v[88:91], v[152:155], v[144:147]
    v_exp_f32 v104, v104
    v_mfma_f32_16x16x32_bf16 v[112:115], v[92:95], v[156:159], v[112:115]
    v_exp_f32 v105, v105
    v_mfma_f32_16x16x32_bf16 v[116:119], v[96:99], v[152:155], v[148:151]
    s_sub_u32 s62, s62, 1
    v_exp_f32 v106, v106
    v_mfma_f32_16x16x32_bf16 v[116:119], v[100:103], v[156:159], v[116:119]
    s_waitcnt vmcnt(3)
    v_exp_f32 v107, v107
    ds_write_b16 v249, v0
    ds_read_b64 v[236:237], v248
    ds_read_b64_tr_b16 v[160:161], v244 offset:4096
    ds_read_b64_tr_b16 v[162:163], v245 offset:4608
    ds_read_b64_tr_b16 v[164:165], v244 offset:5120
    ds_read_b64_tr_b16 v[166:167], v245 offset:5632
    ds_read_u8 v238, v246 offset:0
    ds_read_u8 v240, v246 offset:8
    ds_read_b32 v254, v253
    ds_read_b128 v[152:155], v242 offset:6144
    ds_read_b128 v[156:159], v243 offset:6144
    v_exp_f32 v108, v108
    v_exp_f32 v109, v109
    v_exp_f32 v110, v110
    v_exp_f32 v111, v111
    s_waitcnt lgkmcnt(9)
    v_mfma_f32_4x4x4_16b_bf16 v[176:179], v[236:237], v[168:169], v[176:179] cbsz:4 abid:0
    v_exp_f32 v112, v112
    v_exp_f32 v113, v113
    v_mfma_f32_4x4x4_16b_bf16 v[176:179], v[236:237], v[170:171], v[176:179] cbsz:4 abid:1
    v_exp_f32 v114, v114
    v_exp_f32 v115, v115
    v_mfma_f32_4x4x4_16b_bf16 v[176:179], v[236:237], v[172:173], v[176:179] cbsz:4 abid:2
    v_exp_f32 v116, v116
    v_exp_f32 v117, v117
    v_mfma_f32_4x4x4_16b_bf16 v[176:179], v[236:237], v[174:175], v[176:179] cbsz:4 abid:3
    v_exp_f32 v118, v118
    v_exp_f32 v119, v119
    .p2align 3
    v_pk_add_f32 v[2:3], v[104:105], 1.0 op_sel_hi:[1,0]
    v_pk_fma_f32 v[0:1], v[120:121], v[106:107], v[120:121]
    v_pk_fma_f32 v[0:1], v[122:123], v[2:3], v[0:1]
    v_pk_fma_f32 v[2:3], v[106:107], v[2:3], v[2:3]
    v_pk_fma_f32 v[0:1], v[108:109], v[0:1], v[0:1]
    v_pk_fma_f32 v[0:1], v[124:125], v[2:3], v[0:1]
    v_pk_fma_f32 v[2:3], v[108:109], v[2:3], v[2:3]
    v_pk_fma_f32 v[0:1], v[110:111], v[0:1], v[0:1]
    v_pk_fma_f32 v[0:1], v[126:127], v[2:3], v[0:1]
    v_pk_fma_f32 v[2:3], v[110:111], v[2:3], v[2:3]
    v_pk_fma_f32 v[0:1], v[112:113], v[0:1], v[0:1]
    v_pk_fma_f32 v[0:1], v[128:129], v[2:3], v[0:1]
    v_pk_fma_f32 v[2:3], v[112:113], v[2:3], v[2:3]
    v_pk_fma_f32 v[0:1], v[114:115], v[0:1], v[0:1]
    v_pk_fma_f32 v[0:1], v[130:131], v[2:3], v[0:1]
    v_pk_fma_f32 v[2:3], v[114:115], v[2:3], v[2:3]
    v_pk_fma_f32 v[0:1], v[116:117], v[0:1], v[0:1]
    v_pk_fma_f32 v[0:1], v[132:133], v[2:3], v[0:1]
    v_pk_fma_f32 v[2:3], v[116:117], v[2:3], v[2:3]
    v_pk_fma_f32 v[0:1], v[118:119], v[0:1], v[0:1]
    v_pk_fma_f32 v[0:1], v[134:135], v[2:3], v[0:1]
    v_pk_fma_f32 v[2:3], v[118:119], v[2:3], v[2:3]
    s_waitcnt lgkmcnt(0)
    buffer_load_dwordx4 v[238:239], s[20:23], s72 idxen offen nt lds
    buffer_load_dwordx4 v[240:241], s[20:23], s51 idxen offen offset:1024 nt lds
    s_cbranch_scc1 CEV
U_3:
    v_mfma_f32_16x16x32_bf16 v[104:107], v[72:75], v[152:155], v[136:139]
    s_add_u32 m0, s54, 6144
    v_rcp_f32 v2, v2
    v_mfma_f32_16x16x32_bf16 v[104:107], v[76:79], v[156:159], v[104:107]
    s_mov_b32 s73, 3
    v_rcp_f32 v3, v3
    v_mfma_f32_16x16x32_bf16 v[108:111], v[80:83], v[152:155], v[140:143]
    s_sub_u32 s50, s50, 1
    v_fma_f32 v0, v0, v2, s44
    v_fmac_f32 v0, v1, v3
    v_mfma_f32_16x16x32_bf16 v[108:111], v[84:87], v[156:159], v[108:111]
    s_cbranch_scc1 PEV
    v_add_u32 v246, 16, v246
RET_3:
    v_cvt_pk_bf16_f32 v0, v0, v0
    v_mfma_f32_16x16x32_bf16 v[112:115], v[88:91], v[152:155], v[144:147]
    v_exp_f32 v104, v104
    v_mfma_f32_16x16x32_bf16 v[112:115], v[92:95], v[156:159], v[112:115]
    v_exp_f32 v105, v105
    v_mfma_f32_16x16x32_bf16 v[116:119], v[96:99], v[152:155], v[148:151]
    s_sub_u32 s62, s62, 1
    v_exp_f32 v106, v106
    v_mfma_f32_16x16x32_bf16 v[116:119], v[100:103], v[156:159], v[116:119]
    s_waitcnt vmcnt(3)
    v_exp_f32 v107, v107
    ds_write_b16 v249, v0
    ds_read_b64 v[236:237], v248
    ds_read_b64_tr_b16 v[168:169], v244 offset:6144
    ds_read_b64_tr_b16 v[170:171], v245 offset:6656
    ds_read_b64_tr_b16 v[172:173], v244 offset:7168
    ds_read_b64_tr_b16 v[174:175], v245 offset:7680
    ds_read_u8 v238, v246 offset:0
    ds_read_u8 v240, v246 offset:8
    ds_read_b32 v254, v253
    ds_read_b128 v[152:155], v242 offset:0
    ds_read_b128 v[156:159], v243 offset:0
    v_exp_f32 v108, v108
    v_exp_f32 v109, v109
    v_exp_f32 v110, v110
    v_exp_f32 v111, v111
    s_waitcnt lgkmcnt(9)
    v_mfma_f32_4x4x4_16b_bf16 v[176:179], v[236:237], v[160:161], v[176:179] cbsz:4 abid:0
    v_exp_f32 v112, v112
    v_exp_f32 v113, v113
    v_mfma_f32_4x4x4_16b_bf16 v[176:179], v[236:237], v[162:163], v[176:179] cbsz:4 abid:1
    v_exp_f32 v114, v114
    v_exp_f32 v115, v115
    v_mfma_f32_4x4x4_16b_bf16 v[176:179], v[236:237], v[164:165], v[176:179] cbsz:4 abid:2
    v_exp_f32 v116, v116
    v_exp_f32 v117, v117
    v_mfma_f32_4x4x4_16b_bf16 v[176:179], v[236:237], v[166:167], v[176:179] cbsz:4 abid:3
    v_exp_f32 v118, v118
    v_exp_f32 v119, v119
    .p2align 3
    v_pk_add_f32 v[2:3], v[104:105], 1.0 op_sel_hi:[1,0]
    v_pk_fma_f32 v[0:1], v[120:121], v[106:107], v[120:121]
    v_pk_fma_f32 v[0:1], v[122:123], v[2:3], v[0:1]
    v_pk_fma_f32 v[2:3], v[106:107], v[2:3], v[2:3]
    v_pk_fma_f32 v[0:1], v[108:109], v[0:1], v[0:1]
    v_pk_fma_f32 v[0:1], v[124:125], v[2:3], v[0:1]
    v_pk_fma_f32 v[2:3], v[108:109], v[2:3], v[2:3]
    v_pk_fma_f32 v[0:1], v[110:111], v[0:1], v[0:1]
    v_pk_fma_f32 v[0:1], v[126:127], v[2:3], v[0:1]
    v_pk_fma_f32 v[2:3], v[110:111], v[2:3], v[2:3]
    v_pk_fma_f32 v[0:1], v[112:113], v[0:1], v[0:1]
    v_pk_fma_f32 v[0:1], v[128:129], v[2:3], v[0:1]
    v_pk_fma_f32 v[2:3], v[112:113], v[2:3], v[2:3]
    v_pk_fma_f32 v[0:1], v[114:115], v[0:1], v[0:1]
    v_pk_fma_f32 v[0:1], v[130:131], v[2:3], v[0:1]
    v_pk_fma_f32 v[2:3], v[114:115], v[2:3], v[2:3]
    v_pk_fma_f32 v[0:1], v[116:117], v[0:1], v[0:1]
    v_pk_fma_f32 v[0:1], v[132:133], v[2:3], v[0:1]
    v_pk_fma_f32 v[2:3], v[116:117], v[2:3], v[2:3]
    v_pk_fma_f32 v[0:1], v[118:119], v[0:1], v[0:1]
    v_pk_fma_f32 v[0:1], v[134:135], v[2:3], v[0:1]
    v_pk_fma_f32 v[2:3], v[118:119], v[2:3], v[2:3]
    s_waitcnt lgkmcnt(0)
    buffer_load_dwordx4 v[238:239], s[20:23], s72 idxen offen nt lds
    buffer_load_dwordx4 v[240:241], s[20:23], s51 idxen offen offset:1024 nt lds
    s_cbranch_scc0 U_0
CEV:
    s_cmp_eq_u32 s76, 0
    s_cbranch_scc1 EPI
    s_mov_b32 s53, s52
    s_and_b32 s52, s68, 0xffff
    s_lshr_b64 s[68:69], s[68:69], 16
    s_sub_u32 s75, s75, 16
    s_bitcmp1_b32 s52, 6
    s_cbranch_scc1 DRAIN
BPF:
    s_and_b32 s57, s52, 63
    s_mul_i32 s57, s57, 528
    s_add_u32 s57, s57, 83200
    v_lshl_add_u32 v6, v252, 1, s57
    v_add_u32 v7, s57, v252
    ds_read_b128 v[104:107], v6 offset:0
    ds_read_b128 v[108:111], v6 offset:16
    ds_read_b128 v[144:147], v251 offset:12288
    ds_read_b128 v[148:151], v251 offset:13312
    ds_read_b128 v[112:115], v6 offset:128
    ds_read_b128 v[116:119], v6 offset:144
    s_mov_b32 s62, 0
    s_mov_b32 s76, 0
    s_cmp_lg_u32 s77, 0
    s_waitcnt lgkmcnt(4)
    .p2align 3
    v_pk_fma_f32 v[136:137], v[8:9], v[104:105], v[180:181]
    v_pk_fma_f32 v[138:139], v[10:11], v[106:107], v[182:183]
    v_pk_fma_f32 v[140:141], v[12:13], v[108:109], v[184:185]
    v_pk_fma_f32 v[142:143], v[14:15], v[110:111], v[186:187]
    v_cvt_pk_bf16_f32 v72, v136, v137
    v_cvt_pk_bf16_f32 v73, v138, v139
    v_cvt_pk_bf16_f32 v74, v140, v141
    v_cvt_pk_bf16_f32 v75, v142, v143
    v_pk_fma_f32 v[136:137], v[24:25], v[104:105], v[196:197]
    v_pk_fma_f32 v[138:139], v[26:27], v[106:107], v[198:199]
    v_pk_fma_f32 v[140:141], v[28:29], v[108:109], v[200:201]
    v_pk_fma_f32 v[142:143], v[30:31], v[110:111], v[202:203]
    v_cvt_pk_bf16_f32 v80, v136, v137
    v_cvt_pk_bf16_f32 v81, v138, v139
    v_cvt_pk_bf16_f32 v82, v140, v141
    v_cvt_pk_bf16_f32 v83, v142, v143
    v_pk_fma_f32 v[136:137], v[40:41], v[104:105], v[212:213]
    v_pk_fma_f32 v[138:139], v[42:43], v[106:107], v[214:215]
    v_pk_fma_f32 v[140:141], v[44:45], v[108:109], v[216:217]
    v_pk_fma_f32 v[142:143], v[46:47], v[110:111], v[218:219]
    v_cvt_pk_bf16_f32 v88, v136, v137
    v_cvt_pk_bf16_f32 v89, v138, v139
    v_cvt_pk_bf16_f32 v90, v140, v141
    v_cvt_pk_bf16_f32 v91, v142, v143
    s_waitcnt lgkmcnt(0)
    .p2align 3
    v_pk_fma_f32 v[144:145], v[56:57], v[104:105], v[144:145]
    v_pk_fma_f32 v[146:147], v[58:59], v[106:107], v[146:147]
    v_pk_fma_f32 v[148:149], v[60:61], v[108:109], v[148:149]
    v_pk_fma_f32 v[150:151], v[62:63], v[110:111], v[150:151]
    v_cvt_pk_bf16_f32 v96, v144, v145
    v_cvt_pk_bf16_f32 v97, v146, v147
    v_cvt_pk_bf16_f32 v98, v148, v149
    v_cvt_pk_bf16_f32 v99, v150, v151
    ds_read_b128 v[136:139], v7 offset:256
    ds_read_b128 v[140:143], v7 offset:320
    ds_read_b128 v[144:147], v7 offset:384
    ds_read_b128 v[148:151], v7 offset:448
    v_pk_fma_f32 v[104:105], v[16:17], v[112:113], v[188:189]
    v_pk_fma_f32 v[106:107], v[18:19], v[114:115], v[190:191]
    v_pk_fma_f32 v[108:109], v[20:21], v[116:117], v[192:193]
    v_pk_fma_f32 v[110:111], v[22:23], v[118:119], v[194:195]
    v_cvt_pk_bf16_f32 v76, v104, v105
    v_cvt_pk_bf16_f32 v77, v106, v107
    v_cvt_pk_bf16_f32 v78, v108, v109
    v_cvt_pk_bf16_f32 v79, v110, v111
    v_pk_fma_f32 v[104:105], v[32:33], v[112:113], v[204:205]
    v_pk_fma_f32 v[106:107], v[34:35], v[114:115], v[206:207]
    v_pk_fma_f32 v[108:109], v[36:37], v[116:117], v[208:209]
    v_pk_fma_f32 v[110:111], v[38:39], v[118:119], v[210:211]
    v_cvt_pk_bf16_f32 v84, v104, v105
    v_cvt_pk_bf16_f32 v85, v106, v107
    v_cvt_pk_bf16_f32 v86, v108, v109
    v_cvt_pk_bf16_f32 v87, v110, v111
    v_pk_fma_f32 v[104:105], v[48:49], v[112:113], v[220:221]
    v_pk_fma_f32 v[106:107], v[50:51], v[114:115], v[222:223]
    v_pk_fma_f32 v[108:109], v[52:53], v[116:117], v[224:225]
    v_pk_fma_f32 v[110:111], v[54:55], v[118:119], v[226:227]
    v_cvt_pk_bf16_f32 v92, v104, v105
    v_cvt_pk_bf16_f32 v93, v106, v107
    v_cvt_pk_bf16_f32 v94, v108, v109
    v_cvt_pk_bf16_f32 v95, v110, v111
    v_pk_fma_f32 v[104:105], v[64:65], v[112:113], v[228:229]
    v_pk_fma_f32 v[106:107], v[66:67], v[114:115], v[230:231]
    v_pk_fma_f32 v[108:109], v[68:69], v[116:117], v[232:233]
    v_pk_fma_f32 v[110:111], v[70:71], v[118:119], v[234:235]
    v_cvt_pk_bf16_f32 v100, v104, v105
    v_cvt_pk_bf16_f32 v101, v106, v107
    v_cvt_pk_bf16_f32 v102, v108, v109
    v_cvt_pk_bf16_f32 v103, v110, v111
    s_waitcnt lgkmcnt(0)
    s_cbranch_scc1 BP_X
NEXT:
    s_cmp_eq_u32 s73, 0
    s_cbranch_scc1 U_1
    s_cmp_eq_u32 s73, 1
    s_cbranch_scc1 U_2
    s_cmp_eq_u32 s73, 2
    s_cbranch_scc1 U_3
    s_branch U_0
EPI:
    s_and_b32 s56, s53, 0x7f
    v_pk_add_f32 v[4:5], v[176:177], v[178:179]
    v_add_f32 v4, v4, v5
    v_lshl_add_u32 v5, s56, 8, v250
    v_mul_f32 v4, s46, v4
    s_bitcmp1_b32 s53, 7
    v_cmp_class_f32_e64 vcc, v4, s45
    v_mov_b64 v[176:177], 0
    v_mov_b64 v[178:179], 0
    ds_write_b32 v5, v4
    s_cbranch_scc1 SLOW
    s_cbranch_vccnz SLOW
EPI_R:
    s_bitcmp1_b32 s52, 6
    s_cbranch_scc1 L_DONE
EPI_C:
    s_bfe_u32 s62, s52, 0x40008
    s_sub_u32 s62, s62, 2
    s_mov_b32 s76, 1
    s_cmp_eq_u32 s73, 0
    s_cbranch_scc1 U_1
    s_cmp_eq_u32 s73, 1
    s_cbranch_scc1 U_2
    s_cmp_eq_u32 s73, 2
    s_cbranch_scc1 U_3
    s_branch U_0
PEV:
    s_cmp_eq_u32 s55, 0
    s_cbranch_scc1 P_DR
ADV:
    v_readfirstlane_b32 s66, v254
    s_mov_b32 s67, 0
    s_and_b32 s56, s66, 63
    s_bfe_u32 s50, s66, 0x40008
    s_cbranch_scc0 AW
    s_mul_i32 s51, s56, 25600
    v_lshl_add_u32 v246, s56, 8, v247
    s_add_u32 s51, s51, s49
    s_add_u32 s72, s51, 1024
    s_lshl_b64 s[64:65], s[66:67], s75
    s_or_b64 s[68:69], s[68:69], s[64:65]
    s_add_u32 s75, s75, 16
    s_mov_b32 s55, 0
    s_sub_u32 s50, s50, 3
    s_cbranch_scc1 P_2
P_RET:
    s_cmp_eq_u32 s73, 0
    s_cbranch_scc1 RET_0
    s_cmp_eq_u32 s73, 1
    s_cbranch_scc1 RET_1
    s_cmp_eq_u32 s73, 2
    s_cbranch_scc1 RET_2
    s_branch RET_3
P_DR:
    v_add_u32 v246, 16, v246
P_D2:
    s_mov_b64 exec, 1
    v_mov_b32 v253, 4
    ds_add_rtn_u32 v253, v251, v253 offset:17600
    s_mov_b64 exec, -1
    s_mov_b32 s50, 1
    s_mov_b32 s55, 1
    s_cmp_eq_u32 s73, 0
    s_cbranch_scc1 RET_0
    s_cmp_eq_u32 s73, 1
    s_cbranch_scc1 RET_1
    s_cmp_eq_u32 s73, 2
    s_cbranch_scc1 RET_2
    s_branch RET_3
P_2:
    s_bitcmp1_b32 s66, 6
    s_cbranch_scc0 P_D2
    v_mov_b32 v246, 16896
    s_movk_i32 s50, 0x100
    s_branch P_RET
DRAIN:
    v_rcp_f32 v2, v2
    v_rcp_f32 v3, v3
    v_fma_f32 v0, v0, v2, s44
    v_fmac_f32 v0, v1, v3
    v_cvt_pk_bf16_f32 v0, v0, v0
    s_bitcmp1_b32 s73, 0
    ds_write_b16 v249, v0
    ds_read_b64 v[236:237], v248
    s_waitcnt lgkmcnt(0)
    s_cbranch_scc1 DRAIN1
    v_mfma_f32_4x4x4_16b_bf16 v[176:179], v[236:237], v[160:161], v[176:179] cbsz:4 abid:0
    s_nop 1
    v_mfma_f32_4x4x4_16b_bf16 v[176:179], v[236:237], v[162:163], v[176:179] cbsz:4 abid:1
    s_nop 1
    v_mfma_f32_4x4x4_16b_bf16 v[176:179], v[236:237], v[164:165], v[176:179] cbsz:4 abid:2
    s_nop 1
    v_mfma_f32_4x4x4_16b_bf16 v[176:179], v[236:237], v[166:167], v[176:179] cbsz:4 abid:3
    s_nop 2
    s_branch EPI
DRAIN1:
    v_mfma_f32_4x4x4_16b_bf16 v[176:179], v[236:237], v[168:169], v[176:179] cbsz:4 abid:0
    s_nop 1
    v_mfma_f32_4x4x4_16b_bf16 v[176:179], v[236:237], v[170:171], v[176:179] cbsz:4 abid:1
    s_nop 1
    v_mfma_f32_4x4x4_16b_bf16 v[176:179], v[236:237], v[172:173], v[176:179] cbsz:4 abid:2
    s_nop 1
    v_mfma_f32_4x4x4_16b_bf16 v[176:179], v[236:237], v[174:175], v[176:179] cbsz:4 abid:3
    s_nop 2
    s_branch EPI
L_DONE:
    s_lshl_b32 s56, s48, 11
    s_add_u32 s56, s56, 133376
    v_lshl_add_u32 v0, v251, 1, s56
    s_lshl_b32 s56, s48, 10
    s_waitcnt lgkmcnt(0)
    s_barrier
    ds_read_b128 v[104:107], v0 offset:0
    ds_read_b128 v[108:111], v0 offset:16
    s_waitcnt lgkmcnt(0)
    v_cvt_pk_bf16_f32 v152, v104, v105
    v_cvt_pk_bf16_f32 v153, v106, v107
    v_cvt_pk_bf16_f32 v154, v108, v109
    v_cvt_pk_bf16_f32 v155, v110, v111
    buffer_store_dwordx4 v[152:155], v251, s[28:31], s56 offen nt
L_FIN:
    s_endpgm
AW:
    s_sleep 1
    ds_read_b32 v254, v253
    s_waitcnt lgkmcnt(0)
    s_branch ADV
DRAW_P:
    s_mov_b64 exec, 1
    v_mov_b32 v253, 4
    ds_add_rtn_u32 v253, v251, v253 offset:17600
    s_mov_b64 exec, -1
    s_add_u32 s50, s50, 2
    s_mov_b32 s55, 1
    s_waitcnt lgkmcnt(0)
    ds_read_b32 v254, v253
    s_branch DRET_P
BP_X:
    s_cmp_eq_u32 s77, 1
    s_mov_b32 s77, 0
    s_cbranch_scc1 SLOW_W
    s_branch EPI_C
SLOW:
    s_bitcmp1_b32 s53, 6
    s_cbranch_scc1 EPI_R
    s_mov_b32 s74, s52
    s_mov_b32 s52, s53
    s_mov_b32 s77, 1
    ds_write_b32 v5, v176
    s_branch BPF
SLOW_W:
    s_mov_b32 s52, s74
    s_and_b32 s56, s53, 63
    s_lshr_b32 s57, s53, 12
    s_bfe_u32 s59, s53, 0x40008
    s_lshl4_add_u32 s57, s56, s57
    s_lshl_b32 s57, s57, 4
    s_add_u32 s74, s57, 116992
    s_bitcmp1_b32 s53, 7
    s_cselect_b64 s[66:67], -1, 0
    s_cselect_b32 s59, 13, s59
    v_bfe_u32 v204, v251, 4, 4
    v_mov_b32 v207, v252
    v_mov_b64 v[180:181], 0
    v_mov_b64 v[182:183], 0
    v_mov_b64 v[184:185], 0
    v_mov_b64 v[186:187], 0
    v_mov_b64 v[188:189], 0
    v_mov_b64 v[190:191], 0
    v_mov_b64 v[192:193], 0
    v_mov_b64 v[194:195], 0
    s_mul_i32 s57, s56, 25600
    s_add_u32 s57, s57, s49
    s_mul_i32 s58, s56, 400
SLOW_L:
    v_add_u32 v205, s74, v204
    ds_read_u8 v206, v205
    s_waitcnt lgkmcnt(0)
    v_cndmask_b32_e64 v206, v206, v204, s[66:67]
    v_lshlrev_b32 v205, 1, v206
    buffer_load_dwordx4 v[196:199], v[206:207], s[20:23], s57 idxen offen offset:1024
    buffer_load_dwordx4 v[200:203], v[206:207], s[20:23], s57 idxen offen offset:1088
    buffer_load_ushort v205, v205, s[24:27], s58 offen
    v_cmp_gt_u32 vcc, 200, v206
    v_add_u32 v204, 16, v204
    s_waitcnt vmcnt(0)
    v_mfma_f32_16x16x32_bf16 v[104:107], v[72:75], v[196:199], v[136:139]
    v_mfma_f32_16x16x32_bf16 v[104:107], v[76:79], v[200:203], v[104:107]
    v_mfma_f32_16x16x32_bf16 v[108:111], v[80:83], v[196:199], v[140:143]
    v_mfma_f32_16x16x32_bf16 v[108:111], v[84:87], v[200:203], v[108:111]
    v_mfma_f32_16x16x32_bf16 v[112:115], v[88:91], v[196:199], v[144:147]
    v_mfma_f32_16x16x32_bf16 v[112:115], v[92:95], v[200:203], v[112:115]
    v_mfma_f32_16x16x32_bf16 v[116:119], v[96:99], v[196:199], v[148:151]
    v_mfma_f32_16x16x32_bf16 v[116:119], v[100:103], v[200:203], v[116:119]
    v_lshlrev_b32 v205, 16, v205
    v_cndmask_b32 v205, 0, v205, vcc
    s_nop 7
    v_exp_f32 v104, v104
    v_exp_f32 v105, v105
    v_exp_f32 v106, v106
    v_exp_f32 v107, v107
    v_exp_f32 v108, v108
    v_exp_f32 v109, v109
    v_exp_f32 v110, v110
    v_exp_f32 v111, v111
    v_exp_f32 v112, v112
    v_exp_f32 v113, v113
    v_exp_f32 v114, v114
    v_exp_f32 v115, v115
    v_exp_f32 v116, v116
    v_exp_f32 v117, v117
    v_exp_f32 v118, v118
    v_exp_f32 v119, v119
    v_add_f32 v104, 1.0, v104
    v_add_f32 v105, 1.0, v105
    v_add_f32 v106, 1.0, v106
    v_add_f32 v107, 1.0, v107
    v_add_f32 v108, 1.0, v108
    v_add_f32 v109, 1.0, v109
    v_add_f32 v110, 1.0, v110
    v_add_f32 v111, 1.0, v111
    v_add_f32 v112, 1.0, v112
    v_add_f32 v113, 1.0, v113
    v_add_f32 v114, 1.0, v114
    v_add_f32 v115, 1.0, v115
    v_add_f32 v116, 1.0, v116
    v_add_f32 v117, 1.0, v117
    v_add_f32 v118, 1.0, v118
    v_add_f32 v119, 1.0, v119
    v_rcp_f32 v104, v104
    v_rcp_f32 v105, v105
    v_rcp_f32 v106, v106
    v_rcp_f32 v107, v107
    v_rcp_f32 v108, v108
    v_rcp_f32 v109, v109
    v_rcp_f32 v110, v110
    v_rcp_f32 v111, v111
    v_rcp_f32 v112, v112
    v_rcp_f32 v113, v113
    v_rcp_f32 v114, v114
    v_rcp_f32 v115, v115
    v_rcp_f32 v116, v116
    v_rcp_f32 v117, v117
    v_rcp_f32 v118, v118
    v_rcp_f32 v119, v119
    v_mul_f32 v208, v104, v120
    v_fmac_f32 v208, v105, v121
    v_fmac_f32 v208, v106, v122
    v_fmac_f32 v208, v107, v123
    v_fmac_f32 v208, v108, v124
    v_fmac_f32 v208, v109, v125
    v_fmac_f32 v208, v110, v126
    v_fmac_f32 v208, v111, v127
    v_fmac_f32 v208, v112, v128
    v_fmac_f32 v208, v113, v129
    v_fmac_f32 v208, v114, v130
    v_fmac_f32 v208, v115, v131
    v_fmac_f32 v208, v116, v132
    v_fmac_f32 v208, v117, v133
    v_fmac_f32 v208, v118, v134
    v_fmac_f32 v208, v119, v135
    v_mov_b32 v209, v208
    s_nop 1
    v_permlane32_swap_b32 v208, v209
    v_add_f32 v208, v208, v209
    v_mov_b32 v209, v208
    s_nop 1
    v_permlane16_swap_b32 v208, v209
    v_add_f32 v208, v208, v209
    v_mul_f32 v208, s46, v208
    v_add_f32 v208, s63, v208
    v_mul_f32 v208, v208, v205
    v_lshlrev_b32 v209, 16, v196
    v_and_b32 v210, 0xffff0000, v196
    v_fmac_f32 v180, v208, v209
    v_fmac_f32 v181, v208, v210
    v_lshlrev_b32 v209, 16, v197
    v_and_b32 v210, 0xffff0000, v197
    v_fmac_f32 v182, v208, v209
    v_fmac_f32 v183, v208, v210
    v_lshlrev_b32 v209, 16, v198
    v_and_b32 v210, 0xffff0000, v198
    v_fmac_f32 v184, v208, v209
    v_fmac_f32 v185, v208, v210
    v_lshlrev_b32 v209, 16, v199
    v_and_b32 v210, 0xffff0000, v199
    v_fmac_f32 v186, v208, v209
    v_fmac_f32 v187, v208, v210
    v_lshlrev_b32 v209, 16, v200
    v_and_b32 v210, 0xffff0000, v200
    v_fmac_f32 v188, v208, v209
    v_fmac_f32 v189, v208, v210
    v_lshlrev_b32 v209, 16, v201
    v_and_b32 v210, 0xffff0000, v201
    v_fmac_f32 v190, v208, v209
    v_fmac_f32 v191, v208, v210
    v_lshlrev_b32 v209, 16, v202
    v_and_b32 v210, 0xffff0000, v202
    v_fmac_f32 v192, v208, v209
    v_fmac_f32 v193, v208, v210
    v_lshlrev_b32 v209, 16, v203
    v_and_b32 v210, 0xffff0000, v203
    v_fmac_f32 v194, v208, v209
    v_fmac_f32 v195, v208, v210
    s_sub_u32 s59, s59, 1
    s_cmp_lg_u32 s59, 0
    s_cbranch_scc1 SLOW_L
    v_readfirstlane_b32 s56, v5
    s_nop 1
    v_lshl_add_u32 v208, v252, 1, s56
    ds_add_f32 v208, v180 offset:0
    ds_add_f32 v208, v181 offset:4
    ds_add_f32 v208, v182 offset:8
    ds_add_f32 v208, v183 offset:12
    ds_add_f32 v208, v184 offset:16
    ds_add_f32 v208, v185 offset:20
    ds_add_f32 v208, v186 offset:24
    ds_add_f32 v208, v187 offset:28
    ds_add_f32 v208, v188 offset:128
    ds_add_f32 v208, v189 offset:132
    ds_add_f32 v208, v190 offset:136
    ds_add_f32 v208, v191 offset:140
    ds_add_f32 v208, v192 offset:144
    ds_add_f32 v208, v193 offset:148
    ds_add_f32 v208, v194 offset:152
    ds_add_f32 v208, v195 offset:156
    s_waitcnt lgkmcnt(0)
    s_bitcmp1_b32 s52, 6
    s_cbranch_scc1 L_DONE
    ds_read_b128 v[180:183], v251 offset:0
    ds_read_b128 v[184:187], v251 offset:1024
    ds_read_b128 v[196:199], v251 offset:4096
    ds_read_b128 v[200:203], v251 offset:5120
    ds_read_b128 v[212:215], v251 offset:8192
    ds_read_b128 v[216:219], v251 offset:9216
    ds_read_b128 v[188:191], v251 offset:2048
    ds_read_b128 v[192:195], v251 offset:3072
    ds_read_b128 v[204:207], v251 offset:6144
    ds_read_b128 v[208:211], v251 offset:7168
    ds_read_b128 v[220:223], v251 offset:10240
    ds_read_b128 v[224:227], v251 offset:11264
    ds_read_b128 v[228:231], v251 offset:14336
    ds_read_b128 v[232:235], v251 offset:15360
    s_mov_b32 s77, 2
    s_branch BPF
L_END:
    s_endpgm
.section .rodata,"a"
.p2align 6
.amdhsa_kernel standalone__sequential_behavior_din__recsys_kernel
  .amdhsa_next_free_vgpr 255
  .amdhsa_next_free_sgpr 78
  .amdhsa_accum_offset 256
  .amdhsa_group_segment_fixed_size 0
  .amdhsa_kernarg_size 80
  .amdhsa_user_sgpr_count 2
  .amdhsa_user_sgpr_kernarg_segment_ptr 1
  .amdhsa_system_sgpr_workgroup_id_x 1
.end_amdhsa_kernel
```

```asm
; @launch grid=(256,1,1) block=(512,1,1) lds=153856
.amdgcn_target "amdgcn-amd-amdhsa--gfx950"
.text
.globl standalone__sequential_behavior_din__recsys_kernel
.p2align 8
.type standalone__sequential_behavior_din__recsys_kernel,@function
standalone__sequential_behavior_din__recsys_kernel:
    s_cmpk_ge_u32 s2, 256
    s_cbranch_scc1 L_END
    s_load_dwordx16 s[4:19], s[0:1], 0
    s_setprio 3
    v_lshrrev_b32 v1, 6, v0
    v_and_b32 v176, 63, v0
    v_readfirstlane_b32 s48, v1
    s_getpc_b64 s[40:41]
L_PC:
    s_cmp_lt_u32 s48, 5
    s_cbranch_scc1 P_NC
    s_mov_b32 s42, L_END-L_PC
    s_mov_b32 s43, 0x20000
    v_subrev_u32 v150, 320, v0
    v_lshlrev_b32 v150, 6, v150
    buffer_load_dword v150, v150, s[40:43], 0 offen
P_NC:
    v_and_b32 v2, 31, v0
    v_bfe_u32 v3, v0, 5, 1
    v_cmp_gt_u32 vcc, 25, v2
    v_mul_u32_u24 v4, 400, v3
    v_lshl_add_u32 v179, v2, 4, v4
    v_bfrev_b32 v4, 8
    v_cndmask_b32 v179, v4, v179, vcc
    s_movk_i32 s26, 25600
    s_mul_i32 s57, s2, s26
    s_mul_i32 s71, s48, 800
    s_mov_b32 s27, 0x20000
    s_lshl_b32 s74, s48, 12
    s_lshl_b32 s53, s2, 13
    v_lshlrev_b32 v251, 4, v176
    v_lshlrev_b32 v120, 1, v176
    v_and_b32 v120, 32, v120
    v_xor_b32 v120, v120, v251
    v_xor_b32 v121, 64, v120
    s_mov_b32 s38, 32768
    s_mov_b32 s39, s27
    s_lshl_b32 s58, s48, 10
    s_movk_i32 s34, 8192
    s_mov_b32 s35, s27
    s_add_u32 m0, s74, 121088
    v_and_b32 v178, 15, v176
    v_lshrrev_b32 v177, 4, v176
    v_lshlrev_b32 v252, 4, v177
    v_mul_u32_u24 v208, 0x80008, v2
    v_lshrrev_b32 v238, 3, v176
    v_add_u32 v208, 0x10000, v208
    v_cmp_gt_u32 vcc, 32, v176
    s_waitcnt lgkmcnt(0)
    s_add_u32 s24, s8, s57
    s_addc_u32 s25, s9, 0
    s_mov_b64 s[36:37], s[10:11]
    buffer_load_dwordx4 v[204:207], v179, s[24:27], s71 offen offset:0 nt
    s_setprio 0
    s_add_u32 s32, s4, s53
    s_addc_u32 s33, s5, 0
    s_load_dword s63, s[16:17], 0
    s_cmp_lg_u32 s48, 0
    s_cbranch_scc1 P_LJ
    v_mov_b32 v146, s12
    v_mov_b32 v147, s13
    v_mov_b32 v148, s14
    v_mov_b32 v149, s15
    v_lshlrev_b32 v4, 2, v2
    v_cndmask_b32 v146, v146, v148, vcc
    v_cndmask_b32 v147, v147, v149, vcc
    v_add_co_u32 v146, vcc, v146, v4
    s_nop 1
    v_addc_co_u32 v147, vcc, 0, v147, vcc
    global_load_dword v146, v[146:147], off
P_LJ:
    buffer_load_dwordx4 v[124:127], v251, s[32:35], s58 offen nt
    buffer_load_dwordx4 v120, s[36:39], s74 offen offset:0 lds
    buffer_load_dwordx4 v121, s[36:39], s74 offen offset:1024 lds
    s_lshl1_add_u32 s54, s74, 17664
    s_mul_i32 s49, s2, 1638400
    s_lshl_b32 s57, s48, 9
    v_add_u32 v247, 116992, v238
    v_add_u32 v246, s57, v247
    s_add_u32 s56, s57, 116992
    v_add_u32 v209, 0x20002, v208
    v_add_u32 v210, 0x40004, v208
    v_add_u32 v211, 0x60006, v208
    s_sub_u32 s20, s6, 1024
    s_subb_u32 s21, s7, 0
    s_or_b32 s21, s21, 0x800000
    s_movk_i32 s22, 200
    s_mov_b32 s23, s27
    s_movk_i32 s61, 0x3f80
    v_lshlrev_b32 v250, 2, v176
    v_bfrev_b32 v2, v238
    v_lshrrev_b32 v2, 28, v2
    v_and_b32 v2, 6, v2
    v_xor_b32 v2, v2, v176
    v_and_b32 v2, 7, v2
    v_mul_u32_u24 v143, 528, v238
    v_lshlrev_b32 v239, 4, v2
    v_lshlrev_b32 v241, 4, v2
    v_lshlrev_b32 v153, 4, v2
    v_lshlrev_b32 v155, 4, v2
    s_add_u32 s28, s18, s53
    s_addc_u32 s29, s19, 0
    s_movk_i32 s30, 8192
    s_mov_b32 s31, s27
    s_mov_b32 s60, 0xbfb8aa3b
    s_mov_b32 s46, 0x2b800000
    s_mul_i32 s51, s48, 51200
    s_add_u32 s51, s51, s49
    s_add_u32 s72, s51, 1024
    v_bfrev_b32 v2, v178
    v_lshrrev_b32 v2, 28, v2
    v_and_b32 v2, 6, v2
    v_xor_b32 v2, v2, v177
    v_lshl_add_u32 v2, v2, 4, s54
    v_lshl_add_u32 v242, v178, 7, v2
    v_xor_b32 v243, 64, v242
    v_and_b32 v3, 3, v176
    v_bfe_u32 v2, v176, 2, 2
    v_lshlrev_b32 v7, 3, v3
    v_lshl_add_u32 v7, v2, 7, v7
    v_and_b32 v6, 8, v176
    v_lshlrev_b32 v6, 3, v6
    v_lshl_add_u32 v244, v177, 5, v7
    v_xor_b32 v244, v244, v6
    v_add_u32 v244, s54, v244
    v_xor_b32 v245, 32, v244
    s_lshl_b32 s57, s48, 7
    s_add_u32 s57, s57, 150016
    v_lshl_add_u32 v249, v2, 2, v177
    v_lshl_add_u32 v249, v249, 2, v3
    v_lshl_add_u32 v249, v249, 1, s57
    v_lshl_add_u32 v248, v178, 3, s57
    v_and_b32 v6, 0x60, v250
    v_or_b32 v6, v6, v7
    v_lshl_add_u32 v136, v177, 10, v6
    s_mul_i32 s57, s48, 0x1010
    s_and_b32 s57, s57, 0x1060
    v_xor_b32 v144, s57, v136
    v_add_u32 v136, 121088, v136
    v_add_u32 v144, 121088, v144
    v_xor_b32 v137, 32, v136
    v_xor_b32 v138, 64, v136
    v_xor_b32 v139, 96, v136
    s_and_b32 s59, s48, 4
    s_lshl_b32 s59, s59, 4
    v_xor_b32 v140, s59, v136
    v_xor_b32 v141, 32, v140
    s_and_b32 s57, s48, 3
    s_mul_i32 s57, s57, 8448
    s_lshl1_add_u32 s57, s59, s57
    s_add_u32 s57, s57, 83200
    v_mul_u32_u24 v145, 528, v178
    v_add3_u32 v145, v145, v252, s57
    v_lshl_add_u32 v142, s59, 1, v252
    s_mul_i32 s57, s48, 4224
    s_add_u32 s57, s57, 83200
    v_and_b32 v3, 0x70, v251
    v_add3_u32 v143, v143, v3, s57
    v_add_u32 v3, v143, v3
    s_lshl_b32 s57, s48, 11
    v_add_u32 v151, s57, v251
    s_mov_b32 s66, 0x1b0a0100
    s_mov_b32 s67, 0x966d4c33
    s_lshl_b32 s57, s48, 3
    s_lshr_b64 s[66:67], s[66:67], s57
    s_and_b32 s47, s66, 7
    s_bfe_u32 s70, s66, 0x50003
    s_lshl1_add_u32 s70, s70, 16
    s_mul_i32 s71, s70, 400
    buffer_load_dwordx4 v120, s[36:39], s74 offen offset:2048 lds
    buffer_load_dwordx4 v121, s[36:39], s74 offen offset:3072 lds
    s_cmp_eq_u32 s48, 0
    s_waitcnt vmcnt(6) lgkmcnt(0)
    s_cbranch_scc1 P_M0
    s_waitcnt vmcnt(5)
P_M0:
    s_call_b64 s[36:37], CMP
    s_branch P_C
    .p2align 3
CMP:
    v_cmp_eq_u16_e64 s[4:5], s61, v204
    v_cmp_eq_u16_sdwa s[6:7], v204, s61 src0_sel:WORD_1 src1_sel:WORD_0
    v_cmp_eq_u16_e64 s[8:9], s61, v205
    v_cmp_eq_u16_sdwa s[10:11], v205, s61 src0_sel:WORD_1 src1_sel:WORD_0
    v_cmp_eq_u16_e64 s[12:13], s61, v206
    v_cmp_eq_u16_sdwa s[14:15], v206, s61 src0_sel:WORD_1 src1_sel:WORD_0
    v_cmp_eq_u16_e64 s[16:17], s61, v207
    v_cmp_eq_u16_sdwa s[18:19], v207, s61 src0_sel:WORD_1 src1_sel:WORD_0
    v_lshrrev_b32 v7, 1, v251
    v_add_u32 v7, s56, v7
    v_mov_b64 v[4:5], -1
    ds_write_b64 v7, v[4:5]
    .p2align 3
    v_mbcnt_lo_u32_b32 v6, s4, 0
    v_mbcnt_hi_u32_b32 v6, s5, v6
    v_mbcnt_lo_u32_b32 v6, s6, v6
    v_mbcnt_hi_u32_b32 v6, s7, v6
    v_mbcnt_lo_u32_b32 v6, s8, v6
    v_mbcnt_hi_u32_b32 v6, s9, v6
    v_mbcnt_lo_u32_b32 v6, s10, v6
    v_mbcnt_hi_u32_b32 v6, s11, v6
    v_mbcnt_lo_u32_b32 v6, s12, v6
    v_mbcnt_hi_u32_b32 v6, s13, v6
    v_mbcnt_lo_u32_b32 v6, s14, v6
    v_mbcnt_hi_u32_b32 v6, s15, v6
    v_mbcnt_lo_u32_b32 v6, s16, v6
    v_mbcnt_hi_u32_b32 v6, s17, v6
    v_mbcnt_lo_u32_b32 v6, s18, v6
    v_mbcnt_hi_u32_b32 v6, s19, v6
    v_bcnt_u32_b32 v7, v204, 0
    v_readlane_b32 s59, v6, 31
    v_readlane_b32 s58, v6, 63
    v_add_u32 v6, s56, v6
    s_mov_b32 exec_lo, 0
    s_sub_u32 s57, 256, s59
    v_add_u32 v6, s57, v6
    s_mov_b32 exec_lo, -1
    v_mad_u32_u24 v7, v6, 7, v7
    s_sub_u32 s58, s58, s59
    s_mov_b64 exec, s[4:5]
    ds_write_b8 v6, v208
    v_add_u32 v6, 1, v6
    s_mov_b64 exec, s[6:7]
    ds_write_b8_d16_hi v6, v208
    v_add_u32 v6, 1, v6
    s_mov_b64 exec, s[8:9]
    ds_write_b8 v6, v209
    v_add_u32 v6, 1, v6
    s_mov_b64 exec, s[10:11]
    ds_write_b8_d16_hi v6, v209
    v_add_u32 v6, 1, v6
    s_mov_b64 exec, s[12:13]
    ds_write_b8 v6, v210
    v_add_u32 v6, 1, v6
    s_mov_b64 exec, s[14:15]
    ds_write_b8_d16_hi v6, v210
    v_add_u32 v6, 1, v6
    s_mov_b64 exec, s[16:17]
    ds_write_b8 v6, v211
    v_add_u32 v6, 1, v6
    s_mov_b64 exec, s[18:19]
    ds_write_b8_d16_hi v6, v211
    v_add_u32 v6, 1, v6
    s_mov_b64 exec, -1
    v_bcnt_u32_b32 v7, v205, v7
    v_bcnt_u32_b32 v7, v206, v7
    v_bcnt_u32_b32 v7, v207, v7
    v_mul_u32_u24 v6, 7, v6
    v_cmp_ne_u32 vcc, v6, v7
    s_min_u32 s64, vcc_lo, 1
    s_min_u32 s65, vcc_hi, 1
    s_lshl_b64 s[64:65], s[64:65], 15
    s_or_b32 s57, s59, s64
    s_or_b32 s58, s58, s65
    s_setpc_b64 s[36:37]
P_C:
    ds_read_u8 v238, v246 offset:0
    ds_read_u8 v240, v246 offset:8
    ds_read_u8 v152, v246 offset:16
    ds_read_u8 v154, v246 offset:24
    s_add_u32 m0, s54, 0
    s_waitcnt lgkmcnt(3)
    buffer_load_dwordx4 v[238:239], s[20:23], s72 idxen offen nt lds
    s_waitcnt lgkmcnt(2)
    buffer_load_dwordx4 v[240:241], s[20:23], s51 idxen offen offset:1024 nt lds
    s_add_u32 m0, s54, 2048
    s_waitcnt lgkmcnt(1)
    buffer_load_dwordx4 v[152:153], s[20:23], s72 idxen offen nt lds
    s_waitcnt lgkmcnt(0)
    buffer_load_dwordx4 v[154:155], s[20:23], s51 idxen offen offset:1024 nt lds
    s_lshl_b32 s63, s63, 16
    s_cmp_lg_u32 s48, 0
    s_waitcnt vmcnt(8)
    s_cbranch_scc1 P_SW_J
    v_lshlrev_b32 v148, 16, v146
    v_and_b32 v149, 0xffff0000, v146
    v_mov_b32 v4, -1
    v_mov_b32 v5, 0
    v_mov_b32 v6, 0x240
    v_lshrrev_b32 v0, 1, v251
    ds_write2st64_b32 v250, v4, v5 offset0:66 offset1:67
    s_mov_b32 exec_hi, 0
    v_max3_f32 v2, abs(v148), abs(v149), abs(s63)
    v_ldexp_f32 v148, v148, 40
    v_ldexp_f32 v149, v149, 40
    v_cmp_le_f32 vcc, 0x33800000, v2
    ds_write_b32 v250, v6 offset:17408
    s_mov_b32 exec_hi, -1
    s_movk_i32 s56, 0x3ff
    s_cmp_lg_u64 vcc, 0
    s_cmovk_i32 s56, 0x207
    v_mov_b32 v6, 17184
    v_mov_b32 v7, s56
    ds_write_b64 v0, v[148:149] offset:16384
    ds_write_b64 v5, v[6:7] offset:17600
P_SW_J:
    ds_write_b128 v143, v[124:127] offset:256
    ds_write_b128 v143, v[124:127] offset:384
    v_lshlrev_b32 v104, 16, v124
    v_and_b32 v105, 0xffff0000, v124
    v_lshlrev_b32 v106, 16, v125
    v_and_b32 v107, 0xffff0000, v125
    v_lshlrev_b32 v108, 16, v126
    v_and_b32 v109, 0xffff0000, v126
    v_lshlrev_b32 v110, 16, v127
    v_and_b32 v111, 0xffff0000, v127
    v_mul_f32 v104, s60, v104
    v_mul_f32 v105, s60, v105
    v_mul_f32 v106, s60, v106
    v_mul_f32 v107, s60, v107
    v_mul_f32 v108, s60, v108
    v_mul_f32 v109, s60, v109
    v_mul_f32 v110, s60, v110
    v_mul_f32 v111, s60, v111
    ds_write_b128 v3, v[104:107] offset:0
    ds_write_b128 v3, v[108:111] offset:16
    s_waitcnt vmcnt(4) lgkmcnt(2)
    s_barrier
    ds_read_b64_tr_b16 v[220:221], v144 offset:0
    ds_read_b64_tr_b16 v[222:223], v144 offset:512
    ds_read_b64_tr_b16 v[224:225], v144 offset:16384
    ds_read_b64_tr_b16 v[226:227], v144 offset:16896
    ds_read_b128 v[160:163], v145 offset:256
    ds_read_b128 v[164:167], v145 offset:320
    ds_read_b128 v[104:107], v142 offset:16640
    ds_read_b128 v[108:111], v142 offset:16704
    ds_read_b64_tr_b16 v[40:41], v140 offset:8192
    ds_read_b64_tr_b16 v[42:43], v140 offset:8704
    ds_read_b64_tr_b16 v[44:45], v141 offset:8192
    ds_read_b64_tr_b16 v[46:47], v141 offset:8704
    ds_read_b64_tr_b16 v[48:49], v140 offset:12288
    ds_read_b64_tr_b16 v[50:51], v140 offset:12800
    ds_read_b64_tr_b16 v[52:53], v141 offset:12288
    ds_read_b64_tr_b16 v[54:55], v141 offset:12800
    ds_read_b64_tr_b16 v[56:57], v140 offset:16384
    ds_read_b64_tr_b16 v[58:59], v140 offset:16896
    ds_read_b64_tr_b16 v[60:61], v141 offset:16384
    ds_read_b64_tr_b16 v[62:63], v141 offset:16896
    ds_read_b64_tr_b16 v[64:65], v140 offset:20480
    ds_read_b64_tr_b16 v[66:67], v140 offset:20992
    ds_read_b64_tr_b16 v[68:69], v141 offset:20480
    ds_read_b64_tr_b16 v[70:71], v141 offset:20992
    s_and_b32 s59, s57, 0xff
    s_lshr_b32 s57, s57, 8
    s_add_u32 s59, s59, 15
    s_lshr_b32 s59, s59, 4
    s_max_u32 s59, s59, 4
    s_lshl1_add_u32 s52, s48, s57
    s_lshl_b32 s57, s59, 8
    s_or_b32 s52, s52, s57
    s_sub_u32 s50, s59, 4
    s_and_b32 s59, s58, 0xff
    s_lshr_b32 s58, s58, 8
    s_add_u32 s59, s59, 15
    s_lshr_b32 s59, s59, 4
    s_max_u32 s59, s59, 2
    s_lshl1_add_u32 s74, s48, s58
    s_lshl_b32 s58, s59, 8
    s_or_b32 s74, s74, s58
    s_or_b32 s74, s74, 1
    s_waitcnt lgkmcnt(15)
    v_lshlrev_b32 v8, 16, v220
    v_and_b32 v9, 0xffff0000, v220
    v_lshlrev_b32 v16, 16, v224
    v_and_b32 v17, 0xffff0000, v224
    v_lshlrev_b32 v10, 16, v221
    v_and_b32 v11, 0xffff0000, v221
    v_lshlrev_b32 v18, 16, v225
    v_and_b32 v19, 0xffff0000, v225
    v_lshlrev_b32 v12, 16, v222
    v_and_b32 v13, 0xffff0000, v222
    v_lshlrev_b32 v20, 16, v226
    v_and_b32 v21, 0xffff0000, v226
    v_lshlrev_b32 v14, 16, v223
    v_and_b32 v15, 0xffff0000, v223
    v_lshlrev_b32 v22, 16, v227
    v_and_b32 v23, 0xffff0000, v227
    v_xor_b32 v168, 0x80008000, v160
    v_xor_b32 v169, 0x80008000, v161
    v_xor_b32 v170, 0x80008000, v162
    v_xor_b32 v171, 0x80008000, v163
    v_xor_b32 v172, 0x80008000, v164
    v_xor_b32 v173, 0x80008000, v165
    v_xor_b32 v174, 0x80008000, v166
    v_xor_b32 v175, 0x80008000, v167
    s_waitcnt lgkmcnt(12)
    v_mfma_f32_16x16x32_bf16 v[104:107], v[40:43], v[160:163], v[104:107]
    v_mfma_f32_16x16x32_bf16 v[108:111], v[44:47], v[160:163], v[108:111]
    v_add_f32 v112, v8, v16
    v_add_f32 v113, v9, v17
    s_waitcnt lgkmcnt(8)
    v_mfma_f32_16x16x32_bf16 v[104:107], v[48:51], v[164:167], v[104:107]
    v_mfma_f32_16x16x32_bf16 v[108:111], v[52:55], v[164:167], v[108:111]
    v_add_f32 v114, v10, v18
    v_add_f32 v115, v11, v19
    s_waitcnt lgkmcnt(4)
    v_mfma_f32_16x16x32_bf16 v[104:107], v[56:59], v[168:171], v[104:107]
    v_mfma_f32_16x16x32_bf16 v[108:111], v[60:63], v[168:171], v[108:111]
    v_add_f32 v116, v12, v20
    v_add_f32 v117, v13, v21
    s_waitcnt lgkmcnt(0)
    v_mfma_f32_16x16x32_bf16 v[104:107], v[64:67], v[172:175], v[104:107]
    v_mfma_f32_16x16x32_bf16 v[108:111], v[68:71], v[172:175], v[108:111]
    v_add_f32 v118, v14, v22
    v_add_f32 v119, v15, v23
    ds_read_b64_tr_b16 v[72:73], v136 offset:24576
    ds_read_b64_tr_b16 v[74:75], v136 offset:25088
    ds_read_b64_tr_b16 v[76:77], v136 offset:28672
    ds_read_b64_tr_b16 v[78:79], v136 offset:29184
    ds_read_b64_tr_b16 v[80:81], v137 offset:24576
    ds_read_b64_tr_b16 v[82:83], v137 offset:25088
    ds_read_b64_tr_b16 v[84:85], v137 offset:28672
    ds_read_b64_tr_b16 v[86:87], v137 offset:29184
    ds_read_b64_tr_b16 v[88:89], v138 offset:24576
    ds_read_b64_tr_b16 v[90:91], v138 offset:25088
    ds_read_b64_tr_b16 v[92:93], v138 offset:28672
    ds_read_b64_tr_b16 v[94:95], v138 offset:29184
    ds_read_b64_tr_b16 v[96:97], v139 offset:24576
    ds_read_b64_tr_b16 v[98:99], v139 offset:25088
    ds_read_b64_tr_b16 v[100:101], v139 offset:28672
    ds_read_b64_tr_b16 v[102:103], v139 offset:29184
    s_cmp_le_u32 s47, 0
    s_cbranch_scc1 P_MJ
    buffer_load_dwordx4 v[180:183], v179, s[24:27], s71 offen offset:0 nt
    s_cmp_le_u32 s47, 1
    s_cbranch_scc1 P_MJ
    buffer_load_dwordx4 v[184:187], v179, s[24:27], s71 offen offset:800 nt
    s_cmp_le_u32 s47, 2
    s_cbranch_scc1 P_MJ
    buffer_load_dwordx4 v[188:191], v179, s[24:27], s71 offen offset:1600 nt
    s_cmp_le_u32 s47, 3
    s_cbranch_scc1 P_MJ
    buffer_load_dwordx4 v[192:195], v179, s[24:27], s71 offen offset:2400 nt
    s_cmp_le_u32 s47, 4
    s_cbranch_scc1 P_MJ
    buffer_load_dwordx4 v[196:199], v179, s[24:27], s71 offen offset:3200 nt
    s_cmp_le_u32 s47, 5
    s_cbranch_scc1 P_MJ
    buffer_load_dwordx4 v[200:203], v179, s[24:27], s71 offen offset:4000 nt
P_MJ:
    v_mul_f32 v112, s60, v112
    v_mul_f32 v113, s60, v113
    v_mul_f32 v114, s60, v114
    v_mul_f32 v115, s60, v115
    v_mul_f32 v116, s60, v116
    v_mul_f32 v117, s60, v117
    v_mul_f32 v118, s60, v118
    v_mul_f32 v119, s60, v119
    ds_write_b128 v151, v[112:115] offset:0
    ds_write_b128 v151, v[116:119] offset:1024
    v_mul_f32 v104, s60, v104
    v_mul_f32 v105, s60, v105
    v_mul_f32 v106, s60, v106
    v_mul_f32 v107, s60, v107
    v_mul_f32 v108, s60, v108
    v_mul_f32 v109, s60, v109
    v_mul_f32 v110, s60, v110
    v_mul_f32 v111, s60, v111
    ds_write_b128 v145, v[104:107] offset:256
    ds_write_b128 v145, v[108:111] offset:320
    ds_read_b128 v[120:123], v252 offset:16384
    ds_read_b128 v[124:127], v252 offset:16448
    ds_read_b128 v[128:131], v252 offset:16512
    ds_read_b128 v[132:135], v252 offset:16576
    ds_read_b32 v150, v252 offset:17604
    s_lshl2_add_u32 s56, s48, 17184
    v_mov_b32 v253, s56
    v_mov_b32 v254, s74
    ds_write_b32 v253, v254
    v_ldexp_f32 v2, s63, 38
    v_add_u32 v250, 133376, v250
    v_mov_b64 v[168:169], 0
    v_mov_b64 v[170:171], 0
    v_mov_b64 v[172:173], 0
    v_mov_b64 v[174:175], 0
    v_readfirstlane_b32 s44, v2
    s_waitcnt lgkmcnt(15)
    v_lshlrev_b32 v8, 16, v72
    v_and_b32 v9, 0xffff0000, v72
    v_lshlrev_b32 v10, 16, v73
    v_and_b32 v11, 0xffff0000, v73
    v_lshlrev_b32 v12, 16, v74
    v_and_b32 v13, 0xffff0000, v74
    v_lshlrev_b32 v14, 16, v75
    v_and_b32 v15, 0xffff0000, v75
    v_lshlrev_b32 v16, 16, v76
    v_and_b32 v17, 0xffff0000, v76
    v_lshlrev_b32 v18, 16, v77
    v_and_b32 v19, 0xffff0000, v77
    v_lshlrev_b32 v20, 16, v78
    v_and_b32 v21, 0xffff0000, v78
    v_lshlrev_b32 v22, 16, v79
    v_and_b32 v23, 0xffff0000, v79
    v_lshlrev_b32 v24, 16, v80
    v_and_b32 v25, 0xffff0000, v80
    v_lshlrev_b32 v26, 16, v81
    v_and_b32 v27, 0xffff0000, v81
    v_lshlrev_b32 v28, 16, v82
    v_and_b32 v29, 0xffff0000, v82
    v_lshlrev_b32 v30, 16, v83
    v_and_b32 v31, 0xffff0000, v83
    v_lshlrev_b32 v32, 16, v84
    v_and_b32 v33, 0xffff0000, v84
    v_lshlrev_b32 v34, 16, v85
    v_and_b32 v35, 0xffff0000, v85
    v_lshlrev_b32 v36, 16, v86
    v_and_b32 v37, 0xffff0000, v86
    v_lshlrev_b32 v38, 16, v87
    v_and_b32 v39, 0xffff0000, v87
    s_waitcnt lgkmcnt(0)
    s_barrier
    v_readfirstlane_b32 s45, v150
    ds_read_u8 v238, v246 offset:32
    ds_read_u8 v240, v246 offset:40
    ds_read_u8 v152, v246 offset:48
    ds_read_u8 v154, v246 offset:56
    s_add_u32 m0, s54, 4096
    s_waitcnt lgkmcnt(3)
    buffer_load_dwordx4 v[238:239], s[20:23], s72 idxen offen nt lds
    s_waitcnt lgkmcnt(2)
    buffer_load_dwordx4 v[240:241], s[20:23], s51 idxen offen offset:1024 nt lds
    s_add_u32 m0, s54, 6144
    s_waitcnt lgkmcnt(1)
    buffer_load_dwordx4 v[152:153], s[20:23], s72 idxen offen nt lds
    s_waitcnt lgkmcnt(0)
    buffer_load_dwordx4 v[154:155], s[20:23], s51 idxen offen offset:1024 nt lds
    s_cmp_eq_u32 s47, 0
    s_cbranch_scc1 P_GO
    s_lshl_b32 s56, s70, 8
    s_add_u32 s56, s56, 116992
    s_waitcnt vmcnt(4)
    v_mov_b64 v[204:205], v[180:181]
    v_mov_b64 v[206:207], v[182:183]
    s_call_b64 s[36:37], CMP
    v_writelane_b32 v212, s57, 0
    v_writelane_b32 v212, s58, 1
    s_cmp_le_u32 s47, 1
    s_cbranch_scc1 LATE_D
    s_add_u32 s56, s56, 512
    v_mov_b64 v[204:205], v[184:185]
    v_mov_b64 v[206:207], v[186:187]
    s_call_b64 s[36:37], CMP
    v_writelane_b32 v212, s57, 2
    v_writelane_b32 v212, s58, 3
    s_cmp_le_u32 s47, 2
    s_cbranch_scc1 LATE_D
    s_add_u32 s56, s56, 512
    v_mov_b64 v[204:205], v[188:189]
    v_mov_b64 v[206:207], v[190:191]
    s_call_b64 s[36:37], CMP
    v_writelane_b32 v212, s57, 4
    v_writelane_b32 v212, s58, 5
    s_cmp_le_u32 s47, 3
    s_cbranch_scc1 LATE_D
    s_add_u32 s56, s56, 512
    v_mov_b64 v[204:205], v[192:193]
    v_mov_b64 v[206:207], v[194:195]
    s_call_b64 s[36:37], CMP
    v_writelane_b32 v212, s57, 6
    v_writelane_b32 v212, s58, 7
    s_cmp_le_u32 s47, 4
    s_cbranch_scc1 LATE_D
    s_add_u32 s56, s56, 512
    v_mov_b64 v[204:205], v[196:197]
    v_mov_b64 v[206:207], v[198:199]
    s_call_b64 s[36:37], CMP
    v_writelane_b32 v212, s57, 8
    v_writelane_b32 v212, s58, 9
    s_cmp_le_u32 s47, 5
    s_cbranch_scc1 LATE_D
    s_add_u32 s56, s56, 512
    v_mov_b64 v[204:205], v[200:201]
    v_mov_b64 v[206:207], v[202:203]
    s_call_b64 s[36:37], CMP
    v_writelane_b32 v212, s57, 10
    v_writelane_b32 v212, s58, 11
LATE_D:
    v_add_u32 v4, s70, v176
    s_lshl_b32 s56, s47, 1
    v_and_b32 v5, 0xff, v212
    v_add_u32 v5, 15, v5
    v_lshrrev_b32 v5, 4, v5
    v_max_u32 v5, 2, v5
    v_lshrrev_b32 v212, 8, v212
    v_or_b32 v212, v212, v4
    v_cmp_gt_u32 vcc, 64, v4
    v_lshl_or_b32 v6, v5, 8, v212
    v_lshlrev_b32 v4, 2, v4
    s_bfm_b64 s[66:67], s56, 0
    s_and_b64 exec, s[66:67], vcc
    ds_write_b32 v4, v6 offset:17152
    s_mov_b64 exec, -1
P_GO:
    ds_read_b128 v[180:183], v251 offset:0
    ds_read_b128 v[184:187], v251 offset:1024
    ds_read_b128 v[196:199], v251 offset:4096
    ds_read_b128 v[200:203], v251 offset:5120
    ds_read_b128 v[212:215], v251 offset:8192
    ds_read_b128 v[216:219], v251 offset:9216
    ds_read_b128 v[188:191], v251 offset:2048
    ds_read_b128 v[192:195], v251 offset:3072
    ds_read_b128 v[204:207], v251 offset:6144
    ds_read_b128 v[208:211], v251 offset:7168
    ds_read_b128 v[220:223], v251 offset:10240
    ds_read_b128 v[224:227], v251 offset:11264
    ds_read_b128 v[228:231], v251 offset:14336
    ds_read_b128 v[232:235], v251 offset:15360
    v_lshlrev_b32 v40, 16, v88
    v_and_b32 v41, 0xffff0000, v88
    v_lshlrev_b32 v42, 16, v89
    v_and_b32 v43, 0xffff0000, v89
    v_lshlrev_b32 v44, 16, v90
    v_and_b32 v45, 0xffff0000, v90
    v_lshlrev_b32 v46, 16, v91
    v_and_b32 v47, 0xffff0000, v91
    v_lshlrev_b32 v48, 16, v92
    v_and_b32 v49, 0xffff0000, v92
    v_lshlrev_b32 v50, 16, v93
    v_and_b32 v51, 0xffff0000, v93
    v_lshlrev_b32 v52, 16, v94
    v_and_b32 v53, 0xffff0000, v94
    v_lshlrev_b32 v54, 16, v95
    v_and_b32 v55, 0xffff0000, v95
    v_lshlrev_b32 v56, 16, v96
    v_and_b32 v57, 0xffff0000, v96
    v_lshlrev_b32 v58, 16, v97
    v_and_b32 v59, 0xffff0000, v97
    v_lshlrev_b32 v60, 16, v98
    v_and_b32 v61, 0xffff0000, v98
    v_lshlrev_b32 v62, 16, v99
    v_and_b32 v63, 0xffff0000, v99
    v_lshlrev_b32 v64, 16, v100
    v_and_b32 v65, 0xffff0000, v100
    v_lshlrev_b32 v66, 16, v101
    v_and_b32 v67, 0xffff0000, v101
    v_lshlrev_b32 v68, 16, v102
    v_and_b32 v69, 0xffff0000, v102
    v_lshlrev_b32 v70, 16, v103
    v_and_b32 v71, 0xffff0000, v103
    v_add_u32 v246, 48, v246
    v_mov_b64 v[0:1], 0
    v_mov_b32 v2, 1.0
    v_mov_b32 v3, 1.0
    v_mov_b64 v[176:177], 0
    v_mov_b64 v[178:179], 0
    s_mov_b64 s[68:69], 0
    s_mov_b32 s75, 0
    s_movk_i32 s53, 0x1040
    s_mov_b32 s73, 3
    s_mov_b32 s77, 0
    s_mov_b32 s55, 0
    s_sub_u32 s50, s50, 2
    s_cbranch_scc1 DRAW_P
DRET_P:
    s_waitcnt vmcnt(6)
    ds_read_b128 v[152:155], v242
    ds_read_b128 v[156:159], v243
    s_branch BPF
U_0:
    v_mfma_f32_16x16x32_bf16 v[104:107], v[72:75], v[152:155], v[136:139]
    s_add_u32 m0, s54, 0
    v_rcp_f32 v2, v2
    v_mfma_f32_16x16x32_bf16 v[104:107], v[76:79], v[156:159], v[104:107]
    s_mov_b32 s73, 0
    v_rcp_f32 v3, v3
    v_mfma_f32_16x16x32_bf16 v[108:111], v[80:83], v[152:155], v[140:143]
    s_sub_u32 s50, s50, 1
    v_fma_f32 v0, v0, v2, s44
    v_fmac_f32 v0, v1, v3
    v_mfma_f32_16x16x32_bf16 v[108:111], v[84:87], v[156:159], v[108:111]
    s_cbranch_scc1 PEV
    v_add_u32 v246, 16, v246
RET_0:
    v_cvt_pk_bf16_f32 v0, v0, v0
    v_mfma_f32_16x16x32_bf16 v[112:115], v[88:91], v[152:155], v[144:147]
    v_exp_f32 v104, v104
    v_mfma_f32_16x16x32_bf16 v[112:115], v[92:95], v[156:159], v[112:115]
    v_exp_f32 v105, v105
    v_mfma_f32_16x16x32_bf16 v[116:119], v[96:99], v[152:155], v[148:151]
    s_sub_u32 s62, s62, 1
    v_exp_f32 v106, v106
    v_mfma_f32_16x16x32_bf16 v[116:119], v[100:103], v[156:159], v[116:119]
    s_waitcnt vmcnt(3)
    v_exp_f32 v107, v107
    ds_write_b16 v249, v0
    ds_read_b64 v[236:237], v248
    ds_read_b64_tr_b16 v[160:161], v244 offset:0
    ds_read_b64_tr_b16 v[162:163], v245 offset:512
    ds_read_b64_tr_b16 v[164:165], v244 offset:1024
    ds_read_b64_tr_b16 v[166:167], v245 offset:1536
    ds_read_u8 v238, v246 offset:0
    ds_read_u8 v240, v246 offset:8
    ds_read_b32 v254, v253
    ds_read_b128 v[152:155], v242 offset:2048
    ds_read_b128 v[156:159], v243 offset:2048
    v_exp_f32 v108, v108
    v_exp_f32 v109, v109
    v_exp_f32 v110, v110
    v_exp_f32 v111, v111
    s_waitcnt lgkmcnt(9)
    v_mfma_f32_4x4x4_16b_bf16 v[176:179], v[236:237], v[168:169], v[176:179] cbsz:4 abid:0
    v_exp_f32 v112, v112
    v_exp_f32 v113, v113
    v_mfma_f32_4x4x4_16b_bf16 v[176:179], v[236:237], v[170:171], v[176:179] cbsz:4 abid:1
    v_exp_f32 v114, v114
    v_exp_f32 v115, v115
    v_mfma_f32_4x4x4_16b_bf16 v[176:179], v[236:237], v[172:173], v[176:179] cbsz:4 abid:2
    v_exp_f32 v116, v116
    v_exp_f32 v117, v117
    v_mfma_f32_4x4x4_16b_bf16 v[176:179], v[236:237], v[174:175], v[176:179] cbsz:4 abid:3
    v_exp_f32 v118, v118
    v_exp_f32 v119, v119
    .p2align 3
    v_pk_add_f32 v[2:3], v[104:105], 1.0 op_sel_hi:[1,0]
    v_pk_fma_f32 v[0:1], v[120:121], v[106:107], v[120:121]
    v_pk_fma_f32 v[0:1], v[122:123], v[2:3], v[0:1]
    v_pk_fma_f32 v[2:3], v[106:107], v[2:3], v[2:3]
    v_pk_fma_f32 v[0:1], v[108:109], v[0:1], v[0:1]
    v_pk_fma_f32 v[0:1], v[124:125], v[2:3], v[0:1]
    v_pk_fma_f32 v[2:3], v[108:109], v[2:3], v[2:3]
    v_pk_fma_f32 v[0:1], v[110:111], v[0:1], v[0:1]
    v_pk_fma_f32 v[0:1], v[126:127], v[2:3], v[0:1]
    v_pk_fma_f32 v[2:3], v[110:111], v[2:3], v[2:3]
    v_pk_fma_f32 v[0:1], v[112:113], v[0:1], v[0:1]
    v_pk_fma_f32 v[0:1], v[128:129], v[2:3], v[0:1]
    v_pk_fma_f32 v[2:3], v[112:113], v[2:3], v[2:3]
    v_pk_fma_f32 v[0:1], v[114:115], v[0:1], v[0:1]
    v_pk_fma_f32 v[0:1], v[130:131], v[2:3], v[0:1]
    v_pk_fma_f32 v[2:3], v[114:115], v[2:3], v[2:3]
    v_pk_fma_f32 v[0:1], v[116:117], v[0:1], v[0:1]
    v_pk_fma_f32 v[0:1], v[132:133], v[2:3], v[0:1]
    v_pk_fma_f32 v[2:3], v[116:117], v[2:3], v[2:3]
    v_pk_fma_f32 v[0:1], v[118:119], v[0:1], v[0:1]
    v_pk_fma_f32 v[0:1], v[134:135], v[2:3], v[0:1]
    v_pk_fma_f32 v[2:3], v[118:119], v[2:3], v[2:3]
    s_waitcnt lgkmcnt(0)
    buffer_load_dwordx4 v[238:239], s[20:23], s72 idxen offen nt lds
    buffer_load_dwordx4 v[240:241], s[20:23], s51 idxen offen offset:1024 nt lds
    s_cbranch_scc1 CEV
U_1:
    v_mfma_f32_16x16x32_bf16 v[104:107], v[72:75], v[152:155], v[136:139]
    s_add_u32 m0, s54, 2048
    v_rcp_f32 v2, v2
    v_mfma_f32_16x16x32_bf16 v[104:107], v[76:79], v[156:159], v[104:107]
    s_mov_b32 s73, 1
    v_rcp_f32 v3, v3
    v_mfma_f32_16x16x32_bf16 v[108:111], v[80:83], v[152:155], v[140:143]
    s_sub_u32 s50, s50, 1
    v_fma_f32 v0, v0, v2, s44
    v_fmac_f32 v0, v1, v3
    v_mfma_f32_16x16x32_bf16 v[108:111], v[84:87], v[156:159], v[108:111]
    s_cbranch_scc1 PEV
    v_add_u32 v246, 16, v246
RET_1:
    v_cvt_pk_bf16_f32 v0, v0, v0
    v_mfma_f32_16x16x32_bf16 v[112:115], v[88:91], v[152:155], v[144:147]
    v_exp_f32 v104, v104
    v_mfma_f32_16x16x32_bf16 v[112:115], v[92:95], v[156:159], v[112:115]
    v_exp_f32 v105, v105
    v_mfma_f32_16x16x32_bf16 v[116:119], v[96:99], v[152:155], v[148:151]
    s_sub_u32 s62, s62, 1
    v_exp_f32 v106, v106
    v_mfma_f32_16x16x32_bf16 v[116:119], v[100:103], v[156:159], v[116:119]
    s_waitcnt vmcnt(3)
    v_exp_f32 v107, v107
    ds_write_b16 v249, v0
    ds_read_b64 v[236:237], v248
    ds_read_b64_tr_b16 v[168:169], v244 offset:2048
    ds_read_b64_tr_b16 v[170:171], v245 offset:2560
    ds_read_b64_tr_b16 v[172:173], v244 offset:3072
    ds_read_b64_tr_b16 v[174:175], v245 offset:3584
    ds_read_u8 v238, v246 offset:0
    ds_read_u8 v240, v246 offset:8
    ds_read_b32 v254, v253
    ds_read_b128 v[152:155], v242 offset:4096
    ds_read_b128 v[156:159], v243 offset:4096
    v_exp_f32 v108, v108
    v_exp_f32 v109, v109
    v_exp_f32 v110, v110
    v_exp_f32 v111, v111
    s_waitcnt lgkmcnt(9)
    v_mfma_f32_4x4x4_16b_bf16 v[176:179], v[236:237], v[160:161], v[176:179] cbsz:4 abid:0
    v_exp_f32 v112, v112
    v_exp_f32 v113, v113
    v_mfma_f32_4x4x4_16b_bf16 v[176:179], v[236:237], v[162:163], v[176:179] cbsz:4 abid:1
    v_exp_f32 v114, v114
    v_exp_f32 v115, v115
    v_mfma_f32_4x4x4_16b_bf16 v[176:179], v[236:237], v[164:165], v[176:179] cbsz:4 abid:2
    v_exp_f32 v116, v116
    v_exp_f32 v117, v117
    v_mfma_f32_4x4x4_16b_bf16 v[176:179], v[236:237], v[166:167], v[176:179] cbsz:4 abid:3
    v_exp_f32 v118, v118
    v_exp_f32 v119, v119
    .p2align 3
    v_pk_add_f32 v[2:3], v[104:105], 1.0 op_sel_hi:[1,0]
    v_pk_fma_f32 v[0:1], v[120:121], v[106:107], v[120:121]
    v_pk_fma_f32 v[0:1], v[122:123], v[2:3], v[0:1]
    v_pk_fma_f32 v[2:3], v[106:107], v[2:3], v[2:3]
    v_pk_fma_f32 v[0:1], v[108:109], v[0:1], v[0:1]
    v_pk_fma_f32 v[0:1], v[124:125], v[2:3], v[0:1]
    v_pk_fma_f32 v[2:3], v[108:109], v[2:3], v[2:3]
    v_pk_fma_f32 v[0:1], v[110:111], v[0:1], v[0:1]
    v_pk_fma_f32 v[0:1], v[126:127], v[2:3], v[0:1]
    v_pk_fma_f32 v[2:3], v[110:111], v[2:3], v[2:3]
    v_pk_fma_f32 v[0:1], v[112:113], v[0:1], v[0:1]
    v_pk_fma_f32 v[0:1], v[128:129], v[2:3], v[0:1]
    v_pk_fma_f32 v[2:3], v[112:113], v[2:3], v[2:3]
    v_pk_fma_f32 v[0:1], v[114:115], v[0:1], v[0:1]
    v_pk_fma_f32 v[0:1], v[130:131], v[2:3], v[0:1]
    v_pk_fma_f32 v[2:3], v[114:115], v[2:3], v[2:3]
    v_pk_fma_f32 v[0:1], v[116:117], v[0:1], v[0:1]
    v_pk_fma_f32 v[0:1], v[132:133], v[2:3], v[0:1]
    v_pk_fma_f32 v[2:3], v[116:117], v[2:3], v[2:3]
    v_pk_fma_f32 v[0:1], v[118:119], v[0:1], v[0:1]
    v_pk_fma_f32 v[0:1], v[134:135], v[2:3], v[0:1]
    v_pk_fma_f32 v[2:3], v[118:119], v[2:3], v[2:3]
    s_waitcnt lgkmcnt(0)
    buffer_load_dwordx4 v[238:239], s[20:23], s72 idxen offen nt lds
    buffer_load_dwordx4 v[240:241], s[20:23], s51 idxen offen offset:1024 nt lds
    s_cbranch_scc1 CEV
U_2:
    v_mfma_f32_16x16x32_bf16 v[104:107], v[72:75], v[152:155], v[136:139]
    s_add_u32 m0, s54, 4096
    v_rcp_f32 v2, v2
    v_mfma_f32_16x16x32_bf16 v[104:107], v[76:79], v[156:159], v[104:107]
    s_mov_b32 s73, 2
    v_rcp_f32 v3, v3
    v_mfma_f32_16x16x32_bf16 v[108:111], v[80:83], v[152:155], v[140:143]
    s_sub_u32 s50, s50, 1
    v_fma_f32 v0, v0, v2, s44
    v_fmac_f32 v0, v1, v3
    v_mfma_f32_16x16x32_bf16 v[108:111], v[84:87], v[156:159], v[108:111]
    s_cbranch_scc1 PEV
    v_add_u32 v246, 16, v246
RET_2:
    v_cvt_pk_bf16_f32 v0, v0, v0
    v_mfma_f32_16x16x32_bf16 v[112:115], v[88:91], v[152:155], v[144:147]
    v_exp_f32 v104, v104
    v_mfma_f32_16x16x32_bf16 v[112:115], v[92:95], v[156:159], v[112:115]
    v_exp_f32 v105, v105
    v_mfma_f32_16x16x32_bf16 v[116:119], v[96:99], v[152:155], v[148:151]
    s_sub_u32 s62, s62, 1
    v_exp_f32 v106, v106
    v_mfma_f32_16x16x32_bf16 v[116:119], v[100:103], v[156:159], v[116:119]
    s_waitcnt vmcnt(3)
    v_exp_f32 v107, v107
    ds_write_b16 v249, v0
    ds_read_b64 v[236:237], v248
    ds_read_b64_tr_b16 v[160:161], v244 offset:4096
    ds_read_b64_tr_b16 v[162:163], v245 offset:4608
    ds_read_b64_tr_b16 v[164:165], v244 offset:5120
    ds_read_b64_tr_b16 v[166:167], v245 offset:5632
    ds_read_u8 v238, v246 offset:0
    ds_read_u8 v240, v246 offset:8
    ds_read_b32 v254, v253
    ds_read_b128 v[152:155], v242 offset:6144
    ds_read_b128 v[156:159], v243 offset:6144
    v_exp_f32 v108, v108
    v_exp_f32 v109, v109
    v_exp_f32 v110, v110
    v_exp_f32 v111, v111
    s_waitcnt lgkmcnt(9)
    v_mfma_f32_4x4x4_16b_bf16 v[176:179], v[236:237], v[168:169], v[176:179] cbsz:4 abid:0
    v_exp_f32 v112, v112
    v_exp_f32 v113, v113
    v_mfma_f32_4x4x4_16b_bf16 v[176:179], v[236:237], v[170:171], v[176:179] cbsz:4 abid:1
    v_exp_f32 v114, v114
    v_exp_f32 v115, v115
    v_mfma_f32_4x4x4_16b_bf16 v[176:179], v[236:237], v[172:173], v[176:179] cbsz:4 abid:2
    v_exp_f32 v116, v116
    v_exp_f32 v117, v117
    v_mfma_f32_4x4x4_16b_bf16 v[176:179], v[236:237], v[174:175], v[176:179] cbsz:4 abid:3
    v_exp_f32 v118, v118
    v_exp_f32 v119, v119
    .p2align 3
    v_pk_add_f32 v[2:3], v[104:105], 1.0 op_sel_hi:[1,0]
    v_pk_fma_f32 v[0:1], v[120:121], v[106:107], v[120:121]
    v_pk_fma_f32 v[0:1], v[122:123], v[2:3], v[0:1]
    v_pk_fma_f32 v[2:3], v[106:107], v[2:3], v[2:3]
    v_pk_fma_f32 v[0:1], v[108:109], v[0:1], v[0:1]
    v_pk_fma_f32 v[0:1], v[124:125], v[2:3], v[0:1]
    v_pk_fma_f32 v[2:3], v[108:109], v[2:3], v[2:3]
    v_pk_fma_f32 v[0:1], v[110:111], v[0:1], v[0:1]
    v_pk_fma_f32 v[0:1], v[126:127], v[2:3], v[0:1]
    v_pk_fma_f32 v[2:3], v[110:111], v[2:3], v[2:3]
    v_pk_fma_f32 v[0:1], v[112:113], v[0:1], v[0:1]
    v_pk_fma_f32 v[0:1], v[128:129], v[2:3], v[0:1]
    v_pk_fma_f32 v[2:3], v[112:113], v[2:3], v[2:3]
    v_pk_fma_f32 v[0:1], v[114:115], v[0:1], v[0:1]
    v_pk_fma_f32 v[0:1], v[130:131], v[2:3], v[0:1]
    v_pk_fma_f32 v[2:3], v[114:115], v[2:3], v[2:3]
    v_pk_fma_f32 v[0:1], v[116:117], v[0:1], v[0:1]
    v_pk_fma_f32 v[0:1], v[132:133], v[2:3], v[0:1]
    v_pk_fma_f32 v[2:3], v[116:117], v[2:3], v[2:3]
    v_pk_fma_f32 v[0:1], v[118:119], v[0:1], v[0:1]
    v_pk_fma_f32 v[0:1], v[134:135], v[2:3], v[0:1]
    v_pk_fma_f32 v[2:3], v[118:119], v[2:3], v[2:3]
    s_waitcnt lgkmcnt(0)
    buffer_load_dwordx4 v[238:239], s[20:23], s72 idxen offen nt lds
    buffer_load_dwordx4 v[240:241], s[20:23], s51 idxen offen offset:1024 nt lds
    s_cbranch_scc1 CEV
U_3:
    v_mfma_f32_16x16x32_bf16 v[104:107], v[72:75], v[152:155], v[136:139]
    s_add_u32 m0, s54, 6144
    v_rcp_f32 v2, v2
    v_mfma_f32_16x16x32_bf16 v[104:107], v[76:79], v[156:159], v[104:107]
    s_mov_b32 s73, 3
    v_rcp_f32 v3, v3
    v_mfma_f32_16x16x32_bf16 v[108:111], v[80:83], v[152:155], v[140:143]
    s_sub_u32 s50, s50, 1
    v_fma_f32 v0, v0, v2, s44
    v_fmac_f32 v0, v1, v3
    v_mfma_f32_16x16x32_bf16 v[108:111], v[84:87], v[156:159], v[108:111]
    s_cbranch_scc1 PEV
    v_add_u32 v246, 16, v246
RET_3:
    v_cvt_pk_bf16_f32 v0, v0, v0
    v_mfma_f32_16x16x32_bf16 v[112:115], v[88:91], v[152:155], v[144:147]
    v_exp_f32 v104, v104
    v_mfma_f32_16x16x32_bf16 v[112:115], v[92:95], v[156:159], v[112:115]
    v_exp_f32 v105, v105
    v_mfma_f32_16x16x32_bf16 v[116:119], v[96:99], v[152:155], v[148:151]
    s_sub_u32 s62, s62, 1
    v_exp_f32 v106, v106
    v_mfma_f32_16x16x32_bf16 v[116:119], v[100:103], v[156:159], v[116:119]
    s_waitcnt vmcnt(3)
    v_exp_f32 v107, v107
    ds_write_b16 v249, v0
    ds_read_b64 v[236:237], v248
    ds_read_b64_tr_b16 v[168:169], v244 offset:6144
    ds_read_b64_tr_b16 v[170:171], v245 offset:6656
    ds_read_b64_tr_b16 v[172:173], v244 offset:7168
    ds_read_b64_tr_b16 v[174:175], v245 offset:7680
    ds_read_u8 v238, v246 offset:0
    ds_read_u8 v240, v246 offset:8
    ds_read_b32 v254, v253
    ds_read_b128 v[152:155], v242 offset:0
    ds_read_b128 v[156:159], v243 offset:0
    v_exp_f32 v108, v108
    v_exp_f32 v109, v109
    v_exp_f32 v110, v110
    v_exp_f32 v111, v111
    s_waitcnt lgkmcnt(9)
    v_mfma_f32_4x4x4_16b_bf16 v[176:179], v[236:237], v[160:161], v[176:179] cbsz:4 abid:0
    v_exp_f32 v112, v112
    v_exp_f32 v113, v113
    v_mfma_f32_4x4x4_16b_bf16 v[176:179], v[236:237], v[162:163], v[176:179] cbsz:4 abid:1
    v_exp_f32 v114, v114
    v_exp_f32 v115, v115
    v_mfma_f32_4x4x4_16b_bf16 v[176:179], v[236:237], v[164:165], v[176:179] cbsz:4 abid:2
    v_exp_f32 v116, v116
    v_exp_f32 v117, v117
    v_mfma_f32_4x4x4_16b_bf16 v[176:179], v[236:237], v[166:167], v[176:179] cbsz:4 abid:3
    v_exp_f32 v118, v118
    v_exp_f32 v119, v119
    .p2align 3
    v_pk_add_f32 v[2:3], v[104:105], 1.0 op_sel_hi:[1,0]
    v_pk_fma_f32 v[0:1], v[120:121], v[106:107], v[120:121]
    v_pk_fma_f32 v[0:1], v[122:123], v[2:3], v[0:1]
    v_pk_fma_f32 v[2:3], v[106:107], v[2:3], v[2:3]
    v_pk_fma_f32 v[0:1], v[108:109], v[0:1], v[0:1]
    v_pk_fma_f32 v[0:1], v[124:125], v[2:3], v[0:1]
    v_pk_fma_f32 v[2:3], v[108:109], v[2:3], v[2:3]
    v_pk_fma_f32 v[0:1], v[110:111], v[0:1], v[0:1]
    v_pk_fma_f32 v[0:1], v[126:127], v[2:3], v[0:1]
    v_pk_fma_f32 v[2:3], v[110:111], v[2:3], v[2:3]
    v_pk_fma_f32 v[0:1], v[112:113], v[0:1], v[0:1]
    v_pk_fma_f32 v[0:1], v[128:129], v[2:3], v[0:1]
    v_pk_fma_f32 v[2:3], v[112:113], v[2:3], v[2:3]
    v_pk_fma_f32 v[0:1], v[114:115], v[0:1], v[0:1]
    v_pk_fma_f32 v[0:1], v[130:131], v[2:3], v[0:1]
    v_pk_fma_f32 v[2:3], v[114:115], v[2:3], v[2:3]
    v_pk_fma_f32 v[0:1], v[116:117], v[0:1], v[0:1]
    v_pk_fma_f32 v[0:1], v[132:133], v[2:3], v[0:1]
    v_pk_fma_f32 v[2:3], v[116:117], v[2:3], v[2:3]
    v_pk_fma_f32 v[0:1], v[118:119], v[0:1], v[0:1]
    v_pk_fma_f32 v[0:1], v[134:135], v[2:3], v[0:1]
    v_pk_fma_f32 v[2:3], v[118:119], v[2:3], v[2:3]
    s_waitcnt lgkmcnt(0)
    buffer_load_dwordx4 v[238:239], s[20:23], s72 idxen offen nt lds
    buffer_load_dwordx4 v[240:241], s[20:23], s51 idxen offen offset:1024 nt lds
    s_cbranch_scc0 U_0
CEV:
    s_cmp_eq_u32 s76, 0
    s_cbranch_scc1 EPI
    s_mov_b32 s53, s52
    s_and_b32 s52, s68, 0xffff
    s_lshr_b64 s[68:69], s[68:69], 16
    s_sub_u32 s75, s75, 16
    s_bitcmp1_b32 s52, 6
    s_cbranch_scc1 DRAIN
BPF:
    s_and_b32 s57, s52, 63
    s_mul_i32 s57, s57, 528
    s_add_u32 s57, s57, 83200
    v_lshl_add_u32 v6, v252, 1, s57
    v_add_u32 v7, s57, v252
    ds_read_b128 v[104:107], v6 offset:0
    ds_read_b128 v[108:111], v6 offset:16
    ds_read_b128 v[144:147], v251 offset:12288
    ds_read_b128 v[148:151], v251 offset:13312
    ds_read_b128 v[112:115], v6 offset:128
    ds_read_b128 v[116:119], v6 offset:144
    s_mov_b32 s62, 0
    s_mov_b32 s76, 0
    s_cmp_lg_u32 s77, 0
    s_waitcnt lgkmcnt(4)
    .p2align 3
    v_pk_fma_f32 v[136:137], v[8:9], v[104:105], v[180:181]
    v_pk_fma_f32 v[138:139], v[10:11], v[106:107], v[182:183]
    v_pk_fma_f32 v[140:141], v[12:13], v[108:109], v[184:185]
    v_pk_fma_f32 v[142:143], v[14:15], v[110:111], v[186:187]
    v_cvt_pk_bf16_f32 v72, v136, v137
    v_cvt_pk_bf16_f32 v73, v138, v139
    v_cvt_pk_bf16_f32 v74, v140, v141
    v_cvt_pk_bf16_f32 v75, v142, v143
    v_pk_fma_f32 v[136:137], v[24:25], v[104:105], v[196:197]
    v_pk_fma_f32 v[138:139], v[26:27], v[106:107], v[198:199]
    v_pk_fma_f32 v[140:141], v[28:29], v[108:109], v[200:201]
    v_pk_fma_f32 v[142:143], v[30:31], v[110:111], v[202:203]
    v_cvt_pk_bf16_f32 v80, v136, v137
    v_cvt_pk_bf16_f32 v81, v138, v139
    v_cvt_pk_bf16_f32 v82, v140, v141
    v_cvt_pk_bf16_f32 v83, v142, v143
    v_pk_fma_f32 v[136:137], v[40:41], v[104:105], v[212:213]
    v_pk_fma_f32 v[138:139], v[42:43], v[106:107], v[214:215]
    v_pk_fma_f32 v[140:141], v[44:45], v[108:109], v[216:217]
    v_pk_fma_f32 v[142:143], v[46:47], v[110:111], v[218:219]
    v_cvt_pk_bf16_f32 v88, v136, v137
    v_cvt_pk_bf16_f32 v89, v138, v139
    v_cvt_pk_bf16_f32 v90, v140, v141
    v_cvt_pk_bf16_f32 v91, v142, v143
    s_waitcnt lgkmcnt(0)
    .p2align 3
    v_pk_fma_f32 v[144:145], v[56:57], v[104:105], v[144:145]
    v_pk_fma_f32 v[146:147], v[58:59], v[106:107], v[146:147]
    v_pk_fma_f32 v[148:149], v[60:61], v[108:109], v[148:149]
    v_pk_fma_f32 v[150:151], v[62:63], v[110:111], v[150:151]
    v_cvt_pk_bf16_f32 v96, v144, v145
    v_cvt_pk_bf16_f32 v97, v146, v147
    v_cvt_pk_bf16_f32 v98, v148, v149
    v_cvt_pk_bf16_f32 v99, v150, v151
    ds_read_b128 v[136:139], v7 offset:256
    ds_read_b128 v[140:143], v7 offset:320
    ds_read_b128 v[144:147], v7 offset:384
    ds_read_b128 v[148:151], v7 offset:448
    v_pk_fma_f32 v[104:105], v[16:17], v[112:113], v[188:189]
    v_pk_fma_f32 v[106:107], v[18:19], v[114:115], v[190:191]
    v_pk_fma_f32 v[108:109], v[20:21], v[116:117], v[192:193]
    v_pk_fma_f32 v[110:111], v[22:23], v[118:119], v[194:195]
    v_cvt_pk_bf16_f32 v76, v104, v105
    v_cvt_pk_bf16_f32 v77, v106, v107
    v_cvt_pk_bf16_f32 v78, v108, v109
    v_cvt_pk_bf16_f32 v79, v110, v111
    v_pk_fma_f32 v[104:105], v[32:33], v[112:113], v[204:205]
    v_pk_fma_f32 v[106:107], v[34:35], v[114:115], v[206:207]
    v_pk_fma_f32 v[108:109], v[36:37], v[116:117], v[208:209]
    v_pk_fma_f32 v[110:111], v[38:39], v[118:119], v[210:211]
    v_cvt_pk_bf16_f32 v84, v104, v105
    v_cvt_pk_bf16_f32 v85, v106, v107
    v_cvt_pk_bf16_f32 v86, v108, v109
    v_cvt_pk_bf16_f32 v87, v110, v111
    v_pk_fma_f32 v[104:105], v[48:49], v[112:113], v[220:221]
    v_pk_fma_f32 v[106:107], v[50:51], v[114:115], v[222:223]
    v_pk_fma_f32 v[108:109], v[52:53], v[116:117], v[224:225]
    v_pk_fma_f32 v[110:111], v[54:55], v[118:119], v[226:227]
    v_cvt_pk_bf16_f32 v92, v104, v105
    v_cvt_pk_bf16_f32 v93, v106, v107
    v_cvt_pk_bf16_f32 v94, v108, v109
    v_cvt_pk_bf16_f32 v95, v110, v111
    v_pk_fma_f32 v[104:105], v[64:65], v[112:113], v[228:229]
    v_pk_fma_f32 v[106:107], v[66:67], v[114:115], v[230:231]
    v_pk_fma_f32 v[108:109], v[68:69], v[116:117], v[232:233]
    v_pk_fma_f32 v[110:111], v[70:71], v[118:119], v[234:235]
    v_cvt_pk_bf16_f32 v100, v104, v105
    v_cvt_pk_bf16_f32 v101, v106, v107
    v_cvt_pk_bf16_f32 v102, v108, v109
    v_cvt_pk_bf16_f32 v103, v110, v111
    s_waitcnt lgkmcnt(0)
    s_cbranch_scc1 BP_X
NEXT:
    s_cmp_eq_u32 s73, 0
    s_cbranch_scc1 U_1
    s_cmp_eq_u32 s73, 1
    s_cbranch_scc1 U_2
    s_cmp_eq_u32 s73, 2
    s_cbranch_scc1 U_3
    s_branch U_0
EPI:
    s_and_b32 s56, s53, 0x7f
    v_pk_add_f32 v[4:5], v[176:177], v[178:179]
    v_add_f32 v4, v4, v5
    v_lshl_add_u32 v5, s56, 8, v250
    v_mul_f32 v4, s46, v4
    s_bitcmp1_b32 s53, 7
    v_cmp_class_f32_e64 vcc, v4, s45
    v_mov_b64 v[176:177], 0
    v_mov_b64 v[178:179], 0
    ds_write_b32 v5, v4
    s_cbranch_scc1 SLOW
    s_cbranch_vccnz SLOW
EPI_R:
    s_bitcmp1_b32 s52, 6
    s_cbranch_scc1 L_DONE
EPI_C:
    s_bfe_u32 s62, s52, 0x40008
    s_sub_u32 s62, s62, 2
    s_mov_b32 s76, 1
    s_cmp_eq_u32 s73, 0
    s_cbranch_scc1 U_1
    s_cmp_eq_u32 s73, 1
    s_cbranch_scc1 U_2
    s_cmp_eq_u32 s73, 2
    s_cbranch_scc1 U_3
    s_branch U_0
PEV:
    s_cmp_eq_u32 s55, 0
    s_cbranch_scc1 P_DR
ADV:
    v_readfirstlane_b32 s66, v254
    s_mov_b32 s67, 0
    s_and_b32 s56, s66, 63
    s_bfe_u32 s50, s66, 0x40008
    s_cbranch_scc0 AW
    s_mul_i32 s51, s56, 25600
    v_lshl_add_u32 v246, s56, 8, v247
    s_add_u32 s51, s51, s49
    s_add_u32 s72, s51, 1024
    s_lshl_b64 s[64:65], s[66:67], s75
    s_or_b64 s[68:69], s[68:69], s[64:65]
    s_add_u32 s75, s75, 16
    s_mov_b32 s55, 0
    s_sub_u32 s50, s50, 3
    s_cbranch_scc1 P_2
P_RET:
    s_cmp_eq_u32 s73, 0
    s_cbranch_scc1 RET_0
    s_cmp_eq_u32 s73, 1
    s_cbranch_scc1 RET_1
    s_cmp_eq_u32 s73, 2
    s_cbranch_scc1 RET_2
    s_branch RET_3
P_DR:
    v_add_u32 v246, 16, v246
P_D2:
    s_mov_b64 exec, 1
    v_mov_b32 v253, 4
    ds_add_rtn_u32 v253, v251, v253 offset:17600
    s_mov_b64 exec, -1
    s_mov_b32 s50, 1
    s_mov_b32 s55, 1
    s_cmp_eq_u32 s73, 0
    s_cbranch_scc1 RET_0
    s_cmp_eq_u32 s73, 1
    s_cbranch_scc1 RET_1
    s_cmp_eq_u32 s73, 2
    s_cbranch_scc1 RET_2
    s_branch RET_3
P_2:
    s_bitcmp1_b32 s66, 6
    s_cbranch_scc0 P_D2
    v_mov_b32 v246, 16896
    s_movk_i32 s50, 0x100
    s_branch P_RET
DRAIN:
    v_rcp_f32 v2, v2
    v_rcp_f32 v3, v3
    v_fma_f32 v0, v0, v2, s44
    v_fmac_f32 v0, v1, v3
    v_cvt_pk_bf16_f32 v0, v0, v0
    s_bitcmp1_b32 s73, 0
    ds_write_b16 v249, v0
    ds_read_b64 v[236:237], v248
    s_waitcnt lgkmcnt(0)
    s_cbranch_scc1 DRAIN1
    v_mfma_f32_4x4x4_16b_bf16 v[176:179], v[236:237], v[160:161], v[176:179] cbsz:4 abid:0
    s_nop 1
    v_mfma_f32_4x4x4_16b_bf16 v[176:179], v[236:237], v[162:163], v[176:179] cbsz:4 abid:1
    s_nop 1
    v_mfma_f32_4x4x4_16b_bf16 v[176:179], v[236:237], v[164:165], v[176:179] cbsz:4 abid:2
    s_nop 1
    v_mfma_f32_4x4x4_16b_bf16 v[176:179], v[236:237], v[166:167], v[176:179] cbsz:4 abid:3
    s_nop 2
    s_branch EPI
DRAIN1:
    v_mfma_f32_4x4x4_16b_bf16 v[176:179], v[236:237], v[168:169], v[176:179] cbsz:4 abid:0
    s_nop 1
    v_mfma_f32_4x4x4_16b_bf16 v[176:179], v[236:237], v[170:171], v[176:179] cbsz:4 abid:1
    s_nop 1
    v_mfma_f32_4x4x4_16b_bf16 v[176:179], v[236:237], v[172:173], v[176:179] cbsz:4 abid:2
    s_nop 1
    v_mfma_f32_4x4x4_16b_bf16 v[176:179], v[236:237], v[174:175], v[176:179] cbsz:4 abid:3
    s_nop 2
    s_branch EPI
L_DONE:
    s_lshl_b32 s56, s48, 11
    s_add_u32 s56, s56, 133376
    v_lshl_add_u32 v0, v251, 1, s56
    s_lshl_b32 s56, s48, 10
    s_waitcnt lgkmcnt(0)
    s_barrier
    ds_read_b128 v[104:107], v0 offset:0
    ds_read_b128 v[108:111], v0 offset:16
    s_waitcnt lgkmcnt(0)
    v_cvt_pk_bf16_f32 v152, v104, v105
    v_cvt_pk_bf16_f32 v153, v106, v107
    v_cvt_pk_bf16_f32 v154, v108, v109
    v_cvt_pk_bf16_f32 v155, v110, v111
    buffer_store_dwordx4 v[152:155], v251, s[28:31], s56 offen nt
L_FIN:
    s_endpgm
AW:
    s_sleep 1
    ds_read_b32 v254, v253
    s_waitcnt lgkmcnt(0)
    s_branch ADV
DRAW_P:
    s_mov_b64 exec, 1
    v_mov_b32 v253, 4
    ds_add_rtn_u32 v253, v251, v253 offset:17600
    s_mov_b64 exec, -1
    s_add_u32 s50, s50, 2
    s_mov_b32 s55, 1
    s_waitcnt lgkmcnt(0)
    ds_read_b32 v254, v253
    s_branch DRET_P
BP_X:
    s_cmp_eq_u32 s77, 1
    s_mov_b32 s77, 0
    s_cbranch_scc1 SLOW_W
    s_branch EPI_C
SLOW:
    s_bitcmp1_b32 s53, 6
    s_cbranch_scc1 EPI_R
    s_mov_b32 s74, s52
    s_mov_b32 s52, s53
    s_mov_b32 s77, 1
    ds_write_b32 v5, v176
    s_branch BPF
SLOW_W:
    s_mov_b32 s52, s74
    s_and_b32 s56, s53, 63
    s_lshr_b32 s57, s53, 12
    s_bfe_u32 s59, s53, 0x40008
    s_lshl4_add_u32 s57, s56, s57
    s_lshl_b32 s57, s57, 4
    s_add_u32 s74, s57, 116992
    s_bitcmp1_b32 s53, 7
    s_cselect_b64 s[66:67], -1, 0
    s_cselect_b32 s59, 13, s59
    v_bfe_u32 v204, v251, 4, 4
    v_mov_b32 v207, v252
    v_mov_b64 v[180:181], 0
    v_mov_b64 v[182:183], 0
    v_mov_b64 v[184:185], 0
    v_mov_b64 v[186:187], 0
    v_mov_b64 v[188:189], 0
    v_mov_b64 v[190:191], 0
    v_mov_b64 v[192:193], 0
    v_mov_b64 v[194:195], 0
    s_mul_i32 s57, s56, 25600
    s_add_u32 s57, s57, s49
    s_mul_i32 s58, s56, 400
SLOW_L:
    v_add_u32 v205, s74, v204
    ds_read_u8 v206, v205
    s_waitcnt lgkmcnt(0)
    v_cndmask_b32_e64 v206, v206, v204, s[66:67]
    v_lshlrev_b32 v205, 1, v206
    buffer_load_dwordx4 v[196:199], v[206:207], s[20:23], s57 idxen offen offset:1024
    buffer_load_dwordx4 v[200:203], v[206:207], s[20:23], s57 idxen offen offset:1088
    buffer_load_ushort v205, v205, s[24:27], s58 offen
    v_cmp_gt_u32 vcc, 200, v206
    v_add_u32 v204, 16, v204
    s_waitcnt vmcnt(0)
    v_mfma_f32_16x16x32_bf16 v[104:107], v[72:75], v[196:199], v[136:139]
    v_mfma_f32_16x16x32_bf16 v[104:107], v[76:79], v[200:203], v[104:107]
    v_mfma_f32_16x16x32_bf16 v[108:111], v[80:83], v[196:199], v[140:143]
    v_mfma_f32_16x16x32_bf16 v[108:111], v[84:87], v[200:203], v[108:111]
    v_mfma_f32_16x16x32_bf16 v[112:115], v[88:91], v[196:199], v[144:147]
    v_mfma_f32_16x16x32_bf16 v[112:115], v[92:95], v[200:203], v[112:115]
    v_mfma_f32_16x16x32_bf16 v[116:119], v[96:99], v[196:199], v[148:151]
    v_mfma_f32_16x16x32_bf16 v[116:119], v[100:103], v[200:203], v[116:119]
    v_lshlrev_b32 v205, 16, v205
    v_cndmask_b32 v205, 0, v205, vcc
    s_nop 7
    v_exp_f32 v104, v104
    v_exp_f32 v105, v105
    v_exp_f32 v106, v106
    v_exp_f32 v107, v107
    v_exp_f32 v108, v108
    v_exp_f32 v109, v109
    v_exp_f32 v110, v110
    v_exp_f32 v111, v111
    v_exp_f32 v112, v112
    v_exp_f32 v113, v113
    v_exp_f32 v114, v114
    v_exp_f32 v115, v115
    v_exp_f32 v116, v116
    v_exp_f32 v117, v117
    v_exp_f32 v118, v118
    v_exp_f32 v119, v119
    v_add_f32 v104, 1.0, v104
    v_add_f32 v105, 1.0, v105
    v_add_f32 v106, 1.0, v106
    v_add_f32 v107, 1.0, v107
    v_add_f32 v108, 1.0, v108
    v_add_f32 v109, 1.0, v109
    v_add_f32 v110, 1.0, v110
    v_add_f32 v111, 1.0, v111
    v_add_f32 v112, 1.0, v112
    v_add_f32 v113, 1.0, v113
    v_add_f32 v114, 1.0, v114
    v_add_f32 v115, 1.0, v115
    v_add_f32 v116, 1.0, v116
    v_add_f32 v117, 1.0, v117
    v_add_f32 v118, 1.0, v118
    v_add_f32 v119, 1.0, v119
    v_rcp_f32 v104, v104
    v_rcp_f32 v105, v105
    v_rcp_f32 v106, v106
    v_rcp_f32 v107, v107
    v_rcp_f32 v108, v108
    v_rcp_f32 v109, v109
    v_rcp_f32 v110, v110
    v_rcp_f32 v111, v111
    v_rcp_f32 v112, v112
    v_rcp_f32 v113, v113
    v_rcp_f32 v114, v114
    v_rcp_f32 v115, v115
    v_rcp_f32 v116, v116
    v_rcp_f32 v117, v117
    v_rcp_f32 v118, v118
    v_rcp_f32 v119, v119
    v_mul_f32 v208, v104, v120
    v_fmac_f32 v208, v105, v121
    v_fmac_f32 v208, v106, v122
    v_fmac_f32 v208, v107, v123
    v_fmac_f32 v208, v108, v124
    v_fmac_f32 v208, v109, v125
    v_fmac_f32 v208, v110, v126
    v_fmac_f32 v208, v111, v127
    v_fmac_f32 v208, v112, v128
    v_fmac_f32 v208, v113, v129
    v_fmac_f32 v208, v114, v130
    v_fmac_f32 v208, v115, v131
    v_fmac_f32 v208, v116, v132
    v_fmac_f32 v208, v117, v133
    v_fmac_f32 v208, v118, v134
    v_fmac_f32 v208, v119, v135
    v_mov_b32 v209, v208
    s_nop 1
    v_permlane32_swap_b32 v208, v209
    v_add_f32 v208, v208, v209
    v_mov_b32 v209, v208
    s_nop 1
    v_permlane16_swap_b32 v208, v209
    v_add_f32 v208, v208, v209
    v_mul_f32 v208, s46, v208
    v_add_f32 v208, s63, v208
    v_mul_f32 v208, v208, v205
    v_lshlrev_b32 v209, 16, v196
    v_and_b32 v210, 0xffff0000, v196
    v_fmac_f32 v180, v208, v209
    v_fmac_f32 v181, v208, v210
    v_lshlrev_b32 v209, 16, v197
    v_and_b32 v210, 0xffff0000, v197
    v_fmac_f32 v182, v208, v209
    v_fmac_f32 v183, v208, v210
    v_lshlrev_b32 v209, 16, v198
    v_and_b32 v210, 0xffff0000, v198
    v_fmac_f32 v184, v208, v209
    v_fmac_f32 v185, v208, v210
    v_lshlrev_b32 v209, 16, v199
    v_and_b32 v210, 0xffff0000, v199
    v_fmac_f32 v186, v208, v209
    v_fmac_f32 v187, v208, v210
    v_lshlrev_b32 v209, 16, v200
    v_and_b32 v210, 0xffff0000, v200
    v_fmac_f32 v188, v208, v209
    v_fmac_f32 v189, v208, v210
    v_lshlrev_b32 v209, 16, v201
    v_and_b32 v210, 0xffff0000, v201
    v_fmac_f32 v190, v208, v209
    v_fmac_f32 v191, v208, v210
    v_lshlrev_b32 v209, 16, v202
    v_and_b32 v210, 0xffff0000, v202
    v_fmac_f32 v192, v208, v209
    v_fmac_f32 v193, v208, v210
    v_lshlrev_b32 v209, 16, v203
    v_and_b32 v210, 0xffff0000, v203
    v_fmac_f32 v194, v208, v209
    v_fmac_f32 v195, v208, v210
    s_sub_u32 s59, s59, 1
    s_cmp_lg_u32 s59, 0
    s_cbranch_scc1 SLOW_L
    v_readfirstlane_b32 s56, v5
    s_nop 1
    v_lshl_add_u32 v208, v252, 1, s56
    ds_add_f32 v208, v180 offset:0
    ds_add_f32 v208, v181 offset:4
    ds_add_f32 v208, v182 offset:8
    ds_add_f32 v208, v183 offset:12
    ds_add_f32 v208, v184 offset:16
    ds_add_f32 v208, v185 offset:20
    ds_add_f32 v208, v186 offset:24
    ds_add_f32 v208, v187 offset:28
    ds_add_f32 v208, v188 offset:128
    ds_add_f32 v208, v189 offset:132
    ds_add_f32 v208, v190 offset:136
    ds_add_f32 v208, v191 offset:140
    ds_add_f32 v208, v192 offset:144
    ds_add_f32 v208, v193 offset:148
    ds_add_f32 v208, v194 offset:152
    ds_add_f32 v208, v195 offset:156
    s_waitcnt lgkmcnt(0)
    s_bitcmp1_b32 s52, 6
    s_cbranch_scc1 L_DONE
    ds_read_b128 v[180:183], v251 offset:0
    ds_read_b128 v[184:187], v251 offset:1024
    ds_read_b128 v[196:199], v251 offset:4096
    ds_read_b128 v[200:203], v251 offset:5120
    ds_read_b128 v[212:215], v251 offset:8192
    ds_read_b128 v[216:219], v251 offset:9216
    ds_read_b128 v[188:191], v251 offset:2048
    ds_read_b128 v[192:195], v251 offset:3072
    ds_read_b128 v[204:207], v251 offset:6144
    ds_read_b128 v[208:211], v251 offset:7168
    ds_read_b128 v[220:223], v251 offset:10240
    ds_read_b128 v[224:227], v251 offset:11264
    ds_read_b128 v[228:231], v251 offset:14336
    ds_read_b128 v[232:235], v251 offset:15360
    s_mov_b32 s77, 2
    s_branch BPF
L_END:
    s_endpgm
.section .rodata,"a"
.p2align 6
.amdhsa_kernel standalone__sequential_behavior_din__recsys_kernel
  .amdhsa_next_free_vgpr 255
  .amdhsa_next_free_sgpr 78
  .amdhsa_accum_offset 256
  .amdhsa_group_segment_fixed_size 0
  .amdhsa_kernarg_size 80
  .amdhsa_user_sgpr_count 2
  .amdhsa_user_sgpr_kernarg_segment_ptr 1
  .amdhsa_system_sgpr_workgroup_id_x 1
.end_amdhsa_kernel
```

```asm
; @launch grid=(256,1,1) block=(512,1,1) lds=153856
.amdgcn_target "amdgcn-amd-amdhsa--gfx950"
.text
.globl standalone__sequential_behavior_din__recsys_kernel
.p2align 8
.type standalone__sequential_behavior_din__recsys_kernel,@function
standalone__sequential_behavior_din__recsys_kernel:
    s_cmpk_ge_u32 s2, 256
    s_cbranch_scc1 L_END
    s_load_dwordx16 s[4:19], s[0:1], 0
    s_setprio 3
    v_lshrrev_b32 v1, 6, v0
    v_and_b32 v176, 63, v0
    v_readfirstlane_b32 s48, v1
    s_getpc_b64 s[40:41]
L_PC:
    s_cmp_lt_u32 s48, 5
    s_cbranch_scc1 P_NC
    s_mov_b32 s42, L_END-L_PC
    s_mov_b32 s43, 0x20000
    v_subrev_u32 v150, 320, v0
    v_lshlrev_b32 v150, 6, v150
    buffer_load_dword v150, v150, s[40:43], 0 offen
P_NC:
    v_and_b32 v2, 31, v0
    v_bfe_u32 v3, v0, 5, 1
    v_cmp_gt_u32 vcc, 25, v2
    v_mul_u32_u24 v4, 400, v3
    v_lshl_add_u32 v179, v2, 4, v4
    v_bfrev_b32 v4, 8
    v_cndmask_b32 v179, v4, v179, vcc
    s_movk_i32 s26, 25600
    s_mul_i32 s57, s2, s26
    s_mul_i32 s71, s48, 800
    s_mov_b32 s27, 0x20000
    s_lshl_b32 s74, s48, 12
    s_lshl_b32 s53, s2, 13
    v_lshlrev_b32 v251, 4, v176
    v_lshlrev_b32 v120, 1, v176
    v_and_b32 v120, 32, v120
    v_xor_b32 v120, v120, v251
    v_xor_b32 v121, 64, v120
    s_mov_b32 s38, 32768
    s_mov_b32 s39, s27
    s_lshl_b32 s58, s48, 10
    s_movk_i32 s34, 8192
    s_mov_b32 s35, s27
    s_add_u32 m0, s74, 121088
    v_and_b32 v178, 15, v176
    v_lshrrev_b32 v177, 4, v176
    v_lshlrev_b32 v252, 4, v177
    v_mul_u32_u24 v208, 0x80008, v2
    v_lshrrev_b32 v238, 3, v176
    v_add_u32 v208, 0x10000, v208
    v_cmp_gt_u32 vcc, 32, v176
    s_waitcnt lgkmcnt(0)
    s_add_u32 s24, s8, s57
    s_addc_u32 s25, s9, 0
    s_mov_b64 s[36:37], s[10:11]
    buffer_load_dwordx4 v[204:207], v179, s[24:27], s71 offen offset:0 nt
    s_setprio 0
    s_add_u32 s32, s4, s53
    s_addc_u32 s33, s5, 0
    s_load_dword s63, s[16:17], 0
    s_cmp_lg_u32 s48, 0
    s_cbranch_scc1 P_LJ
    v_mov_b32 v146, s12
    v_mov_b32 v147, s13
    v_mov_b32 v148, s14
    v_mov_b32 v149, s15
    v_lshlrev_b32 v4, 2, v2
    v_cndmask_b32 v146, v146, v148, vcc
    v_cndmask_b32 v147, v147, v149, vcc
    v_add_co_u32 v146, vcc, v146, v4
    s_nop 1
    v_addc_co_u32 v147, vcc, 0, v147, vcc
    global_load_dword v146, v[146:147], off
P_LJ:
    buffer_load_dwordx4 v[124:127], v251, s[32:35], s58 offen nt
    buffer_load_dwordx4 v120, s[36:39], s74 offen offset:0 lds
    buffer_load_dwordx4 v121, s[36:39], s74 offen offset:1024 lds
    s_lshl1_add_u32 s54, s74, 17664
    s_mul_i32 s49, s2, 1638400
    s_lshl_b32 s57, s48, 9
    v_add_u32 v247, 116992, v238
    v_add_u32 v246, s57, v247
    s_add_u32 s56, s57, 116992
    v_add_u32 v209, 0x20002, v208
    v_add_u32 v210, 0x40004, v208
    v_add_u32 v211, 0x60006, v208
    s_sub_u32 s20, s6, 1024
    s_subb_u32 s21, s7, 0
    s_or_b32 s21, s21, 0x800000
    s_movk_i32 s22, 200
    s_mov_b32 s23, s27
    s_movk_i32 s61, 0x3f80
    v_lshrrev_b32 v216, 1, v251
    v_and_b32 v213, 0x100, v216
    v_mov_b64 v[214:215], -1
    v_lshlrev_b32 v250, 2, v176
    v_bfrev_b32 v2, v238
    v_lshrrev_b32 v2, 28, v2
    v_and_b32 v2, 6, v2
    v_xor_b32 v2, v2, v176
    v_and_b32 v2, 7, v2
    v_mul_u32_u24 v143, 528, v238
    v_lshlrev_b32 v239, 4, v2
    v_lshlrev_b32 v241, 4, v2
    v_lshlrev_b32 v153, 4, v2
    v_lshlrev_b32 v155, 4, v2
    s_add_u32 s28, s18, s53
    s_addc_u32 s29, s19, 0
    s_movk_i32 s30, 8192
    s_mov_b32 s31, s27
    s_mov_b32 s60, 0xbfb8aa3b
    s_mov_b32 s46, 0x2b800000
    s_mul_i32 s51, s48, 51200
    s_add_u32 s51, s51, s49
    s_add_u32 s72, s51, 1024
    v_bfrev_b32 v2, v178
    v_lshrrev_b32 v2, 28, v2
    v_and_b32 v2, 6, v2
    v_xor_b32 v2, v2, v177
    v_lshl_add_u32 v2, v2, 4, s54
    v_lshl_add_u32 v242, v178, 7, v2
    v_xor_b32 v243, 64, v242
    v_and_b32 v3, 3, v176
    v_bfe_u32 v2, v176, 2, 2
    v_lshlrev_b32 v7, 3, v3
    v_lshl_add_u32 v7, v2, 7, v7
    v_and_b32 v6, 8, v176
    v_lshlrev_b32 v6, 3, v6
    v_lshl_add_u32 v244, v177, 5, v7
    v_xor_b32 v244, v244, v6
    v_add_u32 v244, s54, v244
    v_xor_b32 v245, 32, v244
    s_lshl_b32 s57, s48, 7
    s_add_u32 s57, s57, 150016
    v_lshl_add_u32 v249, v2, 2, v177
    v_lshl_add_u32 v249, v249, 2, v3
    v_lshl_add_u32 v249, v249, 1, s57
    v_lshl_add_u32 v248, v178, 3, s57
    v_and_b32 v6, 0x60, v250
    v_or_b32 v6, v6, v7
    v_lshl_add_u32 v136, v177, 10, v6
    s_mul_i32 s57, s48, 0x1010
    s_and_b32 s57, s57, 0x1060
    v_xor_b32 v144, s57, v136
    v_add_u32 v136, 121088, v136
    v_add_u32 v144, 121088, v144
    v_xor_b32 v137, 32, v136
    v_xor_b32 v138, 64, v136
    v_xor_b32 v139, 96, v136
    s_and_b32 s59, s48, 4
    s_lshl_b32 s59, s59, 4
    v_xor_b32 v140, s59, v136
    v_xor_b32 v141, 32, v140
    s_and_b32 s57, s48, 3
    s_mul_i32 s57, s57, 8448
    s_lshl1_add_u32 s57, s59, s57
    s_add_u32 s57, s57, 83200
    v_mul_u32_u24 v145, 528, v178
    v_add3_u32 v145, v145, v252, s57
    v_lshl_add_u32 v142, s59, 1, v252
    s_mul_i32 s57, s48, 4224
    s_add_u32 s57, s57, 83200
    v_and_b32 v3, 0x70, v251
    v_add3_u32 v143, v143, v3, s57
    v_add_u32 v3, v143, v3
    s_lshl_b32 s57, s48, 11
    v_add_u32 v151, s57, v251
    s_mov_b32 s66, 0x1b0a0100
    s_mov_b32 s67, 0x966d4c33
    s_lshl_b32 s57, s48, 3
    s_lshr_b64 s[66:67], s[66:67], s57
    s_and_b32 s47, s66, 7
    s_bfe_u32 s70, s66, 0x50003
    s_lshl1_add_u32 s70, s70, 16
    s_mul_i32 s71, s70, 400
    buffer_load_dwordx4 v120, s[36:39], s74 offen offset:2048 lds
    buffer_load_dwordx4 v121, s[36:39], s74 offen offset:3072 lds
    s_cmp_eq_u32 s48, 0
    s_waitcnt vmcnt(6) lgkmcnt(0)
    s_cbranch_scc1 P_M0
    s_waitcnt vmcnt(5)
P_M0:
    s_call_b64 s[36:37], CMP
    s_branch P_C
    .p2align 3
CMP:
    v_bcnt_u32_b32 v7, v204, 0
    v_bcnt_u32_b32 v7, v205, v7
    v_bcnt_u32_b32 v7, v206, v7
    v_bcnt_u32_b32 v7, v207, v7
    v_add_u32 v4, s56, v216
    v_mov_b32 v6, v7
    ds_write_b64 v4, v[214:215]
    v_cmp_eq_u16_e64 s[4:5], s61, v204
    v_cmp_eq_u16_sdwa s[6:7], v204, s61 src0_sel:WORD_1 src1_sel:WORD_0
    v_add_u32_dpp v6, v6, v6 row_shr:1 row_mask:0xf bank_mask:0xf bound_ctrl:0
    v_cmp_eq_u16_e64 s[8:9], s61, v205
    v_cmp_eq_u16_sdwa s[10:11], v205, s61 src0_sel:WORD_1 src1_sel:WORD_0
    v_add_u32_dpp v6, v6, v6 row_shr:2 row_mask:0xf bank_mask:0xf bound_ctrl:0
    v_cmp_eq_u16_e64 s[12:13], s61, v206
    v_cmp_eq_u16_sdwa s[14:15], v206, s61 src0_sel:WORD_1 src1_sel:WORD_0
    v_add_u32_dpp v6, v6, v6 row_shr:4 row_mask:0xf bank_mask:0xf bound_ctrl:0
    v_cmp_eq_u16_e64 s[16:17], s61, v207
    v_cmp_eq_u16_sdwa s[18:19], v207, s61 src0_sel:WORD_1 src1_sel:WORD_0
    v_add_u32_dpp v6, v6, v6 row_shr:8 row_mask:0xf bank_mask:0xf bound_ctrl:0
    s_nop 1
    v_add_u32_dpp v6, v6, v6 row_bcast:15 row_mask:0xa bank_mask:0xf
    v_sub_u32 v6, v6, v7
    v_mul_u32_u24 v6, 9363, v6
    v_lshrrev_b32 v6, 16, v6
    v_min_u32 v6, 200, v6
    v_add3_u32 v226, v6, v213, s56
    v_readlane_b32 s59, v6, 31
    v_readlane_b32 s58, v6, 63
    v_addc_co_u32_e64 v227, vcc, 0, v226, s[4:5]
    v_addc_co_u32_e64 v228, vcc, 0, v227, s[6:7]
    v_addc_co_u32_e64 v229, vcc, 0, v228, s[8:9]
    v_addc_co_u32_e64 v230, vcc, 0, v229, s[10:11]
    v_addc_co_u32_e64 v231, vcc, 0, v230, s[12:13]
    v_addc_co_u32_e64 v232, vcc, 0, v231, s[14:15]
    v_addc_co_u32_e64 v233, vcc, 0, v232, s[16:17]
    v_addc_co_u32_e64 v234, vcc, 0, v233, s[18:19]
    s_mov_b64 exec, s[4:5]
    ds_write_b8 v226, v208
    s_mov_b64 exec, s[6:7]
    ds_write_b8_d16_hi v227, v208
    s_mov_b64 exec, s[8:9]
    ds_write_b8 v228, v209
    s_mov_b64 exec, s[10:11]
    ds_write_b8_d16_hi v229, v209
    s_mov_b64 exec, s[12:13]
    ds_write_b8 v230, v210
    s_mov_b64 exec, s[14:15]
    ds_write_b8_d16_hi v231, v210
    s_mov_b64 exec, s[16:17]
    ds_write_b8 v232, v211
    s_mov_b64 exec, s[18:19]
    ds_write_b8_d16_hi v233, v211
    s_mov_b64 exec, -1
    v_sub_u32 v6, v234, v226
    v_mul_u32_u24 v6, 7, v6
    v_cmp_ne_u32 vcc, v6, v7
    s_min_u32 s64, vcc_lo, 1
    s_min_u32 s65, vcc_hi, 1
    s_lshl_b64 s[64:65], s[64:65], 15
    s_or_b32 s57, s59, s64
    s_or_b32 s58, s58, s65
    s_setpc_b64 s[36:37]
P_C:
    ds_read_u8 v238, v246 offset:0
    ds_read_u8 v240, v246 offset:8
    ds_read_u8 v152, v246 offset:16
    ds_read_u8 v154, v246 offset:24
    s_add_u32 m0, s54, 0
    s_waitcnt lgkmcnt(3)
    buffer_load_dwordx4 v[238:239], s[20:23], s72 idxen offen nt lds
    s_waitcnt lgkmcnt(2)
    buffer_load_dwordx4 v[240:241], s[20:23], s51 idxen offen offset:1024 nt lds
    s_add_u32 m0, s54, 2048
    s_waitcnt lgkmcnt(1)
    buffer_load_dwordx4 v[152:153], s[20:23], s72 idxen offen nt lds
    s_waitcnt lgkmcnt(0)
    buffer_load_dwordx4 v[154:155], s[20:23], s51 idxen offen offset:1024 nt lds
    s_lshl_b32 s63, s63, 16
    s_cmp_lg_u32 s48, 0
    s_waitcnt vmcnt(8)
    s_cbranch_scc1 P_SW_J
    v_lshlrev_b32 v148, 16, v146
    v_and_b32 v149, 0xffff0000, v146
    v_mov_b32 v4, -1
    v_mov_b32 v5, 0
    v_mov_b32 v6, 0x240
    v_lshrrev_b32 v0, 1, v251
    ds_write2st64_b32 v250, v4, v5 offset0:66 offset1:67
    s_mov_b32 exec_hi, 0
    v_max3_f32 v2, abs(v148), abs(v149), abs(s63)
    v_ldexp_f32 v148, v148, 40
    v_ldexp_f32 v149, v149, 40
    v_cmp_le_f32 vcc, 0x33800000, v2
    ds_write_b32 v250, v6 offset:17408
    s_mov_b32 exec_hi, -1
    s_movk_i32 s56, 0x3ff
    s_cmp_lg_u64 vcc, 0
    s_cmovk_i32 s56, 0x207
    v_mov_b32 v6, 17184
    v_mov_b32 v7, s56
    ds_write_b64 v0, v[148:149] offset:16384
    ds_write_b64 v5, v[6:7] offset:17600
P_SW_J:
    ds_write_b128 v143, v[124:127] offset:256
    ds_write_b128 v143, v[124:127] offset:384
    s_waitcnt vmcnt(4) lgkmcnt(0)
    s_barrier
    ds_read_b64_tr_b16 v[218:219], v144 offset:0
    ds_read_b64_tr_b16 v[220:221], v144 offset:512
    ds_read_b64_tr_b16 v[222:223], v144 offset:16384
    ds_read_b64_tr_b16 v[224:225], v144 offset:16896
    ds_read_b128 v[160:163], v145 offset:256
    ds_read_b128 v[164:167], v145 offset:320
    ds_read_b128 v[104:107], v142 offset:16640
    ds_read_b128 v[108:111], v142 offset:16704
    ds_read_b64_tr_b16 v[40:41], v140 offset:8192
    ds_read_b64_tr_b16 v[42:43], v140 offset:8704
    ds_read_b64_tr_b16 v[44:45], v141 offset:8192
    ds_read_b64_tr_b16 v[46:47], v141 offset:8704
    ds_read_b64_tr_b16 v[48:49], v140 offset:12288
    ds_read_b64_tr_b16 v[50:51], v140 offset:12800
    ds_read_b64_tr_b16 v[52:53], v141 offset:12288
    ds_read_b64_tr_b16 v[54:55], v141 offset:12800
    ds_read_b64_tr_b16 v[56:57], v140 offset:16384
    ds_read_b64_tr_b16 v[58:59], v140 offset:16896
    ds_read_b64_tr_b16 v[60:61], v141 offset:16384
    ds_read_b64_tr_b16 v[62:63], v141 offset:16896
    ds_read_b64_tr_b16 v[64:65], v140 offset:20480
    ds_read_b64_tr_b16 v[66:67], v140 offset:20992
    ds_read_b64_tr_b16 v[68:69], v141 offset:20480
    ds_read_b64_tr_b16 v[70:71], v141 offset:20992
    s_and_b32 s59, s57, 0xff
    s_lshr_b32 s57, s57, 8
    s_add_u32 s59, s59, 15
    s_lshr_b32 s59, s59, 4
    s_max_u32 s59, s59, 4
    s_lshl1_add_u32 s52, s48, s57
    s_lshl_b32 s57, s59, 8
    s_or_b32 s52, s52, s57
    s_sub_u32 s50, s59, 4
    s_and_b32 s59, s58, 0xff
    s_lshr_b32 s58, s58, 8
    s_add_u32 s59, s59, 15
    s_lshr_b32 s59, s59, 4
    s_max_u32 s59, s59, 2
    s_lshl1_add_u32 s74, s48, s58
    s_lshl_b32 s58, s59, 8
    s_or_b32 s74, s74, s58
    s_or_b32 s74, s74, 1
    v_lshlrev_b32 v24, 16, v124
    v_and_b32 v25, 0xffff0000, v124
    v_lshlrev_b32 v26, 16, v125
    v_and_b32 v27, 0xffff0000, v125
    v_lshlrev_b32 v28, 16, v126
    v_and_b32 v29, 0xffff0000, v126
    v_lshlrev_b32 v30, 16, v127
    v_and_b32 v31, 0xffff0000, v127
    v_mul_f32 v24, s60, v24
    v_mul_f32 v25, s60, v25
    v_mul_f32 v26, s60, v26
    v_mul_f32 v27, s60, v27
    v_mul_f32 v28, s60, v28
    v_mul_f32 v29, s60, v29
    v_mul_f32 v30, s60, v30
    v_mul_f32 v31, s60, v31
    s_waitcnt lgkmcnt(15)
    v_lshlrev_b32 v8, 16, v218
    v_and_b32 v9, 0xffff0000, v218
    v_lshlrev_b32 v16, 16, v222
    v_and_b32 v17, 0xffff0000, v222
    v_lshlrev_b32 v10, 16, v219
    v_and_b32 v11, 0xffff0000, v219
    v_lshlrev_b32 v18, 16, v223
    v_and_b32 v19, 0xffff0000, v223
    v_lshlrev_b32 v12, 16, v220
    v_and_b32 v13, 0xffff0000, v220
    v_lshlrev_b32 v20, 16, v224
    v_and_b32 v21, 0xffff0000, v224
    v_lshlrev_b32 v14, 16, v221
    v_and_b32 v15, 0xffff0000, v221
    v_lshlrev_b32 v22, 16, v225
    v_and_b32 v23, 0xffff0000, v225
    v_xor_b32 v168, 0x80008000, v160
    v_xor_b32 v169, 0x80008000, v161
    v_xor_b32 v170, 0x80008000, v162
    v_xor_b32 v171, 0x80008000, v163
    v_xor_b32 v172, 0x80008000, v164
    v_xor_b32 v173, 0x80008000, v165
    v_xor_b32 v174, 0x80008000, v166
    v_xor_b32 v175, 0x80008000, v167
    s_waitcnt lgkmcnt(12)
    v_mfma_f32_16x16x32_bf16 v[104:107], v[40:43], v[160:163], v[104:107]
    v_mfma_f32_16x16x32_bf16 v[108:111], v[44:47], v[160:163], v[108:111]
    v_add_f32 v112, v8, v16
    v_add_f32 v113, v9, v17
    s_waitcnt lgkmcnt(8)
    v_mfma_f32_16x16x32_bf16 v[104:107], v[48:51], v[164:167], v[104:107]
    v_mfma_f32_16x16x32_bf16 v[108:111], v[52:55], v[164:167], v[108:111]
    v_add_f32 v114, v10, v18
    v_add_f32 v115, v11, v19
    s_waitcnt lgkmcnt(4)
    v_mfma_f32_16x16x32_bf16 v[104:107], v[56:59], v[168:171], v[104:107]
    v_mfma_f32_16x16x32_bf16 v[108:111], v[60:63], v[168:171], v[108:111]
    v_add_f32 v116, v12, v20
    v_add_f32 v117, v13, v21
    s_waitcnt lgkmcnt(0)
    v_mfma_f32_16x16x32_bf16 v[104:107], v[64:67], v[172:175], v[104:107]
    v_mfma_f32_16x16x32_bf16 v[108:111], v[68:71], v[172:175], v[108:111]
    v_add_f32 v118, v14, v22
    v_add_f32 v119, v15, v23
    ds_read_b64_tr_b16 v[72:73], v136 offset:24576
    ds_read_b64_tr_b16 v[74:75], v136 offset:25088
    ds_read_b64_tr_b16 v[76:77], v136 offset:28672
    ds_read_b64_tr_b16 v[78:79], v136 offset:29184
    ds_read_b64_tr_b16 v[80:81], v137 offset:24576
    ds_read_b64_tr_b16 v[82:83], v137 offset:25088
    ds_read_b64_tr_b16 v[84:85], v137 offset:28672
    ds_read_b64_tr_b16 v[86:87], v137 offset:29184
    ds_read_b64_tr_b16 v[88:89], v138 offset:24576
    ds_read_b64_tr_b16 v[90:91], v138 offset:25088
    ds_read_b64_tr_b16 v[92:93], v138 offset:28672
    ds_read_b64_tr_b16 v[94:95], v138 offset:29184
    ds_read_b64_tr_b16 v[96:97], v139 offset:24576
    ds_read_b64_tr_b16 v[98:99], v139 offset:25088
    ds_read_b64_tr_b16 v[100:101], v139 offset:28672
    ds_read_b64_tr_b16 v[102:103], v139 offset:29184
    s_cmp_le_u32 s47, 0
    s_cbranch_scc1 P_MJ
    buffer_load_dwordx4 v[180:183], v179, s[24:27], s71 offen offset:0 nt
    s_cmp_le_u32 s47, 1
    s_cbranch_scc1 P_MJ
    buffer_load_dwordx4 v[184:187], v179, s[24:27], s71 offen offset:800 nt
    s_cmp_le_u32 s47, 2
    s_cbranch_scc1 P_MJ
    buffer_load_dwordx4 v[188:191], v179, s[24:27], s71 offen offset:1600 nt
    s_cmp_le_u32 s47, 3
    s_cbranch_scc1 P_MJ
    buffer_load_dwordx4 v[192:195], v179, s[24:27], s71 offen offset:2400 nt
    s_cmp_le_u32 s47, 4
    s_cbranch_scc1 P_MJ
    buffer_load_dwordx4 v[196:199], v179, s[24:27], s71 offen offset:3200 nt
    s_cmp_le_u32 s47, 5
    s_cbranch_scc1 P_MJ
    buffer_load_dwordx4 v[200:203], v179, s[24:27], s71 offen offset:4000 nt
P_MJ:
    v_mul_f32 v112, s60, v112
    v_mul_f32 v113, s60, v113
    v_mul_f32 v114, s60, v114
    v_mul_f32 v115, s60, v115
    v_mul_f32 v116, s60, v116
    v_mul_f32 v117, s60, v117
    v_mul_f32 v118, s60, v118
    v_mul_f32 v119, s60, v119
    ds_write_b128 v151, v[112:115] offset:0
    ds_write_b128 v151, v[116:119] offset:1024
    v_mul_f32 v104, s60, v104
    v_mul_f32 v105, s60, v105
    v_mul_f32 v106, s60, v106
    v_mul_f32 v107, s60, v107
    v_mul_f32 v108, s60, v108
    v_mul_f32 v109, s60, v109
    v_mul_f32 v110, s60, v110
    v_mul_f32 v111, s60, v111
    ds_write_b128 v145, v[104:107] offset:256
    ds_write_b128 v145, v[108:111] offset:320
    ds_write_b128 v3, v[24:27] offset:0
    ds_write_b128 v3, v[28:31] offset:16
    ds_read_b128 v[120:123], v252 offset:16384
    ds_read_b128 v[124:127], v252 offset:16448
    ds_read_b128 v[128:131], v252 offset:16512
    ds_read_b128 v[132:135], v252 offset:16576
    ds_read_b32 v150, v252 offset:17604
    s_lshl2_add_u32 s56, s48, 17184
    v_mov_b32 v253, s56
    v_mov_b32 v254, s74
    ds_write_b32 v253, v254
    v_ldexp_f32 v2, s63, 38
    v_add_u32 v250, 133376, v250
    v_mov_b64 v[168:169], 0
    v_mov_b64 v[170:171], 0
    v_mov_b64 v[172:173], 0
    v_mov_b64 v[174:175], 0
    v_readfirstlane_b32 s44, v2
    s_waitcnt lgkmcnt(15)
    v_lshlrev_b32 v8, 16, v72
    v_and_b32 v9, 0xffff0000, v72
    v_lshlrev_b32 v10, 16, v73
    v_and_b32 v11, 0xffff0000, v73
    v_lshlrev_b32 v12, 16, v74
    v_and_b32 v13, 0xffff0000, v74
    v_lshlrev_b32 v14, 16, v75
    v_and_b32 v15, 0xffff0000, v75
    v_lshlrev_b32 v16, 16, v76
    v_and_b32 v17, 0xffff0000, v76
    v_lshlrev_b32 v18, 16, v77
    v_and_b32 v19, 0xffff0000, v77
    v_lshlrev_b32 v20, 16, v78
    v_and_b32 v21, 0xffff0000, v78
    v_lshlrev_b32 v22, 16, v79
    v_and_b32 v23, 0xffff0000, v79
    v_lshlrev_b32 v24, 16, v80
    v_and_b32 v25, 0xffff0000, v80
    v_lshlrev_b32 v26, 16, v81
    v_and_b32 v27, 0xffff0000, v81
    v_lshlrev_b32 v28, 16, v82
    v_and_b32 v29, 0xffff0000, v82
    v_lshlrev_b32 v30, 16, v83
    v_and_b32 v31, 0xffff0000, v83
    v_lshlrev_b32 v32, 16, v84
    v_and_b32 v33, 0xffff0000, v84
    v_lshlrev_b32 v34, 16, v85
    v_and_b32 v35, 0xffff0000, v85
    v_lshlrev_b32 v36, 16, v86
    v_and_b32 v37, 0xffff0000, v86
    v_lshlrev_b32 v38, 16, v87
    v_and_b32 v39, 0xffff0000, v87
    ds_read_u8 v238, v246 offset:32
    ds_read_u8 v240, v246 offset:40
    ds_read_u8 v152, v246 offset:48
    ds_read_u8 v154, v246 offset:56
    s_add_u32 m0, s54, 4096
    v_add_u32 v246, 48, v246
    s_mov_b64 s[68:69], 0
    s_mov_b32 s75, 0
    s_movk_i32 s53, 0x1040
    s_mov_b32 s73, 3
    s_mov_b32 s77, 0
    s_mov_b32 s55, 0
    v_mov_b64 v[0:1], 0
    v_mov_b32 v2, 1.0
    v_mov_b32 v3, 1.0
    s_waitcnt lgkmcnt(0)
    s_barrier
    v_readfirstlane_b32 s45, v150
    buffer_load_dwordx4 v[238:239], s[20:23], s72 idxen offen nt lds
    buffer_load_dwordx4 v[240:241], s[20:23], s51 idxen offen offset:1024 nt lds
    s_add_u32 m0, s54, 6144
    s_nop 0
    buffer_load_dwordx4 v[152:153], s[20:23], s72 idxen offen nt lds
    buffer_load_dwordx4 v[154:155], s[20:23], s51 idxen offen offset:1024 nt lds
    s_cmp_eq_u32 s47, 0
    s_cbranch_scc1 P_GO
    s_lshl_b32 s56, s70, 8
    s_add_u32 s56, s56, 116992
    s_waitcnt vmcnt(4)
    v_mov_b64 v[204:205], v[180:181]
    v_mov_b64 v[206:207], v[182:183]
    s_call_b64 s[36:37], CMP
    v_writelane_b32 v212, s57, 0
    v_writelane_b32 v212, s58, 1
    s_cmp_le_u32 s47, 1
    s_cbranch_scc1 LATE_D
    s_add_u32 s56, s56, 512
    v_mov_b64 v[204:205], v[184:185]
    v_mov_b64 v[206:207], v[186:187]
    s_call_b64 s[36:37], CMP
    v_writelane_b32 v212, s57, 2
    v_writelane_b32 v212, s58, 3
    s_cmp_le_u32 s47, 2
    s_cbranch_scc1 LATE_D
    s_add_u32 s56, s56, 512
    v_mov_b64 v[204:205], v[188:189]
    v_mov_b64 v[206:207], v[190:191]
    s_call_b64 s[36:37], CMP
    v_writelane_b32 v212, s57, 4
    v_writelane_b32 v212, s58, 5
    s_cmp_le_u32 s47, 3
    s_cbranch_scc1 LATE_D
    s_add_u32 s56, s56, 512
    v_mov_b64 v[204:205], v[192:193]
    v_mov_b64 v[206:207], v[194:195]
    s_call_b64 s[36:37], CMP
    v_writelane_b32 v212, s57, 6
    v_writelane_b32 v212, s58, 7
    s_cmp_le_u32 s47, 4
    s_cbranch_scc1 LATE_D
    s_add_u32 s56, s56, 512
    v_mov_b64 v[204:205], v[196:197]
    v_mov_b64 v[206:207], v[198:199]
    s_call_b64 s[36:37], CMP
    v_writelane_b32 v212, s57, 8
    v_writelane_b32 v212, s58, 9
    s_cmp_le_u32 s47, 5
    s_cbranch_scc1 LATE_D
    s_add_u32 s56, s56, 512
    v_mov_b64 v[204:205], v[200:201]
    v_mov_b64 v[206:207], v[202:203]
    s_call_b64 s[36:37], CMP
    v_writelane_b32 v212, s57, 10
    v_writelane_b32 v212, s58, 11
LATE_D:
    v_add_u32 v4, s70, v176
    s_lshl_b32 s56, s47, 1
    v_and_b32 v5, 0xff, v212
    v_add_u32 v5, 15, v5
    v_lshrrev_b32 v5, 4, v5
    v_max_u32 v5, 2, v5
    v_lshrrev_b32 v212, 8, v212
    v_or_b32 v212, v212, v4
    v_cmp_gt_u32 vcc, 64, v4
    v_lshl_or_b32 v6, v5, 8, v212
    v_lshlrev_b32 v4, 2, v4
    s_bfm_b64 s[66:67], s56, 0
    s_and_b64 exec, s[66:67], vcc
    ds_write_b32 v4, v6 offset:17152
    s_mov_b64 exec, -1
P_GO:
    ds_read_b128 v[180:183], v251 offset:0
    ds_read_b128 v[184:187], v251 offset:1024
    ds_read_b128 v[196:199], v251 offset:4096
    ds_read_b128 v[200:203], v251 offset:5120
    ds_read_b128 v[212:215], v251 offset:8192
    ds_read_b128 v[216:219], v251 offset:9216
    ds_read_b128 v[188:191], v251 offset:2048
    ds_read_b128 v[192:195], v251 offset:3072
    ds_read_b128 v[204:207], v251 offset:6144
    ds_read_b128 v[208:211], v251 offset:7168
    ds_read_b128 v[220:223], v251 offset:10240
    ds_read_b128 v[224:227], v251 offset:11264
    ds_read_b128 v[228:231], v251 offset:14336
    ds_read_b128 v[232:235], v251 offset:15360
    v_lshlrev_b32 v40, 16, v88
    v_and_b32 v41, 0xffff0000, v88
    v_lshlrev_b32 v42, 16, v89
    v_and_b32 v43, 0xffff0000, v89
    v_lshlrev_b32 v44, 16, v90
    v_and_b32 v45, 0xffff0000, v90
    v_lshlrev_b32 v46, 16, v91
    v_and_b32 v47, 0xffff0000, v91
    v_lshlrev_b32 v48, 16, v92
    v_and_b32 v49, 0xffff0000, v92
    v_lshlrev_b32 v50, 16, v93
    v_and_b32 v51, 0xffff0000, v93
    v_lshlrev_b32 v52, 16, v94
    v_and_b32 v53, 0xffff0000, v94
    v_lshlrev_b32 v54, 16, v95
    v_and_b32 v55, 0xffff0000, v95
    v_lshlrev_b32 v56, 16, v96
    v_and_b32 v57, 0xffff0000, v96
    v_lshlrev_b32 v58, 16, v97
    v_and_b32 v59, 0xffff0000, v97
    v_lshlrev_b32 v60, 16, v98
    v_and_b32 v61, 0xffff0000, v98
    v_lshlrev_b32 v62, 16, v99
    v_and_b32 v63, 0xffff0000, v99
    v_lshlrev_b32 v64, 16, v100
    v_and_b32 v65, 0xffff0000, v100
    v_lshlrev_b32 v66, 16, v101
    v_and_b32 v67, 0xffff0000, v101
    v_lshlrev_b32 v68, 16, v102
    v_and_b32 v69, 0xffff0000, v102
    v_lshlrev_b32 v70, 16, v103
    v_and_b32 v71, 0xffff0000, v103
    v_mov_b64 v[176:177], 0
    v_mov_b64 v[178:179], 0
    s_sub_u32 s50, s50, 2
    s_cbranch_scc1 DRAW_P
DRET_P:
    s_waitcnt vmcnt(6)
    ds_read_b128 v[152:155], v242
    ds_read_b128 v[156:159], v243
    s_branch BPF
U_0:
    v_mfma_f32_16x16x32_bf16 v[104:107], v[72:75], v[152:155], v[136:139]
    s_add_u32 m0, s54, 0
    v_rcp_f32 v2, v2
    v_mfma_f32_16x16x32_bf16 v[104:107], v[76:79], v[156:159], v[104:107]
    s_mov_b32 s73, 0
    v_rcp_f32 v3, v3
    v_mfma_f32_16x16x32_bf16 v[108:111], v[80:83], v[152:155], v[140:143]
    s_sub_u32 s50, s50, 1
    v_fma_f32 v0, v0, v2, s44
    v_fmac_f32 v0, v1, v3
    v_mfma_f32_16x16x32_bf16 v[108:111], v[84:87], v[156:159], v[108:111]
    s_cbranch_scc1 PEV
    v_add_u32 v246, 16, v246
RET_0:
    v_cvt_pk_bf16_f32 v0, v0, v0
    v_mfma_f32_16x16x32_bf16 v[112:115], v[88:91], v[152:155], v[144:147]
    v_exp_f32 v104, v104
    v_mfma_f32_16x16x32_bf16 v[112:115], v[92:95], v[156:159], v[112:115]
    v_exp_f32 v105, v105
    v_mfma_f32_16x16x32_bf16 v[116:119], v[96:99], v[152:155], v[148:151]
    s_sub_u32 s62, s62, 1
    v_exp_f32 v106, v106
    v_mfma_f32_16x16x32_bf16 v[116:119], v[100:103], v[156:159], v[116:119]
    s_waitcnt vmcnt(3)
    v_exp_f32 v107, v107
    ds_write_b16 v249, v0
    ds_read_b64 v[236:237], v248
    ds_read_b64_tr_b16 v[160:161], v244 offset:0
    ds_read_b64_tr_b16 v[162:163], v245 offset:512
    ds_read_b64_tr_b16 v[164:165], v244 offset:1024
    ds_read_b64_tr_b16 v[166:167], v245 offset:1536
    ds_read_u8 v238, v246 offset:0
    ds_read_u8 v240, v246 offset:8
    ds_read_b32 v254, v253
    ds_read_b128 v[152:155], v242 offset:2048
    ds_read_b128 v[156:159], v243 offset:2048
    v_exp_f32 v108, v108
    v_exp_f32 v109, v109
    v_exp_f32 v110, v110
    v_exp_f32 v111, v111
    s_waitcnt lgkmcnt(9)
    v_mfma_f32_4x4x4_16b_bf16 v[176:179], v[236:237], v[168:169], v[176:179] cbsz:4 abid:0
    v_exp_f32 v112, v112
    v_exp_f32 v113, v113
    v_mfma_f32_4x4x4_16b_bf16 v[176:179], v[236:237], v[170:171], v[176:179] cbsz:4 abid:1
    v_exp_f32 v114, v114
    v_exp_f32 v115, v115
    v_mfma_f32_4x4x4_16b_bf16 v[176:179], v[236:237], v[172:173], v[176:179] cbsz:4 abid:2
    v_exp_f32 v116, v116
    v_exp_f32 v117, v117
    v_mfma_f32_4x4x4_16b_bf16 v[176:179], v[236:237], v[174:175], v[176:179] cbsz:4 abid:3
    v_exp_f32 v118, v118
    v_exp_f32 v119, v119
    .p2align 3
    v_pk_add_f32 v[2:3], v[104:105], 1.0 op_sel_hi:[1,0]
    v_pk_fma_f32 v[0:1], v[120:121], v[106:107], v[120:121]
    v_pk_fma_f32 v[0:1], v[122:123], v[2:3], v[0:1]
    v_pk_fma_f32 v[2:3], v[106:107], v[2:3], v[2:3]
    v_pk_fma_f32 v[0:1], v[108:109], v[0:1], v[0:1]
    v_pk_fma_f32 v[0:1], v[124:125], v[2:3], v[0:1]
    v_pk_fma_f32 v[2:3], v[108:109], v[2:3], v[2:3]
    v_pk_fma_f32 v[0:1], v[110:111], v[0:1], v[0:1]
    v_pk_fma_f32 v[0:1], v[126:127], v[2:3], v[0:1]
    v_pk_fma_f32 v[2:3], v[110:111], v[2:3], v[2:3]
    v_pk_fma_f32 v[0:1], v[112:113], v[0:1], v[0:1]
    v_pk_fma_f32 v[0:1], v[128:129], v[2:3], v[0:1]
    v_pk_fma_f32 v[2:3], v[112:113], v[2:3], v[2:3]
    v_pk_fma_f32 v[0:1], v[114:115], v[0:1], v[0:1]
    v_pk_fma_f32 v[0:1], v[130:131], v[2:3], v[0:1]
    v_pk_fma_f32 v[2:3], v[114:115], v[2:3], v[2:3]
    v_pk_fma_f32 v[0:1], v[116:117], v[0:1], v[0:1]
    v_pk_fma_f32 v[0:1], v[132:133], v[2:3], v[0:1]
    v_pk_fma_f32 v[2:3], v[116:117], v[2:3], v[2:3]
    v_pk_fma_f32 v[0:1], v[118:119], v[0:1], v[0:1]
    v_pk_fma_f32 v[0:1], v[134:135], v[2:3], v[0:1]
    v_pk_fma_f32 v[2:3], v[118:119], v[2:3], v[2:3]
    s_waitcnt lgkmcnt(0)
    buffer_load_dwordx4 v[238:239], s[20:23], s72 idxen offen nt lds
    buffer_load_dwordx4 v[240:241], s[20:23], s51 idxen offen offset:1024 nt lds
    s_cbranch_scc1 CEV
U_1:
    v_mfma_f32_16x16x32_bf16 v[104:107], v[72:75], v[152:155], v[136:139]
    s_add_u32 m0, s54, 2048
    v_rcp_f32 v2, v2
    v_mfma_f32_16x16x32_bf16 v[104:107], v[76:79], v[156:159], v[104:107]
    s_mov_b32 s73, 1
    v_rcp_f32 v3, v3
    v_mfma_f32_16x16x32_bf16 v[108:111], v[80:83], v[152:155], v[140:143]
    s_sub_u32 s50, s50, 1
    v_fma_f32 v0, v0, v2, s44
    v_fmac_f32 v0, v1, v3
    v_mfma_f32_16x16x32_bf16 v[108:111], v[84:87], v[156:159], v[108:111]
    s_cbranch_scc1 PEV
    v_add_u32 v246, 16, v246
RET_1:
    v_cvt_pk_bf16_f32 v0, v0, v0
    v_mfma_f32_16x16x32_bf16 v[112:115], v[88:91], v[152:155], v[144:147]
    v_exp_f32 v104, v104
    v_mfma_f32_16x16x32_bf16 v[112:115], v[92:95], v[156:159], v[112:115]
    v_exp_f32 v105, v105
    v_mfma_f32_16x16x32_bf16 v[116:119], v[96:99], v[152:155], v[148:151]
    s_sub_u32 s62, s62, 1
    v_exp_f32 v106, v106
    v_mfma_f32_16x16x32_bf16 v[116:119], v[100:103], v[156:159], v[116:119]
    s_waitcnt vmcnt(3)
    v_exp_f32 v107, v107
    ds_write_b16 v249, v0
    ds_read_b64 v[236:237], v248
    ds_read_b64_tr_b16 v[168:169], v244 offset:2048
    ds_read_b64_tr_b16 v[170:171], v245 offset:2560
    ds_read_b64_tr_b16 v[172:173], v244 offset:3072
    ds_read_b64_tr_b16 v[174:175], v245 offset:3584
    ds_read_u8 v238, v246 offset:0
    ds_read_u8 v240, v246 offset:8
    ds_read_b32 v254, v253
    ds_read_b128 v[152:155], v242 offset:4096
    ds_read_b128 v[156:159], v243 offset:4096
    v_exp_f32 v108, v108
    v_exp_f32 v109, v109
    v_exp_f32 v110, v110
    v_exp_f32 v111, v111
    s_waitcnt lgkmcnt(9)
    v_mfma_f32_4x4x4_16b_bf16 v[176:179], v[236:237], v[160:161], v[176:179] cbsz:4 abid:0
    v_exp_f32 v112, v112
    v_exp_f32 v113, v113
    v_mfma_f32_4x4x4_16b_bf16 v[176:179], v[236:237], v[162:163], v[176:179] cbsz:4 abid:1
    v_exp_f32 v114, v114
    v_exp_f32 v115, v115
    v_mfma_f32_4x4x4_16b_bf16 v[176:179], v[236:237], v[164:165], v[176:179] cbsz:4 abid:2
    v_exp_f32 v116, v116
    v_exp_f32 v117, v117
    v_mfma_f32_4x4x4_16b_bf16 v[176:179], v[236:237], v[166:167], v[176:179] cbsz:4 abid:3
    v_exp_f32 v118, v118
    v_exp_f32 v119, v119
    .p2align 3
    v_pk_add_f32 v[2:3], v[104:105], 1.0 op_sel_hi:[1,0]
    v_pk_fma_f32 v[0:1], v[120:121], v[106:107], v[120:121]
    v_pk_fma_f32 v[0:1], v[122:123], v[2:3], v[0:1]
    v_pk_fma_f32 v[2:3], v[106:107], v[2:3], v[2:3]
    v_pk_fma_f32 v[0:1], v[108:109], v[0:1], v[0:1]
    v_pk_fma_f32 v[0:1], v[124:125], v[2:3], v[0:1]
    v_pk_fma_f32 v[2:3], v[108:109], v[2:3], v[2:3]
    v_pk_fma_f32 v[0:1], v[110:111], v[0:1], v[0:1]
    v_pk_fma_f32 v[0:1], v[126:127], v[2:3], v[0:1]
    v_pk_fma_f32 v[2:3], v[110:111], v[2:3], v[2:3]
    v_pk_fma_f32 v[0:1], v[112:113], v[0:1], v[0:1]
    v_pk_fma_f32 v[0:1], v[128:129], v[2:3], v[0:1]
    v_pk_fma_f32 v[2:3], v[112:113], v[2:3], v[2:3]
    v_pk_fma_f32 v[0:1], v[114:115], v[0:1], v[0:1]
    v_pk_fma_f32 v[0:1], v[130:131], v[2:3], v[0:1]
    v_pk_fma_f32 v[2:3], v[114:115], v[2:3], v[2:3]
    v_pk_fma_f32 v[0:1], v[116:117], v[0:1], v[0:1]
    v_pk_fma_f32 v[0:1], v[132:133], v[2:3], v[0:1]
    v_pk_fma_f32 v[2:3], v[116:117], v[2:3], v[2:3]
    v_pk_fma_f32 v[0:1], v[118:119], v[0:1], v[0:1]
    v_pk_fma_f32 v[0:1], v[134:135], v[2:3], v[0:1]
    v_pk_fma_f32 v[2:3], v[118:119], v[2:3], v[2:3]
    s_waitcnt lgkmcnt(0)
    buffer_load_dwordx4 v[238:239], s[20:23], s72 idxen offen nt lds
    buffer_load_dwordx4 v[240:241], s[20:23], s51 idxen offen offset:1024 nt lds
    s_cbranch_scc1 CEV
U_2:
    v_mfma_f32_16x16x32_bf16 v[104:107], v[72:75], v[152:155], v[136:139]
    s_add_u32 m0, s54, 4096
    v_rcp_f32 v2, v2
    v_mfma_f32_16x16x32_bf16 v[104:107], v[76:79], v[156:159], v[104:107]
    s_mov_b32 s73, 2
    v_rcp_f32 v3, v3
    v_mfma_f32_16x16x32_bf16 v[108:111], v[80:83], v[152:155], v[140:143]
    s_sub_u32 s50, s50, 1
    v_fma_f32 v0, v0, v2, s44
    v_fmac_f32 v0, v1, v3
    v_mfma_f32_16x16x32_bf16 v[108:111], v[84:87], v[156:159], v[108:111]
    s_cbranch_scc1 PEV
    v_add_u32 v246, 16, v246
RET_2:
    v_cvt_pk_bf16_f32 v0, v0, v0
    v_mfma_f32_16x16x32_bf16 v[112:115], v[88:91], v[152:155], v[144:147]
    v_exp_f32 v104, v104
    v_mfma_f32_16x16x32_bf16 v[112:115], v[92:95], v[156:159], v[112:115]
    v_exp_f32 v105, v105
    v_mfma_f32_16x16x32_bf16 v[116:119], v[96:99], v[152:155], v[148:151]
    s_sub_u32 s62, s62, 1
    v_exp_f32 v106, v106
    v_mfma_f32_16x16x32_bf16 v[116:119], v[100:103], v[156:159], v[116:119]
    s_waitcnt vmcnt(3)
    v_exp_f32 v107, v107
    ds_write_b16 v249, v0
    ds_read_b64 v[236:237], v248
    ds_read_b64_tr_b16 v[160:161], v244 offset:4096
    ds_read_b64_tr_b16 v[162:163], v245 offset:4608
    ds_read_b64_tr_b16 v[164:165], v244 offset:5120
    ds_read_b64_tr_b16 v[166:167], v245 offset:5632
    ds_read_u8 v238, v246 offset:0
    ds_read_u8 v240, v246 offset:8
    ds_read_b32 v254, v253
    ds_read_b128 v[152:155], v242 offset:6144
    ds_read_b128 v[156:159], v243 offset:6144
    v_exp_f32 v108, v108
    v_exp_f32 v109, v109
    v_exp_f32 v110, v110
    v_exp_f32 v111, v111
    s_waitcnt lgkmcnt(9)
    v_mfma_f32_4x4x4_16b_bf16 v[176:179], v[236:237], v[168:169], v[176:179] cbsz:4 abid:0
    v_exp_f32 v112, v112
    v_exp_f32 v113, v113
    v_mfma_f32_4x4x4_16b_bf16 v[176:179], v[236:237], v[170:171], v[176:179] cbsz:4 abid:1
    v_exp_f32 v114, v114
    v_exp_f32 v115, v115
    v_mfma_f32_4x4x4_16b_bf16 v[176:179], v[236:237], v[172:173], v[176:179] cbsz:4 abid:2
    v_exp_f32 v116, v116
    v_exp_f32 v117, v117
    v_mfma_f32_4x4x4_16b_bf16 v[176:179], v[236:237], v[174:175], v[176:179] cbsz:4 abid:3
    v_exp_f32 v118, v118
    v_exp_f32 v119, v119
    .p2align 3
    v_pk_add_f32 v[2:3], v[104:105], 1.0 op_sel_hi:[1,0]
    v_pk_fma_f32 v[0:1], v[120:121], v[106:107], v[120:121]
    v_pk_fma_f32 v[0:1], v[122:123], v[2:3], v[0:1]
    v_pk_fma_f32 v[2:3], v[106:107], v[2:3], v[2:3]
    v_pk_fma_f32 v[0:1], v[108:109], v[0:1], v[0:1]
    v_pk_fma_f32 v[0:1], v[124:125], v[2:3], v[0:1]
    v_pk_fma_f32 v[2:3], v[108:109], v[2:3], v[2:3]
    v_pk_fma_f32 v[0:1], v[110:111], v[0:1], v[0:1]
    v_pk_fma_f32 v[0:1], v[126:127], v[2:3], v[0:1]
    v_pk_fma_f32 v[2:3], v[110:111], v[2:3], v[2:3]
    v_pk_fma_f32 v[0:1], v[112:113], v[0:1], v[0:1]
    v_pk_fma_f32 v[0:1], v[128:129], v[2:3], v[0:1]
    v_pk_fma_f32 v[2:3], v[112:113], v[2:3], v[2:3]
    v_pk_fma_f32 v[0:1], v[114:115], v[0:1], v[0:1]
    v_pk_fma_f32 v[0:1], v[130:131], v[2:3], v[0:1]
    v_pk_fma_f32 v[2:3], v[114:115], v[2:3], v[2:3]
    v_pk_fma_f32 v[0:1], v[116:117], v[0:1], v[0:1]
    v_pk_fma_f32 v[0:1], v[132:133], v[2:3], v[0:1]
    v_pk_fma_f32 v[2:3], v[116:117], v[2:3], v[2:3]
    v_pk_fma_f32 v[0:1], v[118:119], v[0:1], v[0:1]
    v_pk_fma_f32 v[0:1], v[134:135], v[2:3], v[0:1]
    v_pk_fma_f32 v[2:3], v[118:119], v[2:3], v[2:3]
    s_waitcnt lgkmcnt(0)
    buffer_load_dwordx4 v[238:239], s[20:23], s72 idxen offen nt lds
    buffer_load_dwordx4 v[240:241], s[20:23], s51 idxen offen offset:1024 nt lds
    s_cbranch_scc1 CEV
U_3:
    v_mfma_f32_16x16x32_bf16 v[104:107], v[72:75], v[152:155], v[136:139]
    s_add_u32 m0, s54, 6144
    v_rcp_f32 v2, v2
    v_mfma_f32_16x16x32_bf16 v[104:107], v[76:79], v[156:159], v[104:107]
    s_mov_b32 s73, 3
    v_rcp_f32 v3, v3
    v_mfma_f32_16x16x32_bf16 v[108:111], v[80:83], v[152:155], v[140:143]
    s_sub_u32 s50, s50, 1
    v_fma_f32 v0, v0, v2, s44
    v_fmac_f32 v0, v1, v3
    v_mfma_f32_16x16x32_bf16 v[108:111], v[84:87], v[156:159], v[108:111]
    s_cbranch_scc1 PEV
    v_add_u32 v246, 16, v246
RET_3:
    v_cvt_pk_bf16_f32 v0, v0, v0
    v_mfma_f32_16x16x32_bf16 v[112:115], v[88:91], v[152:155], v[144:147]
    v_exp_f32 v104, v104
    v_mfma_f32_16x16x32_bf16 v[112:115], v[92:95], v[156:159], v[112:115]
    v_exp_f32 v105, v105
    v_mfma_f32_16x16x32_bf16 v[116:119], v[96:99], v[152:155], v[148:151]
    s_sub_u32 s62, s62, 1
    v_exp_f32 v106, v106
    v_mfma_f32_16x16x32_bf16 v[116:119], v[100:103], v[156:159], v[116:119]
    s_waitcnt vmcnt(3)
    v_exp_f32 v107, v107
    ds_write_b16 v249, v0
    ds_read_b64 v[236:237], v248
    ds_read_b64_tr_b16 v[168:169], v244 offset:6144
    ds_read_b64_tr_b16 v[170:171], v245 offset:6656
    ds_read_b64_tr_b16 v[172:173], v244 offset:7168
    ds_read_b64_tr_b16 v[174:175], v245 offset:7680
    ds_read_u8 v238, v246 offset:0
    ds_read_u8 v240, v246 offset:8
    ds_read_b32 v254, v253
    ds_read_b128 v[152:155], v242 offset:0
    ds_read_b128 v[156:159], v243 offset:0
    v_exp_f32 v108, v108
    v_exp_f32 v109, v109
    v_exp_f32 v110, v110
    v_exp_f32 v111, v111
    s_waitcnt lgkmcnt(9)
    v_mfma_f32_4x4x4_16b_bf16 v[176:179], v[236:237], v[160:161], v[176:179] cbsz:4 abid:0
    v_exp_f32 v112, v112
    v_exp_f32 v113, v113
    v_mfma_f32_4x4x4_16b_bf16 v[176:179], v[236:237], v[162:163], v[176:179] cbsz:4 abid:1
    v_exp_f32 v114, v114
    v_exp_f32 v115, v115
    v_mfma_f32_4x4x4_16b_bf16 v[176:179], v[236:237], v[164:165], v[176:179] cbsz:4 abid:2
    v_exp_f32 v116, v116
    v_exp_f32 v117, v117
    v_mfma_f32_4x4x4_16b_bf16 v[176:179], v[236:237], v[166:167], v[176:179] cbsz:4 abid:3
    v_exp_f32 v118, v118
    v_exp_f32 v119, v119
    .p2align 3
    v_pk_add_f32 v[2:3], v[104:105], 1.0 op_sel_hi:[1,0]
    v_pk_fma_f32 v[0:1], v[120:121], v[106:107], v[120:121]
    v_pk_fma_f32 v[0:1], v[122:123], v[2:3], v[0:1]
    v_pk_fma_f32 v[2:3], v[106:107], v[2:3], v[2:3]
    v_pk_fma_f32 v[0:1], v[108:109], v[0:1], v[0:1]
    v_pk_fma_f32 v[0:1], v[124:125], v[2:3], v[0:1]
    v_pk_fma_f32 v[2:3], v[108:109], v[2:3], v[2:3]
    v_pk_fma_f32 v[0:1], v[110:111], v[0:1], v[0:1]
    v_pk_fma_f32 v[0:1], v[126:127], v[2:3], v[0:1]
    v_pk_fma_f32 v[2:3], v[110:111], v[2:3], v[2:3]
    v_pk_fma_f32 v[0:1], v[112:113], v[0:1], v[0:1]
    v_pk_fma_f32 v[0:1], v[128:129], v[2:3], v[0:1]
    v_pk_fma_f32 v[2:3], v[112:113], v[2:3], v[2:3]
    v_pk_fma_f32 v[0:1], v[114:115], v[0:1], v[0:1]
    v_pk_fma_f32 v[0:1], v[130:131], v[2:3], v[0:1]
    v_pk_fma_f32 v[2:3], v[114:115], v[2:3], v[2:3]
    v_pk_fma_f32 v[0:1], v[116:117], v[0:1], v[0:1]
    v_pk_fma_f32 v[0:1], v[132:133], v[2:3], v[0:1]
    v_pk_fma_f32 v[2:3], v[116:117], v[2:3], v[2:3]
    v_pk_fma_f32 v[0:1], v[118:119], v[0:1], v[0:1]
    v_pk_fma_f32 v[0:1], v[134:135], v[2:3], v[0:1]
    v_pk_fma_f32 v[2:3], v[118:119], v[2:3], v[2:3]
    s_waitcnt lgkmcnt(0)
    buffer_load_dwordx4 v[238:239], s[20:23], s72 idxen offen nt lds
    buffer_load_dwordx4 v[240:241], s[20:23], s51 idxen offen offset:1024 nt lds
    s_cbranch_scc0 U_0
CEV:
    s_cmp_eq_u32 s76, 0
    s_cbranch_scc1 EPI
    s_mov_b32 s53, s52
    s_and_b32 s52, s68, 0xffff
    s_lshr_b64 s[68:69], s[68:69], 16
    s_sub_u32 s75, s75, 16
    s_bitcmp1_b32 s52, 6
    s_cbranch_scc1 DRAIN
BPF:
    s_and_b32 s57, s52, 63
    s_mul_i32 s57, s57, 528
    s_add_u32 s57, s57, 83200
    v_lshl_add_u32 v6, v252, 1, s57
    v_add_u32 v7, s57, v252
    ds_read_b128 v[104:107], v6 offset:0
    ds_read_b128 v[108:111], v6 offset:16
    ds_read_b128 v[144:147], v251 offset:12288
    ds_read_b128 v[148:151], v251 offset:13312
    ds_read_b128 v[112:115], v6 offset:128
    ds_read_b128 v[116:119], v6 offset:144
    s_mov_b32 s62, 0
    s_mov_b32 s76, 0
    s_cmp_lg_u32 s77, 0
    s_waitcnt lgkmcnt(4)
    .p2align 3
    v_pk_fma_f32 v[136:137], v[8:9], v[104:105], v[180:181]
    v_pk_fma_f32 v[138:139], v[10:11], v[106:107], v[182:183]
    v_pk_fma_f32 v[140:141], v[12:13], v[108:109], v[184:185]
    v_pk_fma_f32 v[142:143], v[14:15], v[110:111], v[186:187]
    v_cvt_pk_bf16_f32 v72, v136, v137
    v_cvt_pk_bf16_f32 v73, v138, v139
    v_cvt_pk_bf16_f32 v74, v140, v141
    v_cvt_pk_bf16_f32 v75, v142, v143
    v_pk_fma_f32 v[136:137], v[24:25], v[104:105], v[196:197]
    v_pk_fma_f32 v[138:139], v[26:27], v[106:107], v[198:199]
    v_pk_fma_f32 v[140:141], v[28:29], v[108:109], v[200:201]
    v_pk_fma_f32 v[142:143], v[30:31], v[110:111], v[202:203]
    v_cvt_pk_bf16_f32 v80, v136, v137
    v_cvt_pk_bf16_f32 v81, v138, v139
    v_cvt_pk_bf16_f32 v82, v140, v141
    v_cvt_pk_bf16_f32 v83, v142, v143
    v_pk_fma_f32 v[136:137], v[40:41], v[104:105], v[212:213]
    v_pk_fma_f32 v[138:139], v[42:43], v[106:107], v[214:215]
    v_pk_fma_f32 v[140:141], v[44:45], v[108:109], v[216:217]
    v_pk_fma_f32 v[142:143], v[46:47], v[110:111], v[218:219]
    v_cvt_pk_bf16_f32 v88, v136, v137
    v_cvt_pk_bf16_f32 v89, v138, v139
    v_cvt_pk_bf16_f32 v90, v140, v141
    v_cvt_pk_bf16_f32 v91, v142, v143
    s_waitcnt lgkmcnt(0)
    .p2align 3
    v_pk_fma_f32 v[144:145], v[56:57], v[104:105], v[144:145]
    v_pk_fma_f32 v[146:147], v[58:59], v[106:107], v[146:147]
    v_pk_fma_f32 v[148:149], v[60:61], v[108:109], v[148:149]
    v_pk_fma_f32 v[150:151], v[62:63], v[110:111], v[150:151]
    v_cvt_pk_bf16_f32 v96, v144, v145
    v_cvt_pk_bf16_f32 v97, v146, v147
    v_cvt_pk_bf16_f32 v98, v148, v149
    v_cvt_pk_bf16_f32 v99, v150, v151
    ds_read_b128 v[136:139], v7 offset:256
    ds_read_b128 v[140:143], v7 offset:320
    ds_read_b128 v[144:147], v7 offset:384
    ds_read_b128 v[148:151], v7 offset:448
    v_pk_fma_f32 v[104:105], v[16:17], v[112:113], v[188:189]
    v_pk_fma_f32 v[106:107], v[18:19], v[114:115], v[190:191]
    v_pk_fma_f32 v[108:109], v[20:21], v[116:117], v[192:193]
    v_pk_fma_f32 v[110:111], v[22:23], v[118:119], v[194:195]
    v_cvt_pk_bf16_f32 v76, v104, v105
    v_cvt_pk_bf16_f32 v77, v106, v107
    v_cvt_pk_bf16_f32 v78, v108, v109
    v_cvt_pk_bf16_f32 v79, v110, v111
    v_pk_fma_f32 v[104:105], v[32:33], v[112:113], v[204:205]
    v_pk_fma_f32 v[106:107], v[34:35], v[114:115], v[206:207]
    v_pk_fma_f32 v[108:109], v[36:37], v[116:117], v[208:209]
    v_pk_fma_f32 v[110:111], v[38:39], v[118:119], v[210:211]
    v_cvt_pk_bf16_f32 v84, v104, v105
    v_cvt_pk_bf16_f32 v85, v106, v107
    v_cvt_pk_bf16_f32 v86, v108, v109
    v_cvt_pk_bf16_f32 v87, v110, v111
    v_pk_fma_f32 v[104:105], v[48:49], v[112:113], v[220:221]
    v_pk_fma_f32 v[106:107], v[50:51], v[114:115], v[222:223]
    v_pk_fma_f32 v[108:109], v[52:53], v[116:117], v[224:225]
    v_pk_fma_f32 v[110:111], v[54:55], v[118:119], v[226:227]
    v_cvt_pk_bf16_f32 v92, v104, v105
    v_cvt_pk_bf16_f32 v93, v106, v107
    v_cvt_pk_bf16_f32 v94, v108, v109
    v_cvt_pk_bf16_f32 v95, v110, v111
    v_pk_fma_f32 v[104:105], v[64:65], v[112:113], v[228:229]
    v_pk_fma_f32 v[106:107], v[66:67], v[114:115], v[230:231]
    v_pk_fma_f32 v[108:109], v[68:69], v[116:117], v[232:233]
    v_pk_fma_f32 v[110:111], v[70:71], v[118:119], v[234:235]
    v_cvt_pk_bf16_f32 v100, v104, v105
    v_cvt_pk_bf16_f32 v101, v106, v107
    v_cvt_pk_bf16_f32 v102, v108, v109
    v_cvt_pk_bf16_f32 v103, v110, v111
    s_waitcnt lgkmcnt(0)
    s_cbranch_scc1 BP_X
NEXT:
    s_cmp_eq_u32 s73, 0
    s_cbranch_scc1 U_1
    s_cmp_eq_u32 s73, 1
    s_cbranch_scc1 U_2
    s_cmp_eq_u32 s73, 2
    s_cbranch_scc1 U_3
    s_branch U_0
EPI:
    s_and_b32 s56, s53, 0x7f
    v_pk_add_f32 v[4:5], v[176:177], v[178:179]
    v_add_f32 v4, v4, v5
    v_lshl_add_u32 v5, s56, 8, v250
    v_mul_f32 v4, s46, v4
    s_bitcmp1_b32 s53, 7
    v_cmp_class_f32_e64 vcc, v4, s45
    v_mov_b64 v[176:177], 0
    v_mov_b64 v[178:179], 0
    ds_write_b32 v5, v4
    s_cbranch_scc1 SLOW
    s_cbranch_vccnz SLOW
EPI_R:
    s_bitcmp1_b32 s52, 6
    s_cbranch_scc1 L_DONE
EPI_C:
    s_bfe_u32 s62, s52, 0x40008
    s_sub_u32 s62, s62, 2
    s_mov_b32 s76, 1
    s_cmp_eq_u32 s73, 0
    s_cbranch_scc1 U_1
    s_cmp_eq_u32 s73, 1
    s_cbranch_scc1 U_2
    s_cmp_eq_u32 s73, 2
    s_cbranch_scc1 U_3
    s_branch U_0
PEV:
    s_cmp_eq_u32 s55, 0
    s_cbranch_scc1 P_DR
ADV:
    v_readfirstlane_b32 s66, v254
    s_mov_b32 s67, 0
    s_and_b32 s56, s66, 63
    s_bfe_u32 s50, s66, 0x40008
    s_cbranch_scc0 AW
    s_mul_i32 s51, s56, 25600
    v_lshl_add_u32 v246, s56, 8, v247
    s_add_u32 s51, s51, s49
    s_add_u32 s72, s51, 1024
    s_lshl_b64 s[64:65], s[66:67], s75
    s_or_b64 s[68:69], s[68:69], s[64:65]
    s_add_u32 s75, s75, 16
    s_mov_b32 s55, 0
    s_sub_u32 s50, s50, 3
    s_cbranch_scc1 P_2
P_RET:
    s_cmp_eq_u32 s73, 0
    s_cbranch_scc1 RET_0
    s_cmp_eq_u32 s73, 1
    s_cbranch_scc1 RET_1
    s_cmp_eq_u32 s73, 2
    s_cbranch_scc1 RET_2
    s_branch RET_3
P_DR:
    v_add_u32 v246, 16, v246
P_D2:
    s_mov_b64 exec, 1
    v_mov_b32 v253, 4
    ds_add_rtn_u32 v253, v251, v253 offset:17600
    s_mov_b64 exec, -1
    s_mov_b32 s50, 1
    s_mov_b32 s55, 1
    s_cmp_eq_u32 s73, 0
    s_cbranch_scc1 RET_0
    s_cmp_eq_u32 s73, 1
    s_cbranch_scc1 RET_1
    s_cmp_eq_u32 s73, 2
    s_cbranch_scc1 RET_2
    s_branch RET_3
P_2:
    s_bitcmp1_b32 s66, 6
    s_cbranch_scc0 P_D2
    v_mov_b32 v246, 16896
    s_movk_i32 s50, 0x100
    s_branch P_RET
DRAIN:
    v_rcp_f32 v2, v2
    v_rcp_f32 v3, v3
    v_fma_f32 v0, v0, v2, s44
    v_fmac_f32 v0, v1, v3
    v_cvt_pk_bf16_f32 v0, v0, v0
    s_bitcmp1_b32 s73, 0
    ds_write_b16 v249, v0
    ds_read_b64 v[236:237], v248
    s_waitcnt lgkmcnt(0)
    s_cbranch_scc1 DRAIN1
    v_mfma_f32_4x4x4_16b_bf16 v[176:179], v[236:237], v[160:161], v[176:179] cbsz:4 abid:0
    s_nop 1
    v_mfma_f32_4x4x4_16b_bf16 v[176:179], v[236:237], v[162:163], v[176:179] cbsz:4 abid:1
    s_nop 1
    v_mfma_f32_4x4x4_16b_bf16 v[176:179], v[236:237], v[164:165], v[176:179] cbsz:4 abid:2
    s_nop 1
    v_mfma_f32_4x4x4_16b_bf16 v[176:179], v[236:237], v[166:167], v[176:179] cbsz:4 abid:3
    s_nop 2
    s_branch EPI
DRAIN1:
    v_mfma_f32_4x4x4_16b_bf16 v[176:179], v[236:237], v[168:169], v[176:179] cbsz:4 abid:0
    s_nop 1
    v_mfma_f32_4x4x4_16b_bf16 v[176:179], v[236:237], v[170:171], v[176:179] cbsz:4 abid:1
    s_nop 1
    v_mfma_f32_4x4x4_16b_bf16 v[176:179], v[236:237], v[172:173], v[176:179] cbsz:4 abid:2
    s_nop 1
    v_mfma_f32_4x4x4_16b_bf16 v[176:179], v[236:237], v[174:175], v[176:179] cbsz:4 abid:3
    s_nop 2
    s_branch EPI
L_DONE:
    s_lshl_b32 s56, s48, 11
    s_add_u32 s56, s56, 133376
    v_lshl_add_u32 v0, v251, 1, s56
    s_lshl_b32 s56, s48, 10
    s_waitcnt lgkmcnt(0)
    s_barrier
    ds_read_b128 v[104:107], v0 offset:0
    ds_read_b128 v[108:111], v0 offset:16
    s_waitcnt lgkmcnt(0)
    v_cvt_pk_bf16_f32 v152, v104, v105
    v_cvt_pk_bf16_f32 v153, v106, v107
    v_cvt_pk_bf16_f32 v154, v108, v109
    v_cvt_pk_bf16_f32 v155, v110, v111
    buffer_store_dwordx4 v[152:155], v251, s[28:31], s56 offen nt
L_FIN:
    s_endpgm
AW:
    s_sleep 1
    ds_read_b32 v254, v253
    s_waitcnt lgkmcnt(0)
    s_branch ADV
DRAW_P:
    s_mov_b64 exec, 1
    v_mov_b32 v253, 4
    ds_add_rtn_u32 v253, v251, v253 offset:17600
    s_mov_b64 exec, -1
    s_add_u32 s50, s50, 2
    s_mov_b32 s55, 1
    s_waitcnt lgkmcnt(0)
    ds_read_b32 v254, v253
    s_branch DRET_P
BP_X:
    s_cmp_eq_u32 s77, 1
    s_mov_b32 s77, 0
    s_cbranch_scc1 SLOW_W
    s_branch EPI_C
SLOW:
    s_bitcmp1_b32 s53, 6
    s_cbranch_scc1 EPI_R
    s_mov_b32 s74, s52
    s_mov_b32 s52, s53
    s_mov_b32 s77, 1
    ds_write_b32 v5, v176
    s_branch BPF
SLOW_W:
    s_mov_b32 s52, s74
    s_and_b32 s56, s53, 63
    s_lshr_b32 s57, s53, 12
    s_bfe_u32 s59, s53, 0x40008
    s_lshl4_add_u32 s57, s56, s57
    s_lshl_b32 s57, s57, 4
    s_add_u32 s74, s57, 116992
    s_bitcmp1_b32 s53, 7
    s_cselect_b64 s[66:67], -1, 0
    s_cselect_b32 s59, 13, s59
    v_bfe_u32 v204, v251, 4, 4
    v_mov_b32 v207, v252
    v_mov_b64 v[180:181], 0
    v_mov_b64 v[182:183], 0
    v_mov_b64 v[184:185], 0
    v_mov_b64 v[186:187], 0
    v_mov_b64 v[188:189], 0
    v_mov_b64 v[190:191], 0
    v_mov_b64 v[192:193], 0
    v_mov_b64 v[194:195], 0
    s_mul_i32 s57, s56, 25600
    s_add_u32 s57, s57, s49
    s_mul_i32 s58, s56, 400
SLOW_L:
    v_add_u32 v205, s74, v204
    ds_read_u8 v206, v205
    s_waitcnt lgkmcnt(0)
    v_cndmask_b32_e64 v206, v206, v204, s[66:67]
    v_lshlrev_b32 v205, 1, v206
    buffer_load_dwordx4 v[196:199], v[206:207], s[20:23], s57 idxen offen offset:1024
    buffer_load_dwordx4 v[200:203], v[206:207], s[20:23], s57 idxen offen offset:1088
    buffer_load_ushort v205, v205, s[24:27], s58 offen
    v_cmp_gt_u32 vcc, 200, v206
    v_add_u32 v204, 16, v204
    s_waitcnt vmcnt(0)
    v_mfma_f32_16x16x32_bf16 v[104:107], v[72:75], v[196:199], v[136:139]
    v_mfma_f32_16x16x32_bf16 v[104:107], v[76:79], v[200:203], v[104:107]
    v_mfma_f32_16x16x32_bf16 v[108:111], v[80:83], v[196:199], v[140:143]
    v_mfma_f32_16x16x32_bf16 v[108:111], v[84:87], v[200:203], v[108:111]
    v_mfma_f32_16x16x32_bf16 v[112:115], v[88:91], v[196:199], v[144:147]
    v_mfma_f32_16x16x32_bf16 v[112:115], v[92:95], v[200:203], v[112:115]
    v_mfma_f32_16x16x32_bf16 v[116:119], v[96:99], v[196:199], v[148:151]
    v_mfma_f32_16x16x32_bf16 v[116:119], v[100:103], v[200:203], v[116:119]
    v_lshlrev_b32 v205, 16, v205
    v_cndmask_b32 v205, 0, v205, vcc
    s_nop 7
    v_exp_f32 v104, v104
    v_exp_f32 v105, v105
    v_exp_f32 v106, v106
    v_exp_f32 v107, v107
    v_exp_f32 v108, v108
    v_exp_f32 v109, v109
    v_exp_f32 v110, v110
    v_exp_f32 v111, v111
    v_exp_f32 v112, v112
    v_exp_f32 v113, v113
    v_exp_f32 v114, v114
    v_exp_f32 v115, v115
    v_exp_f32 v116, v116
    v_exp_f32 v117, v117
    v_exp_f32 v118, v118
    v_exp_f32 v119, v119
    v_add_f32 v104, 1.0, v104
    v_add_f32 v105, 1.0, v105
    v_add_f32 v106, 1.0, v106
    v_add_f32 v107, 1.0, v107
    v_add_f32 v108, 1.0, v108
    v_add_f32 v109, 1.0, v109
    v_add_f32 v110, 1.0, v110
    v_add_f32 v111, 1.0, v111
    v_add_f32 v112, 1.0, v112
    v_add_f32 v113, 1.0, v113
    v_add_f32 v114, 1.0, v114
    v_add_f32 v115, 1.0, v115
    v_add_f32 v116, 1.0, v116
    v_add_f32 v117, 1.0, v117
    v_add_f32 v118, 1.0, v118
    v_add_f32 v119, 1.0, v119
    v_rcp_f32 v104, v104
    v_rcp_f32 v105, v105
    v_rcp_f32 v106, v106
    v_rcp_f32 v107, v107
    v_rcp_f32 v108, v108
    v_rcp_f32 v109, v109
    v_rcp_f32 v110, v110
    v_rcp_f32 v111, v111
    v_rcp_f32 v112, v112
    v_rcp_f32 v113, v113
    v_rcp_f32 v114, v114
    v_rcp_f32 v115, v115
    v_rcp_f32 v116, v116
    v_rcp_f32 v117, v117
    v_rcp_f32 v118, v118
    v_rcp_f32 v119, v119
    v_mul_f32 v208, v104, v120
    v_fmac_f32 v208, v105, v121
    v_fmac_f32 v208, v106, v122
    v_fmac_f32 v208, v107, v123
    v_fmac_f32 v208, v108, v124
    v_fmac_f32 v208, v109, v125
    v_fmac_f32 v208, v110, v126
    v_fmac_f32 v208, v111, v127
    v_fmac_f32 v208, v112, v128
    v_fmac_f32 v208, v113, v129
    v_fmac_f32 v208, v114, v130
    v_fmac_f32 v208, v115, v131
    v_fmac_f32 v208, v116, v132
    v_fmac_f32 v208, v117, v133
    v_fmac_f32 v208, v118, v134
    v_fmac_f32 v208, v119, v135
    v_mov_b32 v209, v208
    s_nop 1
    v_permlane32_swap_b32 v208, v209
    v_add_f32 v208, v208, v209
    v_mov_b32 v209, v208
    s_nop 1
    v_permlane16_swap_b32 v208, v209
    v_add_f32 v208, v208, v209
    v_mul_f32 v208, s46, v208
    v_add_f32 v208, s63, v208
    v_mul_f32 v208, v208, v205
    v_lshlrev_b32 v209, 16, v196
    v_and_b32 v210, 0xffff0000, v196
    v_fmac_f32 v180, v208, v209
    v_fmac_f32 v181, v208, v210
    v_lshlrev_b32 v209, 16, v197
    v_and_b32 v210, 0xffff0000, v197
    v_fmac_f32 v182, v208, v209
    v_fmac_f32 v183, v208, v210
    v_lshlrev_b32 v209, 16, v198
    v_and_b32 v210, 0xffff0000, v198
    v_fmac_f32 v184, v208, v209
    v_fmac_f32 v185, v208, v210
    v_lshlrev_b32 v209, 16, v199
    v_and_b32 v210, 0xffff0000, v199
    v_fmac_f32 v186, v208, v209
    v_fmac_f32 v187, v208, v210
    v_lshlrev_b32 v209, 16, v200
    v_and_b32 v210, 0xffff0000, v200
    v_fmac_f32 v188, v208, v209
    v_fmac_f32 v189, v208, v210
    v_lshlrev_b32 v209, 16, v201
    v_and_b32 v210, 0xffff0000, v201
    v_fmac_f32 v190, v208, v209
    v_fmac_f32 v191, v208, v210
    v_lshlrev_b32 v209, 16, v202
    v_and_b32 v210, 0xffff0000, v202
    v_fmac_f32 v192, v208, v209
    v_fmac_f32 v193, v208, v210
    v_lshlrev_b32 v209, 16, v203
    v_and_b32 v210, 0xffff0000, v203
    v_fmac_f32 v194, v208, v209
    v_fmac_f32 v195, v208, v210
    s_sub_u32 s59, s59, 1
    s_cmp_lg_u32 s59, 0
    s_cbranch_scc1 SLOW_L
    v_readfirstlane_b32 s56, v5
    s_nop 1
    v_lshl_add_u32 v208, v252, 1, s56
    ds_add_f32 v208, v180 offset:0
    ds_add_f32 v208, v181 offset:4
    ds_add_f32 v208, v182 offset:8
    ds_add_f32 v208, v183 offset:12
    ds_add_f32 v208, v184 offset:16
    ds_add_f32 v208, v185 offset:20
    ds_add_f32 v208, v186 offset:24
    ds_add_f32 v208, v187 offset:28
    ds_add_f32 v208, v188 offset:128
    ds_add_f32 v208, v189 offset:132
    ds_add_f32 v208, v190 offset:136
    ds_add_f32 v208, v191 offset:140
    ds_add_f32 v208, v192 offset:144
    ds_add_f32 v208, v193 offset:148
    ds_add_f32 v208, v194 offset:152
    ds_add_f32 v208, v195 offset:156
    s_waitcnt lgkmcnt(0)
    s_bitcmp1_b32 s52, 6
    s_cbranch_scc1 L_DONE
    ds_read_b128 v[180:183], v251 offset:0
    ds_read_b128 v[184:187], v251 offset:1024
    ds_read_b128 v[196:199], v251 offset:4096
    ds_read_b128 v[200:203], v251 offset:5120
    ds_read_b128 v[212:215], v251 offset:8192
    ds_read_b128 v[216:219], v251 offset:9216
    ds_read_b128 v[188:191], v251 offset:2048
    ds_read_b128 v[192:195], v251 offset:3072
    ds_read_b128 v[204:207], v251 offset:6144
    ds_read_b128 v[208:211], v251 offset:7168
    ds_read_b128 v[220:223], v251 offset:10240
    ds_read_b128 v[224:227], v251 offset:11264
    ds_read_b128 v[228:231], v251 offset:14336
    ds_read_b128 v[232:235], v251 offset:15360
    s_mov_b32 s77, 2
    s_branch BPF
L_END:
    s_endpgm
.section .rodata,"a"
.p2align 6
.amdhsa_kernel standalone__sequential_behavior_din__recsys_kernel
  .amdhsa_next_free_vgpr 255
  .amdhsa_next_free_sgpr 78
  .amdhsa_accum_offset 256
  .amdhsa_group_segment_fixed_size 0
  .amdhsa_kernarg_size 80
  .amdhsa_user_sgpr_count 2
  .amdhsa_user_sgpr_kernarg_segment_ptr 1
  .amdhsa_system_sgpr_workgroup_id_x 1
.end_amdhsa_kernel
```

```asm
; @launch grid=(256,1,1) block=(512,1,1) lds=153856
.amdgcn_target "amdgcn-amd-amdhsa--gfx950"
.text
.globl standalone__sequential_behavior_din__recsys_kernel
.p2align 8
.type standalone__sequential_behavior_din__recsys_kernel,@function
standalone__sequential_behavior_din__recsys_kernel:
    s_cmpk_ge_u32 s2, 256
    s_cbranch_scc1 L_END
    s_load_dwordx16 s[4:19], s[0:1], 0
    s_setprio 3
    v_lshrrev_b32 v1, 6, v0
    v_and_b32 v176, 63, v0
    v_readfirstlane_b32 s48, v1
    s_getpc_b64 s[40:41]
L_PC:
    s_cmp_lt_u32 s48, 5
    s_cbranch_scc1 P_NC
    s_mov_b32 s42, L_END-L_PC
    s_mov_b32 s43, 0x20000
    v_subrev_u32 v150, 320, v0
    v_lshlrev_b32 v150, 6, v150
    buffer_load_dword v150, v150, s[40:43], 0 offen
P_NC:
    v_and_b32 v2, 31, v0
    v_bfe_u32 v3, v0, 5, 1
    v_cmp_gt_u32 vcc, 25, v2
    v_mul_u32_u24 v4, 400, v3
    v_lshl_add_u32 v179, v2, 4, v4
    v_bfrev_b32 v4, 8
    v_cndmask_b32 v179, v4, v179, vcc
    s_mul_i32 s57, s2, 3200
    s_sub_u32 s26, 6553600, s57
    s_lshr_b32 s59, s48, 2
    s_mul_i32 s71, s48, 800
    s_mul_i32 s59, s59, 816000
    s_add_u32 s71, s71, s59
    s_mov_b32 s27, 0x20000
    s_lshl_b32 s74, s48, 12
    s_lshl_b32 s53, s2, 10
    v_lshlrev_b32 v251, 4, v176
    v_lshlrev_b32 v120, 1, v176
    v_and_b32 v120, 32, v120
    v_xor_b32 v120, v120, v251
    v_xor_b32 v121, 64, v120
    s_mov_b32 s38, 32768
    s_mov_b32 s39, s27
    s_lshl_b32 s58, s48, 18
    s_sub_u32 s34, 2097152, s53
    s_mov_b32 s35, s27
    s_add_u32 m0, s74, 121088
    v_and_b32 v178, 15, v176
    v_lshrrev_b32 v177, 4, v176
    v_lshlrev_b32 v252, 4, v177
    v_mul_u32_u24 v208, 0x80008, v2
    v_lshrrev_b32 v238, 3, v176
    v_add_u32 v208, 0x10000, v208
    v_cmp_gt_u32 vcc, 32, v176
    s_waitcnt lgkmcnt(0)
    s_add_u32 s24, s8, s57
    s_addc_u32 s25, s9, 0
    s_mov_b64 s[36:37], s[10:11]
    buffer_load_dwordx4 v[204:207], v179, s[24:27], s71 offen offset:0 nt
    s_setprio 0
    s_add_u32 s32, s4, s53
    s_addc_u32 s33, s5, 0
    s_load_dword s63, s[16:17], 0
    s_cmp_lg_u32 s48, 0
    s_cbranch_scc1 P_LJ
    v_mov_b32 v146, s12
    v_mov_b32 v147, s13
    v_mov_b32 v148, s14
    v_mov_b32 v149, s15
    v_lshlrev_b32 v4, 2, v2
    v_cndmask_b32 v146, v146, v148, vcc
    v_cndmask_b32 v147, v147, v149, vcc
    v_add_co_u32 v146, vcc, v146, v4
    s_nop 1
    v_addc_co_u32 v147, vcc, 0, v147, vcc
    global_load_dword v146, v[146:147], off
P_LJ:
    buffer_load_dwordx4 v[124:127], v251, s[32:35], s58 offen nt
    buffer_load_dwordx4 v120, s[36:39], s74 offen offset:0 lds
    buffer_load_dwordx4 v121, s[36:39], s74 offen offset:1024 lds
    s_lshl1_add_u32 s54, s74, 17664
    s_mul_i32 s49, s2, 204800
    s_lshl_b32 s57, s48, 9
    v_add_u32 v247, 116992, v238
    v_add_u32 v246, s57, v247
    s_add_u32 s56, s57, 116992
    v_add_u32 v209, 0x20002, v208
    v_add_u32 v210, 0x40004, v208
    v_add_u32 v211, 0x60006, v208
    s_sub_u32 s20, s6, 1024
    s_subb_u32 s21, s7, 0
    s_or_b32 s21, s21, 0x800000
    s_movk_i32 s22, 200
    s_mov_b32 s23, s27
    s_movk_i32 s61, 0x3f80
    v_lshrrev_b32 v216, 1, v251
    v_and_b32 v213, 0x100, v216
    v_mov_b64 v[214:215], -1
    v_lshlrev_b32 v250, 2, v176
    v_bfrev_b32 v2, v238
    v_lshrrev_b32 v2, 28, v2
    v_and_b32 v2, 6, v2
    v_xor_b32 v2, v2, v176
    v_and_b32 v2, 7, v2
    v_mul_u32_u24 v143, 528, v238
    v_lshlrev_b32 v239, 4, v2
    v_lshlrev_b32 v241, 4, v2
    v_lshlrev_b32 v153, 4, v2
    v_lshlrev_b32 v155, 4, v2
    s_add_u32 s28, s18, s53
    s_addc_u32 s29, s19, 0
    s_sub_u32 s30, 2097152, s53
    s_mov_b32 s31, s27
    s_mov_b32 s60, 0xbfb8aa3b
    s_mov_b32 s46, 0x2b800000
    s_lshr_b32 s59, s48, 2
    s_mul_i32 s51, s48, 51200
    s_mul_i32 s59, s59, 52224000
    s_add_u32 s51, s51, s59
    s_add_u32 s51, s51, s49
    s_add_u32 s72, s51, 1024
    v_bfrev_b32 v2, v178
    v_lshrrev_b32 v2, 28, v2
    v_and_b32 v2, 6, v2
    v_xor_b32 v2, v2, v177
    v_lshl_add_u32 v2, v2, 4, s54
    v_lshl_add_u32 v242, v178, 7, v2
    v_xor_b32 v243, 64, v242
    v_and_b32 v3, 3, v176
    v_bfe_u32 v2, v176, 2, 2
    v_lshlrev_b32 v7, 3, v3
    v_lshl_add_u32 v7, v2, 7, v7
    v_and_b32 v6, 8, v176
    v_lshlrev_b32 v6, 3, v6
    v_lshl_add_u32 v244, v177, 5, v7
    v_xor_b32 v244, v244, v6
    v_add_u32 v244, s54, v244
    v_xor_b32 v245, 32, v244
    s_lshl_b32 s57, s48, 7
    s_add_u32 s57, s57, 150016
    v_lshl_add_u32 v249, v2, 2, v177
    v_lshl_add_u32 v249, v249, 2, v3
    v_lshl_add_u32 v249, v249, 1, s57
    v_lshl_add_u32 v248, v178, 3, s57
    v_and_b32 v6, 0x60, v250
    v_or_b32 v6, v6, v7
    v_lshl_add_u32 v136, v177, 10, v6
    s_mul_i32 s57, s48, 0x1010
    s_and_b32 s57, s57, 0x1060
    v_xor_b32 v144, s57, v136
    v_add_u32 v136, 121088, v136
    v_add_u32 v144, 121088, v144
    v_xor_b32 v137, 32, v136
    v_xor_b32 v138, 64, v136
    v_xor_b32 v139, 96, v136
    s_and_b32 s59, s48, 4
    s_lshl_b32 s59, s59, 4
    v_xor_b32 v140, s59, v136
    v_xor_b32 v141, 32, v140
    s_and_b32 s57, s48, 3
    s_mul_i32 s57, s57, 8448
    s_lshl1_add_u32 s57, s59, s57
    s_add_u32 s57, s57, 83200
    v_mul_u32_u24 v145, 528, v178
    v_add3_u32 v145, v145, v252, s57
    v_lshl_add_u32 v142, s59, 1, v252
    s_mul_i32 s57, s48, 4224
    s_add_u32 s57, s57, 83200
    v_and_b32 v3, 0x70, v251
    v_add3_u32 v143, v143, v3, s57
    v_add_u32 v3, v143, v3
    s_lshl_b32 s57, s48, 11
    v_add_u32 v151, s57, v251
    s_mov_b32 s66, 0x1b0a0100
    s_mov_b32 s67, 0x966d4c33
    s_lshl_b32 s57, s48, 3
    s_lshr_b64 s[66:67], s[66:67], s57
    s_and_b32 s47, s66, 7
    s_bfe_u32 s70, s66, 0x50003
    s_lshl1_add_u32 s70, s70, 16
    s_mul_i32 s71, s70, 400
    buffer_load_dwordx4 v120, s[36:39], s74 offen offset:2048 lds
    buffer_load_dwordx4 v121, s[36:39], s74 offen offset:3072 lds
    s_cmp_eq_u32 s48, 0
    s_waitcnt vmcnt(6) lgkmcnt(0)
    s_cbranch_scc1 P_M0
    s_waitcnt vmcnt(5)
P_M0:
    s_call_b64 s[36:37], CMP
    s_branch P_C
    .p2align 3
CMP:
    v_bcnt_u32_b32 v7, v204, 0
    v_bcnt_u32_b32 v7, v205, v7
    v_bcnt_u32_b32 v7, v206, v7
    v_bcnt_u32_b32 v7, v207, v7
    v_add_u32 v4, s56, v216
    v_mov_b32 v6, v7
    ds_write_b64 v4, v[214:215]
    v_cmp_eq_u16_e64 s[4:5], s61, v204
    v_cmp_eq_u16_sdwa s[6:7], v204, s61 src0_sel:WORD_1 src1_sel:WORD_0
    v_add_u32_dpp v6, v6, v6 row_shr:1 row_mask:0xf bank_mask:0xf bound_ctrl:0
    v_cmp_eq_u16_e64 s[8:9], s61, v205
    v_cmp_eq_u16_sdwa s[10:11], v205, s61 src0_sel:WORD_1 src1_sel:WORD_0
    v_add_u32_dpp v6, v6, v6 row_shr:2 row_mask:0xf bank_mask:0xf bound_ctrl:0
    v_cmp_eq_u16_e64 s[12:13], s61, v206
    v_cmp_eq_u16_sdwa s[14:15], v206, s61 src0_sel:WORD_1 src1_sel:WORD_0
    v_add_u32_dpp v6, v6, v6 row_shr:4 row_mask:0xf bank_mask:0xf bound_ctrl:0
    v_cmp_eq_u16_e64 s[16:17], s61, v207
    v_cmp_eq_u16_sdwa s[18:19], v207, s61 src0_sel:WORD_1 src1_sel:WORD_0
    v_add_u32_dpp v6, v6, v6 row_shr:8 row_mask:0xf bank_mask:0xf bound_ctrl:0
    s_nop 1
    v_add_u32_dpp v6, v6, v6 row_bcast:15 row_mask:0xa bank_mask:0xf
    v_sub_u32 v6, v6, v7
    v_mul_u32_u24 v6, 9363, v6
    v_lshrrev_b32 v6, 16, v6
    v_min_u32 v6, 200, v6
    v_add3_u32 v226, v6, v213, s56
    v_readlane_b32 s59, v6, 31
    v_readlane_b32 s58, v6, 63
    v_addc_co_u32_e64 v227, vcc, 0, v226, s[4:5]
    v_addc_co_u32_e64 v228, vcc, 0, v227, s[6:7]
    v_addc_co_u32_e64 v229, vcc, 0, v228, s[8:9]
    v_addc_co_u32_e64 v230, vcc, 0, v229, s[10:11]
    v_addc_co_u32_e64 v231, vcc, 0, v230, s[12:13]
    v_addc_co_u32_e64 v232, vcc, 0, v231, s[14:15]
    v_addc_co_u32_e64 v233, vcc, 0, v232, s[16:17]
    v_addc_co_u32_e64 v234, vcc, 0, v233, s[18:19]
    s_mov_b64 exec, s[4:5]
    ds_write_b8 v226, v208
    s_mov_b64 exec, s[6:7]
    ds_write_b8_d16_hi v227, v208
    s_mov_b64 exec, s[8:9]
    ds_write_b8 v228, v209
    s_mov_b64 exec, s[10:11]
    ds_write_b8_d16_hi v229, v209
    s_mov_b64 exec, s[12:13]
    ds_write_b8 v230, v210
    s_mov_b64 exec, s[14:15]
    ds_write_b8_d16_hi v231, v210
    s_mov_b64 exec, s[16:17]
    ds_write_b8 v232, v211
    s_mov_b64 exec, s[18:19]
    ds_write_b8_d16_hi v233, v211
    s_mov_b64 exec, -1
    v_sub_u32 v6, v234, v226
    v_mul_u32_u24 v6, 7, v6
    v_cmp_ne_u32 vcc, v6, v7
    s_min_u32 s64, vcc_lo, 1
    s_min_u32 s65, vcc_hi, 1
    s_lshl_b64 s[64:65], s[64:65], 15
    s_or_b32 s57, s59, s64
    s_or_b32 s58, s58, s65
    s_setpc_b64 s[36:37]
P_C:
    ds_read_u8 v238, v246 offset:0
    ds_read_u8 v240, v246 offset:8
    ds_read_u8 v152, v246 offset:16
    ds_read_u8 v154, v246 offset:24
    s_add_u32 m0, s54, 0
    s_waitcnt lgkmcnt(3)
    buffer_load_dwordx4 v[238:239], s[20:23], s72 idxen offen nt lds
    s_waitcnt lgkmcnt(2)
    buffer_load_dwordx4 v[240:241], s[20:23], s51 idxen offen offset:1024 nt lds
    s_add_u32 m0, s54, 2048
    s_waitcnt lgkmcnt(1)
    buffer_load_dwordx4 v[152:153], s[20:23], s72 idxen offen nt lds
    s_waitcnt lgkmcnt(0)
    buffer_load_dwordx4 v[154:155], s[20:23], s51 idxen offen offset:1024 nt lds
    s_lshl_b32 s63, s63, 16
    s_cmp_lg_u32 s48, 0
    s_waitcnt vmcnt(8)
    s_cbranch_scc1 P_SW_J
    v_lshlrev_b32 v148, 16, v146
    v_and_b32 v149, 0xffff0000, v146
    v_mov_b32 v4, -1
    v_mov_b32 v5, 0
    v_mov_b32 v6, 0x240
    v_lshrrev_b32 v0, 1, v251
    ds_write2st64_b32 v250, v4, v5 offset0:66 offset1:67
    s_mov_b32 exec_hi, 0
    v_max3_f32 v2, abs(v148), abs(v149), abs(s63)
    v_ldexp_f32 v148, v148, 40
    v_ldexp_f32 v149, v149, 40
    v_cmp_le_f32 vcc, 0x33800000, v2
    ds_write_b32 v250, v6 offset:17408
    s_mov_b32 exec_hi, -1
    s_movk_i32 s56, 0x3ff
    s_cmp_lg_u64 vcc, 0
    s_cmovk_i32 s56, 0x207
    v_mov_b32 v6, 17184
    v_mov_b32 v7, s56
    ds_write_b64 v0, v[148:149] offset:16384
    ds_write_b64 v5, v[6:7] offset:17600
P_SW_J:
    ds_write_b128 v143, v[124:127] offset:256
    ds_write_b128 v143, v[124:127] offset:384
    s_waitcnt vmcnt(4) lgkmcnt(0)
    s_barrier
    ds_read_b64_tr_b16 v[218:219], v144 offset:0
    ds_read_b64_tr_b16 v[220:221], v144 offset:512
    ds_read_b64_tr_b16 v[222:223], v144 offset:16384
    ds_read_b64_tr_b16 v[224:225], v144 offset:16896
    ds_read_b128 v[160:163], v145 offset:256
    ds_read_b128 v[164:167], v145 offset:320
    ds_read_b128 v[104:107], v142 offset:16640
    ds_read_b128 v[108:111], v142 offset:16704
    ds_read_b64_tr_b16 v[40:41], v140 offset:8192
    ds_read_b64_tr_b16 v[42:43], v140 offset:8704
    ds_read_b64_tr_b16 v[44:45], v141 offset:8192
    ds_read_b64_tr_b16 v[46:47], v141 offset:8704
    ds_read_b64_tr_b16 v[48:49], v140 offset:12288
    ds_read_b64_tr_b16 v[50:51], v140 offset:12800
    ds_read_b64_tr_b16 v[52:53], v141 offset:12288
    ds_read_b64_tr_b16 v[54:55], v141 offset:12800
    ds_read_b64_tr_b16 v[56:57], v140 offset:16384
    ds_read_b64_tr_b16 v[58:59], v140 offset:16896
    ds_read_b64_tr_b16 v[60:61], v141 offset:16384
    ds_read_b64_tr_b16 v[62:63], v141 offset:16896
    ds_read_b64_tr_b16 v[64:65], v140 offset:20480
    ds_read_b64_tr_b16 v[66:67], v140 offset:20992
    ds_read_b64_tr_b16 v[68:69], v141 offset:20480
    ds_read_b64_tr_b16 v[70:71], v141 offset:20992
    s_and_b32 s59, s57, 0xff
    s_lshr_b32 s57, s57, 8
    s_add_u32 s59, s59, 15
    s_lshr_b32 s59, s59, 4
    s_max_u32 s59, s59, 4
    s_lshl1_add_u32 s52, s48, s57
    s_lshl_b32 s57, s59, 8
    s_or_b32 s52, s52, s57
    s_sub_u32 s50, s59, 4
    s_and_b32 s59, s58, 0xff
    s_lshr_b32 s58, s58, 8
    s_add_u32 s59, s59, 15
    s_lshr_b32 s59, s59, 4
    s_max_u32 s59, s59, 2
    s_lshl1_add_u32 s74, s48, s58
    s_lshl_b32 s58, s59, 8
    s_or_b32 s74, s74, s58
    s_or_b32 s74, s74, 1
    v_lshlrev_b32 v24, 16, v124
    v_and_b32 v25, 0xffff0000, v124
    v_lshlrev_b32 v26, 16, v125
    v_and_b32 v27, 0xffff0000, v125
    v_lshlrev_b32 v28, 16, v126
    v_and_b32 v29, 0xffff0000, v126
    v_lshlrev_b32 v30, 16, v127
    v_and_b32 v31, 0xffff0000, v127
    v_mul_f32 v24, s60, v24
    v_mul_f32 v25, s60, v25
    v_mul_f32 v26, s60, v26
    v_mul_f32 v27, s60, v27
    v_mul_f32 v28, s60, v28
    v_mul_f32 v29, s60, v29
    v_mul_f32 v30, s60, v30
    v_mul_f32 v31, s60, v31
    s_waitcnt lgkmcnt(15)
    v_lshlrev_b32 v8, 16, v218
    v_and_b32 v9, 0xffff0000, v218
    v_lshlrev_b32 v16, 16, v222
    v_and_b32 v17, 0xffff0000, v222
    v_lshlrev_b32 v10, 16, v219
    v_and_b32 v11, 0xffff0000, v219
    v_lshlrev_b32 v18, 16, v223
    v_and_b32 v19, 0xffff0000, v223
    v_lshlrev_b32 v12, 16, v220
    v_and_b32 v13, 0xffff0000, v220
    v_lshlrev_b32 v20, 16, v224
    v_and_b32 v21, 0xffff0000, v224
    v_lshlrev_b32 v14, 16, v221
    v_and_b32 v15, 0xffff0000, v221
    v_lshlrev_b32 v22, 16, v225
    v_and_b32 v23, 0xffff0000, v225
    v_xor_b32 v168, 0x80008000, v160
    v_xor_b32 v169, 0x80008000, v161
    v_xor_b32 v170, 0x80008000, v162
    v_xor_b32 v171, 0x80008000, v163
    v_xor_b32 v172, 0x80008000, v164
    v_xor_b32 v173, 0x80008000, v165
    v_xor_b32 v174, 0x80008000, v166
    v_xor_b32 v175, 0x80008000, v167
    s_waitcnt lgkmcnt(12)
    v_mfma_f32_16x16x32_bf16 v[104:107], v[40:43], v[160:163], v[104:107]
    v_mfma_f32_16x16x32_bf16 v[108:111], v[44:47], v[160:163], v[108:111]
    v_add_f32 v112, v8, v16
    v_add_f32 v113, v9, v17
    s_waitcnt lgkmcnt(8)
    v_mfma_f32_16x16x32_bf16 v[104:107], v[48:51], v[164:167], v[104:107]
    v_mfma_f32_16x16x32_bf16 v[108:111], v[52:55], v[164:167], v[108:111]
    v_add_f32 v114, v10, v18
    v_add_f32 v115, v11, v19
    s_waitcnt lgkmcnt(4)
    v_mfma_f32_16x16x32_bf16 v[104:107], v[56:59], v[168:171], v[104:107]
    v_mfma_f32_16x16x32_bf16 v[108:111], v[60:63], v[168:171], v[108:111]
    v_add_f32 v116, v12, v20
    v_add_f32 v117, v13, v21
    s_waitcnt lgkmcnt(0)
    v_mfma_f32_16x16x32_bf16 v[104:107], v[64:67], v[172:175], v[104:107]
    v_mfma_f32_16x16x32_bf16 v[108:111], v[68:71], v[172:175], v[108:111]
    v_add_f32 v118, v14, v22
    v_add_f32 v119, v15, v23
    ds_read_b64_tr_b16 v[72:73], v136 offset:24576
    ds_read_b64_tr_b16 v[74:75], v136 offset:25088
    ds_read_b64_tr_b16 v[76:77], v136 offset:28672
    ds_read_b64_tr_b16 v[78:79], v136 offset:29184
    ds_read_b64_tr_b16 v[80:81], v137 offset:24576
    ds_read_b64_tr_b16 v[82:83], v137 offset:25088
    ds_read_b64_tr_b16 v[84:85], v137 offset:28672
    ds_read_b64_tr_b16 v[86:87], v137 offset:29184
    ds_read_b64_tr_b16 v[88:89], v138 offset:24576
    ds_read_b64_tr_b16 v[90:91], v138 offset:25088
    ds_read_b64_tr_b16 v[92:93], v138 offset:28672
    ds_read_b64_tr_b16 v[94:95], v138 offset:29184
    ds_read_b64_tr_b16 v[96:97], v139 offset:24576
    ds_read_b64_tr_b16 v[98:99], v139 offset:25088
    ds_read_b64_tr_b16 v[100:101], v139 offset:28672
    ds_read_b64_tr_b16 v[102:103], v139 offset:29184
    s_cmp_le_u32 s47, 0
    s_cbranch_scc1 P_MJ
    s_lshr_b32 s56, s70, 1
    s_lshr_b32 s59, s56, 2
    s_mul_i32 s71, s56, 800
    s_mul_i32 s59, s59, 816000
    s_add_u32 s71, s71, s59
    buffer_load_dwordx4 v[180:183], v179, s[24:27], s71 offen offset:0 nt
    s_cmp_le_u32 s47, 1
    s_cbranch_scc1 P_MJ
    s_lshr_b32 s56, s70, 1
    s_add_u32 s56, s56, 1
    s_lshr_b32 s59, s56, 2
    s_mul_i32 s71, s56, 800
    s_mul_i32 s59, s59, 816000
    s_add_u32 s71, s71, s59
    buffer_load_dwordx4 v[184:187], v179, s[24:27], s71 offen offset:0 nt
    s_cmp_le_u32 s47, 2
    s_cbranch_scc1 P_MJ
    s_lshr_b32 s56, s70, 1
    s_add_u32 s56, s56, 2
    s_lshr_b32 s59, s56, 2
    s_mul_i32 s71, s56, 800
    s_mul_i32 s59, s59, 816000
    s_add_u32 s71, s71, s59
    buffer_load_dwordx4 v[188:191], v179, s[24:27], s71 offen offset:0 nt
    s_cmp_le_u32 s47, 3
    s_cbranch_scc1 P_MJ
    s_lshr_b32 s56, s70, 1
    s_add_u32 s56, s56, 3
    s_lshr_b32 s59, s56, 2
    s_mul_i32 s71, s56, 800
    s_mul_i32 s59, s59, 816000
    s_add_u32 s71, s71, s59
    buffer_load_dwordx4 v[192:195], v179, s[24:27], s71 offen offset:0 nt
    s_cmp_le_u32 s47, 4
    s_cbranch_scc1 P_MJ
    s_lshr_b32 s56, s70, 1
    s_add_u32 s56, s56, 4
    s_lshr_b32 s59, s56, 2
    s_mul_i32 s71, s56, 800
    s_mul_i32 s59, s59, 816000
    s_add_u32 s71, s71, s59
    buffer_load_dwordx4 v[196:199], v179, s[24:27], s71 offen offset:0 nt
    s_cmp_le_u32 s47, 5
    s_cbranch_scc1 P_MJ
    s_lshr_b32 s56, s70, 1
    s_add_u32 s56, s56, 5
    s_lshr_b32 s59, s56, 2
    s_mul_i32 s71, s56, 800
    s_mul_i32 s59, s59, 816000
    s_add_u32 s71, s71, s59
    buffer_load_dwordx4 v[200:203], v179, s[24:27], s71 offen offset:0 nt
P_MJ:
    v_mul_f32 v112, s60, v112
    v_mul_f32 v113, s60, v113
    v_mul_f32 v114, s60, v114
    v_mul_f32 v115, s60, v115
    v_mul_f32 v116, s60, v116
    v_mul_f32 v117, s60, v117
    v_mul_f32 v118, s60, v118
    v_mul_f32 v119, s60, v119
    ds_write_b128 v151, v[112:115] offset:0
    ds_write_b128 v151, v[116:119] offset:1024
    v_mul_f32 v104, s60, v104
    v_mul_f32 v105, s60, v105
    v_mul_f32 v106, s60, v106
    v_mul_f32 v107, s60, v107
    v_mul_f32 v108, s60, v108
    v_mul_f32 v109, s60, v109
    v_mul_f32 v110, s60, v110
    v_mul_f32 v111, s60, v111
    ds_write_b128 v145, v[104:107] offset:256
    ds_write_b128 v145, v[108:111] offset:320
    ds_write_b128 v3, v[24:27] offset:0
    ds_write_b128 v3, v[28:31] offset:16
    ds_read_b128 v[120:123], v252 offset:16384
    ds_read_b128 v[124:127], v252 offset:16448
    ds_read_b128 v[128:131], v252 offset:16512
    ds_read_b128 v[132:135], v252 offset:16576
    ds_read_b32 v150, v252 offset:17604
    s_lshl2_add_u32 s56, s48, 17184
    v_mov_b32 v253, s56
    v_mov_b32 v254, s74
    ds_write_b32 v253, v254
    v_ldexp_f32 v2, s63, 38
    v_add_u32 v250, 133376, v250
    v_mov_b64 v[168:169], 0
    v_mov_b64 v[170:171], 0
    v_mov_b64 v[172:173], 0
    v_mov_b64 v[174:175], 0
    v_readfirstlane_b32 s44, v2
    s_waitcnt lgkmcnt(15)
    v_lshlrev_b32 v8, 16, v72
    v_and_b32 v9, 0xffff0000, v72
    v_lshlrev_b32 v10, 16, v73
    v_and_b32 v11, 0xffff0000, v73
    v_lshlrev_b32 v12, 16, v74
    v_and_b32 v13, 0xffff0000, v74
    v_lshlrev_b32 v14, 16, v75
    v_and_b32 v15, 0xffff0000, v75
    v_lshlrev_b32 v16, 16, v76
    v_and_b32 v17, 0xffff0000, v76
    v_lshlrev_b32 v18, 16, v77
    v_and_b32 v19, 0xffff0000, v77
    v_lshlrev_b32 v20, 16, v78
    v_and_b32 v21, 0xffff0000, v78
    v_lshlrev_b32 v22, 16, v79
    v_and_b32 v23, 0xffff0000, v79
    v_lshlrev_b32 v24, 16, v80
    v_and_b32 v25, 0xffff0000, v80
    v_lshlrev_b32 v26, 16, v81
    v_and_b32 v27, 0xffff0000, v81
    v_lshlrev_b32 v28, 16, v82
    v_and_b32 v29, 0xffff0000, v82
    v_lshlrev_b32 v30, 16, v83
    v_and_b32 v31, 0xffff0000, v83
    v_lshlrev_b32 v32, 16, v84
    v_and_b32 v33, 0xffff0000, v84
    v_lshlrev_b32 v34, 16, v85
    v_and_b32 v35, 0xffff0000, v85
    v_lshlrev_b32 v36, 16, v86
    v_and_b32 v37, 0xffff0000, v86
    v_lshlrev_b32 v38, 16, v87
    v_and_b32 v39, 0xffff0000, v87
    ds_read_u8 v238, v246 offset:32
    ds_read_u8 v240, v246 offset:40
    ds_read_u8 v152, v246 offset:48
    ds_read_u8 v154, v246 offset:56
    s_add_u32 m0, s54, 4096
    v_add_u32 v246, 48, v246
    s_mov_b64 s[68:69], 0
    s_mov_b32 s75, 0
    s_movk_i32 s53, 0x1040
    s_mov_b32 s73, 3
    s_mov_b32 s77, 0
    s_mov_b32 s55, 0
    v_mov_b64 v[0:1], 0
    v_mov_b32 v2, 1.0
    v_mov_b32 v3, 1.0
    s_waitcnt lgkmcnt(0)
    s_barrier
    v_readfirstlane_b32 s45, v150
    buffer_load_dwordx4 v[238:239], s[20:23], s72 idxen offen nt lds
    buffer_load_dwordx4 v[240:241], s[20:23], s51 idxen offen offset:1024 nt lds
    s_add_u32 m0, s54, 6144
    s_nop 0
    buffer_load_dwordx4 v[152:153], s[20:23], s72 idxen offen nt lds
    buffer_load_dwordx4 v[154:155], s[20:23], s51 idxen offen offset:1024 nt lds
    s_cmp_eq_u32 s47, 0
    s_cbranch_scc1 P_GO
    s_lshl_b32 s56, s70, 8
    s_add_u32 s56, s56, 116992
    s_waitcnt vmcnt(4)
    v_mov_b64 v[204:205], v[180:181]
    v_mov_b64 v[206:207], v[182:183]
    s_call_b64 s[36:37], CMP
    v_writelane_b32 v212, s57, 0
    v_writelane_b32 v212, s58, 1
    s_cmp_le_u32 s47, 1
    s_cbranch_scc1 LATE_D
    s_add_u32 s56, s56, 512
    v_mov_b64 v[204:205], v[184:185]
    v_mov_b64 v[206:207], v[186:187]
    s_call_b64 s[36:37], CMP
    v_writelane_b32 v212, s57, 2
    v_writelane_b32 v212, s58, 3
    s_cmp_le_u32 s47, 2
    s_cbranch_scc1 LATE_D
    s_add_u32 s56, s56, 512
    v_mov_b64 v[204:205], v[188:189]
    v_mov_b64 v[206:207], v[190:191]
    s_call_b64 s[36:37], CMP
    v_writelane_b32 v212, s57, 4
    v_writelane_b32 v212, s58, 5
    s_cmp_le_u32 s47, 3
    s_cbranch_scc1 LATE_D
    s_add_u32 s56, s56, 512
    v_mov_b64 v[204:205], v[192:193]
    v_mov_b64 v[206:207], v[194:195]
    s_call_b64 s[36:37], CMP
    v_writelane_b32 v212, s57, 6
    v_writelane_b32 v212, s58, 7
    s_cmp_le_u32 s47, 4
    s_cbranch_scc1 LATE_D
    s_add_u32 s56, s56, 512
    v_mov_b64 v[204:205], v[196:197]
    v_mov_b64 v[206:207], v[198:199]
    s_call_b64 s[36:37], CMP
    v_writelane_b32 v212, s57, 8
    v_writelane_b32 v212, s58, 9
    s_cmp_le_u32 s47, 5
    s_cbranch_scc1 LATE_D
    s_add_u32 s56, s56, 512
    v_mov_b64 v[204:205], v[200:201]
    v_mov_b64 v[206:207], v[202:203]
    s_call_b64 s[36:37], CMP
    v_writelane_b32 v212, s57, 10
    v_writelane_b32 v212, s58, 11
LATE_D:
    v_add_u32 v4, s70, v176
    s_lshl_b32 s56, s47, 1
    v_and_b32 v5, 0xff, v212
    v_add_u32 v5, 15, v5
    v_lshrrev_b32 v5, 4, v5
    v_max_u32 v5, 2, v5
    v_lshrrev_b32 v212, 8, v212
    v_or_b32 v212, v212, v4
    v_cmp_gt_u32 vcc, 64, v4
    v_lshl_or_b32 v6, v5, 8, v212
    v_lshlrev_b32 v4, 2, v4
    s_bfm_b64 s[66:67], s56, 0
    s_and_b64 exec, s[66:67], vcc
    ds_write_b32 v4, v6 offset:17152
    s_mov_b64 exec, -1
P_GO:
    ds_read_b128 v[180:183], v251 offset:0
    ds_read_b128 v[184:187], v251 offset:1024
    ds_read_b128 v[196:199], v251 offset:4096
    ds_read_b128 v[200:203], v251 offset:5120
    ds_read_b128 v[212:215], v251 offset:8192
    ds_read_b128 v[216:219], v251 offset:9216
    ds_read_b128 v[188:191], v251 offset:2048
    ds_read_b128 v[192:195], v251 offset:3072
    ds_read_b128 v[204:207], v251 offset:6144
    ds_read_b128 v[208:211], v251 offset:7168
    ds_read_b128 v[220:223], v251 offset:10240
    ds_read_b128 v[224:227], v251 offset:11264
    ds_read_b128 v[228:231], v251 offset:14336
    ds_read_b128 v[232:235], v251 offset:15360
    v_lshlrev_b32 v40, 16, v88
    v_and_b32 v41, 0xffff0000, v88
    v_lshlrev_b32 v42, 16, v89
    v_and_b32 v43, 0xffff0000, v89
    v_lshlrev_b32 v44, 16, v90
    v_and_b32 v45, 0xffff0000, v90
    v_lshlrev_b32 v46, 16, v91
    v_and_b32 v47, 0xffff0000, v91
    v_lshlrev_b32 v48, 16, v92
    v_and_b32 v49, 0xffff0000, v92
    v_lshlrev_b32 v50, 16, v93
    v_and_b32 v51, 0xffff0000, v93
    v_lshlrev_b32 v52, 16, v94
    v_and_b32 v53, 0xffff0000, v94
    v_lshlrev_b32 v54, 16, v95
    v_and_b32 v55, 0xffff0000, v95
    v_lshlrev_b32 v56, 16, v96
    v_and_b32 v57, 0xffff0000, v96
    v_lshlrev_b32 v58, 16, v97
    v_and_b32 v59, 0xffff0000, v97
    v_lshlrev_b32 v60, 16, v98
    v_and_b32 v61, 0xffff0000, v98
    v_lshlrev_b32 v62, 16, v99
    v_and_b32 v63, 0xffff0000, v99
    v_lshlrev_b32 v64, 16, v100
    v_and_b32 v65, 0xffff0000, v100
    v_lshlrev_b32 v66, 16, v101
    v_and_b32 v67, 0xffff0000, v101
    v_lshlrev_b32 v68, 16, v102
    v_and_b32 v69, 0xffff0000, v102
    v_lshlrev_b32 v70, 16, v103
    v_and_b32 v71, 0xffff0000, v103
    v_mov_b64 v[176:177], 0
    v_mov_b64 v[178:179], 0
    s_sub_u32 s50, s50, 2
    s_cbranch_scc1 DRAW_P
DRET_P:
    s_waitcnt vmcnt(6)
    ds_read_b128 v[152:155], v242
    ds_read_b128 v[156:159], v243
    s_branch BPF
U_0:
    v_mfma_f32_16x16x32_bf16 v[104:107], v[72:75], v[152:155], v[136:139]
    s_add_u32 m0, s54, 0
    v_rcp_f32 v2, v2
    v_mfma_f32_16x16x32_bf16 v[104:107], v[76:79], v[156:159], v[104:107]
    s_mov_b32 s73, 0
    v_rcp_f32 v3, v3
    v_mfma_f32_16x16x32_bf16 v[108:111], v[80:83], v[152:155], v[140:143]
    s_sub_u32 s50, s50, 1
    v_fma_f32 v0, v0, v2, s44
    v_fmac_f32 v0, v1, v3
    v_mfma_f32_16x16x32_bf16 v[108:111], v[84:87], v[156:159], v[108:111]
    s_cbranch_scc1 PEV
    v_add_u32 v246, 16, v246
RET_0:
    v_cvt_pk_bf16_f32 v0, v0, v0
    v_mfma_f32_16x16x32_bf16 v[112:115], v[88:91], v[152:155], v[144:147]
    v_exp_f32 v104, v104
    v_mfma_f32_16x16x32_bf16 v[112:115], v[92:95], v[156:159], v[112:115]
    v_exp_f32 v105, v105
    v_mfma_f32_16x16x32_bf16 v[116:119], v[96:99], v[152:155], v[148:151]
    s_sub_u32 s62, s62, 1
    v_exp_f32 v106, v106
    v_mfma_f32_16x16x32_bf16 v[116:119], v[100:103], v[156:159], v[116:119]
    s_waitcnt vmcnt(4)
    v_exp_f32 v107, v107
    ds_write_b16 v249, v0
    ds_read_b64 v[236:237], v248
    ds_read_b64_tr_b16 v[160:161], v244 offset:0
    ds_read_b64_tr_b16 v[162:163], v245 offset:512
    ds_read_b64_tr_b16 v[164:165], v244 offset:1024
    ds_read_b64_tr_b16 v[166:167], v245 offset:1536
    ds_read_u8 v238, v246 offset:0
    ds_read_u8 v240, v246 offset:8
    ds_read_b32 v254, v253
    ds_read_b128 v[152:155], v242 offset:2048
    ds_read_b128 v[156:159], v243 offset:2048
    v_exp_f32 v108, v108
    v_exp_f32 v109, v109
    v_exp_f32 v110, v110
    v_exp_f32 v111, v111
    s_waitcnt lgkmcnt(9)
    v_mfma_f32_4x4x4_16b_bf16 v[176:179], v[236:237], v[168:169], v[176:179] cbsz:4 abid:0
    v_exp_f32 v112, v112
    v_exp_f32 v113, v113
    v_mfma_f32_4x4x4_16b_bf16 v[176:179], v[236:237], v[170:171], v[176:179] cbsz:4 abid:1
    v_exp_f32 v114, v114
    v_exp_f32 v115, v115
    v_mfma_f32_4x4x4_16b_bf16 v[176:179], v[236:237], v[172:173], v[176:179] cbsz:4 abid:2
    v_exp_f32 v116, v116
    v_exp_f32 v117, v117
    v_mfma_f32_4x4x4_16b_bf16 v[176:179], v[236:237], v[174:175], v[176:179] cbsz:4 abid:3
    v_exp_f32 v118, v118
    v_exp_f32 v119, v119
    .p2align 3
    v_pk_add_f32 v[2:3], v[104:105], 1.0 op_sel_hi:[1,0]
    v_pk_fma_f32 v[0:1], v[120:121], v[106:107], v[120:121]
    v_pk_fma_f32 v[0:1], v[122:123], v[2:3], v[0:1]
    v_pk_fma_f32 v[2:3], v[106:107], v[2:3], v[2:3]
    v_pk_fma_f32 v[0:1], v[108:109], v[0:1], v[0:1]
    v_pk_fma_f32 v[0:1], v[124:125], v[2:3], v[0:1]
    v_pk_fma_f32 v[2:3], v[108:109], v[2:3], v[2:3]
    v_pk_fma_f32 v[0:1], v[110:111], v[0:1], v[0:1]
    v_pk_fma_f32 v[0:1], v[126:127], v[2:3], v[0:1]
    v_pk_fma_f32 v[2:3], v[110:111], v[2:3], v[2:3]
    v_pk_fma_f32 v[0:1], v[112:113], v[0:1], v[0:1]
    v_pk_fma_f32 v[0:1], v[128:129], v[2:3], v[0:1]
    v_pk_fma_f32 v[2:3], v[112:113], v[2:3], v[2:3]
    v_pk_fma_f32 v[0:1], v[114:115], v[0:1], v[0:1]
    v_pk_fma_f32 v[0:1], v[130:131], v[2:3], v[0:1]
    v_pk_fma_f32 v[2:3], v[114:115], v[2:3], v[2:3]
    v_pk_fma_f32 v[0:1], v[116:117], v[0:1], v[0:1]
    v_pk_fma_f32 v[0:1], v[132:133], v[2:3], v[0:1]
    v_pk_fma_f32 v[2:3], v[116:117], v[2:3], v[2:3]
    v_pk_fma_f32 v[0:1], v[118:119], v[0:1], v[0:1]
    v_pk_fma_f32 v[0:1], v[134:135], v[2:3], v[0:1]
    v_pk_fma_f32 v[2:3], v[118:119], v[2:3], v[2:3]
    s_waitcnt lgkmcnt(0)
    buffer_load_dwordx4 v[238:239], s[20:23], s72 idxen offen nt lds
    buffer_load_dwordx4 v[240:241], s[20:23], s51 idxen offen offset:1024 nt lds
    s_cbranch_scc1 CEV
U_1:
    v_mfma_f32_16x16x32_bf16 v[104:107], v[72:75], v[152:155], v[136:139]
    s_add_u32 m0, s54, 2048
    v_rcp_f32 v2, v2
    v_mfma_f32_16x16x32_bf16 v[104:107], v[76:79], v[156:159], v[104:107]
    s_mov_b32 s73, 1
    v_rcp_f32 v3, v3
    v_mfma_f32_16x16x32_bf16 v[108:111], v[80:83], v[152:155], v[140:143]
    s_sub_u32 s50, s50, 1
    v_fma_f32 v0, v0, v2, s44
    v_fmac_f32 v0, v1, v3
    v_mfma_f32_16x16x32_bf16 v[108:111], v[84:87], v[156:159], v[108:111]
    s_cbranch_scc1 PEV
    v_add_u32 v246, 16, v246
RET_1:
    v_cvt_pk_bf16_f32 v0, v0, v0
    v_mfma_f32_16x16x32_bf16 v[112:115], v[88:91], v[152:155], v[144:147]
    v_exp_f32 v104, v104
    v_mfma_f32_16x16x32_bf16 v[112:115], v[92:95], v[156:159], v[112:115]
    v_exp_f32 v105, v105
    v_mfma_f32_16x16x32_bf16 v[116:119], v[96:99], v[152:155], v[148:151]
    s_sub_u32 s62, s62, 1
    v_exp_f32 v106, v106
    v_mfma_f32_16x16x32_bf16 v[116:119], v[100:103], v[156:159], v[116:119]
    s_waitcnt vmcnt(4)
    v_exp_f32 v107, v107
    ds_write_b16 v249, v0
    ds_read_b64 v[236:237], v248
    ds_read_b64_tr_b16 v[168:169], v244 offset:2048
    ds_read_b64_tr_b16 v[170:171], v245 offset:2560
    ds_read_b64_tr_b16 v[172:173], v244 offset:3072
    ds_read_b64_tr_b16 v[174:175], v245 offset:3584
    ds_read_u8 v238, v246 offset:0
    ds_read_u8 v240, v246 offset:8
    ds_read_b32 v254, v253
    ds_read_b128 v[152:155], v242 offset:4096
    ds_read_b128 v[156:159], v243 offset:4096
    v_exp_f32 v108, v108
    v_exp_f32 v109, v109
    v_exp_f32 v110, v110
    v_exp_f32 v111, v111
    s_waitcnt lgkmcnt(9)
    v_mfma_f32_4x4x4_16b_bf16 v[176:179], v[236:237], v[160:161], v[176:179] cbsz:4 abid:0
    v_exp_f32 v112, v112
    v_exp_f32 v113, v113
    v_mfma_f32_4x4x4_16b_bf16 v[176:179], v[236:237], v[162:163], v[176:179] cbsz:4 abid:1
    v_exp_f32 v114, v114
    v_exp_f32 v115, v115
    v_mfma_f32_4x4x4_16b_bf16 v[176:179], v[236:237], v[164:165], v[176:179] cbsz:4 abid:2
    v_exp_f32 v116, v116
    v_exp_f32 v117, v117
    v_mfma_f32_4x4x4_16b_bf16 v[176:179], v[236:237], v[166:167], v[176:179] cbsz:4 abid:3
    v_exp_f32 v118, v118
    v_exp_f32 v119, v119
    .p2align 3
    v_pk_add_f32 v[2:3], v[104:105], 1.0 op_sel_hi:[1,0]
    v_pk_fma_f32 v[0:1], v[120:121], v[106:107], v[120:121]
    v_pk_fma_f32 v[0:1], v[122:123], v[2:3], v[0:1]
    v_pk_fma_f32 v[2:3], v[106:107], v[2:3], v[2:3]
    v_pk_fma_f32 v[0:1], v[108:109], v[0:1], v[0:1]
    v_pk_fma_f32 v[0:1], v[124:125], v[2:3], v[0:1]
    v_pk_fma_f32 v[2:3], v[108:109], v[2:3], v[2:3]
    v_pk_fma_f32 v[0:1], v[110:111], v[0:1], v[0:1]
    v_pk_fma_f32 v[0:1], v[126:127], v[2:3], v[0:1]
    v_pk_fma_f32 v[2:3], v[110:111], v[2:3], v[2:3]
    v_pk_fma_f32 v[0:1], v[112:113], v[0:1], v[0:1]
    v_pk_fma_f32 v[0:1], v[128:129], v[2:3], v[0:1]
    v_pk_fma_f32 v[2:3], v[112:113], v[2:3], v[2:3]
    v_pk_fma_f32 v[0:1], v[114:115], v[0:1], v[0:1]
    v_pk_fma_f32 v[0:1], v[130:131], v[2:3], v[0:1]
    v_pk_fma_f32 v[2:3], v[114:115], v[2:3], v[2:3]
    v_pk_fma_f32 v[0:1], v[116:117], v[0:1], v[0:1]
    v_pk_fma_f32 v[0:1], v[132:133], v[2:3], v[0:1]
    v_pk_fma_f32 v[2:3], v[116:117], v[2:3], v[2:3]
    v_pk_fma_f32 v[0:1], v[118:119], v[0:1], v[0:1]
    v_pk_fma_f32 v[0:1], v[134:135], v[2:3], v[0:1]
    v_pk_fma_f32 v[2:3], v[118:119], v[2:3], v[2:3]
    s_waitcnt lgkmcnt(0)
    buffer_load_dwordx4 v[238:239], s[20:23], s72 idxen offen nt lds
    buffer_load_dwordx4 v[240:241], s[20:23], s51 idxen offen offset:1024 nt lds
    s_cbranch_scc1 CEV
U_2:
    v_mfma_f32_16x16x32_bf16 v[104:107], v[72:75], v[152:155], v[136:139]
    s_add_u32 m0, s54, 4096
    v_rcp_f32 v2, v2
    v_mfma_f32_16x16x32_bf16 v[104:107], v[76:79], v[156:159], v[104:107]
    s_mov_b32 s73, 2
    v_rcp_f32 v3, v3
    v_mfma_f32_16x16x32_bf16 v[108:111], v[80:83], v[152:155], v[140:143]
    s_sub_u32 s50, s50, 1
    v_fma_f32 v0, v0, v2, s44
    v_fmac_f32 v0, v1, v3
    v_mfma_f32_16x16x32_bf16 v[108:111], v[84:87], v[156:159], v[108:111]
    s_cbranch_scc1 PEV
    v_add_u32 v246, 16, v246
RET_2:
    v_cvt_pk_bf16_f32 v0, v0, v0
    v_mfma_f32_16x16x32_bf16 v[112:115], v[88:91], v[152:155], v[144:147]
    v_exp_f32 v104, v104
    v_mfma_f32_16x16x32_bf16 v[112:115], v[92:95], v[156:159], v[112:115]
    v_exp_f32 v105, v105
    v_mfma_f32_16x16x32_bf16 v[116:119], v[96:99], v[152:155], v[148:151]
    s_sub_u32 s62, s62, 1
    v_exp_f32 v106, v106
    v_mfma_f32_16x16x32_bf16 v[116:119], v[100:103], v[156:159], v[116:119]
    s_waitcnt vmcnt(4)
    v_exp_f32 v107, v107
    ds_write_b16 v249, v0
    ds_read_b64 v[236:237], v248
    ds_read_b64_tr_b16 v[160:161], v244 offset:4096
    ds_read_b64_tr_b16 v[162:163], v245 offset:4608
    ds_read_b64_tr_b16 v[164:165], v244 offset:5120
    ds_read_b64_tr_b16 v[166:167], v245 offset:5632
    ds_read_u8 v238, v246 offset:0
    ds_read_u8 v240, v246 offset:8
    ds_read_b32 v254, v253
    ds_read_b128 v[152:155], v242 offset:6144
    ds_read_b128 v[156:159], v243 offset:6144
    v_exp_f32 v108, v108
    v_exp_f32 v109, v109
    v_exp_f32 v110, v110
    v_exp_f32 v111, v111
    s_waitcnt lgkmcnt(9)
    v_mfma_f32_4x4x4_16b_bf16 v[176:179], v[236:237], v[168:169], v[176:179] cbsz:4 abid:0
    v_exp_f32 v112, v112
    v_exp_f32 v113, v113
    v_mfma_f32_4x4x4_16b_bf16 v[176:179], v[236:237], v[170:171], v[176:179] cbsz:4 abid:1
    v_exp_f32 v114, v114
    v_exp_f32 v115, v115
    v_mfma_f32_4x4x4_16b_bf16 v[176:179], v[236:237], v[172:173], v[176:179] cbsz:4 abid:2
    v_exp_f32 v116, v116
    v_exp_f32 v117, v117
    v_mfma_f32_4x4x4_16b_bf16 v[176:179], v[236:237], v[174:175], v[176:179] cbsz:4 abid:3
    v_exp_f32 v118, v118
    v_exp_f32 v119, v119
    .p2align 3
    v_pk_add_f32 v[2:3], v[104:105], 1.0 op_sel_hi:[1,0]
    v_pk_fma_f32 v[0:1], v[120:121], v[106:107], v[120:121]
    v_pk_fma_f32 v[0:1], v[122:123], v[2:3], v[0:1]
    v_pk_fma_f32 v[2:3], v[106:107], v[2:3], v[2:3]
    v_pk_fma_f32 v[0:1], v[108:109], v[0:1], v[0:1]
    v_pk_fma_f32 v[0:1], v[124:125], v[2:3], v[0:1]
    v_pk_fma_f32 v[2:3], v[108:109], v[2:3], v[2:3]
    v_pk_fma_f32 v[0:1], v[110:111], v[0:1], v[0:1]
    v_pk_fma_f32 v[0:1], v[126:127], v[2:3], v[0:1]
    v_pk_fma_f32 v[2:3], v[110:111], v[2:3], v[2:3]
    v_pk_fma_f32 v[0:1], v[112:113], v[0:1], v[0:1]
    v_pk_fma_f32 v[0:1], v[128:129], v[2:3], v[0:1]
    v_pk_fma_f32 v[2:3], v[112:113], v[2:3], v[2:3]
    v_pk_fma_f32 v[0:1], v[114:115], v[0:1], v[0:1]
    v_pk_fma_f32 v[0:1], v[130:131], v[2:3], v[0:1]
    v_pk_fma_f32 v[2:3], v[114:115], v[2:3], v[2:3]
    v_pk_fma_f32 v[0:1], v[116:117], v[0:1], v[0:1]
    v_pk_fma_f32 v[0:1], v[132:133], v[2:3], v[0:1]
    v_pk_fma_f32 v[2:3], v[116:117], v[2:3], v[2:3]
    v_pk_fma_f32 v[0:1], v[118:119], v[0:1], v[0:1]
    v_pk_fma_f32 v[0:1], v[134:135], v[2:3], v[0:1]
    v_pk_fma_f32 v[2:3], v[118:119], v[2:3], v[2:3]
    s_waitcnt lgkmcnt(0)
    buffer_load_dwordx4 v[238:239], s[20:23], s72 idxen offen nt lds
    buffer_load_dwordx4 v[240:241], s[20:23], s51 idxen offen offset:1024 nt lds
    s_cbranch_scc1 CEV
U_3:
    v_mfma_f32_16x16x32_bf16 v[104:107], v[72:75], v[152:155], v[136:139]
    s_add_u32 m0, s54, 6144
    v_rcp_f32 v2, v2
    v_mfma_f32_16x16x32_bf16 v[104:107], v[76:79], v[156:159], v[104:107]
    s_mov_b32 s73, 3
    v_rcp_f32 v3, v3
    v_mfma_f32_16x16x32_bf16 v[108:111], v[80:83], v[152:155], v[140:143]
    s_sub_u32 s50, s50, 1
    v_fma_f32 v0, v0, v2, s44
    v_fmac_f32 v0, v1, v3
    v_mfma_f32_16x16x32_bf16 v[108:111], v[84:87], v[156:159], v[108:111]
    s_cbranch_scc1 PEV
    v_add_u32 v246, 16, v246
RET_3:
    v_cvt_pk_bf16_f32 v0, v0, v0
    v_mfma_f32_16x16x32_bf16 v[112:115], v[88:91], v[152:155], v[144:147]
    v_exp_f32 v104, v104
    v_mfma_f32_16x16x32_bf16 v[112:115], v[92:95], v[156:159], v[112:115]
    v_exp_f32 v105, v105
    v_mfma_f32_16x16x32_bf16 v[116:119], v[96:99], v[152:155], v[148:151]
    s_sub_u32 s62, s62, 1
    v_exp_f32 v106, v106
    v_mfma_f32_16x16x32_bf16 v[116:119], v[100:103], v[156:159], v[116:119]
    s_waitcnt vmcnt(4)
    v_exp_f32 v107, v107
    ds_write_b16 v249, v0
    ds_read_b64 v[236:237], v248
    ds_read_b64_tr_b16 v[168:169], v244 offset:6144
    ds_read_b64_tr_b16 v[170:171], v245 offset:6656
    ds_read_b64_tr_b16 v[172:173], v244 offset:7168
    ds_read_b64_tr_b16 v[174:175], v245 offset:7680
    ds_read_u8 v238, v246 offset:0
    ds_read_u8 v240, v246 offset:8
    ds_read_b32 v254, v253
    ds_read_b128 v[152:155], v242 offset:0
    ds_read_b128 v[156:159], v243 offset:0
    v_exp_f32 v108, v108
    v_exp_f32 v109, v109
    v_exp_f32 v110, v110
    v_exp_f32 v111, v111
    s_waitcnt lgkmcnt(9)
    v_mfma_f32_4x4x4_16b_bf16 v[176:179], v[236:237], v[160:161], v[176:179] cbsz:4 abid:0
    v_exp_f32 v112, v112
    v_exp_f32 v113, v113
    v_mfma_f32_4x4x4_16b_bf16 v[176:179], v[236:237], v[162:163], v[176:179] cbsz:4 abid:1
    v_exp_f32 v114, v114
    v_exp_f32 v115, v115
    v_mfma_f32_4x4x4_16b_bf16 v[176:179], v[236:237], v[164:165], v[176:179] cbsz:4 abid:2
    v_exp_f32 v116, v116
    v_exp_f32 v117, v117
    v_mfma_f32_4x4x4_16b_bf16 v[176:179], v[236:237], v[166:167], v[176:179] cbsz:4 abid:3
    v_exp_f32 v118, v118
    v_exp_f32 v119, v119
    .p2align 3
    v_pk_add_f32 v[2:3], v[104:105], 1.0 op_sel_hi:[1,0]
    v_pk_fma_f32 v[0:1], v[120:121], v[106:107], v[120:121]
    v_pk_fma_f32 v[0:1], v[122:123], v[2:3], v[0:1]
    v_pk_fma_f32 v[2:3], v[106:107], v[2:3], v[2:3]
    v_pk_fma_f32 v[0:1], v[108:109], v[0:1], v[0:1]
    v_pk_fma_f32 v[0:1], v[124:125], v[2:3], v[0:1]
    v_pk_fma_f32 v[2:3], v[108:109], v[2:3], v[2:3]
    v_pk_fma_f32 v[0:1], v[110:111], v[0:1], v[0:1]
    v_pk_fma_f32 v[0:1], v[126:127], v[2:3], v[0:1]
    v_pk_fma_f32 v[2:3], v[110:111], v[2:3], v[2:3]
    v_pk_fma_f32 v[0:1], v[112:113], v[0:1], v[0:1]
    v_pk_fma_f32 v[0:1], v[128:129], v[2:3], v[0:1]
    v_pk_fma_f32 v[2:3], v[112:113], v[2:3], v[2:3]
    v_pk_fma_f32 v[0:1], v[114:115], v[0:1], v[0:1]
    v_pk_fma_f32 v[0:1], v[130:131], v[2:3], v[0:1]
    v_pk_fma_f32 v[2:3], v[114:115], v[2:3], v[2:3]
    v_pk_fma_f32 v[0:1], v[116:117], v[0:1], v[0:1]
    v_pk_fma_f32 v[0:1], v[132:133], v[2:3], v[0:1]
    v_pk_fma_f32 v[2:3], v[116:117], v[2:3], v[2:3]
    v_pk_fma_f32 v[0:1], v[118:119], v[0:1], v[0:1]
    v_pk_fma_f32 v[0:1], v[134:135], v[2:3], v[0:1]
    v_pk_fma_f32 v[2:3], v[118:119], v[2:3], v[2:3]
    s_waitcnt lgkmcnt(0)
    buffer_load_dwordx4 v[238:239], s[20:23], s72 idxen offen nt lds
    buffer_load_dwordx4 v[240:241], s[20:23], s51 idxen offen offset:1024 nt lds
    s_cbranch_scc0 U_0
CEV:
    s_cmp_eq_u32 s76, 0
    s_cbranch_scc1 EPI
    s_mov_b32 s53, s52
    s_and_b32 s52, s68, 0xffff
    s_lshr_b64 s[68:69], s[68:69], 16
    s_sub_u32 s75, s75, 16
    s_bitcmp1_b32 s52, 6
    s_cbranch_scc1 DRAIN
BPF:
    s_and_b32 s57, s52, 63
    s_mul_i32 s57, s57, 528
    s_add_u32 s57, s57, 83200
    v_lshl_add_u32 v6, v252, 1, s57
    v_add_u32 v7, s57, v252
    ds_read_b128 v[104:107], v6 offset:0
    ds_read_b128 v[108:111], v6 offset:16
    ds_read_b128 v[144:147], v251 offset:12288
    ds_read_b128 v[148:151], v251 offset:13312
    ds_read_b128 v[112:115], v6 offset:128
    ds_read_b128 v[116:119], v6 offset:144
    s_mov_b32 s62, 0
    s_mov_b32 s76, 0
    s_cmp_lg_u32 s77, 0
    s_waitcnt lgkmcnt(4)
    .p2align 3
    v_pk_fma_f32 v[136:137], v[8:9], v[104:105], v[180:181]
    v_pk_fma_f32 v[138:139], v[10:11], v[106:107], v[182:183]
    v_pk_fma_f32 v[140:141], v[12:13], v[108:109], v[184:185]
    v_pk_fma_f32 v[142:143], v[14:15], v[110:111], v[186:187]
    v_cvt_pk_bf16_f32 v72, v136, v137
    v_cvt_pk_bf16_f32 v73, v138, v139
    v_cvt_pk_bf16_f32 v74, v140, v141
    v_cvt_pk_bf16_f32 v75, v142, v143
    v_pk_fma_f32 v[136:137], v[24:25], v[104:105], v[196:197]
    v_pk_fma_f32 v[138:139], v[26:27], v[106:107], v[198:199]
    v_pk_fma_f32 v[140:141], v[28:29], v[108:109], v[200:201]
    v_pk_fma_f32 v[142:143], v[30:31], v[110:111], v[202:203]
    v_cvt_pk_bf16_f32 v80, v136, v137
    v_cvt_pk_bf16_f32 v81, v138, v139
    v_cvt_pk_bf16_f32 v82, v140, v141
    v_cvt_pk_bf16_f32 v83, v142, v143
    v_pk_fma_f32 v[136:137], v[40:41], v[104:105], v[212:213]
    v_pk_fma_f32 v[138:139], v[42:43], v[106:107], v[214:215]
    v_pk_fma_f32 v[140:141], v[44:45], v[108:109], v[216:217]
    v_pk_fma_f32 v[142:143], v[46:47], v[110:111], v[218:219]
    v_cvt_pk_bf16_f32 v88, v136, v137
    v_cvt_pk_bf16_f32 v89, v138, v139
    v_cvt_pk_bf16_f32 v90, v140, v141
    v_cvt_pk_bf16_f32 v91, v142, v143
    s_waitcnt lgkmcnt(0)
    .p2align 3
    v_pk_fma_f32 v[144:145], v[56:57], v[104:105], v[144:145]
    v_pk_fma_f32 v[146:147], v[58:59], v[106:107], v[146:147]
    v_pk_fma_f32 v[148:149], v[60:61], v[108:109], v[148:149]
    v_pk_fma_f32 v[150:151], v[62:63], v[110:111], v[150:151]
    v_cvt_pk_bf16_f32 v96, v144, v145
    v_cvt_pk_bf16_f32 v97, v146, v147
    v_cvt_pk_bf16_f32 v98, v148, v149
    v_cvt_pk_bf16_f32 v99, v150, v151
    ds_read_b128 v[136:139], v7 offset:256
    ds_read_b128 v[140:143], v7 offset:320
    ds_read_b128 v[144:147], v7 offset:384
    ds_read_b128 v[148:151], v7 offset:448
    v_pk_fma_f32 v[104:105], v[16:17], v[112:113], v[188:189]
    v_pk_fma_f32 v[106:107], v[18:19], v[114:115], v[190:191]
    v_pk_fma_f32 v[108:109], v[20:21], v[116:117], v[192:193]
    v_pk_fma_f32 v[110:111], v[22:23], v[118:119], v[194:195]
    v_cvt_pk_bf16_f32 v76, v104, v105
    v_cvt_pk_bf16_f32 v77, v106, v107
    v_cvt_pk_bf16_f32 v78, v108, v109
    v_cvt_pk_bf16_f32 v79, v110, v111
    v_pk_fma_f32 v[104:105], v[32:33], v[112:113], v[204:205]
    v_pk_fma_f32 v[106:107], v[34:35], v[114:115], v[206:207]
    v_pk_fma_f32 v[108:109], v[36:37], v[116:117], v[208:209]
    v_pk_fma_f32 v[110:111], v[38:39], v[118:119], v[210:211]
    v_cvt_pk_bf16_f32 v84, v104, v105
    v_cvt_pk_bf16_f32 v85, v106, v107
    v_cvt_pk_bf16_f32 v86, v108, v109
    v_cvt_pk_bf16_f32 v87, v110, v111
    v_pk_fma_f32 v[104:105], v[48:49], v[112:113], v[220:221]
    v_pk_fma_f32 v[106:107], v[50:51], v[114:115], v[222:223]
    v_pk_fma_f32 v[108:109], v[52:53], v[116:117], v[224:225]
    v_pk_fma_f32 v[110:111], v[54:55], v[118:119], v[226:227]
    v_cvt_pk_bf16_f32 v92, v104, v105
    v_cvt_pk_bf16_f32 v93, v106, v107
    v_cvt_pk_bf16_f32 v94, v108, v109
    v_cvt_pk_bf16_f32 v95, v110, v111
    v_pk_fma_f32 v[104:105], v[64:65], v[112:113], v[228:229]
    v_pk_fma_f32 v[106:107], v[66:67], v[114:115], v[230:231]
    v_pk_fma_f32 v[108:109], v[68:69], v[116:117], v[232:233]
    v_pk_fma_f32 v[110:111], v[70:71], v[118:119], v[234:235]
    v_cvt_pk_bf16_f32 v100, v104, v105
    v_cvt_pk_bf16_f32 v101, v106, v107
    v_cvt_pk_bf16_f32 v102, v108, v109
    v_cvt_pk_bf16_f32 v103, v110, v111
    s_waitcnt lgkmcnt(0)
    s_cbranch_scc1 BP_X
NEXT:
    s_cmp_eq_u32 s73, 0
    s_cbranch_scc1 U_1
    s_cmp_eq_u32 s73, 1
    s_cbranch_scc1 U_2
    s_cmp_eq_u32 s73, 2
    s_cbranch_scc1 U_3
    s_branch U_0
EPI:
    s_and_b32 s56, s53, 0x7f
    v_pk_add_f32 v[4:5], v[176:177], v[178:179]
    v_add_f32 v4, v4, v5
    v_lshl_add_u32 v5, s56, 8, v250
    v_mul_f32 v4, s46, v4
    s_bitcmp1_b32 s53, 7
    v_cmp_class_f32_e64 vcc, v4, s45
    v_mov_b64 v[176:177], 0
    v_mov_b64 v[178:179], 0
    ds_write_b32 v5, v4
    s_cbranch_scc1 SLOW
    s_cbranch_vccnz SLOW
EPI_R:
    s_bitcmp1_b32 s52, 6
    s_cbranch_scc1 L_DONE
EPI_C:
    s_bfe_u32 s62, s52, 0x40008
    s_sub_u32 s62, s62, 2
    s_mov_b32 s76, 1
    s_cmp_eq_u32 s73, 0
    s_cbranch_scc1 U_1
    s_cmp_eq_u32 s73, 1
    s_cbranch_scc1 U_2
    s_cmp_eq_u32 s73, 2
    s_cbranch_scc1 U_3
    s_branch U_0
PEV:
    s_cmp_eq_u32 s55, 0
    s_cbranch_scc1 P_DR
ADV:
    v_readfirstlane_b32 s66, v254
    s_mov_b32 s67, 0
    s_and_b32 s56, s66, 63
    s_bfe_u32 s50, s66, 0x40008
    s_cbranch_scc0 AW
    s_lshr_b32 s57, s56, 3
    s_mul_i32 s51, s56, 25600
    s_mul_i32 s57, s57, 52224000
    s_add_u32 s51, s51, s57
    v_lshl_add_u32 v246, s56, 8, v247
    s_add_u32 s51, s51, s49
    s_add_u32 s72, s51, 1024
    s_lshl_b64 s[64:65], s[66:67], s75
    s_or_b64 s[68:69], s[68:69], s[64:65]
    s_add_u32 s75, s75, 16
    s_mov_b32 s55, 0
    s_sub_u32 s50, s50, 3
    s_cbranch_scc1 P_2
P_RET:
    s_cmp_eq_u32 s73, 0
    s_cbranch_scc1 RET_0
    s_cmp_eq_u32 s73, 1
    s_cbranch_scc1 RET_1
    s_cmp_eq_u32 s73, 2
    s_cbranch_scc1 RET_2
    s_branch RET_3
P_DR:
    v_add_u32 v246, 16, v246
P_D2:
    s_mov_b64 exec, 1
    v_mov_b32 v253, 4
    ds_add_rtn_u32 v253, v251, v253 offset:17600
    s_mov_b64 exec, -1
    s_mov_b32 s50, 1
    s_mov_b32 s55, 1
    s_cmp_eq_u32 s73, 0
    s_cbranch_scc1 RET_0
    s_cmp_eq_u32 s73, 1
    s_cbranch_scc1 RET_1
    s_cmp_eq_u32 s73, 2
    s_cbranch_scc1 RET_2
    s_branch RET_3
P_2:
    s_bitcmp1_b32 s66, 6
    s_cbranch_scc0 P_D2
    v_mov_b32 v246, 16896
    s_movk_i32 s50, 0x100
    s_branch P_RET
DRAIN:
    v_rcp_f32 v2, v2
    v_rcp_f32 v3, v3
    v_fma_f32 v0, v0, v2, s44
    v_fmac_f32 v0, v1, v3
    v_cvt_pk_bf16_f32 v0, v0, v0
    s_bitcmp1_b32 s73, 0
    ds_write_b16 v249, v0
    ds_read_b64 v[236:237], v248
    s_waitcnt lgkmcnt(0)
    s_cbranch_scc1 DRAIN1
    v_mfma_f32_4x4x4_16b_bf16 v[176:179], v[236:237], v[160:161], v[176:179] cbsz:4 abid:0
    s_nop 1
    v_mfma_f32_4x4x4_16b_bf16 v[176:179], v[236:237], v[162:163], v[176:179] cbsz:4 abid:1
    s_nop 1
    v_mfma_f32_4x4x4_16b_bf16 v[176:179], v[236:237], v[164:165], v[176:179] cbsz:4 abid:2
    s_nop 1
    v_mfma_f32_4x4x4_16b_bf16 v[176:179], v[236:237], v[166:167], v[176:179] cbsz:4 abid:3
    s_nop 2
    s_branch EPI
DRAIN1:
    v_mfma_f32_4x4x4_16b_bf16 v[176:179], v[236:237], v[168:169], v[176:179] cbsz:4 abid:0
    s_nop 1
    v_mfma_f32_4x4x4_16b_bf16 v[176:179], v[236:237], v[170:171], v[176:179] cbsz:4 abid:1
    s_nop 1
    v_mfma_f32_4x4x4_16b_bf16 v[176:179], v[236:237], v[172:173], v[176:179] cbsz:4 abid:2
    s_nop 1
    v_mfma_f32_4x4x4_16b_bf16 v[176:179], v[236:237], v[174:175], v[176:179] cbsz:4 abid:3
    s_nop 2
    s_branch EPI
L_DONE:
    s_lshl_b32 s56, s48, 11
    s_add_u32 s56, s56, 133376
    v_lshl_add_u32 v0, v251, 1, s56
    s_lshl_b32 s56, s48, 18
    s_waitcnt lgkmcnt(0)
    s_barrier
    ds_read_b128 v[104:107], v0 offset:0
    ds_read_b128 v[108:111], v0 offset:16
    s_waitcnt lgkmcnt(0)
    v_cvt_pk_bf16_f32 v152, v104, v105
    v_cvt_pk_bf16_f32 v153, v106, v107
    v_cvt_pk_bf16_f32 v154, v108, v109
    v_cvt_pk_bf16_f32 v155, v110, v111
    buffer_store_dwordx4 v[152:155], v251, s[28:31], s56 offen nt
L_FIN:
    s_endpgm
AW:
    s_sleep 1
    ds_read_b32 v254, v253
    s_waitcnt lgkmcnt(0)
    s_branch ADV
DRAW_P:
    s_mov_b64 exec, 1
    v_mov_b32 v253, 4
    ds_add_rtn_u32 v253, v251, v253 offset:17600
    s_mov_b64 exec, -1
    s_add_u32 s50, s50, 2
    s_mov_b32 s55, 1
    s_waitcnt lgkmcnt(0)
    ds_read_b32 v254, v253
    s_branch DRET_P
BP_X:
    s_cmp_eq_u32 s77, 1
    s_mov_b32 s77, 0
    s_cbranch_scc1 SLOW_W
    s_branch EPI_C
SLOW:
    s_bitcmp1_b32 s53, 6
    s_cbranch_scc1 EPI_R
    s_mov_b32 s74, s52
    s_mov_b32 s52, s53
    s_mov_b32 s77, 1
    ds_write_b32 v5, v176
    s_branch BPF
SLOW_W:
    s_mov_b32 s52, s74
    s_and_b32 s56, s53, 63
    s_lshr_b32 s57, s53, 12
    s_bfe_u32 s59, s53, 0x40008
    s_lshl4_add_u32 s57, s56, s57
    s_lshl_b32 s57, s57, 4
    s_add_u32 s74, s57, 116992
    s_bitcmp1_b32 s53, 7
    s_cselect_b64 s[66:67], -1, 0
    s_cselect_b32 s59, 13, s59
    v_bfe_u32 v204, v251, 4, 4
    v_mov_b32 v207, v252
    v_mov_b64 v[180:181], 0
    v_mov_b64 v[182:183], 0
    v_mov_b64 v[184:185], 0
    v_mov_b64 v[186:187], 0
    v_mov_b64 v[188:189], 0
    v_mov_b64 v[190:191], 0
    v_mov_b64 v[192:193], 0
    v_mov_b64 v[194:195], 0
    s_lshr_b32 s58, s56, 3
    s_mul_i32 s57, s56, 25600
    s_mul_i32 s58, s58, 52224000
    s_add_u32 s57, s57, s58
    s_add_u32 s57, s57, s49
    s_lshr_b32 s64, s56, 3
    s_mul_i32 s58, s56, 400
    s_mul_i32 s64, s64, 816000
    s_add_u32 s58, s58, s64
SLOW_L:
    v_add_u32 v205, s74, v204
    ds_read_u8 v206, v205
    s_waitcnt lgkmcnt(0)
    v_cndmask_b32_e64 v206, v206, v204, s[66:67]
    v_lshlrev_b32 v205, 1, v206
    buffer_load_dwordx4 v[196:199], v[206:207], s[20:23], s57 idxen offen offset:1024
    buffer_load_dwordx4 v[200:203], v[206:207], s[20:23], s57 idxen offen offset:1088
    buffer_load_ushort v205, v205, s[24:27], s58 offen
    v_cmp_gt_u32 vcc, 200, v206
    v_add_u32 v204, 16, v204
    s_waitcnt vmcnt(0)
    v_mfma_f32_16x16x32_bf16 v[104:107], v[72:75], v[196:199], v[136:139]
    v_mfma_f32_16x16x32_bf16 v[104:107], v[76:79], v[200:203], v[104:107]
    v_mfma_f32_16x16x32_bf16 v[108:111], v[80:83], v[196:199], v[140:143]
    v_mfma_f32_16x16x32_bf16 v[108:111], v[84:87], v[200:203], v[108:111]
    v_mfma_f32_16x16x32_bf16 v[112:115], v[88:91], v[196:199], v[144:147]
    v_mfma_f32_16x16x32_bf16 v[112:115], v[92:95], v[200:203], v[112:115]
    v_mfma_f32_16x16x32_bf16 v[116:119], v[96:99], v[196:199], v[148:151]
    v_mfma_f32_16x16x32_bf16 v[116:119], v[100:103], v[200:203], v[116:119]
    v_lshlrev_b32 v205, 16, v205
    v_cndmask_b32 v205, 0, v205, vcc
    s_nop 7
    v_exp_f32 v104, v104
    v_exp_f32 v105, v105
    v_exp_f32 v106, v106
    v_exp_f32 v107, v107
    v_exp_f32 v108, v108
    v_exp_f32 v109, v109
    v_exp_f32 v110, v110
    v_exp_f32 v111, v111
    v_exp_f32 v112, v112
    v_exp_f32 v113, v113
    v_exp_f32 v114, v114
    v_exp_f32 v115, v115
    v_exp_f32 v116, v116
    v_exp_f32 v117, v117
    v_exp_f32 v118, v118
    v_exp_f32 v119, v119
    v_add_f32 v104, 1.0, v104
    v_add_f32 v105, 1.0, v105
    v_add_f32 v106, 1.0, v106
    v_add_f32 v107, 1.0, v107
    v_add_f32 v108, 1.0, v108
    v_add_f32 v109, 1.0, v109
    v_add_f32 v110, 1.0, v110
    v_add_f32 v111, 1.0, v111
    v_add_f32 v112, 1.0, v112
    v_add_f32 v113, 1.0, v113
    v_add_f32 v114, 1.0, v114
    v_add_f32 v115, 1.0, v115
    v_add_f32 v116, 1.0, v116
    v_add_f32 v117, 1.0, v117
    v_add_f32 v118, 1.0, v118
    v_add_f32 v119, 1.0, v119
    v_rcp_f32 v104, v104
    v_rcp_f32 v105, v105
    v_rcp_f32 v106, v106
    v_rcp_f32 v107, v107
    v_rcp_f32 v108, v108
    v_rcp_f32 v109, v109
    v_rcp_f32 v110, v110
    v_rcp_f32 v111, v111
    v_rcp_f32 v112, v112
    v_rcp_f32 v113, v113
    v_rcp_f32 v114, v114
    v_rcp_f32 v115, v115
    v_rcp_f32 v116, v116
    v_rcp_f32 v117, v117
    v_rcp_f32 v118, v118
    v_rcp_f32 v119, v119
    v_mul_f32 v208, v104, v120
    v_fmac_f32 v208, v105, v121
    v_fmac_f32 v208, v106, v122
    v_fmac_f32 v208, v107, v123
    v_fmac_f32 v208, v108, v124
    v_fmac_f32 v208, v109, v125
    v_fmac_f32 v208, v110, v126
    v_fmac_f32 v208, v111, v127
    v_fmac_f32 v208, v112, v128
    v_fmac_f32 v208, v113, v129
    v_fmac_f32 v208, v114, v130
    v_fmac_f32 v208, v115, v131
    v_fmac_f32 v208, v116, v132
    v_fmac_f32 v208, v117, v133
    v_fmac_f32 v208, v118, v134
    v_fmac_f32 v208, v119, v135
    v_mov_b32 v209, v208
    s_nop 1
    v_permlane32_swap_b32 v208, v209
    v_add_f32 v208, v208, v209
    v_mov_b32 v209, v208
    s_nop 1
    v_permlane16_swap_b32 v208, v209
    v_add_f32 v208, v208, v209
    v_mul_f32 v208, s46, v208
    v_add_f32 v208, s63, v208
    v_mul_f32 v208, v208, v205
    v_lshlrev_b32 v209, 16, v196
    v_and_b32 v210, 0xffff0000, v196
    v_fmac_f32 v180, v208, v209
    v_fmac_f32 v181, v208, v210
    v_lshlrev_b32 v209, 16, v197
    v_and_b32 v210, 0xffff0000, v197
    v_fmac_f32 v182, v208, v209
    v_fmac_f32 v183, v208, v210
    v_lshlrev_b32 v209, 16, v198
    v_and_b32 v210, 0xffff0000, v198
    v_fmac_f32 v184, v208, v209
    v_fmac_f32 v185, v208, v210
    v_lshlrev_b32 v209, 16, v199
    v_and_b32 v210, 0xffff0000, v199
    v_fmac_f32 v186, v208, v209
    v_fmac_f32 v187, v208, v210
    v_lshlrev_b32 v209, 16, v200
    v_and_b32 v210, 0xffff0000, v200
    v_fmac_f32 v188, v208, v209
    v_fmac_f32 v189, v208, v210
    v_lshlrev_b32 v209, 16, v201
    v_and_b32 v210, 0xffff0000, v201
    v_fmac_f32 v190, v208, v209
    v_fmac_f32 v191, v208, v210
    v_lshlrev_b32 v209, 16, v202
    v_and_b32 v210, 0xffff0000, v202
    v_fmac_f32 v192, v208, v209
    v_fmac_f32 v193, v208, v210
    v_lshlrev_b32 v209, 16, v203
    v_and_b32 v210, 0xffff0000, v203
    v_fmac_f32 v194, v208, v209
    v_fmac_f32 v195, v208, v210
    s_sub_u32 s59, s59, 1
    s_cmp_lg_u32 s59, 0
    s_cbranch_scc1 SLOW_L
    v_readfirstlane_b32 s56, v5
    s_nop 1
    v_lshl_add_u32 v208, v252, 1, s56
    ds_add_f32 v208, v180 offset:0
    ds_add_f32 v208, v181 offset:4
    ds_add_f32 v208, v182 offset:8
    ds_add_f32 v208, v183 offset:12
    ds_add_f32 v208, v184 offset:16
    ds_add_f32 v208, v185 offset:20
    ds_add_f32 v208, v186 offset:24
    ds_add_f32 v208, v187 offset:28
    ds_add_f32 v208, v188 offset:128
    ds_add_f32 v208, v189 offset:132
    ds_add_f32 v208, v190 offset:136
    ds_add_f32 v208, v191 offset:140
    ds_add_f32 v208, v192 offset:144
    ds_add_f32 v208, v193 offset:148
    ds_add_f32 v208, v194 offset:152
    ds_add_f32 v208, v195 offset:156
    s_waitcnt lgkmcnt(0)
    s_bitcmp1_b32 s52, 6
    s_cbranch_scc1 L_DONE
    ds_read_b128 v[180:183], v251 offset:0
    ds_read_b128 v[184:187], v251 offset:1024
    ds_read_b128 v[196:199], v251 offset:4096
    ds_read_b128 v[200:203], v251 offset:5120
    ds_read_b128 v[212:215], v251 offset:8192
    ds_read_b128 v[216:219], v251 offset:9216
    ds_read_b128 v[188:191], v251 offset:2048
    ds_read_b128 v[192:195], v251 offset:3072
    ds_read_b128 v[204:207], v251 offset:6144
    ds_read_b128 v[208:211], v251 offset:7168
    ds_read_b128 v[220:223], v251 offset:10240
    ds_read_b128 v[224:227], v251 offset:11264
    ds_read_b128 v[228:231], v251 offset:14336
    ds_read_b128 v[232:235], v251 offset:15360
    s_mov_b32 s77, 2
    s_branch BPF
L_END:
    s_endpgm
.section .rodata,"a"
.p2align 6
.amdhsa_kernel standalone__sequential_behavior_din__recsys_kernel
  .amdhsa_next_free_vgpr 255
  .amdhsa_next_free_sgpr 78
  .amdhsa_accum_offset 256
  .amdhsa_group_segment_fixed_size 0
  .amdhsa_kernarg_size 80
  .amdhsa_user_sgpr_count 2
  .amdhsa_user_sgpr_kernarg_segment_ptr 1
  .amdhsa_system_sgpr_workgroup_id_x 1
.end_amdhsa_kernel
```

```asm
; @launch grid=(256,1,1) block=(512,1,1) lds=153856
.amdgcn_target "amdgcn-amd-amdhsa--gfx950"
.text
.globl standalone__sequential_behavior_din__recsys_kernel
.p2align 8
.type standalone__sequential_behavior_din__recsys_kernel,@function
standalone__sequential_behavior_din__recsys_kernel:
    s_cmpk_ge_u32 s2, 256
    s_cbranch_scc1 L_END
    s_load_dwordx16 s[4:19], s[0:1], 0
    s_setprio 3
    v_lshrrev_b32 v1, 6, v0
    v_and_b32 v176, 63, v0
    v_readfirstlane_b32 s48, v1
    s_getpc_b64 s[40:41]
L_PC:
    s_cmp_lt_u32 s48, 5
    s_cbranch_scc1 P_NC
    s_mov_b32 s42, L_END-L_PC
    s_mov_b32 s43, 0x20000
    v_subrev_u32 v150, 320, v0
    v_lshlrev_b32 v150, 6, v150
    buffer_load_dword v150, v150, s[40:43], 0 offen
P_NC:
    v_and_b32 v2, 31, v0
    v_bfe_u32 v3, v0, 5, 1
    v_cmp_gt_u32 vcc, 25, v2
    v_mul_u32_u24 v4, 400, v3
    v_lshl_add_u32 v179, v2, 4, v4
    v_bfrev_b32 v4, 8
    v_cndmask_b32 v179, v4, v179, vcc
    s_mul_i32 s57, s2, 3200
    s_sub_u32 s26, 6553600, s57
    s_lshr_b32 s59, s48, 2
    s_mul_i32 s71, s48, 800
    s_mul_i32 s59, s59, 816000
    s_add_u32 s71, s71, s59
    s_mov_b32 s27, 0x20000
    s_lshl_b32 s74, s48, 12
    s_lshl_b32 s53, s2, 10
    v_lshlrev_b32 v251, 4, v176
    v_lshlrev_b32 v120, 1, v176
    v_and_b32 v120, 32, v120
    v_xor_b32 v120, v120, v251
    v_xor_b32 v121, 64, v120
    s_mov_b32 s38, 32768
    s_mov_b32 s39, s27
    s_lshl_b32 s58, s48, 18
    s_sub_u32 s34, 2097152, s53
    s_mov_b32 s35, s27
    s_add_u32 m0, s74, 121088
    v_and_b32 v178, 15, v176
    v_lshrrev_b32 v177, 4, v176
    v_lshlrev_b32 v252, 4, v177
    v_mul_u32_u24 v208, 0x80008, v2
    v_lshrrev_b32 v238, 3, v176
    v_add_u32 v208, 0x10000, v208
    v_cmp_gt_u32 vcc, 32, v176
    s_waitcnt lgkmcnt(0)
    s_add_u32 s24, s8, s57
    s_addc_u32 s25, s9, 0
    s_mov_b64 s[36:37], s[10:11]
    buffer_load_dwordx4 v[204:207], v179, s[24:27], s71 offen offset:0 nt
    s_setprio 0
    s_add_u32 s32, s4, s53
    s_addc_u32 s33, s5, 0
    s_load_dword s63, s[16:17], 0
    s_cmp_lg_u32 s48, 0
    s_cbranch_scc1 P_LJ
    v_mov_b32 v146, s12
    v_mov_b32 v147, s13
    v_mov_b32 v148, s14
    v_mov_b32 v149, s15
    v_lshlrev_b32 v4, 2, v2
    v_cndmask_b32 v146, v146, v148, vcc
    v_cndmask_b32 v147, v147, v149, vcc
    v_add_co_u32 v146, vcc, v146, v4
    s_nop 1
    v_addc_co_u32 v147, vcc, 0, v147, vcc
    global_load_dword v146, v[146:147], off
P_LJ:
    buffer_load_dwordx4 v[124:127], v251, s[32:35], s58 offen nt
    buffer_load_dwordx4 v120, s[36:39], s74 offen offset:0 lds
    buffer_load_dwordx4 v121, s[36:39], s74 offen offset:1024 lds
    s_lshl1_add_u32 s54, s74, 17664
    s_mul_i32 s49, s2, 204800
    s_lshl_b32 s57, s48, 9
    v_add_u32 v247, 116992, v238
    v_add_u32 v246, s57, v247
    s_add_u32 s56, s57, 116992
    v_add_u32 v209, 0x20002, v208
    v_add_u32 v210, 0x40004, v208
    v_add_u32 v211, 0x60006, v208
    s_sub_u32 s20, s6, 1024
    s_subb_u32 s21, s7, 0
    s_or_b32 s21, s21, 0x800000
    s_movk_i32 s22, 200
    s_mov_b32 s23, s27
    s_movk_i32 s61, 0x3f80
    v_lshrrev_b32 v216, 1, v251
    v_and_b32 v213, 0x100, v216
    v_mov_b64 v[214:215], -1
    v_lshlrev_b32 v250, 2, v176
    v_bfrev_b32 v2, v238
    v_lshrrev_b32 v2, 28, v2
    v_and_b32 v2, 6, v2
    v_xor_b32 v2, v2, v176
    v_and_b32 v2, 7, v2
    v_mul_u32_u24 v143, 528, v238
    v_lshlrev_b32 v239, 4, v2
    v_lshlrev_b32 v241, 4, v2
    v_lshlrev_b32 v153, 4, v2
    v_lshlrev_b32 v155, 4, v2
    s_add_u32 s28, s18, s53
    s_addc_u32 s29, s19, 0
    s_sub_u32 s30, 2097152, s53
    s_mov_b32 s31, s27
    s_mov_b32 s60, 0xbfb8aa3b
    s_mov_b32 s46, 0x2b800000
    s_lshr_b32 s59, s48, 2
    s_mul_i32 s51, s48, 51200
    s_mul_i32 s59, s59, 52224000
    s_add_u32 s51, s51, s59
    s_add_u32 s51, s51, s49
    s_add_u32 s72, s51, 1024
    v_bfrev_b32 v2, v178
    v_lshrrev_b32 v2, 28, v2
    v_and_b32 v2, 6, v2
    v_xor_b32 v2, v2, v177
    v_lshl_add_u32 v2, v2, 4, s54
    v_lshl_add_u32 v242, v178, 7, v2
    v_xor_b32 v243, 64, v242
    v_and_b32 v3, 3, v176
    v_bfe_u32 v2, v176, 2, 2
    v_lshlrev_b32 v7, 3, v3
    v_lshl_add_u32 v7, v2, 7, v7
    v_and_b32 v6, 8, v176
    v_lshlrev_b32 v6, 3, v6
    v_lshl_add_u32 v244, v177, 5, v7
    v_xor_b32 v244, v244, v6
    v_add_u32 v244, s54, v244
    v_xor_b32 v245, 32, v244
    s_lshl_b32 s57, s48, 7
    s_add_u32 s57, s57, 150016
    v_lshl_add_u32 v249, v2, 2, v177
    v_lshl_add_u32 v249, v249, 2, v3
    v_lshl_add_u32 v249, v249, 1, s57
    v_lshl_add_u32 v248, v178, 3, s57
    v_and_b32 v6, 0x60, v250
    v_or_b32 v6, v6, v7
    v_lshl_add_u32 v136, v177, 10, v6
    s_mul_i32 s57, s48, 0x1010
    s_and_b32 s57, s57, 0x1060
    v_xor_b32 v144, s57, v136
    v_add_u32 v136, 121088, v136
    v_add_u32 v144, 121088, v144
    v_xor_b32 v137, 32, v136
    v_xor_b32 v138, 64, v136
    v_xor_b32 v139, 96, v136
    s_and_b32 s59, s48, 4
    s_lshl_b32 s59, s59, 4
    v_xor_b32 v140, s59, v136
    v_xor_b32 v141, 32, v140
    s_and_b32 s57, s48, 3
    s_mul_i32 s57, s57, 8448
    s_lshl1_add_u32 s57, s59, s57
    s_add_u32 s57, s57, 83200
    v_mul_u32_u24 v145, 528, v178
    v_add3_u32 v145, v145, v252, s57
    v_lshl_add_u32 v142, s59, 1, v252
    s_mul_i32 s57, s48, 4224
    s_add_u32 s57, s57, 83200
    v_and_b32 v3, 0x70, v251
    v_add3_u32 v143, v143, v3, s57
    v_add_u32 v3, v143, v3
    s_lshl_b32 s57, s48, 11
    v_add_u32 v151, s57, v251
    s_mov_b32 s66, 0x1b0a0100
    s_mov_b32 s67, 0x966d4c33
    s_lshl_b32 s57, s48, 3
    s_lshr_b64 s[66:67], s[66:67], s57
    s_and_b32 s47, s66, 7
    s_bfe_u32 s70, s66, 0x50003
    s_lshl1_add_u32 s70, s70, 16
    s_mul_i32 s71, s70, 400
    buffer_load_dwordx4 v120, s[36:39], s74 offen offset:2048 lds
    buffer_load_dwordx4 v121, s[36:39], s74 offen offset:3072 lds
    s_cmp_eq_u32 s48, 0
    s_waitcnt vmcnt(6) lgkmcnt(0)
    s_cbranch_scc1 P_M0
    s_waitcnt vmcnt(5)
P_M0:
    s_call_b64 s[36:37], CMP
    s_branch P_C
    .p2align 3
CMP:
    v_bcnt_u32_b32 v7, v204, 0
    v_bcnt_u32_b32 v7, v205, v7
    v_bcnt_u32_b32 v7, v206, v7
    v_bcnt_u32_b32 v7, v207, v7
    v_add_u32 v4, s56, v216
    v_mov_b32 v6, v7
    ds_write_b64 v4, v[214:215]
    v_cmp_eq_u16_e64 s[4:5], s61, v204
    v_cmp_eq_u16_sdwa s[6:7], v204, s61 src0_sel:WORD_1 src1_sel:WORD_0
    v_add_u32_dpp v6, v6, v6 row_shr:1 row_mask:0xf bank_mask:0xf bound_ctrl:0
    v_cmp_eq_u16_e64 s[8:9], s61, v205
    v_cmp_eq_u16_sdwa s[10:11], v205, s61 src0_sel:WORD_1 src1_sel:WORD_0
    v_add_u32_dpp v6, v6, v6 row_shr:2 row_mask:0xf bank_mask:0xf bound_ctrl:0
    v_cmp_eq_u16_e64 s[12:13], s61, v206
    v_cmp_eq_u16_sdwa s[14:15], v206, s61 src0_sel:WORD_1 src1_sel:WORD_0
    v_add_u32_dpp v6, v6, v6 row_shr:4 row_mask:0xf bank_mask:0xf bound_ctrl:0
    v_cmp_eq_u16_e64 s[16:17], s61, v207
    v_cmp_eq_u16_sdwa s[18:19], v207, s61 src0_sel:WORD_1 src1_sel:WORD_0
    v_add_u32_dpp v6, v6, v6 row_shr:8 row_mask:0xf bank_mask:0xf bound_ctrl:0
    s_nop 1
    v_add_u32_dpp v6, v6, v6 row_bcast:15 row_mask:0xa bank_mask:0xf
    v_sub_u32 v6, v6, v7
    v_mul_u32_u24 v6, 9363, v6
    v_lshrrev_b32 v6, 16, v6
    v_min_u32 v6, 200, v6
    v_add3_u32 v226, v6, v213, s56
    v_readlane_b32 s59, v6, 31
    v_readlane_b32 s58, v6, 63
    v_addc_co_u32_e64 v227, vcc, 0, v226, s[4:5]
    v_addc_co_u32_e64 v228, vcc, 0, v227, s[6:7]
    v_addc_co_u32_e64 v229, vcc, 0, v228, s[8:9]
    v_addc_co_u32_e64 v230, vcc, 0, v229, s[10:11]
    v_addc_co_u32_e64 v231, vcc, 0, v230, s[12:13]
    v_addc_co_u32_e64 v232, vcc, 0, v231, s[14:15]
    v_addc_co_u32_e64 v233, vcc, 0, v232, s[16:17]
    v_addc_co_u32_e64 v234, vcc, 0, v233, s[18:19]
    s_mov_b64 exec, s[4:5]
    ds_write_b8 v226, v208
    s_mov_b64 exec, s[6:7]
    ds_write_b8_d16_hi v227, v208
    s_mov_b64 exec, s[8:9]
    ds_write_b8 v228, v209
    s_mov_b64 exec, s[10:11]
    ds_write_b8_d16_hi v229, v209
    s_mov_b64 exec, s[12:13]
    ds_write_b8 v230, v210
    s_mov_b64 exec, s[14:15]
    ds_write_b8_d16_hi v231, v210
    s_mov_b64 exec, s[16:17]
    ds_write_b8 v232, v211
    s_mov_b64 exec, s[18:19]
    ds_write_b8_d16_hi v233, v211
    s_mov_b64 exec, -1
    v_sub_u32 v6, v234, v226
    v_mul_u32_u24 v6, 7, v6
    v_cmp_ne_u32 vcc, v6, v7
    s_min_u32 s64, vcc_lo, 1
    s_min_u32 s65, vcc_hi, 1
    s_lshl_b64 s[64:65], s[64:65], 15
    s_or_b32 s57, s59, s64
    s_or_b32 s58, s58, s65
    s_setpc_b64 s[36:37]
P_C:
    ds_read_u8 v238, v246 offset:0
    ds_read_u8 v240, v246 offset:8
    ds_read_u8 v152, v246 offset:16
    ds_read_u8 v154, v246 offset:24
    s_add_u32 m0, s54, 0
    s_waitcnt lgkmcnt(3)
    buffer_load_dwordx4 v[238:239], s[20:23], s72 idxen offen nt lds
    s_waitcnt lgkmcnt(2)
    buffer_load_dwordx4 v[240:241], s[20:23], s51 idxen offen offset:1024 nt lds
    s_add_u32 m0, s54, 2048
    s_waitcnt lgkmcnt(1)
    buffer_load_dwordx4 v[152:153], s[20:23], s72 idxen offen nt lds
    s_waitcnt lgkmcnt(0)
    buffer_load_dwordx4 v[154:155], s[20:23], s51 idxen offen offset:1024 nt lds
    s_lshl_b32 s63, s63, 16
    s_cmp_lg_u32 s48, 0
    s_waitcnt vmcnt(8)
    s_cbranch_scc1 P_SW_J
    v_lshlrev_b32 v148, 16, v146
    v_and_b32 v149, 0xffff0000, v146
    v_mov_b32 v4, -1
    v_mov_b32 v5, 0
    v_mov_b32 v6, 0x240
    v_lshrrev_b32 v0, 1, v251
    ds_write2st64_b32 v250, v4, v5 offset0:66 offset1:67
    s_mov_b32 exec_hi, 0
    v_max3_f32 v2, abs(v148), abs(v149), abs(s63)
    v_ldexp_f32 v148, v148, 40
    v_ldexp_f32 v149, v149, 40
    v_cmp_le_f32 vcc, 0x33800000, v2
    ds_write_b32 v250, v6 offset:17408
    s_mov_b32 exec_hi, -1
    s_movk_i32 s56, 0x3ff
    s_cmp_lg_u64 vcc, 0
    s_cmovk_i32 s56, 0x207
    v_mov_b32 v6, 17184
    v_mov_b32 v7, s56
    ds_write_b64 v0, v[148:149] offset:16384
    ds_write_b64 v5, v[6:7] offset:17600
P_SW_J:
    ds_write_b128 v143, v[124:127] offset:256
    ds_write_b128 v143, v[124:127] offset:384
    s_waitcnt vmcnt(4) lgkmcnt(0)
    s_barrier
    ds_read_b64_tr_b16 v[218:219], v144 offset:0
    ds_read_b64_tr_b16 v[220:221], v144 offset:512
    ds_read_b64_tr_b16 v[222:223], v144 offset:16384
    ds_read_b64_tr_b16 v[224:225], v144 offset:16896
    ds_read_b128 v[160:163], v145 offset:256
    ds_read_b128 v[164:167], v145 offset:320
    ds_read_b128 v[104:107], v142 offset:16640
    ds_read_b128 v[108:111], v142 offset:16704
    ds_read_b64_tr_b16 v[40:41], v140 offset:8192
    ds_read_b64_tr_b16 v[42:43], v140 offset:8704
    ds_read_b64_tr_b16 v[44:45], v141 offset:8192
    ds_read_b64_tr_b16 v[46:47], v141 offset:8704
    ds_read_b64_tr_b16 v[48:49], v140 offset:12288
    ds_read_b64_tr_b16 v[50:51], v140 offset:12800
    ds_read_b64_tr_b16 v[52:53], v141 offset:12288
    ds_read_b64_tr_b16 v[54:55], v141 offset:12800
    ds_read_b64_tr_b16 v[56:57], v140 offset:16384
    ds_read_b64_tr_b16 v[58:59], v140 offset:16896
    ds_read_b64_tr_b16 v[60:61], v141 offset:16384
    ds_read_b64_tr_b16 v[62:63], v141 offset:16896
    ds_read_b64_tr_b16 v[64:65], v140 offset:20480
    ds_read_b64_tr_b16 v[66:67], v140 offset:20992
    ds_read_b64_tr_b16 v[68:69], v141 offset:20480
    ds_read_b64_tr_b16 v[70:71], v141 offset:20992
    s_and_b32 s59, s57, 0xff
    s_lshr_b32 s57, s57, 8
    s_add_u32 s59, s59, 15
    s_lshr_b32 s59, s59, 4
    s_max_u32 s59, s59, 4
    s_lshl1_add_u32 s52, s48, s57
    s_lshl_b32 s57, s59, 8
    s_or_b32 s52, s52, s57
    s_sub_u32 s50, s59, 4
    s_and_b32 s59, s58, 0xff
    s_lshr_b32 s58, s58, 8
    s_add_u32 s59, s59, 15
    s_lshr_b32 s59, s59, 4
    s_max_u32 s59, s59, 2
    s_lshl1_add_u32 s74, s48, s58
    s_lshl_b32 s58, s59, 8
    s_or_b32 s74, s74, s58
    s_or_b32 s74, s74, 1
    v_lshlrev_b32 v24, 16, v124
    v_and_b32 v25, 0xffff0000, v124
    v_lshlrev_b32 v26, 16, v125
    v_and_b32 v27, 0xffff0000, v125
    v_lshlrev_b32 v28, 16, v126
    v_and_b32 v29, 0xffff0000, v126
    v_lshlrev_b32 v30, 16, v127
    v_and_b32 v31, 0xffff0000, v127
    v_mul_f32 v24, s60, v24
    v_mul_f32 v25, s60, v25
    v_mul_f32 v26, s60, v26
    v_mul_f32 v27, s60, v27
    v_mul_f32 v28, s60, v28
    v_mul_f32 v29, s60, v29
    v_mul_f32 v30, s60, v30
    v_mul_f32 v31, s60, v31
    s_waitcnt lgkmcnt(15)
    v_lshlrev_b32 v8, 16, v218
    v_and_b32 v9, 0xffff0000, v218
    v_lshlrev_b32 v16, 16, v222
    v_and_b32 v17, 0xffff0000, v222
    v_lshlrev_b32 v10, 16, v219
    v_and_b32 v11, 0xffff0000, v219
    v_lshlrev_b32 v18, 16, v223
    v_and_b32 v19, 0xffff0000, v223
    v_lshlrev_b32 v12, 16, v220
    v_and_b32 v13, 0xffff0000, v220
    v_lshlrev_b32 v20, 16, v224
    v_and_b32 v21, 0xffff0000, v224
    v_lshlrev_b32 v14, 16, v221
    v_and_b32 v15, 0xffff0000, v221
    v_lshlrev_b32 v22, 16, v225
    v_and_b32 v23, 0xffff0000, v225
    v_xor_b32 v168, 0x80008000, v160
    v_xor_b32 v169, 0x80008000, v161
    v_xor_b32 v170, 0x80008000, v162
    v_xor_b32 v171, 0x80008000, v163
    v_xor_b32 v172, 0x80008000, v164
    v_xor_b32 v173, 0x80008000, v165
    v_xor_b32 v174, 0x80008000, v166
    v_xor_b32 v175, 0x80008000, v167
    s_waitcnt lgkmcnt(12)
    v_mfma_f32_16x16x32_bf16 v[104:107], v[40:43], v[160:163], v[104:107]
    v_mfma_f32_16x16x32_bf16 v[108:111], v[44:47], v[160:163], v[108:111]
    v_add_f32 v112, v8, v16
    v_add_f32 v113, v9, v17
    s_waitcnt lgkmcnt(8)
    v_mfma_f32_16x16x32_bf16 v[104:107], v[48:51], v[164:167], v[104:107]
    v_mfma_f32_16x16x32_bf16 v[108:111], v[52:55], v[164:167], v[108:111]
    v_add_f32 v114, v10, v18
    v_add_f32 v115, v11, v19
    s_waitcnt lgkmcnt(4)
    v_mfma_f32_16x16x32_bf16 v[104:107], v[56:59], v[168:171], v[104:107]
    v_mfma_f32_16x16x32_bf16 v[108:111], v[60:63], v[168:171], v[108:111]
    v_add_f32 v116, v12, v20
    v_add_f32 v117, v13, v21
    s_waitcnt lgkmcnt(0)
    v_mfma_f32_16x16x32_bf16 v[104:107], v[64:67], v[172:175], v[104:107]
    v_mfma_f32_16x16x32_bf16 v[108:111], v[68:71], v[172:175], v[108:111]
    v_add_f32 v118, v14, v22
    v_add_f32 v119, v15, v23
    ds_read_b64_tr_b16 v[72:73], v136 offset:24576
    ds_read_b64_tr_b16 v[74:75], v136 offset:25088
    ds_read_b64_tr_b16 v[76:77], v136 offset:28672
    ds_read_b64_tr_b16 v[78:79], v136 offset:29184
    ds_read_b64_tr_b16 v[80:81], v137 offset:24576
    ds_read_b64_tr_b16 v[82:83], v137 offset:25088
    ds_read_b64_tr_b16 v[84:85], v137 offset:28672
    ds_read_b64_tr_b16 v[86:87], v137 offset:29184
    ds_read_b64_tr_b16 v[88:89], v138 offset:24576
    ds_read_b64_tr_b16 v[90:91], v138 offset:25088
    ds_read_b64_tr_b16 v[92:93], v138 offset:28672
    ds_read_b64_tr_b16 v[94:95], v138 offset:29184
    ds_read_b64_tr_b16 v[96:97], v139 offset:24576
    ds_read_b64_tr_b16 v[98:99], v139 offset:25088
    ds_read_b64_tr_b16 v[100:101], v139 offset:28672
    ds_read_b64_tr_b16 v[102:103], v139 offset:29184
    s_cmp_le_u32 s47, 0
    s_cbranch_scc1 P_MJ
    s_lshr_b32 s56, s70, 1
    s_lshr_b32 s59, s56, 2
    s_mul_i32 s71, s56, 800
    s_mul_i32 s59, s59, 816000
    s_add_u32 s71, s71, s59
    buffer_load_dwordx4 v[180:183], v179, s[24:27], s71 offen offset:0 nt
    s_cmp_le_u32 s47, 1
    s_cbranch_scc1 P_MJ
    s_lshr_b32 s56, s70, 1
    s_add_u32 s56, s56, 1
    s_lshr_b32 s59, s56, 2
    s_mul_i32 s71, s56, 800
    s_mul_i32 s59, s59, 816000
    s_add_u32 s71, s71, s59
    buffer_load_dwordx4 v[184:187], v179, s[24:27], s71 offen offset:0 nt
    s_cmp_le_u32 s47, 2
    s_cbranch_scc1 P_MJ
    s_lshr_b32 s56, s70, 1
    s_add_u32 s56, s56, 2
    s_lshr_b32 s59, s56, 2
    s_mul_i32 s71, s56, 800
    s_mul_i32 s59, s59, 816000
    s_add_u32 s71, s71, s59
    buffer_load_dwordx4 v[188:191], v179, s[24:27], s71 offen offset:0 nt
    s_cmp_le_u32 s47, 3
    s_cbranch_scc1 P_MJ
    s_lshr_b32 s56, s70, 1
    s_add_u32 s56, s56, 3
    s_lshr_b32 s59, s56, 2
    s_mul_i32 s71, s56, 800
    s_mul_i32 s59, s59, 816000
    s_add_u32 s71, s71, s59
    buffer_load_dwordx4 v[192:195], v179, s[24:27], s71 offen offset:0 nt
    s_cmp_le_u32 s47, 4
    s_cbranch_scc1 P_MJ
    s_lshr_b32 s56, s70, 1
    s_add_u32 s56, s56, 4
    s_lshr_b32 s59, s56, 2
    s_mul_i32 s71, s56, 800
    s_mul_i32 s59, s59, 816000
    s_add_u32 s71, s71, s59
    buffer_load_dwordx4 v[196:199], v179, s[24:27], s71 offen offset:0 nt
    s_cmp_le_u32 s47, 5
    s_cbranch_scc1 P_MJ
    s_lshr_b32 s56, s70, 1
    s_add_u32 s56, s56, 5
    s_lshr_b32 s59, s56, 2
    s_mul_i32 s71, s56, 800
    s_mul_i32 s59, s59, 816000
    s_add_u32 s71, s71, s59
    buffer_load_dwordx4 v[200:203], v179, s[24:27], s71 offen offset:0 nt
P_MJ:
    v_mul_f32 v112, s60, v112
    v_mul_f32 v113, s60, v113
    v_mul_f32 v114, s60, v114
    v_mul_f32 v115, s60, v115
    v_mul_f32 v116, s60, v116
    v_mul_f32 v117, s60, v117
    v_mul_f32 v118, s60, v118
    v_mul_f32 v119, s60, v119
    ds_write_b128 v151, v[112:115] offset:0
    ds_write_b128 v151, v[116:119] offset:1024
    v_mul_f32 v104, s60, v104
    v_mul_f32 v105, s60, v105
    v_mul_f32 v106, s60, v106
    v_mul_f32 v107, s60, v107
    v_mul_f32 v108, s60, v108
    v_mul_f32 v109, s60, v109
    v_mul_f32 v110, s60, v110
    v_mul_f32 v111, s60, v111
    ds_write_b128 v145, v[104:107] offset:256
    ds_write_b128 v145, v[108:111] offset:320
    ds_write_b128 v3, v[24:27] offset:0
    ds_write_b128 v3, v[28:31] offset:16
    ds_read_b128 v[120:123], v252 offset:16384
    ds_read_b128 v[124:127], v252 offset:16448
    ds_read_b128 v[128:131], v252 offset:16512
    ds_read_b128 v[132:135], v252 offset:16576
    ds_read_b32 v150, v252 offset:17604
    s_lshl2_add_u32 s56, s48, 17184
    v_mov_b32 v253, s56
    v_mov_b32 v254, s74
    ds_write_b32 v253, v254
    v_ldexp_f32 v2, s63, 38
    v_add_u32 v250, 133376, v250
    v_mov_b64 v[168:169], 0
    v_mov_b64 v[170:171], 0
    v_mov_b64 v[172:173], 0
    v_mov_b64 v[174:175], 0
    v_readfirstlane_b32 s44, v2
    s_waitcnt lgkmcnt(15)
    v_lshlrev_b32 v8, 16, v72
    v_and_b32 v9, 0xffff0000, v72
    v_lshlrev_b32 v10, 16, v73
    v_and_b32 v11, 0xffff0000, v73
    v_lshlrev_b32 v12, 16, v74
    v_and_b32 v13, 0xffff0000, v74
    v_lshlrev_b32 v14, 16, v75
    v_and_b32 v15, 0xffff0000, v75
    v_lshlrev_b32 v16, 16, v76
    v_and_b32 v17, 0xffff0000, v76
    v_lshlrev_b32 v18, 16, v77
    v_and_b32 v19, 0xffff0000, v77
    v_lshlrev_b32 v20, 16, v78
    v_and_b32 v21, 0xffff0000, v78
    v_lshlrev_b32 v22, 16, v79
    v_and_b32 v23, 0xffff0000, v79
    v_lshlrev_b32 v24, 16, v80
    v_and_b32 v25, 0xffff0000, v80
    v_lshlrev_b32 v26, 16, v81
    v_and_b32 v27, 0xffff0000, v81
    v_lshlrev_b32 v28, 16, v82
    v_and_b32 v29, 0xffff0000, v82
    v_lshlrev_b32 v30, 16, v83
    v_and_b32 v31, 0xffff0000, v83
    v_lshlrev_b32 v32, 16, v84
    v_and_b32 v33, 0xffff0000, v84
    v_lshlrev_b32 v34, 16, v85
    v_and_b32 v35, 0xffff0000, v85
    v_lshlrev_b32 v36, 16, v86
    v_and_b32 v37, 0xffff0000, v86
    v_lshlrev_b32 v38, 16, v87
    v_and_b32 v39, 0xffff0000, v87
    ds_read_u8 v238, v246 offset:32
    ds_read_u8 v240, v246 offset:40
    ds_read_u8 v152, v246 offset:48
    ds_read_u8 v154, v246 offset:56
    s_add_u32 m0, s54, 4096
    v_add_u32 v246, 48, v246
    s_mov_b64 s[68:69], 0
    s_mov_b32 s75, 0
    s_movk_i32 s53, 0x1040
    s_mov_b32 s73, 3
    s_mov_b32 s77, 0
    s_mov_b32 s55, 0
    v_mov_b64 v[0:1], 0
    v_mov_b32 v2, 1.0
    v_mov_b32 v3, 1.0
    s_waitcnt lgkmcnt(0)
    s_barrier
    v_readfirstlane_b32 s45, v150
    buffer_load_dwordx4 v[238:239], s[20:23], s72 idxen offen nt lds
    buffer_load_dwordx4 v[240:241], s[20:23], s51 idxen offen offset:1024 nt lds
    s_add_u32 m0, s54, 6144
    s_nop 0
    buffer_load_dwordx4 v[152:153], s[20:23], s72 idxen offen nt lds
    buffer_load_dwordx4 v[154:155], s[20:23], s51 idxen offen offset:1024 nt lds
    s_cmp_eq_u32 s47, 0
    s_cbranch_scc1 P_GO
    s_lshl_b32 s56, s70, 8
    s_add_u32 s56, s56, 116992
    s_waitcnt vmcnt(4)
    v_mov_b64 v[204:205], v[180:181]
    v_mov_b64 v[206:207], v[182:183]
    s_call_b64 s[36:37], CMP
    v_writelane_b32 v212, s57, 0
    v_writelane_b32 v212, s58, 1
    s_cmp_le_u32 s47, 1
    s_cbranch_scc1 LATE_D
    s_add_u32 s56, s56, 512
    v_mov_b64 v[204:205], v[184:185]
    v_mov_b64 v[206:207], v[186:187]
    s_call_b64 s[36:37], CMP
    v_writelane_b32 v212, s57, 2
    v_writelane_b32 v212, s58, 3
    s_cmp_le_u32 s47, 2
    s_cbranch_scc1 LATE_D
    s_add_u32 s56, s56, 512
    v_mov_b64 v[204:205], v[188:189]
    v_mov_b64 v[206:207], v[190:191]
    s_call_b64 s[36:37], CMP
    v_writelane_b32 v212, s57, 4
    v_writelane_b32 v212, s58, 5
    s_cmp_le_u32 s47, 3
    s_cbranch_scc1 LATE_D
    s_add_u32 s56, s56, 512
    v_mov_b64 v[204:205], v[192:193]
    v_mov_b64 v[206:207], v[194:195]
    s_call_b64 s[36:37], CMP
    v_writelane_b32 v212, s57, 6
    v_writelane_b32 v212, s58, 7
    s_cmp_le_u32 s47, 4
    s_cbranch_scc1 LATE_D
    s_add_u32 s56, s56, 512
    v_mov_b64 v[204:205], v[196:197]
    v_mov_b64 v[206:207], v[198:199]
    s_call_b64 s[36:37], CMP
    v_writelane_b32 v212, s57, 8
    v_writelane_b32 v212, s58, 9
    s_cmp_le_u32 s47, 5
    s_cbranch_scc1 LATE_D
    s_add_u32 s56, s56, 512
    v_mov_b64 v[204:205], v[200:201]
    v_mov_b64 v[206:207], v[202:203]
    s_call_b64 s[36:37], CMP
    v_writelane_b32 v212, s57, 10
    v_writelane_b32 v212, s58, 11
LATE_D:
    v_add_u32 v4, s70, v176
    s_lshl_b32 s56, s47, 1
    v_and_b32 v5, 0xff, v212
    v_add_u32 v5, 15, v5
    v_lshrrev_b32 v5, 4, v5
    v_max_u32 v5, 2, v5
    v_lshrrev_b32 v212, 8, v212
    v_or_b32 v212, v212, v4
    v_cmp_gt_u32 vcc, 64, v4
    v_lshl_or_b32 v6, v5, 8, v212
    v_lshlrev_b32 v4, 2, v4
    s_bfm_b64 s[66:67], s56, 0
    s_and_b64 exec, s[66:67], vcc
    ds_write_b32 v4, v6 offset:17152
    s_mov_b64 exec, -1
P_GO:
    ds_read_b128 v[180:183], v251 offset:0
    ds_read_b128 v[184:187], v251 offset:1024
    ds_read_b128 v[196:199], v251 offset:4096
    ds_read_b128 v[200:203], v251 offset:5120
    ds_read_b128 v[212:215], v251 offset:8192
    ds_read_b128 v[216:219], v251 offset:9216
    ds_read_b128 v[188:191], v251 offset:2048
    ds_read_b128 v[192:195], v251 offset:3072
    ds_read_b128 v[204:207], v251 offset:6144
    ds_read_b128 v[208:211], v251 offset:7168
    ds_read_b128 v[220:223], v251 offset:10240
    ds_read_b128 v[224:227], v251 offset:11264
    ds_read_b128 v[228:231], v251 offset:14336
    ds_read_b128 v[232:235], v251 offset:15360
    v_lshlrev_b32 v40, 16, v88
    v_and_b32 v41, 0xffff0000, v88
    v_lshlrev_b32 v42, 16, v89
    v_and_b32 v43, 0xffff0000, v89
    v_lshlrev_b32 v44, 16, v90
    v_and_b32 v45, 0xffff0000, v90
    v_lshlrev_b32 v46, 16, v91
    v_and_b32 v47, 0xffff0000, v91
    v_lshlrev_b32 v48, 16, v92
    v_and_b32 v49, 0xffff0000, v92
    v_lshlrev_b32 v50, 16, v93
    v_and_b32 v51, 0xffff0000, v93
    v_lshlrev_b32 v52, 16, v94
    v_and_b32 v53, 0xffff0000, v94
    v_lshlrev_b32 v54, 16, v95
    v_and_b32 v55, 0xffff0000, v95
    v_lshlrev_b32 v56, 16, v96
    v_and_b32 v57, 0xffff0000, v96
    v_lshlrev_b32 v58, 16, v97
    v_and_b32 v59, 0xffff0000, v97
    v_lshlrev_b32 v60, 16, v98
    v_and_b32 v61, 0xffff0000, v98
    v_lshlrev_b32 v62, 16, v99
    v_and_b32 v63, 0xffff0000, v99
    v_lshlrev_b32 v64, 16, v100
    v_and_b32 v65, 0xffff0000, v100
    v_lshlrev_b32 v66, 16, v101
    v_and_b32 v67, 0xffff0000, v101
    v_lshlrev_b32 v68, 16, v102
    v_and_b32 v69, 0xffff0000, v102
    v_lshlrev_b32 v70, 16, v103
    v_and_b32 v71, 0xffff0000, v103
    v_mov_b64 v[176:177], 0
    v_mov_b64 v[178:179], 0
    s_sub_u32 s50, s50, 2
    s_cbranch_scc1 DRAW_P
DRET_P:
    s_waitcnt vmcnt(6)
    ds_read_b128 v[152:155], v242
    ds_read_b128 v[156:159], v243
    s_branch BPF
U_0:
    v_mfma_f32_16x16x32_bf16 v[104:107], v[72:75], v[152:155], v[136:139]
    s_add_u32 m0, s54, 0
    v_rcp_f32 v2, v2
    v_mfma_f32_16x16x32_bf16 v[104:107], v[76:79], v[156:159], v[104:107]
    s_mov_b32 s73, 0
    v_rcp_f32 v3, v3
    v_mfma_f32_16x16x32_bf16 v[108:111], v[80:83], v[152:155], v[140:143]
    s_sub_u32 s50, s50, 1
    v_fma_f32 v0, v0, v2, s44
    v_fmac_f32 v0, v1, v3
    v_mfma_f32_16x16x32_bf16 v[108:111], v[84:87], v[156:159], v[108:111]
    s_cbranch_scc1 PEV
    v_add_u32 v246, 16, v246
RET_0:
    v_cvt_pk_bf16_f32 v0, v0, v0
    v_mfma_f32_16x16x32_bf16 v[112:115], v[88:91], v[152:155], v[144:147]
    v_exp_f32 v104, v104
    v_mfma_f32_16x16x32_bf16 v[112:115], v[92:95], v[156:159], v[112:115]
    v_exp_f32 v105, v105
    v_mfma_f32_16x16x32_bf16 v[116:119], v[96:99], v[152:155], v[148:151]
    s_sub_u32 s62, s62, 1
    v_exp_f32 v106, v106
    v_mfma_f32_16x16x32_bf16 v[116:119], v[100:103], v[156:159], v[116:119]
    v_exp_f32 v107, v107
    ds_write_b16 v249, v0
    ds_read_b64 v[236:237], v248
    ds_read_b64_tr_b16 v[160:161], v244 offset:0
    ds_read_b64_tr_b16 v[162:163], v245 offset:512
    ds_read_b64_tr_b16 v[164:165], v244 offset:1024
    ds_read_b64_tr_b16 v[166:167], v245 offset:1536
    ds_read_u8 v238, v246 offset:0
    ds_read_u8 v240, v246 offset:8
    ds_read_b32 v254, v253
    v_exp_f32 v108, v108
    v_exp_f32 v109, v109
    v_exp_f32 v110, v110
    v_exp_f32 v111, v111
    s_waitcnt lgkmcnt(7)
    v_mfma_f32_4x4x4_16b_bf16 v[176:179], v[236:237], v[168:169], v[176:179] cbsz:4 abid:0
    v_exp_f32 v112, v112
    v_exp_f32 v113, v113
    v_mfma_f32_4x4x4_16b_bf16 v[176:179], v[236:237], v[170:171], v[176:179] cbsz:4 abid:1
    v_exp_f32 v114, v114
    v_exp_f32 v115, v115
    v_mfma_f32_4x4x4_16b_bf16 v[176:179], v[236:237], v[172:173], v[176:179] cbsz:4 abid:2
    v_exp_f32 v116, v116
    v_exp_f32 v117, v117
    v_mfma_f32_4x4x4_16b_bf16 v[176:179], v[236:237], v[174:175], v[176:179] cbsz:4 abid:3
    v_exp_f32 v118, v118
    v_exp_f32 v119, v119
    s_waitcnt lgkmcnt(0)
    buffer_load_dwordx4 v[238:239], s[20:23], s72 idxen offen nt lds
    buffer_load_dwordx4 v[240:241], s[20:23], s51 idxen offen offset:1024 nt lds
    s_waitcnt vmcnt(5)
    ds_read_b128 v[152:155], v242 offset:2048
    ds_read_b128 v[156:159], v243 offset:2048
    .p2align 3
    v_pk_add_f32 v[2:3], v[104:105], 1.0 op_sel_hi:[1,0]
    v_pk_fma_f32 v[0:1], v[120:121], v[106:107], v[120:121]
    v_pk_fma_f32 v[0:1], v[122:123], v[2:3], v[0:1]
    v_pk_fma_f32 v[2:3], v[106:107], v[2:3], v[2:3]
    v_pk_fma_f32 v[0:1], v[108:109], v[0:1], v[0:1]
    v_pk_fma_f32 v[0:1], v[124:125], v[2:3], v[0:1]
    v_pk_fma_f32 v[2:3], v[108:109], v[2:3], v[2:3]
    v_pk_fma_f32 v[0:1], v[110:111], v[0:1], v[0:1]
    v_pk_fma_f32 v[0:1], v[126:127], v[2:3], v[0:1]
    v_pk_fma_f32 v[2:3], v[110:111], v[2:3], v[2:3]
    v_pk_fma_f32 v[0:1], v[112:113], v[0:1], v[0:1]
    v_pk_fma_f32 v[0:1], v[128:129], v[2:3], v[0:1]
    v_pk_fma_f32 v[2:3], v[112:113], v[2:3], v[2:3]
    v_pk_fma_f32 v[0:1], v[114:115], v[0:1], v[0:1]
    v_pk_fma_f32 v[0:1], v[130:131], v[2:3], v[0:1]
    v_pk_fma_f32 v[2:3], v[114:115], v[2:3], v[2:3]
    v_pk_fma_f32 v[0:1], v[116:117], v[0:1], v[0:1]
    v_pk_fma_f32 v[0:1], v[132:133], v[2:3], v[0:1]
    v_pk_fma_f32 v[2:3], v[116:117], v[2:3], v[2:3]
    v_pk_fma_f32 v[0:1], v[118:119], v[0:1], v[0:1]
    v_pk_fma_f32 v[0:1], v[134:135], v[2:3], v[0:1]
    v_pk_fma_f32 v[2:3], v[118:119], v[2:3], v[2:3]
    s_waitcnt lgkmcnt(0)
    s_cbranch_scc1 CEV
U_1:
    v_mfma_f32_16x16x32_bf16 v[104:107], v[72:75], v[152:155], v[136:139]
    s_add_u32 m0, s54, 2048
    v_rcp_f32 v2, v2
    v_mfma_f32_16x16x32_bf16 v[104:107], v[76:79], v[156:159], v[104:107]
    s_mov_b32 s73, 1
    v_rcp_f32 v3, v3
    v_mfma_f32_16x16x32_bf16 v[108:111], v[80:83], v[152:155], v[140:143]
    s_sub_u32 s50, s50, 1
    v_fma_f32 v0, v0, v2, s44
    v_fmac_f32 v0, v1, v3
    v_mfma_f32_16x16x32_bf16 v[108:111], v[84:87], v[156:159], v[108:111]
    s_cbranch_scc1 PEV
    v_add_u32 v246, 16, v246
RET_1:
    v_cvt_pk_bf16_f32 v0, v0, v0
    v_mfma_f32_16x16x32_bf16 v[112:115], v[88:91], v[152:155], v[144:147]
    v_exp_f32 v104, v104
    v_mfma_f32_16x16x32_bf16 v[112:115], v[92:95], v[156:159], v[112:115]
    v_exp_f32 v105, v105
    v_mfma_f32_16x16x32_bf16 v[116:119], v[96:99], v[152:155], v[148:151]
    s_sub_u32 s62, s62, 1
    v_exp_f32 v106, v106
    v_mfma_f32_16x16x32_bf16 v[116:119], v[100:103], v[156:159], v[116:119]
    v_exp_f32 v107, v107
    ds_write_b16 v249, v0
    ds_read_b64 v[236:237], v248
    ds_read_b64_tr_b16 v[168:169], v244 offset:2048
    ds_read_b64_tr_b16 v[170:171], v245 offset:2560
    ds_read_b64_tr_b16 v[172:173], v244 offset:3072
    ds_read_b64_tr_b16 v[174:175], v245 offset:3584
    ds_read_u8 v238, v246 offset:0
    ds_read_u8 v240, v246 offset:8
    ds_read_b32 v254, v253
    v_exp_f32 v108, v108
    v_exp_f32 v109, v109
    v_exp_f32 v110, v110
    v_exp_f32 v111, v111
    s_waitcnt lgkmcnt(7)
    v_mfma_f32_4x4x4_16b_bf16 v[176:179], v[236:237], v[160:161], v[176:179] cbsz:4 abid:0
    v_exp_f32 v112, v112
    v_exp_f32 v113, v113
    v_mfma_f32_4x4x4_16b_bf16 v[176:179], v[236:237], v[162:163], v[176:179] cbsz:4 abid:1
    v_exp_f32 v114, v114
    v_exp_f32 v115, v115
    v_mfma_f32_4x4x4_16b_bf16 v[176:179], v[236:237], v[164:165], v[176:179] cbsz:4 abid:2
    v_exp_f32 v116, v116
    v_exp_f32 v117, v117
    v_mfma_f32_4x4x4_16b_bf16 v[176:179], v[236:237], v[166:167], v[176:179] cbsz:4 abid:3
    v_exp_f32 v118, v118
    v_exp_f32 v119, v119
    s_waitcnt lgkmcnt(0)
    buffer_load_dwordx4 v[238:239], s[20:23], s72 idxen offen nt lds
    buffer_load_dwordx4 v[240:241], s[20:23], s51 idxen offen offset:1024 nt lds
    s_waitcnt vmcnt(5)
    ds_read_b128 v[152:155], v242 offset:4096
    ds_read_b128 v[156:159], v243 offset:4096
    .p2align 3
    v_pk_add_f32 v[2:3], v[104:105], 1.0 op_sel_hi:[1,0]
    v_pk_fma_f32 v[0:1], v[120:121], v[106:107], v[120:121]
    v_pk_fma_f32 v[0:1], v[122:123], v[2:3], v[0:1]
    v_pk_fma_f32 v[2:3], v[106:107], v[2:3], v[2:3]
    v_pk_fma_f32 v[0:1], v[108:109], v[0:1], v[0:1]
    v_pk_fma_f32 v[0:1], v[124:125], v[2:3], v[0:1]
    v_pk_fma_f32 v[2:3], v[108:109], v[2:3], v[2:3]
    v_pk_fma_f32 v[0:1], v[110:111], v[0:1], v[0:1]
    v_pk_fma_f32 v[0:1], v[126:127], v[2:3], v[0:1]
    v_pk_fma_f32 v[2:3], v[110:111], v[2:3], v[2:3]
    v_pk_fma_f32 v[0:1], v[112:113], v[0:1], v[0:1]
    v_pk_fma_f32 v[0:1], v[128:129], v[2:3], v[0:1]
    v_pk_fma_f32 v[2:3], v[112:113], v[2:3], v[2:3]
    v_pk_fma_f32 v[0:1], v[114:115], v[0:1], v[0:1]
    v_pk_fma_f32 v[0:1], v[130:131], v[2:3], v[0:1]
    v_pk_fma_f32 v[2:3], v[114:115], v[2:3], v[2:3]
    v_pk_fma_f32 v[0:1], v[116:117], v[0:1], v[0:1]
    v_pk_fma_f32 v[0:1], v[132:133], v[2:3], v[0:1]
    v_pk_fma_f32 v[2:3], v[116:117], v[2:3], v[2:3]
    v_pk_fma_f32 v[0:1], v[118:119], v[0:1], v[0:1]
    v_pk_fma_f32 v[0:1], v[134:135], v[2:3], v[0:1]
    v_pk_fma_f32 v[2:3], v[118:119], v[2:3], v[2:3]
    s_waitcnt lgkmcnt(0)
    s_cbranch_scc1 CEV
U_2:
    v_mfma_f32_16x16x32_bf16 v[104:107], v[72:75], v[152:155], v[136:139]
    s_add_u32 m0, s54, 4096
    v_rcp_f32 v2, v2
    v_mfma_f32_16x16x32_bf16 v[104:107], v[76:79], v[156:159], v[104:107]
    s_mov_b32 s73, 2
    v_rcp_f32 v3, v3
    v_mfma_f32_16x16x32_bf16 v[108:111], v[80:83], v[152:155], v[140:143]
    s_sub_u32 s50, s50, 1
    v_fma_f32 v0, v0, v2, s44
    v_fmac_f32 v0, v1, v3
    v_mfma_f32_16x16x32_bf16 v[108:111], v[84:87], v[156:159], v[108:111]
    s_cbranch_scc1 PEV
    v_add_u32 v246, 16, v246
RET_2:
    v_cvt_pk_bf16_f32 v0, v0, v0
    v_mfma_f32_16x16x32_bf16 v[112:115], v[88:91], v[152:155], v[144:147]
    v_exp_f32 v104, v104
    v_mfma_f32_16x16x32_bf16 v[112:115], v[92:95], v[156:159], v[112:115]
    v_exp_f32 v105, v105
    v_mfma_f32_16x16x32_bf16 v[116:119], v[96:99], v[152:155], v[148:151]
    s_sub_u32 s62, s62, 1
    v_exp_f32 v106, v106
    v_mfma_f32_16x16x32_bf16 v[116:119], v[100:103], v[156:159], v[116:119]
    v_exp_f32 v107, v107
    ds_write_b16 v249, v0
    ds_read_b64 v[236:237], v248
    ds_read_b64_tr_b16 v[160:161], v244 offset:4096
    ds_read_b64_tr_b16 v[162:163], v245 offset:4608
    ds_read_b64_tr_b16 v[164:165], v244 offset:5120
    ds_read_b64_tr_b16 v[166:167], v245 offset:5632
    ds_read_u8 v238, v246 offset:0
    ds_read_u8 v240, v246 offset:8
    ds_read_b32 v254, v253
    v_exp_f32 v108, v108
    v_exp_f32 v109, v109
    v_exp_f32 v110, v110
    v_exp_f32 v111, v111
    s_waitcnt lgkmcnt(7)
    v_mfma_f32_4x4x4_16b_bf16 v[176:179], v[236:237], v[168:169], v[176:179] cbsz:4 abid:0
    v_exp_f32 v112, v112
    v_exp_f32 v113, v113
    v_mfma_f32_4x4x4_16b_bf16 v[176:179], v[236:237], v[170:171], v[176:179] cbsz:4 abid:1
    v_exp_f32 v114, v114
    v_exp_f32 v115, v115
    v_mfma_f32_4x4x4_16b_bf16 v[176:179], v[236:237], v[172:173], v[176:179] cbsz:4 abid:2
    v_exp_f32 v116, v116
    v_exp_f32 v117, v117
    v_mfma_f32_4x4x4_16b_bf16 v[176:179], v[236:237], v[174:175], v[176:179] cbsz:4 abid:3
    v_exp_f32 v118, v118
    v_exp_f32 v119, v119
    s_waitcnt lgkmcnt(0)
    buffer_load_dwordx4 v[238:239], s[20:23], s72 idxen offen nt lds
    buffer_load_dwordx4 v[240:241], s[20:23], s51 idxen offen offset:1024 nt lds
    s_waitcnt vmcnt(5)
    ds_read_b128 v[152:155], v242 offset:6144
    ds_read_b128 v[156:159], v243 offset:6144
    .p2align 3
    v_pk_add_f32 v[2:3], v[104:105], 1.0 op_sel_hi:[1,0]
    v_pk_fma_f32 v[0:1], v[120:121], v[106:107], v[120:121]
    v_pk_fma_f32 v[0:1], v[122:123], v[2:3], v[0:1]
    v_pk_fma_f32 v[2:3], v[106:107], v[2:3], v[2:3]
    v_pk_fma_f32 v[0:1], v[108:109], v[0:1], v[0:1]
    v_pk_fma_f32 v[0:1], v[124:125], v[2:3], v[0:1]
    v_pk_fma_f32 v[2:3], v[108:109], v[2:3], v[2:3]
    v_pk_fma_f32 v[0:1], v[110:111], v[0:1], v[0:1]
    v_pk_fma_f32 v[0:1], v[126:127], v[2:3], v[0:1]
    v_pk_fma_f32 v[2:3], v[110:111], v[2:3], v[2:3]
    v_pk_fma_f32 v[0:1], v[112:113], v[0:1], v[0:1]
    v_pk_fma_f32 v[0:1], v[128:129], v[2:3], v[0:1]
    v_pk_fma_f32 v[2:3], v[112:113], v[2:3], v[2:3]
    v_pk_fma_f32 v[0:1], v[114:115], v[0:1], v[0:1]
    v_pk_fma_f32 v[0:1], v[130:131], v[2:3], v[0:1]
    v_pk_fma_f32 v[2:3], v[114:115], v[2:3], v[2:3]
    v_pk_fma_f32 v[0:1], v[116:117], v[0:1], v[0:1]
    v_pk_fma_f32 v[0:1], v[132:133], v[2:3], v[0:1]
    v_pk_fma_f32 v[2:3], v[116:117], v[2:3], v[2:3]
    v_pk_fma_f32 v[0:1], v[118:119], v[0:1], v[0:1]
    v_pk_fma_f32 v[0:1], v[134:135], v[2:3], v[0:1]
    v_pk_fma_f32 v[2:3], v[118:119], v[2:3], v[2:3]
    s_waitcnt lgkmcnt(0)
    s_cbranch_scc1 CEV
U_3:
    v_mfma_f32_16x16x32_bf16 v[104:107], v[72:75], v[152:155], v[136:139]
    s_add_u32 m0, s54, 6144
    v_rcp_f32 v2, v2
    v_mfma_f32_16x16x32_bf16 v[104:107], v[76:79], v[156:159], v[104:107]
    s_mov_b32 s73, 3
    v_rcp_f32 v3, v3
    v_mfma_f32_16x16x32_bf16 v[108:111], v[80:83], v[152:155], v[140:143]
    s_sub_u32 s50, s50, 1
    v_fma_f32 v0, v0, v2, s44
    v_fmac_f32 v0, v1, v3
    v_mfma_f32_16x16x32_bf16 v[108:111], v[84:87], v[156:159], v[108:111]
    s_cbranch_scc1 PEV
    v_add_u32 v246, 16, v246
RET_3:
    v_cvt_pk_bf16_f32 v0, v0, v0
    v_mfma_f32_16x16x32_bf16 v[112:115], v[88:91], v[152:155], v[144:147]
    v_exp_f32 v104, v104
    v_mfma_f32_16x16x32_bf16 v[112:115], v[92:95], v[156:159], v[112:115]
    v_exp_f32 v105, v105
    v_mfma_f32_16x16x32_bf16 v[116:119], v[96:99], v[152:155], v[148:151]
    s_sub_u32 s62, s62, 1
    v_exp_f32 v106, v106
    v_mfma_f32_16x16x32_bf16 v[116:119], v[100:103], v[156:159], v[116:119]
    v_exp_f32 v107, v107
    ds_write_b16 v249, v0
    ds_read_b64 v[236:237], v248
    ds_read_b64_tr_b16 v[168:169], v244 offset:6144
    ds_read_b64_tr_b16 v[170:171], v245 offset:6656
    ds_read_b64_tr_b16 v[172:173], v244 offset:7168
    ds_read_b64_tr_b16 v[174:175], v245 offset:7680
    ds_read_u8 v238, v246 offset:0
    ds_read_u8 v240, v246 offset:8
    ds_read_b32 v254, v253
    v_exp_f32 v108, v108
    v_exp_f32 v109, v109
    v_exp_f32 v110, v110
    v_exp_f32 v111, v111
    s_waitcnt lgkmcnt(7)
    v_mfma_f32_4x4x4_16b_bf16 v[176:179], v[236:237], v[160:161], v[176:179] cbsz:4 abid:0
    v_exp_f32 v112, v112
    v_exp_f32 v113, v113
    v_mfma_f32_4x4x4_16b_bf16 v[176:179], v[236:237], v[162:163], v[176:179] cbsz:4 abid:1
    v_exp_f32 v114, v114
    v_exp_f32 v115, v115
    v_mfma_f32_4x4x4_16b_bf16 v[176:179], v[236:237], v[164:165], v[176:179] cbsz:4 abid:2
    v_exp_f32 v116, v116
    v_exp_f32 v117, v117
    v_mfma_f32_4x4x4_16b_bf16 v[176:179], v[236:237], v[166:167], v[176:179] cbsz:4 abid:3
    v_exp_f32 v118, v118
    v_exp_f32 v119, v119
    s_waitcnt lgkmcnt(0)
    buffer_load_dwordx4 v[238:239], s[20:23], s72 idxen offen nt lds
    buffer_load_dwordx4 v[240:241], s[20:23], s51 idxen offen offset:1024 nt lds
    s_waitcnt vmcnt(5)
    ds_read_b128 v[152:155], v242 offset:0
    ds_read_b128 v[156:159], v243 offset:0
    .p2align 3
    v_pk_add_f32 v[2:3], v[104:105], 1.0 op_sel_hi:[1,0]
    v_pk_fma_f32 v[0:1], v[120:121], v[106:107], v[120:121]
    v_pk_fma_f32 v[0:1], v[122:123], v[2:3], v[0:1]
    v_pk_fma_f32 v[2:3], v[106:107], v[2:3], v[2:3]
    v_pk_fma_f32 v[0:1], v[108:109], v[0:1], v[0:1]
    v_pk_fma_f32 v[0:1], v[124:125], v[2:3], v[0:1]
    v_pk_fma_f32 v[2:3], v[108:109], v[2:3], v[2:3]
    v_pk_fma_f32 v[0:1], v[110:111], v[0:1], v[0:1]
    v_pk_fma_f32 v[0:1], v[126:127], v[2:3], v[0:1]
    v_pk_fma_f32 v[2:3], v[110:111], v[2:3], v[2:3]
    v_pk_fma_f32 v[0:1], v[112:113], v[0:1], v[0:1]
    v_pk_fma_f32 v[0:1], v[128:129], v[2:3], v[0:1]
    v_pk_fma_f32 v[2:3], v[112:113], v[2:3], v[2:3]
    v_pk_fma_f32 v[0:1], v[114:115], v[0:1], v[0:1]
    v_pk_fma_f32 v[0:1], v[130:131], v[2:3], v[0:1]
    v_pk_fma_f32 v[2:3], v[114:115], v[2:3], v[2:3]
    v_pk_fma_f32 v[0:1], v[116:117], v[0:1], v[0:1]
    v_pk_fma_f32 v[0:1], v[132:133], v[2:3], v[0:1]
    v_pk_fma_f32 v[2:3], v[116:117], v[2:3], v[2:3]
    v_pk_fma_f32 v[0:1], v[118:119], v[0:1], v[0:1]
    v_pk_fma_f32 v[0:1], v[134:135], v[2:3], v[0:1]
    v_pk_fma_f32 v[2:3], v[118:119], v[2:3], v[2:3]
    s_waitcnt lgkmcnt(0)
    s_cbranch_scc0 U_0
CEV:
    s_cmp_eq_u32 s76, 0
    s_cbranch_scc1 EPI
    s_mov_b32 s53, s52
    s_and_b32 s52, s68, 0xffff
    s_lshr_b64 s[68:69], s[68:69], 16
    s_sub_u32 s75, s75, 16
    s_bitcmp1_b32 s52, 6
    s_cbranch_scc1 DRAIN
BPF:
    s_and_b32 s57, s52, 63
    s_mul_i32 s57, s57, 528
    s_add_u32 s57, s57, 83200
    v_lshl_add_u32 v6, v252, 1, s57
    v_add_u32 v7, s57, v252
    ds_read_b128 v[104:107], v6 offset:0
    ds_read_b128 v[108:111], v6 offset:16
    ds_read_b128 v[144:147], v251 offset:12288
    ds_read_b128 v[148:151], v251 offset:13312
    ds_read_b128 v[112:115], v6 offset:128
    ds_read_b128 v[116:119], v6 offset:144
    s_mov_b32 s62, 0
    s_mov_b32 s76, 0
    s_cmp_lg_u32 s77, 0
    s_waitcnt lgkmcnt(4)
    .p2align 3
    v_pk_fma_f32 v[136:137], v[8:9], v[104:105], v[180:181]
    v_pk_fma_f32 v[138:139], v[10:11], v[106:107], v[182:183]
    v_pk_fma_f32 v[140:141], v[12:13], v[108:109], v[184:185]
    v_pk_fma_f32 v[142:143], v[14:15], v[110:111], v[186:187]
    v_cvt_pk_bf16_f32 v72, v136, v137
    v_cvt_pk_bf16_f32 v73, v138, v139
    v_cvt_pk_bf16_f32 v74, v140, v141
    v_cvt_pk_bf16_f32 v75, v142, v143
    v_pk_fma_f32 v[136:137], v[24:25], v[104:105], v[196:197]
    v_pk_fma_f32 v[138:139], v[26:27], v[106:107], v[198:199]
    v_pk_fma_f32 v[140:141], v[28:29], v[108:109], v[200:201]
    v_pk_fma_f32 v[142:143], v[30:31], v[110:111], v[202:203]
    v_cvt_pk_bf16_f32 v80, v136, v137
    v_cvt_pk_bf16_f32 v81, v138, v139
    v_cvt_pk_bf16_f32 v82, v140, v141
    v_cvt_pk_bf16_f32 v83, v142, v143
    v_pk_fma_f32 v[136:137], v[40:41], v[104:105], v[212:213]
    v_pk_fma_f32 v[138:139], v[42:43], v[106:107], v[214:215]
    v_pk_fma_f32 v[140:141], v[44:45], v[108:109], v[216:217]
    v_pk_fma_f32 v[142:143], v[46:47], v[110:111], v[218:219]
    v_cvt_pk_bf16_f32 v88, v136, v137
    v_cvt_pk_bf16_f32 v89, v138, v139
    v_cvt_pk_bf16_f32 v90, v140, v141
    v_cvt_pk_bf16_f32 v91, v142, v143
    s_waitcnt lgkmcnt(0)
    .p2align 3
    v_pk_fma_f32 v[144:145], v[56:57], v[104:105], v[144:145]
    v_pk_fma_f32 v[146:147], v[58:59], v[106:107], v[146:147]
    v_pk_fma_f32 v[148:149], v[60:61], v[108:109], v[148:149]
    v_pk_fma_f32 v[150:151], v[62:63], v[110:111], v[150:151]
    v_cvt_pk_bf16_f32 v96, v144, v145
    v_cvt_pk_bf16_f32 v97, v146, v147
    v_cvt_pk_bf16_f32 v98, v148, v149
    v_cvt_pk_bf16_f32 v99, v150, v151
    ds_read_b128 v[136:139], v7 offset:256
    ds_read_b128 v[140:143], v7 offset:320
    ds_read_b128 v[144:147], v7 offset:384
    ds_read_b128 v[148:151], v7 offset:448
    v_pk_fma_f32 v[104:105], v[16:17], v[112:113], v[188:189]
    v_pk_fma_f32 v[106:107], v[18:19], v[114:115], v[190:191]
    v_pk_fma_f32 v[108:109], v[20:21], v[116:117], v[192:193]
    v_pk_fma_f32 v[110:111], v[22:23], v[118:119], v[194:195]
    v_cvt_pk_bf16_f32 v76, v104, v105
    v_cvt_pk_bf16_f32 v77, v106, v107
    v_cvt_pk_bf16_f32 v78, v108, v109
    v_cvt_pk_bf16_f32 v79, v110, v111
    v_pk_fma_f32 v[104:105], v[32:33], v[112:113], v[204:205]
    v_pk_fma_f32 v[106:107], v[34:35], v[114:115], v[206:207]
    v_pk_fma_f32 v[108:109], v[36:37], v[116:117], v[208:209]
    v_pk_fma_f32 v[110:111], v[38:39], v[118:119], v[210:211]
    v_cvt_pk_bf16_f32 v84, v104, v105
    v_cvt_pk_bf16_f32 v85, v106, v107
    v_cvt_pk_bf16_f32 v86, v108, v109
    v_cvt_pk_bf16_f32 v87, v110, v111
    v_pk_fma_f32 v[104:105], v[48:49], v[112:113], v[220:221]
    v_pk_fma_f32 v[106:107], v[50:51], v[114:115], v[222:223]
    v_pk_fma_f32 v[108:109], v[52:53], v[116:117], v[224:225]
    v_pk_fma_f32 v[110:111], v[54:55], v[118:119], v[226:227]
    v_cvt_pk_bf16_f32 v92, v104, v105
    v_cvt_pk_bf16_f32 v93, v106, v107
    v_cvt_pk_bf16_f32 v94, v108, v109
    v_cvt_pk_bf16_f32 v95, v110, v111
    v_pk_fma_f32 v[104:105], v[64:65], v[112:113], v[228:229]
    v_pk_fma_f32 v[106:107], v[66:67], v[114:115], v[230:231]
    v_pk_fma_f32 v[108:109], v[68:69], v[116:117], v[232:233]
    v_pk_fma_f32 v[110:111], v[70:71], v[118:119], v[234:235]
    v_cvt_pk_bf16_f32 v100, v104, v105
    v_cvt_pk_bf16_f32 v101, v106, v107
    v_cvt_pk_bf16_f32 v102, v108, v109
    v_cvt_pk_bf16_f32 v103, v110, v111
    s_waitcnt lgkmcnt(0)
    s_cbranch_scc1 BP_X
NEXT:
    s_cmp_eq_u32 s73, 0
    s_cbranch_scc1 U_1
    s_cmp_eq_u32 s73, 1
    s_cbranch_scc1 U_2
    s_cmp_eq_u32 s73, 2
    s_cbranch_scc1 U_3
    s_branch U_0
EPI:
    s_and_b32 s56, s53, 0x7f
    v_pk_add_f32 v[4:5], v[176:177], v[178:179]
    v_add_f32 v4, v4, v5
    v_lshl_add_u32 v5, s56, 8, v250
    v_mul_f32 v4, s46, v4
    s_bitcmp1_b32 s53, 7
    v_cmp_class_f32_e64 vcc, v4, s45
    v_mov_b64 v[176:177], 0
    v_mov_b64 v[178:179], 0
    ds_write_b32 v5, v4
    s_cbranch_scc1 SLOW
    s_cbranch_vccnz SLOW
EPI_R:
    s_bitcmp1_b32 s52, 6
    s_cbranch_scc1 L_DONE
EPI_C:
    s_bfe_u32 s62, s52, 0x40008
    s_sub_u32 s62, s62, 2
    s_mov_b32 s76, 1
    s_cmp_eq_u32 s73, 0
    s_cbranch_scc1 U_1
    s_cmp_eq_u32 s73, 1
    s_cbranch_scc1 U_2
    s_cmp_eq_u32 s73, 2
    s_cbranch_scc1 U_3
    s_branch U_0
PEV:
    s_cmp_eq_u32 s55, 0
    s_cbranch_scc1 P_DR
ADV:
    v_readfirstlane_b32 s66, v254
    s_mov_b32 s67, 0
    s_and_b32 s56, s66, 63
    s_bfe_u32 s50, s66, 0x40008
    s_cbranch_scc0 AW
    s_lshr_b32 s57, s56, 3
    s_mul_i32 s51, s56, 25600
    s_mul_i32 s57, s57, 52224000
    s_add_u32 s51, s51, s57
    v_lshl_add_u32 v246, s56, 8, v247
    s_add_u32 s51, s51, s49
    s_add_u32 s72, s51, 1024
    s_lshl_b64 s[64:65], s[66:67], s75
    s_or_b64 s[68:69], s[68:69], s[64:65]
    s_add_u32 s75, s75, 16
    s_mov_b32 s55, 0
    s_sub_u32 s50, s50, 3
    s_cbranch_scc1 P_2
P_RET:
    s_cmp_eq_u32 s73, 0
    s_cbranch_scc1 RET_0
    s_cmp_eq_u32 s73, 1
    s_cbranch_scc1 RET_1
    s_cmp_eq_u32 s73, 2
    s_cbranch_scc1 RET_2
    s_branch RET_3
P_DR:
    v_add_u32 v246, 16, v246
P_D2:
    s_mov_b64 exec, 1
    v_mov_b32 v253, 4
    ds_add_rtn_u32 v253, v251, v253 offset:17600
    s_mov_b64 exec, -1
    s_mov_b32 s50, 1
    s_mov_b32 s55, 1
    s_cmp_eq_u32 s73, 0
    s_cbranch_scc1 RET_0
    s_cmp_eq_u32 s73, 1
    s_cbranch_scc1 RET_1
    s_cmp_eq_u32 s73, 2
    s_cbranch_scc1 RET_2
    s_branch RET_3
P_2:
    s_bitcmp1_b32 s66, 6
    s_cbranch_scc0 P_D2
    v_mov_b32 v246, 16896
    s_movk_i32 s50, 0x100
    s_branch P_RET
DRAIN:
    v_rcp_f32 v2, v2
    v_rcp_f32 v3, v3
    v_fma_f32 v0, v0, v2, s44
    v_fmac_f32 v0, v1, v3
    v_cvt_pk_bf16_f32 v0, v0, v0
    s_bitcmp1_b32 s73, 0
    ds_write_b16 v249, v0
    ds_read_b64 v[236:237], v248
    s_waitcnt lgkmcnt(0)
    s_cbranch_scc1 DRAIN1
    v_mfma_f32_4x4x4_16b_bf16 v[176:179], v[236:237], v[160:161], v[176:179] cbsz:4 abid:0
    s_nop 1
    v_mfma_f32_4x4x4_16b_bf16 v[176:179], v[236:237], v[162:163], v[176:179] cbsz:4 abid:1
    s_nop 1
    v_mfma_f32_4x4x4_16b_bf16 v[176:179], v[236:237], v[164:165], v[176:179] cbsz:4 abid:2
    s_nop 1
    v_mfma_f32_4x4x4_16b_bf16 v[176:179], v[236:237], v[166:167], v[176:179] cbsz:4 abid:3
    s_nop 2
    s_branch EPI
DRAIN1:
    v_mfma_f32_4x4x4_16b_bf16 v[176:179], v[236:237], v[168:169], v[176:179] cbsz:4 abid:0
    s_nop 1
    v_mfma_f32_4x4x4_16b_bf16 v[176:179], v[236:237], v[170:171], v[176:179] cbsz:4 abid:1
    s_nop 1
    v_mfma_f32_4x4x4_16b_bf16 v[176:179], v[236:237], v[172:173], v[176:179] cbsz:4 abid:2
    s_nop 1
    v_mfma_f32_4x4x4_16b_bf16 v[176:179], v[236:237], v[174:175], v[176:179] cbsz:4 abid:3
    s_nop 2
    s_branch EPI
L_DONE:
    s_lshl_b32 s56, s48, 11
    s_add_u32 s56, s56, 133376
    v_lshl_add_u32 v0, v251, 1, s56
    s_lshl_b32 s56, s48, 18
    s_waitcnt lgkmcnt(0)
    s_barrier
    ds_read_b128 v[104:107], v0 offset:0
    ds_read_b128 v[108:111], v0 offset:16
    s_waitcnt lgkmcnt(0)
    v_cvt_pk_bf16_f32 v152, v104, v105
    v_cvt_pk_bf16_f32 v153, v106, v107
    v_cvt_pk_bf16_f32 v154, v108, v109
    v_cvt_pk_bf16_f32 v155, v110, v111
    buffer_store_dwordx4 v[152:155], v251, s[28:31], s56 offen nt
L_FIN:
    s_endpgm
AW:
    s_sleep 1
    ds_read_b32 v254, v253
    s_waitcnt lgkmcnt(0)
    s_branch ADV
DRAW_P:
    s_mov_b64 exec, 1
    v_mov_b32 v253, 4
    ds_add_rtn_u32 v253, v251, v253 offset:17600
    s_mov_b64 exec, -1
    s_add_u32 s50, s50, 2
    s_mov_b32 s55, 1
    s_waitcnt lgkmcnt(0)
    ds_read_b32 v254, v253
    s_branch DRET_P
BP_X:
    s_cmp_eq_u32 s77, 1
    s_mov_b32 s77, 0
    s_cbranch_scc1 SLOW_W
    s_branch EPI_C
SLOW:
    s_bitcmp1_b32 s53, 6
    s_cbranch_scc1 EPI_R
    s_mov_b32 s74, s52
    s_mov_b32 s52, s53
    s_mov_b32 s77, 1
    ds_write_b32 v5, v176
    s_branch BPF
SLOW_W:
    s_mov_b32 s52, s74
    s_and_b32 s56, s53, 63
    s_lshr_b32 s57, s53, 12
    s_bfe_u32 s59, s53, 0x40008
    s_lshl4_add_u32 s57, s56, s57
    s_lshl_b32 s57, s57, 4
    s_add_u32 s74, s57, 116992
    s_bitcmp1_b32 s53, 7
    s_cselect_b64 s[66:67], -1, 0
    s_cselect_b32 s59, 13, s59
    v_bfe_u32 v204, v251, 4, 4
    v_mov_b32 v207, v252
    v_mov_b64 v[180:181], 0
    v_mov_b64 v[182:183], 0
    v_mov_b64 v[184:185], 0
    v_mov_b64 v[186:187], 0
    v_mov_b64 v[188:189], 0
    v_mov_b64 v[190:191], 0
    v_mov_b64 v[192:193], 0
    v_mov_b64 v[194:195], 0
    s_lshr_b32 s58, s56, 3
    s_mul_i32 s57, s56, 25600
    s_mul_i32 s58, s58, 52224000
    s_add_u32 s57, s57, s58
    s_add_u32 s57, s57, s49
    s_lshr_b32 s64, s56, 3
    s_mul_i32 s58, s56, 400
    s_mul_i32 s64, s64, 816000
    s_add_u32 s58, s58, s64
SLOW_L:
    v_add_u32 v205, s74, v204
    ds_read_u8 v206, v205
    s_waitcnt lgkmcnt(0)
    v_cndmask_b32_e64 v206, v206, v204, s[66:67]
    v_lshlrev_b32 v205, 1, v206
    buffer_load_dwordx4 v[196:199], v[206:207], s[20:23], s57 idxen offen offset:1024
    buffer_load_dwordx4 v[200:203], v[206:207], s[20:23], s57 idxen offen offset:1088
    buffer_load_ushort v205, v205, s[24:27], s58 offen
    v_cmp_gt_u32 vcc, 200, v206
    v_add_u32 v204, 16, v204
    s_waitcnt vmcnt(0)
    v_mfma_f32_16x16x32_bf16 v[104:107], v[72:75], v[196:199], v[136:139]
    v_mfma_f32_16x16x32_bf16 v[104:107], v[76:79], v[200:203], v[104:107]
    v_mfma_f32_16x16x32_bf16 v[108:111], v[80:83], v[196:199], v[140:143]
    v_mfma_f32_16x16x32_bf16 v[108:111], v[84:87], v[200:203], v[108:111]
    v_mfma_f32_16x16x32_bf16 v[112:115], v[88:91], v[196:199], v[144:147]
    v_mfma_f32_16x16x32_bf16 v[112:115], v[92:95], v[200:203], v[112:115]
    v_mfma_f32_16x16x32_bf16 v[116:119], v[96:99], v[196:199], v[148:151]
    v_mfma_f32_16x16x32_bf16 v[116:119], v[100:103], v[200:203], v[116:119]
    v_lshlrev_b32 v205, 16, v205
    v_cndmask_b32 v205, 0, v205, vcc
    s_nop 7
    v_exp_f32 v104, v104
    v_exp_f32 v105, v105
    v_exp_f32 v106, v106
    v_exp_f32 v107, v107
    v_exp_f32 v108, v108
    v_exp_f32 v109, v109
    v_exp_f32 v110, v110
    v_exp_f32 v111, v111
    v_exp_f32 v112, v112
    v_exp_f32 v113, v113
    v_exp_f32 v114, v114
    v_exp_f32 v115, v115
    v_exp_f32 v116, v116
    v_exp_f32 v117, v117
    v_exp_f32 v118, v118
    v_exp_f32 v119, v119
    v_add_f32 v104, 1.0, v104
    v_add_f32 v105, 1.0, v105
    v_add_f32 v106, 1.0, v106
    v_add_f32 v107, 1.0, v107
    v_add_f32 v108, 1.0, v108
    v_add_f32 v109, 1.0, v109
    v_add_f32 v110, 1.0, v110
    v_add_f32 v111, 1.0, v111
    v_add_f32 v112, 1.0, v112
    v_add_f32 v113, 1.0, v113
    v_add_f32 v114, 1.0, v114
    v_add_f32 v115, 1.0, v115
    v_add_f32 v116, 1.0, v116
    v_add_f32 v117, 1.0, v117
    v_add_f32 v118, 1.0, v118
    v_add_f32 v119, 1.0, v119
    v_rcp_f32 v104, v104
    v_rcp_f32 v105, v105
    v_rcp_f32 v106, v106
    v_rcp_f32 v107, v107
    v_rcp_f32 v108, v108
    v_rcp_f32 v109, v109
    v_rcp_f32 v110, v110
    v_rcp_f32 v111, v111
    v_rcp_f32 v112, v112
    v_rcp_f32 v113, v113
    v_rcp_f32 v114, v114
    v_rcp_f32 v115, v115
    v_rcp_f32 v116, v116
    v_rcp_f32 v117, v117
    v_rcp_f32 v118, v118
    v_rcp_f32 v119, v119
    v_mul_f32 v208, v104, v120
    v_fmac_f32 v208, v105, v121
    v_fmac_f32 v208, v106, v122
    v_fmac_f32 v208, v107, v123
    v_fmac_f32 v208, v108, v124
    v_fmac_f32 v208, v109, v125
    v_fmac_f32 v208, v110, v126
    v_fmac_f32 v208, v111, v127
    v_fmac_f32 v208, v112, v128
    v_fmac_f32 v208, v113, v129
    v_fmac_f32 v208, v114, v130
    v_fmac_f32 v208, v115, v131
    v_fmac_f32 v208, v116, v132
    v_fmac_f32 v208, v117, v133
    v_fmac_f32 v208, v118, v134
    v_fmac_f32 v208, v119, v135
    v_mov_b32 v209, v208
    s_nop 1
    v_permlane32_swap_b32 v208, v209
    v_add_f32 v208, v208, v209
    v_mov_b32 v209, v208
    s_nop 1
    v_permlane16_swap_b32 v208, v209
    v_add_f32 v208, v208, v209
    v_mul_f32 v208, s46, v208
    v_add_f32 v208, s63, v208
    v_mul_f32 v208, v208, v205
    v_lshlrev_b32 v209, 16, v196
    v_and_b32 v210, 0xffff0000, v196
    v_fmac_f32 v180, v208, v209
    v_fmac_f32 v181, v208, v210
    v_lshlrev_b32 v209, 16, v197
    v_and_b32 v210, 0xffff0000, v197
    v_fmac_f32 v182, v208, v209
    v_fmac_f32 v183, v208, v210
    v_lshlrev_b32 v209, 16, v198
    v_and_b32 v210, 0xffff0000, v198
    v_fmac_f32 v184, v208, v209
    v_fmac_f32 v185, v208, v210
    v_lshlrev_b32 v209, 16, v199
    v_and_b32 v210, 0xffff0000, v199
    v_fmac_f32 v186, v208, v209
    v_fmac_f32 v187, v208, v210
    v_lshlrev_b32 v209, 16, v200
    v_and_b32 v210, 0xffff0000, v200
    v_fmac_f32 v188, v208, v209
    v_fmac_f32 v189, v208, v210
    v_lshlrev_b32 v209, 16, v201
    v_and_b32 v210, 0xffff0000, v201
    v_fmac_f32 v190, v208, v209
    v_fmac_f32 v191, v208, v210
    v_lshlrev_b32 v209, 16, v202
    v_and_b32 v210, 0xffff0000, v202
    v_fmac_f32 v192, v208, v209
    v_fmac_f32 v193, v208, v210
    v_lshlrev_b32 v209, 16, v203
    v_and_b32 v210, 0xffff0000, v203
    v_fmac_f32 v194, v208, v209
    v_fmac_f32 v195, v208, v210
    s_sub_u32 s59, s59, 1
    s_cmp_lg_u32 s59, 0
    s_cbranch_scc1 SLOW_L
    v_readfirstlane_b32 s56, v5
    s_nop 1
    v_lshl_add_u32 v208, v252, 1, s56
    ds_add_f32 v208, v180 offset:0
    ds_add_f32 v208, v181 offset:4
    ds_add_f32 v208, v182 offset:8
    ds_add_f32 v208, v183 offset:12
    ds_add_f32 v208, v184 offset:16
    ds_add_f32 v208, v185 offset:20
    ds_add_f32 v208, v186 offset:24
    ds_add_f32 v208, v187 offset:28
    ds_add_f32 v208, v188 offset:128
    ds_add_f32 v208, v189 offset:132
    ds_add_f32 v208, v190 offset:136
    ds_add_f32 v208, v191 offset:140
    ds_add_f32 v208, v192 offset:144
    ds_add_f32 v208, v193 offset:148
    ds_add_f32 v208, v194 offset:152
    ds_add_f32 v208, v195 offset:156
    s_waitcnt lgkmcnt(0)
    s_bitcmp1_b32 s52, 6
    s_cbranch_scc1 L_DONE
    ds_read_b128 v[180:183], v251 offset:0
    ds_read_b128 v[184:187], v251 offset:1024
    ds_read_b128 v[196:199], v251 offset:4096
    ds_read_b128 v[200:203], v251 offset:5120
    ds_read_b128 v[212:215], v251 offset:8192
    ds_read_b128 v[216:219], v251 offset:9216
    ds_read_b128 v[188:191], v251 offset:2048
    ds_read_b128 v[192:195], v251 offset:3072
    ds_read_b128 v[204:207], v251 offset:6144
    ds_read_b128 v[208:211], v251 offset:7168
    ds_read_b128 v[220:223], v251 offset:10240
    ds_read_b128 v[224:227], v251 offset:11264
    ds_read_b128 v[228:231], v251 offset:14336
    ds_read_b128 v[232:235], v251 offset:15360
    s_mov_b32 s77, 2
    s_branch BPF
L_END:
    s_endpgm
.section .rodata,"a"
.p2align 6
.amdhsa_kernel standalone__sequential_behavior_din__recsys_kernel
  .amdhsa_next_free_vgpr 255
  .amdhsa_next_free_sgpr 78
  .amdhsa_accum_offset 256
  .amdhsa_group_segment_fixed_size 0
  .amdhsa_kernarg_size 80
  .amdhsa_user_sgpr_count 2
  .amdhsa_user_sgpr_kernarg_segment_ptr 1
  .amdhsa_system_sgpr_workgroup_id_x 1
.end_amdhsa_kernel
```

```asm
; @launch grid=(256,1,1) block=(512,1,1) lds=153856
.amdgcn_target "amdgcn-amd-amdhsa--gfx950"
.text
.globl standalone__sequential_behavior_din__recsys_kernel
.p2align 8
.type standalone__sequential_behavior_din__recsys_kernel,@function
standalone__sequential_behavior_din__recsys_kernel:
    s_cmpk_ge_u32 s2, 256
    s_cbranch_scc1 L_END
    s_load_dwordx16 s[4:19], s[0:1], 0
    s_setprio 3
    v_lshrrev_b32 v1, 6, v0
    v_and_b32 v176, 63, v0
    v_readfirstlane_b32 s48, v1
    s_getpc_b64 s[40:41]
L_PC:
    s_cmp_lt_u32 s48, 5
    s_cbranch_scc1 P_NC
    s_mov_b32 s42, L_END-L_PC
    s_mov_b32 s43, 0x20000
    v_subrev_u32 v150, 320, v0
    v_lshlrev_b32 v150, 6, v150
    buffer_load_dword v150, v150, s[40:43], 0 offen
P_NC:
    v_and_b32 v2, 31, v0
    v_bfe_u32 v3, v0, 5, 1
    v_cmp_gt_u32 vcc, 25, v2
    v_mul_u32_u24 v4, 400, v3
    v_lshl_add_u32 v179, v2, 4, v4
    v_bfrev_b32 v4, 8
    v_cndmask_b32 v179, v4, v179, vcc
    s_mul_i32 s57, s2, 3200
    s_sub_u32 s26, 6553600, s57
    s_lshr_b32 s59, s48, 2
    s_mul_i32 s71, s48, 800
    s_mul_i32 s59, s59, 816000
    s_add_u32 s71, s71, s59
    s_mov_b32 s27, 0x20000
    s_lshl_b32 s74, s48, 12
    s_lshl_b32 s53, s2, 10
    v_lshlrev_b32 v251, 4, v176
    v_lshlrev_b32 v120, 1, v176
    v_and_b32 v120, 32, v120
    v_xor_b32 v120, v120, v251
    v_xor_b32 v121, 64, v120
    s_mov_b32 s38, 32768
    s_mov_b32 s39, s27
    s_lshl_b32 s58, s48, 18
    s_sub_u32 s34, 2097152, s53
    s_mov_b32 s35, s27
    s_add_u32 m0, s74, 121088
    v_and_b32 v178, 15, v176
    v_lshrrev_b32 v177, 4, v176
    v_lshlrev_b32 v252, 4, v177
    v_mul_u32_u24 v208, 0x80008, v2
    v_lshrrev_b32 v238, 3, v176
    v_add_u32 v208, 0x10000, v208
    v_cmp_gt_u32 vcc, 32, v176
    s_waitcnt lgkmcnt(0)
    s_add_u32 s24, s8, s57
    s_addc_u32 s25, s9, 0
    s_mov_b64 s[36:37], s[10:11]
    buffer_load_dwordx4 v[204:207], v179, s[24:27], s71 offen offset:0 nt
    s_setprio 0
    s_add_u32 s32, s4, s53
    s_addc_u32 s33, s5, 0
    s_load_dword s63, s[16:17], 0
    s_cmp_lg_u32 s48, 0
    s_cbranch_scc1 P_LJ
    v_mov_b32 v146, s12
    v_mov_b32 v147, s13
    v_mov_b32 v148, s14
    v_mov_b32 v149, s15
    v_lshlrev_b32 v4, 2, v2
    v_cndmask_b32 v146, v146, v148, vcc
    v_cndmask_b32 v147, v147, v149, vcc
    v_add_co_u32 v146, vcc, v146, v4
    s_nop 1
    v_addc_co_u32 v147, vcc, 0, v147, vcc
    global_load_dword v146, v[146:147], off
P_LJ:
    buffer_load_dwordx4 v[124:127], v251, s[32:35], s58 offen nt
    buffer_load_dwordx4 v120, s[36:39], s74 offen offset:0 lds
    buffer_load_dwordx4 v121, s[36:39], s74 offen offset:1024 lds
    s_lshl1_add_u32 s54, s74, 17664
    s_mul_i32 s49, s2, 204800
    s_lshl_b32 s57, s48, 9
    v_add_u32 v247, 116992, v238
    v_add_u32 v246, s57, v247
    s_add_u32 s56, s57, 116992
    v_add_u32 v209, 0x20002, v208
    v_add_u32 v210, 0x40004, v208
    v_add_u32 v211, 0x60006, v208
    s_sub_u32 s20, s6, 1024
    s_subb_u32 s21, s7, 0
    s_or_b32 s21, s21, 0x800000
    s_movk_i32 s22, 200
    s_mov_b32 s23, s27
    s_movk_i32 s61, 0x3f80
    v_lshrrev_b32 v216, 1, v251
    v_and_b32 v213, 0x100, v216
    v_mov_b64 v[214:215], -1
    v_lshlrev_b32 v250, 2, v176
    v_bfrev_b32 v2, v238
    v_lshrrev_b32 v2, 28, v2
    v_and_b32 v2, 6, v2
    v_xor_b32 v2, v2, v176
    v_and_b32 v2, 7, v2
    v_mul_u32_u24 v143, 528, v238
    v_lshlrev_b32 v239, 4, v2
    v_lshlrev_b32 v241, 4, v2
    v_lshlrev_b32 v153, 4, v2
    v_lshlrev_b32 v155, 4, v2
    s_add_u32 s28, s18, s53
    s_addc_u32 s29, s19, 0
    s_sub_u32 s30, 2097152, s53
    s_mov_b32 s31, s27
    s_mov_b32 s60, 0xbfb8aa3b
    s_mov_b32 s42, 0x21800000
    s_mov_b32 s46, 0x2b800000
    s_lshr_b32 s59, s48, 2
    s_mul_i32 s51, s48, 51200
    s_mul_i32 s59, s59, 52224000
    s_add_u32 s51, s51, s59
    s_add_u32 s51, s51, s49
    s_add_u32 s72, s51, 1024
    v_bfrev_b32 v2, v178
    v_lshrrev_b32 v2, 28, v2
    v_and_b32 v2, 6, v2
    v_xor_b32 v2, v2, v177
    v_lshl_add_u32 v2, v2, 4, s54
    v_lshl_add_u32 v242, v178, 7, v2
    v_xor_b32 v243, 64, v242
    v_and_b32 v3, 3, v176
    v_bfe_u32 v2, v176, 2, 2
    v_lshlrev_b32 v7, 3, v3
    v_lshl_add_u32 v7, v2, 7, v7
    v_and_b32 v6, 8, v176
    v_lshlrev_b32 v6, 3, v6
    v_lshl_add_u32 v244, v177, 5, v7
    v_xor_b32 v244, v244, v6
    v_add_u32 v244, s54, v244
    v_xor_b32 v245, 32, v244
    s_lshl_b32 s57, s48, 7
    s_add_u32 s57, s57, 150016
    v_lshl_add_u32 v249, v2, 2, v177
    v_lshl_add_u32 v249, v249, 2, v3
    v_lshl_add_u32 v249, v249, 1, s57
    v_lshl_add_u32 v248, v178, 3, s57
    v_and_b32 v6, 0x60, v250
    v_or_b32 v6, v6, v7
    v_lshl_add_u32 v136, v177, 10, v6
    s_mul_i32 s57, s48, 0x1010
    s_and_b32 s57, s57, 0x1060
    v_xor_b32 v144, s57, v136
    v_add_u32 v136, 121088, v136
    v_add_u32 v144, 121088, v144
    v_xor_b32 v137, 32, v136
    v_xor_b32 v138, 64, v136
    v_xor_b32 v139, 96, v136
    s_and_b32 s59, s48, 4
    s_lshl_b32 s59, s59, 4
    v_xor_b32 v140, s59, v136
    v_xor_b32 v141, 32, v140
    s_and_b32 s57, s48, 3
    s_mul_i32 s57, s57, 8448
    s_lshl1_add_u32 s57, s59, s57
    s_add_u32 s57, s57, 83200
    v_mul_u32_u24 v145, 528, v178
    v_add3_u32 v145, v145, v252, s57
    v_lshl_add_u32 v142, s59, 1, v252
    s_mul_i32 s57, s48, 4224
    s_add_u32 s57, s57, 83200
    v_and_b32 v3, 0x70, v251
    v_add3_u32 v143, v143, v3, s57
    v_add_u32 v3, v143, v3
    s_lshl_b32 s57, s48, 11
    v_add_u32 v151, s57, v251
    s_mov_b32 s66, 0x1b0a0100
    s_mov_b32 s67, 0x966d4c33
    s_lshl_b32 s57, s48, 3
    s_lshr_b64 s[66:67], s[66:67], s57
    s_and_b32 s47, s66, 7
    s_bfe_u32 s70, s66, 0x50003
    s_lshl1_add_u32 s70, s70, 16
    s_mul_i32 s71, s70, 400
    buffer_load_dwordx4 v120, s[36:39], s74 offen offset:2048 lds
    buffer_load_dwordx4 v121, s[36:39], s74 offen offset:3072 lds
    s_cmp_eq_u32 s48, 0
    s_waitcnt vmcnt(6) lgkmcnt(0)
    s_cbranch_scc1 P_M0
    s_waitcnt vmcnt(5)
P_M0:
    s_call_b64 s[36:37], CMP
    s_branch P_C
    .p2align 3
CMP:
    v_bcnt_u32_b32 v7, v204, 0
    v_bcnt_u32_b32 v7, v205, v7
    v_bcnt_u32_b32 v7, v206, v7
    v_bcnt_u32_b32 v7, v207, v7
    v_add_u32 v4, s56, v216
    v_mov_b32 v6, v7
    ds_write_b64 v4, v[214:215]
    v_cmp_eq_u16_e64 s[4:5], s61, v204
    v_cmp_eq_u16_sdwa s[6:7], v204, s61 src0_sel:WORD_1 src1_sel:WORD_0
    v_add_u32_dpp v6, v6, v6 row_shr:1 row_mask:0xf bank_mask:0xf bound_ctrl:0
    v_cmp_eq_u16_e64 s[8:9], s61, v205
    v_cmp_eq_u16_sdwa s[10:11], v205, s61 src0_sel:WORD_1 src1_sel:WORD_0
    v_add_u32_dpp v6, v6, v6 row_shr:2 row_mask:0xf bank_mask:0xf bound_ctrl:0
    v_cmp_eq_u16_e64 s[12:13], s61, v206
    v_cmp_eq_u16_sdwa s[14:15], v206, s61 src0_sel:WORD_1 src1_sel:WORD_0
    v_add_u32_dpp v6, v6, v6 row_shr:4 row_mask:0xf bank_mask:0xf bound_ctrl:0
    v_cmp_eq_u16_e64 s[16:17], s61, v207
    v_cmp_eq_u16_sdwa s[18:19], v207, s61 src0_sel:WORD_1 src1_sel:WORD_0
    v_add_u32_dpp v6, v6, v6 row_shr:8 row_mask:0xf bank_mask:0xf bound_ctrl:0
    s_nop 1
    v_add_u32_dpp v6, v6, v6 row_bcast:15 row_mask:0xa bank_mask:0xf
    v_sub_u32 v6, v6, v7
    v_mul_u32_u24 v6, 9363, v6
    v_lshrrev_b32 v6, 16, v6
    v_min_u32 v6, 200, v6
    v_add3_u32 v226, v6, v213, s56
    v_readlane_b32 s59, v6, 31
    v_readlane_b32 s58, v6, 63
    v_addc_co_u32_e64 v227, vcc, 0, v226, s[4:5]
    v_addc_co_u32_e64 v228, vcc, 0, v227, s[6:7]
    v_addc_co_u32_e64 v229, vcc, 0, v228, s[8:9]
    v_addc_co_u32_e64 v230, vcc, 0, v229, s[10:11]
    v_addc_co_u32_e64 v231, vcc, 0, v230, s[12:13]
    v_addc_co_u32_e64 v232, vcc, 0, v231, s[14:15]
    v_addc_co_u32_e64 v233, vcc, 0, v232, s[16:17]
    v_addc_co_u32_e64 v234, vcc, 0, v233, s[18:19]
    s_mov_b64 exec, s[4:5]
    ds_write_b8 v226, v208
    s_mov_b64 exec, s[6:7]
    ds_write_b8_d16_hi v227, v208
    s_mov_b64 exec, s[8:9]
    ds_write_b8 v228, v209
    s_mov_b64 exec, s[10:11]
    ds_write_b8_d16_hi v229, v209
    s_mov_b64 exec, s[12:13]
    ds_write_b8 v230, v210
    s_mov_b64 exec, s[14:15]
    ds_write_b8_d16_hi v231, v210
    s_mov_b64 exec, s[16:17]
    ds_write_b8 v232, v211
    s_mov_b64 exec, s[18:19]
    ds_write_b8_d16_hi v233, v211
    s_mov_b64 exec, -1
    v_sub_u32 v6, v234, v226
    v_mul_u32_u24 v6, 7, v6
    v_cmp_ne_u32 vcc, v6, v7
    s_min_u32 s64, vcc_lo, 1
    s_min_u32 s65, vcc_hi, 1
    s_lshl_b64 s[64:65], s[64:65], 15
    s_or_b32 s57, s59, s64
    s_or_b32 s58, s58, s65
    s_setpc_b64 s[36:37]
P_C:
    ds_read_u8 v238, v246 offset:0
    ds_read_u8 v240, v246 offset:8
    ds_read_u8 v152, v246 offset:16
    ds_read_u8 v154, v246 offset:24
    s_add_u32 m0, s54, 0
    s_waitcnt lgkmcnt(3)
    buffer_load_dwordx4 v[238:239], s[20:23], s72 idxen offen nt lds
    s_waitcnt lgkmcnt(2)
    buffer_load_dwordx4 v[240:241], s[20:23], s51 idxen offen offset:1024 nt lds
    s_add_u32 m0, s54, 2048
    s_waitcnt lgkmcnt(1)
    buffer_load_dwordx4 v[152:153], s[20:23], s72 idxen offen nt lds
    s_waitcnt lgkmcnt(0)
    buffer_load_dwordx4 v[154:155], s[20:23], s51 idxen offen offset:1024 nt lds
    s_lshl_b32 s63, s63, 16
    s_cmp_lg_u32 s48, 0
    s_waitcnt vmcnt(8)
    s_cbranch_scc1 P_SW_J
    v_lshlrev_b32 v148, 16, v146
    v_and_b32 v149, 0xffff0000, v146
    v_mov_b32 v4, -1
    v_mov_b32 v5, 0
    v_mov_b32 v6, 0x240
    v_lshrrev_b32 v0, 1, v251
    ds_write2st64_b32 v250, v4, v5 offset0:66 offset1:67
    s_mov_b32 exec_hi, 0
    v_max3_f32 v2, abs(v148), abs(v149), abs(s63)
    v_ldexp_f32 v148, v148, 40
    v_ldexp_f32 v149, v149, 40
    v_cmp_le_f32 vcc, 0x33800000, v2
    s_mov_b32 exec_lo, 0x55
    v_mul_f32 v148, s42, v148
    v_mul_f32 v149, s42, v149
    s_mov_b32 exec_lo, -1
    ds_write_b32 v250, v6 offset:17408
    s_mov_b32 exec_hi, -1
    s_movk_i32 s56, 0x3ff
    s_cmp_lg_u64 vcc, 0
    s_cmovk_i32 s56, 0x207
    v_mov_b32 v6, 17184
    v_mov_b32 v7, s56
    ds_write_b64 v0, v[148:149] offset:16384
    ds_write_b64 v5, v[6:7] offset:17600
P_SW_J:
    ds_write_b128 v143, v[124:127] offset:256
    ds_write_b128 v143, v[124:127] offset:384
    s_waitcnt vmcnt(4) lgkmcnt(0)
    s_barrier
    ds_read_b64_tr_b16 v[218:219], v144 offset:0
    ds_read_b64_tr_b16 v[220:221], v144 offset:512
    ds_read_b64_tr_b16 v[222:223], v144 offset:16384
    ds_read_b64_tr_b16 v[224:225], v144 offset:16896
    ds_read_b128 v[160:163], v145 offset:256
    ds_read_b128 v[164:167], v145 offset:320
    ds_read_b128 v[104:107], v142 offset:16640
    ds_read_b128 v[108:111], v142 offset:16704
    ds_read_b64_tr_b16 v[40:41], v140 offset:8192
    ds_read_b64_tr_b16 v[42:43], v140 offset:8704
    ds_read_b64_tr_b16 v[44:45], v141 offset:8192
    ds_read_b64_tr_b16 v[46:47], v141 offset:8704
    ds_read_b64_tr_b16 v[48:49], v140 offset:12288
    ds_read_b64_tr_b16 v[50:51], v140 offset:12800
    ds_read_b64_tr_b16 v[52:53], v141 offset:12288
    ds_read_b64_tr_b16 v[54:55], v141 offset:12800
    ds_read_b64_tr_b16 v[56:57], v140 offset:16384
    ds_read_b64_tr_b16 v[58:59], v140 offset:16896
    ds_read_b64_tr_b16 v[60:61], v141 offset:16384
    ds_read_b64_tr_b16 v[62:63], v141 offset:16896
    ds_read_b64_tr_b16 v[64:65], v140 offset:20480
    ds_read_b64_tr_b16 v[66:67], v140 offset:20992
    ds_read_b64_tr_b16 v[68:69], v141 offset:20480
    ds_read_b64_tr_b16 v[70:71], v141 offset:20992
    s_and_b32 s59, s57, 0xff
    s_lshr_b32 s57, s57, 8
    s_add_u32 s59, s59, 15
    s_lshr_b32 s59, s59, 4
    s_max_u32 s59, s59, 4
    s_lshl1_add_u32 s52, s48, s57
    s_lshl_b32 s57, s59, 8
    s_or_b32 s52, s52, s57
    s_sub_u32 s50, s59, 4
    s_and_b32 s59, s58, 0xff
    s_lshr_b32 s58, s58, 8
    s_add_u32 s59, s59, 15
    s_lshr_b32 s59, s59, 4
    s_max_u32 s59, s59, 2
    s_lshl1_add_u32 s74, s48, s58
    s_lshl_b32 s58, s59, 8
    s_or_b32 s74, s74, s58
    s_or_b32 s74, s74, 1
    v_lshlrev_b32 v24, 16, v124
    v_and_b32 v25, 0xffff0000, v124
    v_lshlrev_b32 v26, 16, v125
    v_and_b32 v27, 0xffff0000, v125
    v_lshlrev_b32 v28, 16, v126
    v_and_b32 v29, 0xffff0000, v126
    v_lshlrev_b32 v30, 16, v127
    v_and_b32 v31, 0xffff0000, v127
    v_mul_f32 v24, s60, v24
    v_mul_f32 v25, s60, v25
    v_mul_f32 v26, s60, v26
    v_mul_f32 v27, s60, v27
    v_mul_f32 v28, s60, v28
    v_mul_f32 v29, s60, v29
    v_mul_f32 v30, s60, v30
    v_mul_f32 v31, s60, v31
    s_waitcnt lgkmcnt(15)
    v_lshlrev_b32 v8, 16, v218
    v_and_b32 v9, 0xffff0000, v218
    v_lshlrev_b32 v16, 16, v222
    v_and_b32 v17, 0xffff0000, v222
    v_lshlrev_b32 v10, 16, v219
    v_and_b32 v11, 0xffff0000, v219
    v_lshlrev_b32 v18, 16, v223
    v_and_b32 v19, 0xffff0000, v223
    v_lshlrev_b32 v12, 16, v220
    v_and_b32 v13, 0xffff0000, v220
    v_lshlrev_b32 v20, 16, v224
    v_and_b32 v21, 0xffff0000, v224
    v_lshlrev_b32 v14, 16, v221
    v_and_b32 v15, 0xffff0000, v221
    v_lshlrev_b32 v22, 16, v225
    v_and_b32 v23, 0xffff0000, v225
    v_xor_b32 v168, 0x80008000, v160
    v_xor_b32 v169, 0x80008000, v161
    v_xor_b32 v170, 0x80008000, v162
    v_xor_b32 v171, 0x80008000, v163
    v_xor_b32 v172, 0x80008000, v164
    v_xor_b32 v173, 0x80008000, v165
    v_xor_b32 v174, 0x80008000, v166
    v_xor_b32 v175, 0x80008000, v167
    s_waitcnt lgkmcnt(12)
    v_mfma_f32_16x16x32_bf16 v[104:107], v[40:43], v[160:163], v[104:107]
    v_mfma_f32_16x16x32_bf16 v[108:111], v[44:47], v[160:163], v[108:111]
    v_add_f32 v112, v8, v16
    v_add_f32 v113, v9, v17
    s_waitcnt lgkmcnt(8)
    v_mfma_f32_16x16x32_bf16 v[104:107], v[48:51], v[164:167], v[104:107]
    v_mfma_f32_16x16x32_bf16 v[108:111], v[52:55], v[164:167], v[108:111]
    v_add_f32 v114, v10, v18
    v_add_f32 v115, v11, v19
    s_waitcnt lgkmcnt(4)
    v_mfma_f32_16x16x32_bf16 v[104:107], v[56:59], v[168:171], v[104:107]
    v_mfma_f32_16x16x32_bf16 v[108:111], v[60:63], v[168:171], v[108:111]
    v_add_f32 v116, v12, v20
    v_add_f32 v117, v13, v21
    s_waitcnt lgkmcnt(0)
    v_mfma_f32_16x16x32_bf16 v[104:107], v[64:67], v[172:175], v[104:107]
    v_mfma_f32_16x16x32_bf16 v[108:111], v[68:71], v[172:175], v[108:111]
    v_add_f32 v118, v14, v22
    v_add_f32 v119, v15, v23
    ds_read_b64_tr_b16 v[72:73], v136 offset:24576
    ds_read_b64_tr_b16 v[74:75], v136 offset:25088
    ds_read_b64_tr_b16 v[76:77], v136 offset:28672
    ds_read_b64_tr_b16 v[78:79], v136 offset:29184
    ds_read_b64_tr_b16 v[80:81], v137 offset:24576
    ds_read_b64_tr_b16 v[82:83], v137 offset:25088
    ds_read_b64_tr_b16 v[84:85], v137 offset:28672
    ds_read_b64_tr_b16 v[86:87], v137 offset:29184
    ds_read_b64_tr_b16 v[88:89], v138 offset:24576
    ds_read_b64_tr_b16 v[90:91], v138 offset:25088
    ds_read_b64_tr_b16 v[92:93], v138 offset:28672
    ds_read_b64_tr_b16 v[94:95], v138 offset:29184
    ds_read_b64_tr_b16 v[96:97], v139 offset:24576
    ds_read_b64_tr_b16 v[98:99], v139 offset:25088
    ds_read_b64_tr_b16 v[100:101], v139 offset:28672
    ds_read_b64_tr_b16 v[102:103], v139 offset:29184
    s_cmp_le_u32 s47, 0
    s_cbranch_scc1 P_MJ
    s_lshr_b32 s56, s70, 1
    s_lshr_b32 s59, s56, 2
    s_mul_i32 s71, s56, 800
    s_mul_i32 s59, s59, 816000
    s_add_u32 s71, s71, s59
    buffer_load_dwordx4 v[180:183], v179, s[24:27], s71 offen offset:0 nt
    s_cmp_le_u32 s47, 1
    s_cbranch_scc1 P_MJ
    s_lshr_b32 s56, s70, 1
    s_add_u32 s56, s56, 1
    s_lshr_b32 s59, s56, 2
    s_mul_i32 s71, s56, 800
    s_mul_i32 s59, s59, 816000
    s_add_u32 s71, s71, s59
    buffer_load_dwordx4 v[184:187], v179, s[24:27], s71 offen offset:0 nt
    s_cmp_le_u32 s47, 2
    s_cbranch_scc1 P_MJ
    s_lshr_b32 s56, s70, 1
    s_add_u32 s56, s56, 2
    s_lshr_b32 s59, s56, 2
    s_mul_i32 s71, s56, 800
    s_mul_i32 s59, s59, 816000
    s_add_u32 s71, s71, s59
    buffer_load_dwordx4 v[188:191], v179, s[24:27], s71 offen offset:0 nt
    s_cmp_le_u32 s47, 3
    s_cbranch_scc1 P_MJ
    s_lshr_b32 s56, s70, 1
    s_add_u32 s56, s56, 3
    s_lshr_b32 s59, s56, 2
    s_mul_i32 s71, s56, 800
    s_mul_i32 s59, s59, 816000
    s_add_u32 s71, s71, s59
    buffer_load_dwordx4 v[192:195], v179, s[24:27], s71 offen offset:0 nt
    s_cmp_le_u32 s47, 4
    s_cbranch_scc1 P_MJ
    s_lshr_b32 s56, s70, 1
    s_add_u32 s56, s56, 4
    s_lshr_b32 s59, s56, 2
    s_mul_i32 s71, s56, 800
    s_mul_i32 s59, s59, 816000
    s_add_u32 s71, s71, s59
    buffer_load_dwordx4 v[196:199], v179, s[24:27], s71 offen offset:0 nt
    s_cmp_le_u32 s47, 5
    s_cbranch_scc1 P_MJ
    s_lshr_b32 s56, s70, 1
    s_add_u32 s56, s56, 5
    s_lshr_b32 s59, s56, 2
    s_mul_i32 s71, s56, 800
    s_mul_i32 s59, s59, 816000
    s_add_u32 s71, s71, s59
    buffer_load_dwordx4 v[200:203], v179, s[24:27], s71 offen offset:0 nt
P_MJ:
    v_mul_f32 v112, s60, v112
    v_mul_f32 v113, s60, v113
    v_mul_f32 v114, s60, v114
    v_mul_f32 v115, s60, v115
    v_mul_f32 v116, s60, v116
    v_mul_f32 v117, s60, v117
    v_mul_f32 v118, s60, v118
    v_mul_f32 v119, s60, v119
    ds_write_b128 v151, v[112:115] offset:0
    ds_write_b128 v151, v[116:119] offset:1024
    v_mul_f32 v104, s60, v104
    v_mul_f32 v105, s60, v105
    v_mul_f32 v106, s60, v106
    v_mul_f32 v107, s60, v107
    v_mul_f32 v108, s60, v108
    v_mul_f32 v109, s60, v109
    v_mul_f32 v110, s60, v110
    v_mul_f32 v111, s60, v111
    ds_write_b128 v145, v[104:107] offset:256
    ds_write_b128 v145, v[108:111] offset:320
    ds_write_b128 v3, v[24:27] offset:0
    ds_write_b128 v3, v[28:31] offset:16
    ds_read_b128 v[120:123], v252 offset:16384
    ds_read_b128 v[124:127], v252 offset:16448
    ds_read_b128 v[128:131], v252 offset:16512
    ds_read_b128 v[132:135], v252 offset:16576
    ds_read_b32 v150, v252 offset:17604
    s_lshl2_add_u32 s56, s48, 17184
    v_mov_b32 v253, s56
    v_mov_b32 v254, s74
    ds_write_b32 v253, v254
    v_ldexp_f32 v2, s63, 38
    v_add_u32 v250, 133376, v250
    v_mov_b64 v[168:169], 0
    v_mov_b64 v[170:171], 0
    v_mov_b64 v[172:173], 0
    v_mov_b64 v[174:175], 0
    v_readfirstlane_b32 s44, v2
    s_waitcnt lgkmcnt(15)
    v_lshlrev_b32 v8, 16, v72
    v_and_b32 v9, 0xffff0000, v72
    v_lshlrev_b32 v10, 16, v73
    v_and_b32 v11, 0xffff0000, v73
    v_lshlrev_b32 v12, 16, v74
    v_and_b32 v13, 0xffff0000, v74
    v_lshlrev_b32 v14, 16, v75
    v_and_b32 v15, 0xffff0000, v75
    v_lshlrev_b32 v16, 16, v76
    v_and_b32 v17, 0xffff0000, v76
    v_lshlrev_b32 v18, 16, v77
    v_and_b32 v19, 0xffff0000, v77
    v_lshlrev_b32 v20, 16, v78
    v_and_b32 v21, 0xffff0000, v78
    v_lshlrev_b32 v22, 16, v79
    v_and_b32 v23, 0xffff0000, v79
    v_lshlrev_b32 v24, 16, v80
    v_and_b32 v25, 0xffff0000, v80
    v_lshlrev_b32 v26, 16, v81
    v_and_b32 v27, 0xffff0000, v81
    v_lshlrev_b32 v28, 16, v82
    v_and_b32 v29, 0xffff0000, v82
    v_lshlrev_b32 v30, 16, v83
    v_and_b32 v31, 0xffff0000, v83
    v_lshlrev_b32 v32, 16, v84
    v_and_b32 v33, 0xffff0000, v84
    v_lshlrev_b32 v34, 16, v85
    v_and_b32 v35, 0xffff0000, v85
    v_lshlrev_b32 v36, 16, v86
    v_and_b32 v37, 0xffff0000, v86
    v_lshlrev_b32 v38, 16, v87
    v_and_b32 v39, 0xffff0000, v87
    ds_read_u8 v238, v246 offset:32
    ds_read_u8 v240, v246 offset:40
    ds_read_u8 v152, v246 offset:48
    ds_read_u8 v154, v246 offset:56
    s_add_u32 m0, s54, 4096
    v_add_u32 v246, 48, v246
    s_mov_b64 s[68:69], 0
    s_mov_b32 s75, 0
    s_movk_i32 s53, 0x1040
    s_mov_b32 s73, 3
    s_mov_b32 s77, 0
    s_mov_b32 s55, 0
    v_mov_b64 v[0:1], 0
    v_mov_b32 v2, 1.0
    v_mov_b32 v3, 1.0
    s_waitcnt lgkmcnt(0)
    s_barrier
    v_readfirstlane_b32 s45, v150
    buffer_load_dwordx4 v[238:239], s[20:23], s72 idxen offen nt lds
    buffer_load_dwordx4 v[240:241], s[20:23], s51 idxen offen offset:1024 nt lds
    s_add_u32 m0, s54, 6144
    s_nop 0
    buffer_load_dwordx4 v[152:153], s[20:23], s72 idxen offen nt lds
    buffer_load_dwordx4 v[154:155], s[20:23], s51 idxen offen offset:1024 nt lds
    s_cmp_eq_u32 s47, 0
    s_cbranch_scc1 P_GO
    s_lshl_b32 s56, s70, 8
    s_add_u32 s56, s56, 116992
    s_waitcnt vmcnt(4)
    v_mov_b64 v[204:205], v[180:181]
    v_mov_b64 v[206:207], v[182:183]
    s_call_b64 s[36:37], CMP
    v_writelane_b32 v212, s57, 0
    v_writelane_b32 v212, s58, 1
    s_cmp_le_u32 s47, 1
    s_cbranch_scc1 LATE_D
    s_add_u32 s56, s56, 512
    v_mov_b64 v[204:205], v[184:185]
    v_mov_b64 v[206:207], v[186:187]
    s_call_b64 s[36:37], CMP
    v_writelane_b32 v212, s57, 2
    v_writelane_b32 v212, s58, 3
    s_cmp_le_u32 s47, 2
    s_cbranch_scc1 LATE_D
    s_add_u32 s56, s56, 512
    v_mov_b64 v[204:205], v[188:189]
    v_mov_b64 v[206:207], v[190:191]
    s_call_b64 s[36:37], CMP
    v_writelane_b32 v212, s57, 4
    v_writelane_b32 v212, s58, 5
    s_cmp_le_u32 s47, 3
    s_cbranch_scc1 LATE_D
    s_add_u32 s56, s56, 512
    v_mov_b64 v[204:205], v[192:193]
    v_mov_b64 v[206:207], v[194:195]
    s_call_b64 s[36:37], CMP
    v_writelane_b32 v212, s57, 6
    v_writelane_b32 v212, s58, 7
    s_cmp_le_u32 s47, 4
    s_cbranch_scc1 LATE_D
    s_add_u32 s56, s56, 512
    v_mov_b64 v[204:205], v[196:197]
    v_mov_b64 v[206:207], v[198:199]
    s_call_b64 s[36:37], CMP
    v_writelane_b32 v212, s57, 8
    v_writelane_b32 v212, s58, 9
    s_cmp_le_u32 s47, 5
    s_cbranch_scc1 LATE_D
    s_add_u32 s56, s56, 512
    v_mov_b64 v[204:205], v[200:201]
    v_mov_b64 v[206:207], v[202:203]
    s_call_b64 s[36:37], CMP
    v_writelane_b32 v212, s57, 10
    v_writelane_b32 v212, s58, 11
LATE_D:
    v_add_u32 v4, s70, v176
    s_lshl_b32 s56, s47, 1
    v_and_b32 v5, 0xff, v212
    v_add_u32 v5, 15, v5
    v_lshrrev_b32 v212, 8, v212
    v_lshrrev_b32 v5, 4, v5
    v_max_u32 v5, 2, v5
    v_or_b32 v212, v212, v4
    v_cmp_gt_u32 vcc, 64, v4
    v_lshl_or_b32 v6, v5, 8, v212
    v_lshlrev_b32 v4, 2, v4
    s_bfm_b64 s[66:67], s56, 0
    s_and_b64 exec, s[66:67], vcc
    ds_write_b32 v4, v6 offset:17152
    s_mov_b64 exec, -1
P_GO:
    ds_read_b128 v[180:183], v251 offset:0
    ds_read_b128 v[184:187], v251 offset:1024
    ds_read_b128 v[196:199], v251 offset:4096
    ds_read_b128 v[200:203], v251 offset:5120
    ds_read_b128 v[212:215], v251 offset:8192
    ds_read_b128 v[216:219], v251 offset:9216
    ds_read_b128 v[188:191], v251 offset:2048
    ds_read_b128 v[192:195], v251 offset:3072
    ds_read_b128 v[204:207], v251 offset:6144
    ds_read_b128 v[208:211], v251 offset:7168
    ds_read_b128 v[220:223], v251 offset:10240
    ds_read_b128 v[224:227], v251 offset:11264
    ds_read_b128 v[228:231], v251 offset:14336
    ds_read_b128 v[232:235], v251 offset:15360
    v_lshlrev_b32 v40, 16, v88
    v_and_b32 v41, 0xffff0000, v88
    v_lshlrev_b32 v42, 16, v89
    v_and_b32 v43, 0xffff0000, v89
    v_lshlrev_b32 v44, 16, v90
    v_and_b32 v45, 0xffff0000, v90
    v_lshlrev_b32 v46, 16, v91
    v_and_b32 v47, 0xffff0000, v91
    v_lshlrev_b32 v48, 16, v92
    v_and_b32 v49, 0xffff0000, v92
    v_lshlrev_b32 v50, 16, v93
    v_and_b32 v51, 0xffff0000, v93
    v_lshlrev_b32 v52, 16, v94
    v_and_b32 v53, 0xffff0000, v94
    v_lshlrev_b32 v54, 16, v95
    v_and_b32 v55, 0xffff0000, v95
    v_lshlrev_b32 v56, 16, v96
    v_and_b32 v57, 0xffff0000, v96
    v_lshlrev_b32 v58, 16, v97
    v_and_b32 v59, 0xffff0000, v97
    v_lshlrev_b32 v60, 16, v98
    v_and_b32 v61, 0xffff0000, v98
    v_lshlrev_b32 v62, 16, v99
    v_and_b32 v63, 0xffff0000, v99
    v_lshlrev_b32 v64, 16, v100
    v_and_b32 v65, 0xffff0000, v100
    v_lshlrev_b32 v66, 16, v101
    v_and_b32 v67, 0xffff0000, v101
    v_lshlrev_b32 v68, 16, v102
    v_and_b32 v69, 0xffff0000, v102
    v_lshlrev_b32 v70, 16, v103
    v_and_b32 v71, 0xffff0000, v103
    v_mov_b64 v[176:177], 0
    v_mov_b64 v[178:179], 0
    s_sub_u32 s50, s50, 2
    s_cbranch_scc1 DRAW_P
DRET_P:
    s_waitcnt vmcnt(6)
    ds_read_b128 v[152:155], v242
    ds_read_b128 v[156:159], v243
    s_branch BPF
U_0:
    v_mfma_f32_16x16x32_bf16 v[104:107], v[72:75], v[152:155], v[136:139]
    s_add_u32 m0, s54, 0
    v_rcp_f32 v2, v2
    v_mfma_f32_16x16x32_bf16 v[104:107], v[76:79], v[156:159], v[104:107]
    s_mov_b32 s73, 0
    v_rcp_f32 v3, v3
    v_mfma_f32_16x16x32_bf16 v[108:111], v[80:83], v[152:155], v[140:143]
    s_sub_u32 s50, s50, 1
    v_fma_f32 v0, v0, v2, s44
    v_fmac_f32 v0, v1, v3
    v_mfma_f32_16x16x32_bf16 v[108:111], v[84:87], v[156:159], v[108:111]
    s_cbranch_scc1 PEV
    v_add_u32 v246, 16, v246
RET_0:
    v_cvt_pk_bf16_f32 v0, v0, v0
    v_mfma_f32_16x16x32_bf16 v[112:115], v[88:91], v[152:155], v[144:147]
    v_exp_f32 v104, v104
    v_mfma_f32_16x16x32_bf16 v[112:115], v[92:95], v[156:159], v[112:115]
    v_exp_f32 v105, v105
    v_mfma_f32_16x16x32_bf16 v[116:119], v[96:99], v[152:155], v[148:151]
    s_sub_u32 s62, s62, 1
    v_exp_f32 v106, v106
    v_mfma_f32_16x16x32_bf16 v[116:119], v[100:103], v[156:159], v[116:119]
    v_exp_f32 v107, v107
    ds_write_b16 v249, v0
    ds_read_b64 v[236:237], v248
    ds_read_b64_tr_b16 v[160:161], v244 offset:0
    ds_read_b64_tr_b16 v[162:163], v245 offset:512
    ds_read_b64_tr_b16 v[164:165], v244 offset:1024
    ds_read_b64_tr_b16 v[166:167], v245 offset:1536
    ds_read_u8 v238, v246 offset:0
    ds_read_u8 v240, v246 offset:8
    v_exp_f32 v108, v108
    v_exp_f32 v109, v109
    v_exp_f32 v110, v110
    v_exp_f32 v111, v111
    s_waitcnt lgkmcnt(6)
    v_mfma_f32_4x4x4_16b_bf16 v[176:179], v[236:237], v[168:169], v[176:179] cbsz:4 abid:0
    v_exp_f32 v112, v112
    v_exp_f32 v113, v113
    v_mfma_f32_4x4x4_16b_bf16 v[176:179], v[236:237], v[170:171], v[176:179] cbsz:4 abid:1
    v_exp_f32 v114, v114
    v_exp_f32 v115, v115
    v_mfma_f32_4x4x4_16b_bf16 v[176:179], v[236:237], v[172:173], v[176:179] cbsz:4 abid:2
    v_exp_f32 v116, v116
    v_exp_f32 v117, v117
    v_mfma_f32_4x4x4_16b_bf16 v[176:179], v[236:237], v[174:175], v[176:179] cbsz:4 abid:3
    v_exp_f32 v118, v118
    v_exp_f32 v119, v119
    s_waitcnt lgkmcnt(0)
    buffer_load_dwordx4 v[238:239], s[20:23], s72 idxen offen nt lds
    buffer_load_dwordx4 v[240:241], s[20:23], s51 idxen offen offset:1024 nt lds
    s_waitcnt vmcnt(5)
    ds_read_b128 v[152:155], v242 offset:2048
    ds_read_b128 v[156:159], v243 offset:2048
    .p2align 3
    v_pk_fma_f32 v[2:3], v[104:105], s[42:43], s[42:43] op_sel_hi:[1,0,0]
    v_pk_fma_f32 v[0:1], v[120:121], v[106:107], v[120:121]
    v_pk_fma_f32 v[0:1], v[122:123], v[2:3], v[0:1]
    v_pk_fma_f32 v[2:3], v[106:107], v[2:3], v[2:3]
    v_pk_fma_f32 v[0:1], v[108:109], v[0:1], v[0:1]
    v_pk_fma_f32 v[0:1], v[124:125], v[2:3], v[0:1]
    v_pk_fma_f32 v[2:3], v[108:109], v[2:3], v[2:3]
    v_pk_fma_f32 v[0:1], v[110:111], v[0:1], v[0:1]
    v_pk_fma_f32 v[0:1], v[126:127], v[2:3], v[0:1]
    v_pk_fma_f32 v[2:3], v[110:111], v[2:3], v[2:3]
    v_pk_fma_f32 v[0:1], v[112:113], v[0:1], v[0:1]
    v_pk_fma_f32 v[0:1], v[128:129], v[2:3], v[0:1]
    v_pk_fma_f32 v[2:3], v[112:113], v[2:3], v[2:3]
    v_pk_fma_f32 v[0:1], v[114:115], v[0:1], v[0:1]
    v_pk_fma_f32 v[0:1], v[130:131], v[2:3], v[0:1]
    v_pk_fma_f32 v[2:3], v[114:115], v[2:3], v[2:3]
    v_pk_fma_f32 v[0:1], v[116:117], v[0:1], v[0:1]
    v_pk_fma_f32 v[0:1], v[132:133], v[2:3], v[0:1]
    v_pk_fma_f32 v[2:3], v[116:117], v[2:3], v[2:3]
    v_pk_fma_f32 v[0:1], v[118:119], v[0:1], v[0:1]
    v_pk_fma_f32 v[0:1], v[134:135], v[2:3], v[0:1]
    v_pk_fma_f32 v[2:3], v[118:119], v[2:3], v[2:3]
    s_waitcnt lgkmcnt(0)
    s_cbranch_scc1 CEV
U_1:
    v_mfma_f32_16x16x32_bf16 v[104:107], v[72:75], v[152:155], v[136:139]
    s_add_u32 m0, s54, 2048
    v_rcp_f32 v2, v2
    v_mfma_f32_16x16x32_bf16 v[104:107], v[76:79], v[156:159], v[104:107]
    s_mov_b32 s73, 1
    v_rcp_f32 v3, v3
    v_mfma_f32_16x16x32_bf16 v[108:111], v[80:83], v[152:155], v[140:143]
    s_sub_u32 s50, s50, 1
    v_fma_f32 v0, v0, v2, s44
    v_fmac_f32 v0, v1, v3
    v_mfma_f32_16x16x32_bf16 v[108:111], v[84:87], v[156:159], v[108:111]
    s_cbranch_scc1 PEV
    v_add_u32 v246, 16, v246
RET_1:
    v_cvt_pk_bf16_f32 v0, v0, v0
    v_mfma_f32_16x16x32_bf16 v[112:115], v[88:91], v[152:155], v[144:147]
    v_exp_f32 v104, v104
    v_mfma_f32_16x16x32_bf16 v[112:115], v[92:95], v[156:159], v[112:115]
    v_exp_f32 v105, v105
    v_mfma_f32_16x16x32_bf16 v[116:119], v[96:99], v[152:155], v[148:151]
    s_sub_u32 s62, s62, 1
    v_exp_f32 v106, v106
    v_mfma_f32_16x16x32_bf16 v[116:119], v[100:103], v[156:159], v[116:119]
    v_exp_f32 v107, v107
    ds_write_b16 v249, v0
    ds_read_b64 v[236:237], v248
    ds_read_b64_tr_b16 v[168:169], v244 offset:2048
    ds_read_b64_tr_b16 v[170:171], v245 offset:2560
    ds_read_b64_tr_b16 v[172:173], v244 offset:3072
    ds_read_b64_tr_b16 v[174:175], v245 offset:3584
    ds_read_u8 v238, v246 offset:0
    ds_read_u8 v240, v246 offset:8
    v_exp_f32 v108, v108
    v_exp_f32 v109, v109
    v_exp_f32 v110, v110
    v_exp_f32 v111, v111
    s_waitcnt lgkmcnt(6)
    v_mfma_f32_4x4x4_16b_bf16 v[176:179], v[236:237], v[160:161], v[176:179] cbsz:4 abid:0
    v_exp_f32 v112, v112
    v_exp_f32 v113, v113
    v_mfma_f32_4x4x4_16b_bf16 v[176:179], v[236:237], v[162:163], v[176:179] cbsz:4 abid:1
    v_exp_f32 v114, v114
    v_exp_f32 v115, v115
    v_mfma_f32_4x4x4_16b_bf16 v[176:179], v[236:237], v[164:165], v[176:179] cbsz:4 abid:2
    v_exp_f32 v116, v116
    v_exp_f32 v117, v117
    v_mfma_f32_4x4x4_16b_bf16 v[176:179], v[236:237], v[166:167], v[176:179] cbsz:4 abid:3
    v_exp_f32 v118, v118
    v_exp_f32 v119, v119
    s_waitcnt lgkmcnt(0)
    buffer_load_dwordx4 v[238:239], s[20:23], s72 idxen offen nt lds
    buffer_load_dwordx4 v[240:241], s[20:23], s51 idxen offen offset:1024 nt lds
    s_waitcnt vmcnt(5)
    ds_read_b128 v[152:155], v242 offset:4096
    ds_read_b128 v[156:159], v243 offset:4096
    .p2align 3
    v_pk_fma_f32 v[2:3], v[104:105], s[42:43], s[42:43] op_sel_hi:[1,0,0]
    v_pk_fma_f32 v[0:1], v[120:121], v[106:107], v[120:121]
    v_pk_fma_f32 v[0:1], v[122:123], v[2:3], v[0:1]
    v_pk_fma_f32 v[2:3], v[106:107], v[2:3], v[2:3]
    v_pk_fma_f32 v[0:1], v[108:109], v[0:1], v[0:1]
    v_pk_fma_f32 v[0:1], v[124:125], v[2:3], v[0:1]
    v_pk_fma_f32 v[2:3], v[108:109], v[2:3], v[2:3]
    v_pk_fma_f32 v[0:1], v[110:111], v[0:1], v[0:1]
    v_pk_fma_f32 v[0:1], v[126:127], v[2:3], v[0:1]
    v_pk_fma_f32 v[2:3], v[110:111], v[2:3], v[2:3]
    v_pk_fma_f32 v[0:1], v[112:113], v[0:1], v[0:1]
    v_pk_fma_f32 v[0:1], v[128:129], v[2:3], v[0:1]
    v_pk_fma_f32 v[2:3], v[112:113], v[2:3], v[2:3]
    v_pk_fma_f32 v[0:1], v[114:115], v[0:1], v[0:1]
    v_pk_fma_f32 v[0:1], v[130:131], v[2:3], v[0:1]
    v_pk_fma_f32 v[2:3], v[114:115], v[2:3], v[2:3]
    v_pk_fma_f32 v[0:1], v[116:117], v[0:1], v[0:1]
    v_pk_fma_f32 v[0:1], v[132:133], v[2:3], v[0:1]
    v_pk_fma_f32 v[2:3], v[116:117], v[2:3], v[2:3]
    v_pk_fma_f32 v[0:1], v[118:119], v[0:1], v[0:1]
    v_pk_fma_f32 v[0:1], v[134:135], v[2:3], v[0:1]
    v_pk_fma_f32 v[2:3], v[118:119], v[2:3], v[2:3]
    s_waitcnt lgkmcnt(0)
    s_cbranch_scc1 CEV
U_2:
    v_mfma_f32_16x16x32_bf16 v[104:107], v[72:75], v[152:155], v[136:139]
    s_add_u32 m0, s54, 4096
    v_rcp_f32 v2, v2
    v_mfma_f32_16x16x32_bf16 v[104:107], v[76:79], v[156:159], v[104:107]
    s_mov_b32 s73, 2
    v_rcp_f32 v3, v3
    v_mfma_f32_16x16x32_bf16 v[108:111], v[80:83], v[152:155], v[140:143]
    s_sub_u32 s50, s50, 1
    v_fma_f32 v0, v0, v2, s44
    v_fmac_f32 v0, v1, v3
    v_mfma_f32_16x16x32_bf16 v[108:111], v[84:87], v[156:159], v[108:111]
    s_cbranch_scc1 PEV
    v_add_u32 v246, 16, v246
RET_2:
    v_cvt_pk_bf16_f32 v0, v0, v0
    v_mfma_f32_16x16x32_bf16 v[112:115], v[88:91], v[152:155], v[144:147]
    v_exp_f32 v104, v104
    v_mfma_f32_16x16x32_bf16 v[112:115], v[92:95], v[156:159], v[112:115]
    v_exp_f32 v105, v105
    v_mfma_f32_16x16x32_bf16 v[116:119], v[96:99], v[152:155], v[148:151]
    s_sub_u32 s62, s62, 1
    v_exp_f32 v106, v106
    v_mfma_f32_16x16x32_bf16 v[116:119], v[100:103], v[156:159], v[116:119]
    v_exp_f32 v107, v107
    ds_write_b16 v249, v0
    ds_read_b64 v[236:237], v248
    ds_read_b64_tr_b16 v[160:161], v244 offset:4096
    ds_read_b64_tr_b16 v[162:163], v245 offset:4608
    ds_read_b64_tr_b16 v[164:165], v244 offset:5120
    ds_read_b64_tr_b16 v[166:167], v245 offset:5632
    ds_read_u8 v238, v246 offset:0
    ds_read_u8 v240, v246 offset:8
    v_exp_f32 v108, v108
    v_exp_f32 v109, v109
    v_exp_f32 v110, v110
    v_exp_f32 v111, v111
    s_waitcnt lgkmcnt(6)
    v_mfma_f32_4x4x4_16b_bf16 v[176:179], v[236:237], v[168:169], v[176:179] cbsz:4 abid:0
    v_exp_f32 v112, v112
    v_exp_f32 v113, v113
    v_mfma_f32_4x4x4_16b_bf16 v[176:179], v[236:237], v[170:171], v[176:179] cbsz:4 abid:1
    v_exp_f32 v114, v114
    v_exp_f32 v115, v115
    v_mfma_f32_4x4x4_16b_bf16 v[176:179], v[236:237], v[172:173], v[176:179] cbsz:4 abid:2
    v_exp_f32 v116, v116
    v_exp_f32 v117, v117
    v_mfma_f32_4x4x4_16b_bf16 v[176:179], v[236:237], v[174:175], v[176:179] cbsz:4 abid:3
    v_exp_f32 v118, v118
    v_exp_f32 v119, v119
    s_waitcnt lgkmcnt(0)
    buffer_load_dwordx4 v[238:239], s[20:23], s72 idxen offen nt lds
    buffer_load_dwordx4 v[240:241], s[20:23], s51 idxen offen offset:1024 nt lds
    s_waitcnt vmcnt(5)
    ds_read_b128 v[152:155], v242 offset:6144
    ds_read_b128 v[156:159], v243 offset:6144
    .p2align 3
    v_pk_fma_f32 v[2:3], v[104:105], s[42:43], s[42:43] op_sel_hi:[1,0,0]
    v_pk_fma_f32 v[0:1], v[120:121], v[106:107], v[120:121]
    v_pk_fma_f32 v[0:1], v[122:123], v[2:3], v[0:1]
    v_pk_fma_f32 v[2:3], v[106:107], v[2:3], v[2:3]
    v_pk_fma_f32 v[0:1], v[108:109], v[0:1], v[0:1]
    v_pk_fma_f32 v[0:1], v[124:125], v[2:3], v[0:1]
    v_pk_fma_f32 v[2:3], v[108:109], v[2:3], v[2:3]
    v_pk_fma_f32 v[0:1], v[110:111], v[0:1], v[0:1]
    v_pk_fma_f32 v[0:1], v[126:127], v[2:3], v[0:1]
    v_pk_fma_f32 v[2:3], v[110:111], v[2:3], v[2:3]
    v_pk_fma_f32 v[0:1], v[112:113], v[0:1], v[0:1]
    v_pk_fma_f32 v[0:1], v[128:129], v[2:3], v[0:1]
    v_pk_fma_f32 v[2:3], v[112:113], v[2:3], v[2:3]
    v_pk_fma_f32 v[0:1], v[114:115], v[0:1], v[0:1]
    v_pk_fma_f32 v[0:1], v[130:131], v[2:3], v[0:1]
    v_pk_fma_f32 v[2:3], v[114:115], v[2:3], v[2:3]
    v_pk_fma_f32 v[0:1], v[116:117], v[0:1], v[0:1]
    v_pk_fma_f32 v[0:1], v[132:133], v[2:3], v[0:1]
    v_pk_fma_f32 v[2:3], v[116:117], v[2:3], v[2:3]
    v_pk_fma_f32 v[0:1], v[118:119], v[0:1], v[0:1]
    v_pk_fma_f32 v[0:1], v[134:135], v[2:3], v[0:1]
    v_pk_fma_f32 v[2:3], v[118:119], v[2:3], v[2:3]
    s_waitcnt lgkmcnt(0)
    s_cbranch_scc1 CEV
U_3:
    v_mfma_f32_16x16x32_bf16 v[104:107], v[72:75], v[152:155], v[136:139]
    s_add_u32 m0, s54, 6144
    v_rcp_f32 v2, v2
    v_mfma_f32_16x16x32_bf16 v[104:107], v[76:79], v[156:159], v[104:107]
    s_mov_b32 s73, 3
    v_rcp_f32 v3, v3
    v_mfma_f32_16x16x32_bf16 v[108:111], v[80:83], v[152:155], v[140:143]
    s_sub_u32 s50, s50, 1
    v_fma_f32 v0, v0, v2, s44
    v_fmac_f32 v0, v1, v3
    v_mfma_f32_16x16x32_bf16 v[108:111], v[84:87], v[156:159], v[108:111]
    s_cbranch_scc1 PEV
    v_add_u32 v246, 16, v246
RET_3:
    v_cvt_pk_bf16_f32 v0, v0, v0
    v_mfma_f32_16x16x32_bf16 v[112:115], v[88:91], v[152:155], v[144:147]
    v_exp_f32 v104, v104
    v_mfma_f32_16x16x32_bf16 v[112:115], v[92:95], v[156:159], v[112:115]
    v_exp_f32 v105, v105
    v_mfma_f32_16x16x32_bf16 v[116:119], v[96:99], v[152:155], v[148:151]
    s_sub_u32 s62, s62, 1
    v_exp_f32 v106, v106
    v_mfma_f32_16x16x32_bf16 v[116:119], v[100:103], v[156:159], v[116:119]
    v_exp_f32 v107, v107
    ds_write_b16 v249, v0
    ds_read_b64 v[236:237], v248
    ds_read_b64_tr_b16 v[168:169], v244 offset:6144
    ds_read_b64_tr_b16 v[170:171], v245 offset:6656
    ds_read_b64_tr_b16 v[172:173], v244 offset:7168
    ds_read_b64_tr_b16 v[174:175], v245 offset:7680
    ds_read_u8 v238, v246 offset:0
    ds_read_u8 v240, v246 offset:8
    v_exp_f32 v108, v108
    v_exp_f32 v109, v109
    v_exp_f32 v110, v110
    v_exp_f32 v111, v111
    s_waitcnt lgkmcnt(6)
    v_mfma_f32_4x4x4_16b_bf16 v[176:179], v[236:237], v[160:161], v[176:179] cbsz:4 abid:0
    v_exp_f32 v112, v112
    v_exp_f32 v113, v113
    v_mfma_f32_4x4x4_16b_bf16 v[176:179], v[236:237], v[162:163], v[176:179] cbsz:4 abid:1
    v_exp_f32 v114, v114
    v_exp_f32 v115, v115
    v_mfma_f32_4x4x4_16b_bf16 v[176:179], v[236:237], v[164:165], v[176:179] cbsz:4 abid:2
    v_exp_f32 v116, v116
    v_exp_f32 v117, v117
    v_mfma_f32_4x4x4_16b_bf16 v[176:179], v[236:237], v[166:167], v[176:179] cbsz:4 abid:3
    v_exp_f32 v118, v118
    v_exp_f32 v119, v119
    s_waitcnt lgkmcnt(0)
    buffer_load_dwordx4 v[238:239], s[20:23], s72 idxen offen nt lds
    buffer_load_dwordx4 v[240:241], s[20:23], s51 idxen offen offset:1024 nt lds
    s_waitcnt vmcnt(5)
    ds_read_b128 v[152:155], v242 offset:0
    ds_read_b128 v[156:159], v243 offset:0
    .p2align 3
    v_pk_fma_f32 v[2:3], v[104:105], s[42:43], s[42:43] op_sel_hi:[1,0,0]
    v_pk_fma_f32 v[0:1], v[120:121], v[106:107], v[120:121]
    v_pk_fma_f32 v[0:1], v[122:123], v[2:3], v[0:1]
    v_pk_fma_f32 v[2:3], v[106:107], v[2:3], v[2:3]
    v_pk_fma_f32 v[0:1], v[108:109], v[0:1], v[0:1]
    v_pk_fma_f32 v[0:1], v[124:125], v[2:3], v[0:1]
    v_pk_fma_f32 v[2:3], v[108:109], v[2:3], v[2:3]
    v_pk_fma_f32 v[0:1], v[110:111], v[0:1], v[0:1]
    v_pk_fma_f32 v[0:1], v[126:127], v[2:3], v[0:1]
    v_pk_fma_f32 v[2:3], v[110:111], v[2:3], v[2:3]
    v_pk_fma_f32 v[0:1], v[112:113], v[0:1], v[0:1]
    v_pk_fma_f32 v[0:1], v[128:129], v[2:3], v[0:1]
    v_pk_fma_f32 v[2:3], v[112:113], v[2:3], v[2:3]
    v_pk_fma_f32 v[0:1], v[114:115], v[0:1], v[0:1]
    v_pk_fma_f32 v[0:1], v[130:131], v[2:3], v[0:1]
    v_pk_fma_f32 v[2:3], v[114:115], v[2:3], v[2:3]
    v_pk_fma_f32 v[0:1], v[116:117], v[0:1], v[0:1]
    v_pk_fma_f32 v[0:1], v[132:133], v[2:3], v[0:1]
    v_pk_fma_f32 v[2:3], v[116:117], v[2:3], v[2:3]
    v_pk_fma_f32 v[0:1], v[118:119], v[0:1], v[0:1]
    v_pk_fma_f32 v[0:1], v[134:135], v[2:3], v[0:1]
    v_pk_fma_f32 v[2:3], v[118:119], v[2:3], v[2:3]
    s_waitcnt lgkmcnt(0)
    s_cbranch_scc0 U_0
CEV:
    s_cmp_eq_u32 s76, 0
    s_cbranch_scc1 EPI
    s_mov_b32 s53, s52
    s_and_b32 s52, s68, 0xffff
    s_lshr_b64 s[68:69], s[68:69], 16
    s_sub_u32 s75, s75, 16
    s_bitcmp1_b32 s52, 6
    s_cbranch_scc1 DRAIN
BPF:
    s_and_b32 s57, s52, 63
    s_mul_i32 s57, s57, 528
    s_add_u32 s57, s57, 83200
    v_lshl_add_u32 v6, v252, 1, s57
    v_add_u32 v7, s57, v252
    ds_read_b128 v[104:107], v6 offset:0
    ds_read_b128 v[108:111], v6 offset:16
    ds_read_b128 v[144:147], v251 offset:12288
    ds_read_b128 v[148:151], v251 offset:13312
    ds_read_b128 v[112:115], v6 offset:128
    ds_read_b128 v[116:119], v6 offset:144
    s_mov_b32 s62, 0
    s_mov_b32 s76, 0
    s_cmp_lg_u32 s77, 0
    s_waitcnt lgkmcnt(4)
    .p2align 3
    v_pk_fma_f32 v[136:137], v[8:9], v[104:105], v[180:181]
    v_pk_fma_f32 v[138:139], v[10:11], v[106:107], v[182:183]
    v_pk_fma_f32 v[140:141], v[12:13], v[108:109], v[184:185]
    v_pk_fma_f32 v[142:143], v[14:15], v[110:111], v[186:187]
    v_cvt_pk_bf16_f32 v72, v136, v137
    v_cvt_pk_bf16_f32 v73, v138, v139
    v_cvt_pk_bf16_f32 v74, v140, v141
    v_cvt_pk_bf16_f32 v75, v142, v143
    v_pk_fma_f32 v[136:137], v[24:25], v[104:105], v[196:197]
    v_pk_fma_f32 v[138:139], v[26:27], v[106:107], v[198:199]
    v_pk_fma_f32 v[140:141], v[28:29], v[108:109], v[200:201]
    v_pk_fma_f32 v[142:143], v[30:31], v[110:111], v[202:203]
    v_cvt_pk_bf16_f32 v80, v136, v137
    v_cvt_pk_bf16_f32 v81, v138, v139
    v_cvt_pk_bf16_f32 v82, v140, v141
    v_cvt_pk_bf16_f32 v83, v142, v143
    v_pk_fma_f32 v[136:137], v[40:41], v[104:105], v[212:213]
    v_pk_fma_f32 v[138:139], v[42:43], v[106:107], v[214:215]
    v_pk_fma_f32 v[140:141], v[44:45], v[108:109], v[216:217]
    v_pk_fma_f32 v[142:143], v[46:47], v[110:111], v[218:219]
    v_cvt_pk_bf16_f32 v88, v136, v137
    v_cvt_pk_bf16_f32 v89, v138, v139
    v_cvt_pk_bf16_f32 v90, v140, v141
    v_cvt_pk_bf16_f32 v91, v142, v143
    s_waitcnt lgkmcnt(0)
    .p2align 3
    v_pk_fma_f32 v[144:145], v[56:57], v[104:105], v[144:145]
    v_pk_fma_f32 v[146:147], v[58:59], v[106:107], v[146:147]
    v_pk_fma_f32 v[148:149], v[60:61], v[108:109], v[148:149]
    v_pk_fma_f32 v[150:151], v[62:63], v[110:111], v[150:151]
    v_cvt_pk_bf16_f32 v96, v144, v145
    v_cvt_pk_bf16_f32 v97, v146, v147
    v_cvt_pk_bf16_f32 v98, v148, v149
    v_cvt_pk_bf16_f32 v99, v150, v151
    ds_read_b128 v[136:139], v7 offset:256
    ds_read_b128 v[140:143], v7 offset:320
    ds_read_b128 v[144:147], v7 offset:384
    ds_read_b128 v[148:151], v7 offset:448
    v_pk_fma_f32 v[104:105], v[16:17], v[112:113], v[188:189]
    v_pk_fma_f32 v[106:107], v[18:19], v[114:115], v[190:191]
    v_pk_fma_f32 v[108:109], v[20:21], v[116:117], v[192:193]
    v_pk_fma_f32 v[110:111], v[22:23], v[118:119], v[194:195]
    v_cvt_pk_bf16_f32 v76, v104, v105
    v_cvt_pk_bf16_f32 v77, v106, v107
    v_cvt_pk_bf16_f32 v78, v108, v109
    v_cvt_pk_bf16_f32 v79, v110, v111
    v_pk_fma_f32 v[104:105], v[32:33], v[112:113], v[204:205]
    v_pk_fma_f32 v[106:107], v[34:35], v[114:115], v[206:207]
    v_pk_fma_f32 v[108:109], v[36:37], v[116:117], v[208:209]
    v_pk_fma_f32 v[110:111], v[38:39], v[118:119], v[210:211]
    v_cvt_pk_bf16_f32 v84, v104, v105
    v_cvt_pk_bf16_f32 v85, v106, v107
    v_cvt_pk_bf16_f32 v86, v108, v109
    v_cvt_pk_bf16_f32 v87, v110, v111
    v_pk_fma_f32 v[104:105], v[48:49], v[112:113], v[220:221]
    v_pk_fma_f32 v[106:107], v[50:51], v[114:115], v[222:223]
    v_pk_fma_f32 v[108:109], v[52:53], v[116:117], v[224:225]
    v_pk_fma_f32 v[110:111], v[54:55], v[118:119], v[226:227]
    v_cvt_pk_bf16_f32 v92, v104, v105
    v_cvt_pk_bf16_f32 v93, v106, v107
    v_cvt_pk_bf16_f32 v94, v108, v109
    v_cvt_pk_bf16_f32 v95, v110, v111
    v_pk_fma_f32 v[104:105], v[64:65], v[112:113], v[228:229]
    v_pk_fma_f32 v[106:107], v[66:67], v[114:115], v[230:231]
    v_pk_fma_f32 v[108:109], v[68:69], v[116:117], v[232:233]
    v_pk_fma_f32 v[110:111], v[70:71], v[118:119], v[234:235]
    v_cvt_pk_bf16_f32 v100, v104, v105
    v_cvt_pk_bf16_f32 v101, v106, v107
    v_cvt_pk_bf16_f32 v102, v108, v109
    v_cvt_pk_bf16_f32 v103, v110, v111
    s_waitcnt lgkmcnt(0)
    s_cbranch_scc1 BP_X
NEXT:
    s_cmp_eq_u32 s73, 0
    s_cbranch_scc1 U_1
    s_cmp_eq_u32 s73, 1
    s_cbranch_scc1 U_2
    s_cmp_eq_u32 s73, 2
    s_cbranch_scc1 U_3
    s_branch U_0
EPI:
    s_and_b32 s56, s53, 0x7f
    v_pk_add_f32 v[4:5], v[176:177], v[178:179]
    v_add_f32 v4, v4, v5
    v_lshl_add_u32 v5, s56, 8, v250
    v_mul_f32 v4, s46, v4
    s_bitcmp1_b32 s53, 7
    v_cmp_class_f32_e64 vcc, v4, s45
    v_mov_b64 v[176:177], 0
    v_mov_b64 v[178:179], 0
    ds_write_b32 v5, v4
    s_cbranch_scc1 SLOW
    s_cbranch_vccnz SLOW
EPI_R:
    s_bitcmp1_b32 s52, 6
    s_cbranch_scc1 L_DONE
EPI_C:
    s_bfe_u32 s62, s52, 0x40008
    s_sub_u32 s62, s62, 2
    s_mov_b32 s76, 1
    s_cmp_eq_u32 s73, 0
    s_cbranch_scc1 U_1
    s_cmp_eq_u32 s73, 1
    s_cbranch_scc1 U_2
    s_cmp_eq_u32 s73, 2
    s_cbranch_scc1 U_3
    s_branch U_0
PEV:
    s_cmp_eq_u32 s55, 0
    s_cbranch_scc1 P_DR
    ds_read_b32 v254, v253
    s_waitcnt lgkmcnt(0)
ADV:
    v_readfirstlane_b32 s66, v254
    s_mov_b32 s67, 0
    s_and_b32 s56, s66, 63
    s_bfe_u32 s50, s66, 0x40008
    s_cbranch_scc0 AW
    s_lshr_b32 s57, s56, 3
    s_mul_i32 s51, s56, 25600
    s_mul_i32 s57, s57, 52224000
    s_add_u32 s51, s51, s57
    v_lshl_add_u32 v246, s56, 8, v247
    s_add_u32 s51, s51, s49
    s_add_u32 s72, s51, 1024
    s_lshl_b64 s[64:65], s[66:67], s75
    s_or_b64 s[68:69], s[68:69], s[64:65]
    s_add_u32 s75, s75, 16
    s_mov_b32 s55, 0
    s_sub_u32 s50, s50, 3
    s_cbranch_scc1 P_2
P_RET:
    s_cmp_eq_u32 s73, 0
    s_cbranch_scc1 RET_0
    s_cmp_eq_u32 s73, 1
    s_cbranch_scc1 RET_1
    s_cmp_eq_u32 s73, 2
    s_cbranch_scc1 RET_2
    s_branch RET_3
P_DR:
    v_add_u32 v246, 16, v246
P_D2:
    s_mov_b64 exec, 1
    v_mov_b32 v253, 4
    ds_add_rtn_u32 v253, v251, v253 offset:17600
    s_mov_b64 exec, -1
    s_mov_b32 s50, 1
    s_mov_b32 s55, 1
    s_cmp_eq_u32 s73, 0
    s_cbranch_scc1 RET_0
    s_cmp_eq_u32 s73, 1
    s_cbranch_scc1 RET_1
    s_cmp_eq_u32 s73, 2
    s_cbranch_scc1 RET_2
    s_branch RET_3
P_2:
    s_bitcmp1_b32 s66, 6
    s_cbranch_scc0 P_D2
    v_mov_b32 v246, 16896
    s_movk_i32 s50, 0x100
    s_branch P_RET
DRAIN:
    v_rcp_f32 v2, v2
    v_rcp_f32 v3, v3
    v_fma_f32 v0, v0, v2, s44
    v_fmac_f32 v0, v1, v3
    v_cvt_pk_bf16_f32 v0, v0, v0
    s_bitcmp1_b32 s73, 0
    ds_write_b16 v249, v0
    ds_read_b64 v[236:237], v248
    s_waitcnt lgkmcnt(0)
    s_cbranch_scc1 DRAIN1
    v_mfma_f32_4x4x4_16b_bf16 v[176:179], v[236:237], v[160:161], v[176:179] cbsz:4 abid:0
    s_nop 1
    v_mfma_f32_4x4x4_16b_bf16 v[176:179], v[236:237], v[162:163], v[176:179] cbsz:4 abid:1
    s_nop 1
    v_mfma_f32_4x4x4_16b_bf16 v[176:179], v[236:237], v[164:165], v[176:179] cbsz:4 abid:2
    s_nop 1
    v_mfma_f32_4x4x4_16b_bf16 v[176:179], v[236:237], v[166:167], v[176:179] cbsz:4 abid:3
    s_nop 2
    s_branch EPI
DRAIN1:
    v_mfma_f32_4x4x4_16b_bf16 v[176:179], v[236:237], v[168:169], v[176:179] cbsz:4 abid:0
    s_nop 1
    v_mfma_f32_4x4x4_16b_bf16 v[176:179], v[236:237], v[170:171], v[176:179] cbsz:4 abid:1
    s_nop 1
    v_mfma_f32_4x4x4_16b_bf16 v[176:179], v[236:237], v[172:173], v[176:179] cbsz:4 abid:2
    s_nop 1
    v_mfma_f32_4x4x4_16b_bf16 v[176:179], v[236:237], v[174:175], v[176:179] cbsz:4 abid:3
    s_nop 2
    s_branch EPI
L_DONE:
    s_lshl_b32 s56, s48, 11
    s_add_u32 s56, s56, 133376
    v_lshl_add_u32 v0, v251, 1, s56
    s_lshl_b32 s56, s48, 18
    s_waitcnt lgkmcnt(0)
    s_barrier
    ds_read_b128 v[104:107], v0 offset:0
    ds_read_b128 v[108:111], v0 offset:16
    s_waitcnt lgkmcnt(0)
    v_cvt_pk_bf16_f32 v152, v104, v105
    v_cvt_pk_bf16_f32 v153, v106, v107
    v_cvt_pk_bf16_f32 v154, v108, v109
    v_cvt_pk_bf16_f32 v155, v110, v111
    buffer_store_dwordx4 v[152:155], v251, s[28:31], s56 offen nt
L_FIN:
    s_endpgm
AW:
    s_sleep 1
    ds_read_b32 v254, v253
    s_waitcnt lgkmcnt(0)
    s_branch ADV
DRAW_P:
    s_mov_b64 exec, 1
    v_mov_b32 v253, 4
    ds_add_rtn_u32 v253, v251, v253 offset:17600
    s_mov_b64 exec, -1
    s_add_u32 s50, s50, 2
    s_mov_b32 s55, 1
    s_waitcnt lgkmcnt(0)
    ds_read_b32 v254, v253
    s_branch DRET_P
BP_X:
    s_cmp_eq_u32 s77, 1
    s_mov_b32 s77, 0
    s_cbranch_scc1 SLOW_W
    s_branch EPI_C
SLOW:
    s_bitcmp1_b32 s53, 6
    s_cbranch_scc1 EPI_R
    s_mov_b32 s74, s52
    s_mov_b32 s52, s53
    s_mov_b32 s77, 1
    ds_write_b32 v5, v176
    s_branch BPF
SLOW_W:
    s_mov_b32 s52, s74
    s_and_b32 s56, s53, 63
    s_lshr_b32 s57, s53, 12
    s_bfe_u32 s59, s53, 0x40008
    s_lshl4_add_u32 s57, s56, s57
    s_lshl_b32 s57, s57, 4
    s_add_u32 s74, s57, 116992
    s_bitcmp1_b32 s53, 7
    s_cselect_b64 s[66:67], -1, 0
    s_cselect_b32 s59, 13, s59
    v_bfe_u32 v204, v251, 4, 4
    v_mov_b32 v207, v252
    v_mov_b64 v[180:181], 0
    v_mov_b64 v[182:183], 0
    v_mov_b64 v[184:185], 0
    v_mov_b64 v[186:187], 0
    v_mov_b64 v[188:189], 0
    v_mov_b64 v[190:191], 0
    v_mov_b64 v[192:193], 0
    v_mov_b64 v[194:195], 0
    s_lshr_b32 s58, s56, 3
    s_mul_i32 s57, s56, 25600
    s_mul_i32 s58, s58, 52224000
    s_add_u32 s57, s57, s58
    s_add_u32 s57, s57, s49
    s_lshr_b32 s64, s56, 3
    s_mul_i32 s58, s56, 400
    s_mul_i32 s64, s64, 816000
    s_add_u32 s58, s58, s64
SLOW_L:
    v_add_u32 v205, s74, v204
    ds_read_u8 v206, v205
    s_waitcnt lgkmcnt(0)
    v_cndmask_b32_e64 v206, v206, v204, s[66:67]
    v_lshlrev_b32 v205, 1, v206
    buffer_load_dwordx4 v[196:199], v[206:207], s[20:23], s57 idxen offen offset:1024
    buffer_load_dwordx4 v[200:203], v[206:207], s[20:23], s57 idxen offen offset:1088
    buffer_load_ushort v205, v205, s[24:27], s58 offen
    v_cmp_gt_u32 vcc, 200, v206
    v_add_u32 v204, 16, v204
    s_waitcnt vmcnt(0)
    v_mfma_f32_16x16x32_bf16 v[104:107], v[72:75], v[196:199], v[136:139]
    v_mfma_f32_16x16x32_bf16 v[104:107], v[76:79], v[200:203], v[104:107]
    v_mfma_f32_16x16x32_bf16 v[108:111], v[80:83], v[196:199], v[140:143]
    v_mfma_f32_16x16x32_bf16 v[108:111], v[84:87], v[200:203], v[108:111]
    v_mfma_f32_16x16x32_bf16 v[112:115], v[88:91], v[196:199], v[144:147]
    v_mfma_f32_16x16x32_bf16 v[112:115], v[92:95], v[200:203], v[112:115]
    v_mfma_f32_16x16x32_bf16 v[116:119], v[96:99], v[196:199], v[148:151]
    v_mfma_f32_16x16x32_bf16 v[116:119], v[100:103], v[200:203], v[116:119]
    v_lshlrev_b32 v205, 16, v205
    v_cndmask_b32 v205, 0, v205, vcc
    s_nop 7
    v_exp_f32 v104, v104
    v_exp_f32 v105, v105
    v_exp_f32 v106, v106
    v_exp_f32 v107, v107
    v_exp_f32 v108, v108
    v_exp_f32 v109, v109
    v_exp_f32 v110, v110
    v_exp_f32 v111, v111
    v_exp_f32 v112, v112
    v_exp_f32 v113, v113
    v_exp_f32 v114, v114
    v_exp_f32 v115, v115
    v_exp_f32 v116, v116
    v_exp_f32 v117, v117
    v_exp_f32 v118, v118
    v_exp_f32 v119, v119
    v_add_f32 v104, 1.0, v104
    v_add_f32 v105, 1.0, v105
    v_add_f32 v106, 1.0, v106
    v_add_f32 v107, 1.0, v107
    v_add_f32 v108, 1.0, v108
    v_add_f32 v109, 1.0, v109
    v_add_f32 v110, 1.0, v110
    v_add_f32 v111, 1.0, v111
    v_add_f32 v112, 1.0, v112
    v_add_f32 v113, 1.0, v113
    v_add_f32 v114, 1.0, v114
    v_add_f32 v115, 1.0, v115
    v_add_f32 v116, 1.0, v116
    v_add_f32 v117, 1.0, v117
    v_add_f32 v118, 1.0, v118
    v_add_f32 v119, 1.0, v119
    v_rcp_f32 v104, v104
    v_rcp_f32 v105, v105
    v_rcp_f32 v106, v106
    v_rcp_f32 v107, v107
    v_rcp_f32 v108, v108
    v_rcp_f32 v109, v109
    v_rcp_f32 v110, v110
    v_rcp_f32 v111, v111
    v_rcp_f32 v112, v112
    v_rcp_f32 v113, v113
    v_rcp_f32 v114, v114
    v_rcp_f32 v115, v115
    v_rcp_f32 v116, v116
    v_rcp_f32 v117, v117
    v_rcp_f32 v118, v118
    v_rcp_f32 v119, v119
    v_mul_f32 v208, v104, v120
    v_fmac_f32 v208, v105, v121
    v_ldexp_f32 v208, v208, 60
    v_fmac_f32 v208, v106, v122
    v_fmac_f32 v208, v107, v123
    v_fmac_f32 v208, v108, v124
    v_fmac_f32 v208, v109, v125
    v_fmac_f32 v208, v110, v126
    v_fmac_f32 v208, v111, v127
    v_fmac_f32 v208, v112, v128
    v_fmac_f32 v208, v113, v129
    v_fmac_f32 v208, v114, v130
    v_fmac_f32 v208, v115, v131
    v_fmac_f32 v208, v116, v132
    v_fmac_f32 v208, v117, v133
    v_fmac_f32 v208, v118, v134
    v_fmac_f32 v208, v119, v135
    v_mov_b32 v209, v208
    s_nop 1
    v_permlane32_swap_b32 v208, v209
    v_add_f32 v208, v208, v209
    v_mov_b32 v209, v208
    s_nop 1
    v_permlane16_swap_b32 v208, v209
    v_add_f32 v208, v208, v209
    v_mul_f32 v208, s46, v208
    v_add_f32 v208, s63, v208
    v_mul_f32 v208, v208, v205
    v_lshlrev_b32 v209, 16, v196
    v_and_b32 v210, 0xffff0000, v196
    v_fmac_f32 v180, v208, v209
    v_fmac_f32 v181, v208, v210
    v_lshlrev_b32 v209, 16, v197
    v_and_b32 v210, 0xffff0000, v197
    v_fmac_f32 v182, v208, v209
    v_fmac_f32 v183, v208, v210
    v_lshlrev_b32 v209, 16, v198
    v_and_b32 v210, 0xffff0000, v198
    v_fmac_f32 v184, v208, v209
    v_fmac_f32 v185, v208, v210
    v_lshlrev_b32 v209, 16, v199
    v_and_b32 v210, 0xffff0000, v199
    v_fmac_f32 v186, v208, v209
    v_fmac_f32 v187, v208, v210
    v_lshlrev_b32 v209, 16, v200
    v_and_b32 v210, 0xffff0000, v200
    v_fmac_f32 v188, v208, v209
    v_fmac_f32 v189, v208, v210
    v_lshlrev_b32 v209, 16, v201
    v_and_b32 v210, 0xffff0000, v201
    v_fmac_f32 v190, v208, v209
    v_fmac_f32 v191, v208, v210
    v_lshlrev_b32 v209, 16, v202
    v_and_b32 v210, 0xffff0000, v202
    v_fmac_f32 v192, v208, v209
    v_fmac_f32 v193, v208, v210
    v_lshlrev_b32 v209, 16, v203
    v_and_b32 v210, 0xffff0000, v203
    v_fmac_f32 v194, v208, v209
    v_fmac_f32 v195, v208, v210
    s_sub_u32 s59, s59, 1
    s_cmp_lg_u32 s59, 0
    s_cbranch_scc1 SLOW_L
    v_readfirstlane_b32 s56, v5
    s_nop 1
    v_lshl_add_u32 v208, v252, 1, s56
    ds_add_f32 v208, v180 offset:0
    ds_add_f32 v208, v181 offset:4
    ds_add_f32 v208, v182 offset:8
    ds_add_f32 v208, v183 offset:12
    ds_add_f32 v208, v184 offset:16
    ds_add_f32 v208, v185 offset:20
    ds_add_f32 v208, v186 offset:24
    ds_add_f32 v208, v187 offset:28
    ds_add_f32 v208, v188 offset:128
    ds_add_f32 v208, v189 offset:132
    ds_add_f32 v208, v190 offset:136
    ds_add_f32 v208, v191 offset:140
    ds_add_f32 v208, v192 offset:144
    ds_add_f32 v208, v193 offset:148
    ds_add_f32 v208, v194 offset:152
    ds_add_f32 v208, v195 offset:156
    s_waitcnt lgkmcnt(0)
    s_bitcmp1_b32 s52, 6
    s_cbranch_scc1 L_DONE
    ds_read_b128 v[180:183], v251 offset:0
    ds_read_b128 v[184:187], v251 offset:1024
    ds_read_b128 v[196:199], v251 offset:4096
    ds_read_b128 v[200:203], v251 offset:5120
    ds_read_b128 v[212:215], v251 offset:8192
    ds_read_b128 v[216:219], v251 offset:9216
    ds_read_b128 v[188:191], v251 offset:2048
    ds_read_b128 v[192:195], v251 offset:3072
    ds_read_b128 v[204:207], v251 offset:6144
    ds_read_b128 v[208:211], v251 offset:7168
    ds_read_b128 v[220:223], v251 offset:10240
    ds_read_b128 v[224:227], v251 offset:11264
    ds_read_b128 v[228:231], v251 offset:14336
    ds_read_b128 v[232:235], v251 offset:15360
    s_mov_b32 s77, 2
    s_branch BPF
L_END:
    s_endpgm
.section .rodata,"a"
.p2align 6
.amdhsa_kernel standalone__sequential_behavior_din__recsys_kernel
  .amdhsa_next_free_vgpr 255
  .amdhsa_next_free_sgpr 80
  .amdhsa_accum_offset 256
  .amdhsa_group_segment_fixed_size 0
  .amdhsa_kernarg_size 80
  .amdhsa_user_sgpr_count 2
  .amdhsa_user_sgpr_kernarg_segment_ptr 1
  .amdhsa_system_sgpr_workgroup_id_x 1
.end_amdhsa_kernel
```

```asm
; @launch grid=(256,1,1) block=(512,1,1) lds=153856
.amdgcn_target "amdgcn-amd-amdhsa--gfx950"
.text
.globl standalone__sequential_behavior_din__recsys_kernel
.p2align 8
.type standalone__sequential_behavior_din__recsys_kernel,@function
standalone__sequential_behavior_din__recsys_kernel:
    s_cmpk_ge_u32 s2, 256
    s_cbranch_scc1 L_END
    s_load_dwordx16 s[4:19], s[0:1], 0
    s_setprio 3
    v_lshrrev_b32 v1, 6, v0
    v_and_b32 v176, 63, v0
    v_readfirstlane_b32 s48, v1
    s_getpc_b64 s[40:41]
L_PC:
    s_cmp_lt_u32 s48, 5
    s_cbranch_scc1 P_NC
    s_mov_b32 s42, L_END-L_PC
    s_mov_b32 s43, 0x20000
    v_subrev_u32 v150, 320, v0
    v_lshlrev_b32 v150, 6, v150
    buffer_load_dword v150, v150, s[40:43], 0 offen
P_NC:
    v_and_b32 v2, 31, v0
    v_bfe_u32 v3, v0, 5, 1
    v_cmp_gt_u32 vcc, 25, v2
    v_mul_u32_u24 v4, 400, v3
    v_lshl_add_u32 v179, v2, 4, v4
    v_bfrev_b32 v4, 8
    v_cndmask_b32 v179, v4, v179, vcc
    s_mul_i32 s57, s2, 3200
    s_sub_u32 s26, 6553600, s57
    s_lshr_b32 s59, s48, 2
    s_mul_i32 s71, s48, 800
    s_mul_i32 s59, s59, 816000
    s_add_u32 s71, s71, s59
    s_mov_b32 s27, 0x20000
    s_lshl_b32 s74, s48, 12
    s_lshl_b32 s53, s2, 10
    v_lshlrev_b32 v251, 4, v176
    v_lshlrev_b32 v120, 1, v176
    v_and_b32 v120, 32, v120
    v_xor_b32 v120, v120, v251
    v_xor_b32 v121, 64, v120
    s_mov_b32 s38, 32768
    s_mov_b32 s39, s27
    s_lshl_b32 s58, s48, 18
    s_sub_u32 s34, 2097152, s53
    s_mov_b32 s35, s27
    s_add_u32 m0, s74, 121088
    v_and_b32 v178, 15, v176
    v_lshrrev_b32 v177, 4, v176
    v_lshlrev_b32 v252, 4, v177
    v_mul_u32_u24 v208, 0x80008, v2
    v_lshrrev_b32 v238, 3, v176
    v_add_u32 v208, 0x10000, v208
    v_cmp_gt_u32 vcc, 32, v176
    s_waitcnt lgkmcnt(0)
    s_add_u32 s24, s8, s57
    s_addc_u32 s25, s9, 0
    s_mov_b64 s[36:37], s[10:11]
    buffer_load_dwordx4 v[204:207], v179, s[24:27], s71 offen offset:0 nt
    s_setprio 0
    s_add_u32 s32, s4, s53
    s_addc_u32 s33, s5, 0
    s_load_dword s63, s[16:17], 0
    s_cmp_lg_u32 s48, 0
    s_cbranch_scc1 P_LJ
    v_mov_b32 v146, s12
    v_mov_b32 v147, s13
    v_mov_b32 v148, s14
    v_mov_b32 v149, s15
    v_lshlrev_b32 v4, 2, v2
    v_cndmask_b32 v146, v146, v148, vcc
    v_cndmask_b32 v147, v147, v149, vcc
    v_add_co_u32 v146, vcc, v146, v4
    s_nop 1
    v_addc_co_u32 v147, vcc, 0, v147, vcc
    global_load_dword v146, v[146:147], off
P_LJ:
    buffer_load_dwordx4 v[124:127], v251, s[32:35], s58 offen nt
    buffer_load_dwordx4 v120, s[36:39], s74 offen offset:0 lds
    buffer_load_dwordx4 v121, s[36:39], s74 offen offset:1024 lds
    s_lshl1_add_u32 s54, s74, 17664
    s_mul_i32 s49, s2, 204800
    s_lshl_b32 s57, s48, 9
    v_add_u32 v247, 116992, v238
    v_add_u32 v246, s57, v247
    s_add_u32 s56, s57, 116992
    v_add_u32 v209, 0x20002, v208
    v_add_u32 v210, 0x40004, v208
    v_add_u32 v211, 0x60006, v208
    s_sub_u32 s20, s6, 1024
    s_subb_u32 s21, s7, 0
    s_or_b32 s21, s21, 0x800000
    s_movk_i32 s22, 200
    s_mov_b32 s23, s27
    s_movk_i32 s61, 0x3f80
    v_lshrrev_b32 v216, 1, v251
    v_and_b32 v213, 0x100, v216
    v_mov_b64 v[214:215], -1
    v_lshlrev_b32 v250, 2, v176
    v_bfrev_b32 v2, v238
    v_lshrrev_b32 v2, 28, v2
    v_and_b32 v2, 6, v2
    v_xor_b32 v2, v2, v176
    v_and_b32 v2, 7, v2
    v_mul_u32_u24 v143, 528, v238
    v_lshlrev_b32 v239, 4, v2
    v_lshlrev_b32 v241, 4, v2
    v_lshlrev_b32 v153, 4, v2
    v_lshlrev_b32 v155, 4, v2
    s_add_u32 s28, s18, s53
    s_addc_u32 s29, s19, 0
    s_sub_u32 s30, 2097152, s53
    s_mov_b32 s31, s27
    s_mov_b32 s60, 0xbfb8aa3b
    s_mov_b32 s42, 0x21800000
    s_mov_b32 s46, 0x2b800000
    s_lshr_b32 s59, s48, 2
    s_mul_i32 s51, s48, 51200
    s_mul_i32 s59, s59, 52224000
    s_add_u32 s51, s51, s59
    s_add_u32 s51, s51, s49
    s_add_u32 s72, s51, 1024
    v_bfrev_b32 v2, v178
    v_lshrrev_b32 v2, 28, v2
    v_and_b32 v2, 6, v2
    v_xor_b32 v2, v2, v177
    v_lshl_add_u32 v2, v2, 4, s54
    v_lshl_add_u32 v242, v178, 7, v2
    v_xor_b32 v243, 64, v242
    v_and_b32 v3, 3, v176
    v_bfe_u32 v2, v176, 2, 2
    v_lshlrev_b32 v7, 3, v3
    v_lshl_add_u32 v7, v2, 7, v7
    v_and_b32 v6, 8, v176
    v_lshlrev_b32 v6, 3, v6
    v_lshl_add_u32 v244, v177, 5, v7
    v_xor_b32 v244, v244, v6
    v_add_u32 v244, s54, v244
    v_xor_b32 v245, 32, v244
    s_lshl_b32 s57, s48, 7
    s_add_u32 s57, s57, 150016
    v_lshl_add_u32 v249, v2, 2, v177
    v_lshl_add_u32 v249, v249, 2, v3
    v_lshl_add_u32 v249, v249, 1, s57
    v_lshl_add_u32 v248, v178, 3, s57
    v_and_b32 v6, 0x60, v250
    v_or_b32 v6, v6, v7
    v_lshl_add_u32 v136, v177, 10, v6
    s_mul_i32 s57, s48, 0x1010
    s_and_b32 s57, s57, 0x1060
    v_xor_b32 v144, s57, v136
    v_add_u32 v136, 121088, v136
    v_add_u32 v144, 121088, v144
    v_xor_b32 v137, 32, v136
    v_xor_b32 v138, 64, v136
    v_xor_b32 v139, 96, v136
    s_and_b32 s59, s48, 4
    s_lshl_b32 s59, s59, 4
    v_xor_b32 v140, s59, v136
    v_xor_b32 v141, 32, v140
    s_and_b32 s57, s48, 3
    s_mul_i32 s57, s57, 8448
    s_lshl1_add_u32 s57, s59, s57
    s_add_u32 s57, s57, 83200
    v_mul_u32_u24 v145, 528, v178
    v_add3_u32 v145, v145, v252, s57
    v_lshl_add_u32 v142, s59, 1, v252
    s_mul_i32 s57, s48, 4224
    s_add_u32 s57, s57, 83200
    v_and_b32 v3, 0x70, v251
    v_add3_u32 v143, v143, v3, s57
    v_add_u32 v3, v143, v3
    s_lshl_b32 s57, s48, 11
    v_add_u32 v151, s57, v251
    s_mov_b32 s66, 0x1b0a0100
    s_mov_b32 s67, 0x966d4c33
    s_lshl_b32 s57, s48, 3
    s_lshr_b64 s[66:67], s[66:67], s57
    s_and_b32 s47, s66, 7
    s_bfe_u32 s70, s66, 0x50003
    s_lshl1_add_u32 s70, s70, 16
    s_mul_i32 s71, s70, 400
    buffer_load_dwordx4 v120, s[36:39], s74 offen offset:2048 lds
    buffer_load_dwordx4 v121, s[36:39], s74 offen offset:3072 lds
    s_cmp_eq_u32 s48, 0
    s_waitcnt vmcnt(6) lgkmcnt(0)
    s_cbranch_scc1 P_M0
    s_waitcnt vmcnt(5)
P_M0:
    s_call_b64 s[36:37], CMP
    s_branch P_C
    .p2align 3
CMP:
    v_bcnt_u32_b32 v7, v204, 0
    v_bcnt_u32_b32 v7, v205, v7
    v_bcnt_u32_b32 v7, v206, v7
    v_bcnt_u32_b32 v7, v207, v7
    v_add_u32 v4, s56, v216
    v_mov_b32 v6, v7
    ds_write_b64 v4, v[214:215]
    v_cmp_eq_u16_e64 s[4:5], s61, v204
    v_cmp_eq_u16_sdwa s[6:7], v204, s61 src0_sel:WORD_1 src1_sel:WORD_0
    v_add_u32_dpp v6, v6, v6 row_shr:1 row_mask:0xf bank_mask:0xf bound_ctrl:0
    v_cmp_eq_u16_e64 s[8:9], s61, v205
    v_cmp_eq_u16_sdwa s[10:11], v205, s61 src0_sel:WORD_1 src1_sel:WORD_0
    v_add_u32_dpp v6, v6, v6 row_shr:2 row_mask:0xf bank_mask:0xf bound_ctrl:0
    v_cmp_eq_u16_e64 s[12:13], s61, v206
    v_cmp_eq_u16_sdwa s[14:15], v206, s61 src0_sel:WORD_1 src1_sel:WORD_0
    v_add_u32_dpp v6, v6, v6 row_shr:4 row_mask:0xf bank_mask:0xf bound_ctrl:0
    v_cmp_eq_u16_e64 s[16:17], s61, v207
    v_cmp_eq_u16_sdwa s[18:19], v207, s61 src0_sel:WORD_1 src1_sel:WORD_0
    v_add_u32_dpp v6, v6, v6 row_shr:8 row_mask:0xf bank_mask:0xf bound_ctrl:0
    s_nop 1
    v_add_u32_dpp v6, v6, v6 row_bcast:15 row_mask:0xa bank_mask:0xf
    v_sub_u32 v6, v6, v7
    v_mul_u32_u24 v6, 9363, v6
    v_lshrrev_b32 v6, 16, v6
    v_min_u32 v6, 200, v6
    v_add3_u32 v226, v6, v213, s56
    v_readlane_b32 s59, v6, 31
    v_readlane_b32 s58, v6, 63
    v_addc_co_u32_e64 v227, vcc, 0, v226, s[4:5]
    v_addc_co_u32_e64 v228, vcc, 0, v227, s[6:7]
    v_addc_co_u32_e64 v229, vcc, 0, v228, s[8:9]
    v_addc_co_u32_e64 v230, vcc, 0, v229, s[10:11]
    v_addc_co_u32_e64 v231, vcc, 0, v230, s[12:13]
    v_addc_co_u32_e64 v232, vcc, 0, v231, s[14:15]
    v_addc_co_u32_e64 v233, vcc, 0, v232, s[16:17]
    v_addc_co_u32_e64 v234, vcc, 0, v233, s[18:19]
    s_mov_b64 exec, s[4:5]
    ds_write_b8 v226, v208
    s_mov_b64 exec, s[6:7]
    ds_write_b8_d16_hi v227, v208
    s_mov_b64 exec, s[8:9]
    ds_write_b8 v228, v209
    s_mov_b64 exec, s[10:11]
    ds_write_b8_d16_hi v229, v209
    s_mov_b64 exec, s[12:13]
    ds_write_b8 v230, v210
    s_mov_b64 exec, s[14:15]
    ds_write_b8_d16_hi v231, v210
    s_mov_b64 exec, s[16:17]
    ds_write_b8 v232, v211
    s_mov_b64 exec, s[18:19]
    ds_write_b8_d16_hi v233, v211
    s_mov_b64 exec, -1
    v_sub_u32 v6, v234, v226
    v_mul_u32_u24 v6, 7, v6
    v_cmp_ne_u32 vcc, v6, v7
    s_min_u32 s64, vcc_lo, 1
    s_min_u32 s65, vcc_hi, 1
    s_lshl_b64 s[64:65], s[64:65], 15
    s_or_b32 s57, s59, s64
    s_or_b32 s58, s58, s65
    s_setpc_b64 s[36:37]
P_C:
    ds_read_u8 v238, v246 offset:0
    ds_read_u8 v240, v246 offset:8
    ds_read_u8 v152, v246 offset:16
    ds_read_u8 v154, v246 offset:24
    s_add_u32 m0, s54, 0
    s_waitcnt lgkmcnt(3)
    buffer_load_dwordx4 v[238:239], s[20:23], s72 idxen offen nt lds
    s_waitcnt lgkmcnt(2)
    buffer_load_dwordx4 v[240:241], s[20:23], s51 idxen offen offset:1024 nt lds
    s_add_u32 m0, s54, 2048
    s_waitcnt lgkmcnt(1)
    buffer_load_dwordx4 v[152:153], s[20:23], s72 idxen offen nt lds
    s_waitcnt lgkmcnt(0)
    buffer_load_dwordx4 v[154:155], s[20:23], s51 idxen offen offset:1024 nt lds
    s_lshl_b32 s63, s63, 16
    s_cmp_lg_u32 s48, 0
    s_waitcnt vmcnt(8)
    s_cbranch_scc1 P_SW_J
    v_lshlrev_b32 v148, 16, v146
    v_and_b32 v149, 0xffff0000, v146
    v_mov_b32 v4, -1
    v_mov_b32 v5, 0
    v_mov_b32 v6, 0x240
    v_lshrrev_b32 v0, 1, v251
    ds_write2st64_b32 v250, v4, v5 offset0:66 offset1:67
    s_mov_b32 exec_hi, 0
    v_max3_f32 v2, abs(v148), abs(v149), abs(s63)
    v_ldexp_f32 v148, v148, 40
    v_ldexp_f32 v149, v149, 40
    v_cmp_le_f32 vcc, 0x33800000, v2
    s_mov_b32 exec_lo, 0x55
    v_mul_f32 v148, s42, v148
    v_mul_f32 v149, s42, v149
    s_mov_b32 exec_lo, -1
    ds_write_b32 v250, v6 offset:17408
    s_mov_b32 exec_hi, -1
    s_movk_i32 s56, 0x3ff
    s_cmp_lg_u64 vcc, 0
    s_cmovk_i32 s56, 0x207
    v_mov_b32 v6, 17184
    v_mov_b32 v7, s56
    ds_write_b64 v0, v[148:149] offset:16384
    ds_write_b64 v5, v[6:7] offset:17600
P_SW_J:
    ds_write_b128 v143, v[124:127] offset:256
    ds_write_b128 v143, v[124:127] offset:384
    s_waitcnt vmcnt(4) lgkmcnt(0)
    s_barrier
    ds_read_b64_tr_b16 v[218:219], v144 offset:0
    ds_read_b64_tr_b16 v[220:221], v144 offset:512
    ds_read_b64_tr_b16 v[222:223], v144 offset:16384
    ds_read_b64_tr_b16 v[224:225], v144 offset:16896
    ds_read_b128 v[160:163], v145 offset:256
    ds_read_b128 v[164:167], v145 offset:320
    ds_read_b128 v[104:107], v142 offset:16640
    ds_read_b128 v[108:111], v142 offset:16704
    ds_read_b64_tr_b16 v[40:41], v140 offset:8192
    ds_read_b64_tr_b16 v[42:43], v140 offset:8704
    ds_read_b64_tr_b16 v[44:45], v141 offset:8192
    ds_read_b64_tr_b16 v[46:47], v141 offset:8704
    ds_read_b64_tr_b16 v[48:49], v140 offset:12288
    ds_read_b64_tr_b16 v[50:51], v140 offset:12800
    ds_read_b64_tr_b16 v[52:53], v141 offset:12288
    ds_read_b64_tr_b16 v[54:55], v141 offset:12800
    ds_read_b64_tr_b16 v[56:57], v140 offset:16384
    ds_read_b64_tr_b16 v[58:59], v140 offset:16896
    ds_read_b64_tr_b16 v[60:61], v141 offset:16384
    ds_read_b64_tr_b16 v[62:63], v141 offset:16896
    ds_read_b64_tr_b16 v[64:65], v140 offset:20480
    ds_read_b64_tr_b16 v[66:67], v140 offset:20992
    ds_read_b64_tr_b16 v[68:69], v141 offset:20480
    ds_read_b64_tr_b16 v[70:71], v141 offset:20992
    s_and_b32 s59, s57, 0xff
    s_lshr_b32 s57, s57, 8
    s_add_u32 s59, s59, 15
    s_and_b32 s52, s59, 15
    s_lshl_b32 s52, s52, 12
    s_or_b32 s57, s57, s52
    s_lshr_b32 s59, s59, 4
    s_max_u32 s59, s59, 3
    s_lshl1_add_u32 s52, s48, s57
    s_lshl_b32 s57, s59, 8
    s_or_b32 s52, s52, s57
    s_sub_u32 s50, s59, 3
    s_and_b32 s59, s58, 0xff
    s_lshr_b32 s58, s58, 8
    s_add_u32 s59, s59, 15
    s_and_b32 s74, s59, 15
    s_lshl_b32 s74, s74, 12
    s_or_b32 s58, s58, s74
    s_lshr_b32 s59, s59, 4
    s_max_u32 s59, s59, 2
    s_lshl1_add_u32 s74, s48, s58
    s_lshl_b32 s58, s59, 8
    s_or_b32 s74, s74, s58
    s_or_b32 s74, s74, 1
    v_lshlrev_b32 v24, 16, v124
    v_and_b32 v25, 0xffff0000, v124
    v_lshlrev_b32 v26, 16, v125
    v_and_b32 v27, 0xffff0000, v125
    v_lshlrev_b32 v28, 16, v126
    v_and_b32 v29, 0xffff0000, v126
    v_lshlrev_b32 v30, 16, v127
    v_and_b32 v31, 0xffff0000, v127
    v_mul_f32 v24, s60, v24
    v_mul_f32 v25, s60, v25
    v_mul_f32 v26, s60, v26
    v_mul_f32 v27, s60, v27
    v_mul_f32 v28, s60, v28
    v_mul_f32 v29, s60, v29
    v_mul_f32 v30, s60, v30
    v_mul_f32 v31, s60, v31
    s_waitcnt lgkmcnt(15)
    v_lshlrev_b32 v8, 16, v218
    v_and_b32 v9, 0xffff0000, v218
    v_lshlrev_b32 v16, 16, v222
    v_and_b32 v17, 0xffff0000, v222
    v_lshlrev_b32 v10, 16, v219
    v_and_b32 v11, 0xffff0000, v219
    v_lshlrev_b32 v18, 16, v223
    v_and_b32 v19, 0xffff0000, v223
    v_lshlrev_b32 v12, 16, v220
    v_and_b32 v13, 0xffff0000, v220
    v_lshlrev_b32 v20, 16, v224
    v_and_b32 v21, 0xffff0000, v224
    v_lshlrev_b32 v14, 16, v221
    v_and_b32 v15, 0xffff0000, v221
    v_lshlrev_b32 v22, 16, v225
    v_and_b32 v23, 0xffff0000, v225
    v_xor_b32 v168, 0x80008000, v160
    v_xor_b32 v169, 0x80008000, v161
    v_xor_b32 v170, 0x80008000, v162
    v_xor_b32 v171, 0x80008000, v163
    v_xor_b32 v172, 0x80008000, v164
    v_xor_b32 v173, 0x80008000, v165
    v_xor_b32 v174, 0x80008000, v166
    v_xor_b32 v175, 0x80008000, v167
    s_waitcnt lgkmcnt(12)
    v_mfma_f32_16x16x32_bf16 v[104:107], v[40:43], v[160:163], v[104:107]
    v_mfma_f32_16x16x32_bf16 v[108:111], v[44:47], v[160:163], v[108:111]
    v_add_f32 v112, v8, v16
    v_add_f32 v113, v9, v17
    s_waitcnt lgkmcnt(8)
    v_mfma_f32_16x16x32_bf16 v[104:107], v[48:51], v[164:167], v[104:107]
    v_mfma_f32_16x16x32_bf16 v[108:111], v[52:55], v[164:167], v[108:111]
    v_add_f32 v114, v10, v18
    v_add_f32 v115, v11, v19
    s_waitcnt lgkmcnt(4)
    v_mfma_f32_16x16x32_bf16 v[104:107], v[56:59], v[168:171], v[104:107]
    v_mfma_f32_16x16x32_bf16 v[108:111], v[60:63], v[168:171], v[108:111]
    v_add_f32 v116, v12, v20
    v_add_f32 v117, v13, v21
    s_waitcnt lgkmcnt(0)
    v_mfma_f32_16x16x32_bf16 v[104:107], v[64:67], v[172:175], v[104:107]
    v_mfma_f32_16x16x32_bf16 v[108:111], v[68:71], v[172:175], v[108:111]
    v_add_f32 v118, v14, v22
    v_add_f32 v119, v15, v23
    ds_read_b64_tr_b16 v[72:73], v136 offset:24576
    ds_read_b64_tr_b16 v[74:75], v136 offset:25088
    ds_read_b64_tr_b16 v[76:77], v136 offset:28672
    ds_read_b64_tr_b16 v[78:79], v136 offset:29184
    ds_read_b64_tr_b16 v[80:81], v137 offset:24576
    ds_read_b64_tr_b16 v[82:83], v137 offset:25088
    ds_read_b64_tr_b16 v[84:85], v137 offset:28672
    ds_read_b64_tr_b16 v[86:87], v137 offset:29184
    ds_read_b64_tr_b16 v[88:89], v138 offset:24576
    ds_read_b64_tr_b16 v[90:91], v138 offset:25088
    ds_read_b64_tr_b16 v[92:93], v138 offset:28672
    ds_read_b64_tr_b16 v[94:95], v138 offset:29184
    ds_read_b64_tr_b16 v[96:97], v139 offset:24576
    ds_read_b64_tr_b16 v[98:99], v139 offset:25088
    ds_read_b64_tr_b16 v[100:101], v139 offset:28672
    ds_read_b64_tr_b16 v[102:103], v139 offset:29184
    s_cmp_le_u32 s47, 0
    s_cbranch_scc1 P_MJ
    s_lshr_b32 s56, s70, 1
    s_lshr_b32 s59, s56, 2
    s_mul_i32 s71, s56, 800
    s_mul_i32 s59, s59, 816000
    s_add_u32 s71, s71, s59
    buffer_load_dwordx4 v[180:183], v179, s[24:27], s71 offen offset:0 nt
    s_cmp_le_u32 s47, 1
    s_cbranch_scc1 P_MJ
    s_lshr_b32 s56, s70, 1
    s_add_u32 s56, s56, 1
    s_lshr_b32 s59, s56, 2
    s_mul_i32 s71, s56, 800
    s_mul_i32 s59, s59, 816000
    s_add_u32 s71, s71, s59
    buffer_load_dwordx4 v[184:187], v179, s[24:27], s71 offen offset:0 nt
    s_cmp_le_u32 s47, 2
    s_cbranch_scc1 P_MJ
    s_lshr_b32 s56, s70, 1
    s_add_u32 s56, s56, 2
    s_lshr_b32 s59, s56, 2
    s_mul_i32 s71, s56, 800
    s_mul_i32 s59, s59, 816000
    s_add_u32 s71, s71, s59
    buffer_load_dwordx4 v[188:191], v179, s[24:27], s71 offen offset:0 nt
    s_cmp_le_u32 s47, 3
    s_cbranch_scc1 P_MJ
    s_lshr_b32 s56, s70, 1
    s_add_u32 s56, s56, 3
    s_lshr_b32 s59, s56, 2
    s_mul_i32 s71, s56, 800
    s_mul_i32 s59, s59, 816000
    s_add_u32 s71, s71, s59
    buffer_load_dwordx4 v[192:195], v179, s[24:27], s71 offen offset:0 nt
    s_cmp_le_u32 s47, 4
    s_cbranch_scc1 P_MJ
    s_lshr_b32 s56, s70, 1
    s_add_u32 s56, s56, 4
    s_lshr_b32 s59, s56, 2
    s_mul_i32 s71, s56, 800
    s_mul_i32 s59, s59, 816000
    s_add_u32 s71, s71, s59
    buffer_load_dwordx4 v[196:199], v179, s[24:27], s71 offen offset:0 nt
    s_cmp_le_u32 s47, 5
    s_cbranch_scc1 P_MJ
    s_lshr_b32 s56, s70, 1
    s_add_u32 s56, s56, 5
    s_lshr_b32 s59, s56, 2
    s_mul_i32 s71, s56, 800
    s_mul_i32 s59, s59, 816000
    s_add_u32 s71, s71, s59
    buffer_load_dwordx4 v[200:203], v179, s[24:27], s71 offen offset:0 nt
P_MJ:
    v_mul_f32 v112, s60, v112
    v_mul_f32 v113, s60, v113
    v_mul_f32 v114, s60, v114
    v_mul_f32 v115, s60, v115
    v_mul_f32 v116, s60, v116
    v_mul_f32 v117, s60, v117
    v_mul_f32 v118, s60, v118
    v_mul_f32 v119, s60, v119
    ds_write_b128 v151, v[112:115] offset:0
    ds_write_b128 v151, v[116:119] offset:1024
    v_mul_f32 v104, s60, v104
    v_mul_f32 v105, s60, v105
    v_mul_f32 v106, s60, v106
    v_mul_f32 v107, s60, v107
    v_mul_f32 v108, s60, v108
    v_mul_f32 v109, s60, v109
    v_mul_f32 v110, s60, v110
    v_mul_f32 v111, s60, v111
    ds_write_b128 v145, v[104:107] offset:256
    ds_write_b128 v145, v[108:111] offset:320
    ds_write_b128 v3, v[24:27] offset:0
    ds_write_b128 v3, v[28:31] offset:16
    ds_read_b128 v[120:123], v252 offset:16384
    ds_read_b128 v[124:127], v252 offset:16448
    ds_read_b128 v[128:131], v252 offset:16512
    ds_read_b128 v[132:135], v252 offset:16576
    ds_read_b32 v150, v252 offset:17604
    s_lshl2_add_u32 s56, s48, 17184
    v_mov_b32 v253, s56
    v_mov_b32 v254, s74
    ds_write_b32 v253, v254
    v_ldexp_f32 v2, s63, 38
    v_add_u32 v250, 133376, v250
    v_mov_b64 v[168:169], 0
    v_mov_b64 v[170:171], 0
    v_mov_b64 v[172:173], 0
    v_mov_b64 v[174:175], 0
    v_readfirstlane_b32 s44, v2
    s_waitcnt lgkmcnt(15)
    v_lshlrev_b32 v8, 16, v72
    v_and_b32 v9, 0xffff0000, v72
    v_lshlrev_b32 v10, 16, v73
    v_and_b32 v11, 0xffff0000, v73
    v_lshlrev_b32 v12, 16, v74
    v_and_b32 v13, 0xffff0000, v74
    v_lshlrev_b32 v14, 16, v75
    v_and_b32 v15, 0xffff0000, v75
    v_lshlrev_b32 v16, 16, v76
    v_and_b32 v17, 0xffff0000, v76
    v_lshlrev_b32 v18, 16, v77
    v_and_b32 v19, 0xffff0000, v77
    v_lshlrev_b32 v20, 16, v78
    v_and_b32 v21, 0xffff0000, v78
    v_lshlrev_b32 v22, 16, v79
    v_and_b32 v23, 0xffff0000, v79
    v_lshlrev_b32 v24, 16, v80
    v_and_b32 v25, 0xffff0000, v80
    v_lshlrev_b32 v26, 16, v81
    v_and_b32 v27, 0xffff0000, v81
    v_lshlrev_b32 v28, 16, v82
    v_and_b32 v29, 0xffff0000, v82
    v_lshlrev_b32 v30, 16, v83
    v_and_b32 v31, 0xffff0000, v83
    v_lshlrev_b32 v32, 16, v84
    v_and_b32 v33, 0xffff0000, v84
    v_lshlrev_b32 v34, 16, v85
    v_and_b32 v35, 0xffff0000, v85
    v_lshlrev_b32 v36, 16, v86
    v_and_b32 v37, 0xffff0000, v86
    v_lshlrev_b32 v38, 16, v87
    v_and_b32 v39, 0xffff0000, v87
    ds_read_u8 v238, v246 offset:32
    ds_read_u8 v240, v246 offset:40
    s_add_u32 m0, s54, 4096
    v_add_u32 v246, 32, v246
    s_mov_b64 s[68:69], 0
    s_mov_b32 s75, 0
    s_movk_i32 s53, 0x1040
    s_mov_b32 s73, 3
    s_mov_b32 s77, 0
    s_mov_b32 s55, 0
    v_mov_b64 v[0:1], 0
    v_mov_b32 v2, 1.0
    v_mov_b32 v3, 1.0
    s_waitcnt lgkmcnt(0)
    s_barrier
    v_readfirstlane_b32 s45, v150
    buffer_load_dwordx4 v[238:239], s[20:23], s72 idxen offen nt lds
    buffer_load_dwordx4 v[240:241], s[20:23], s51 idxen offen offset:1024 nt lds
    s_cmp_eq_u32 s47, 0
    s_cbranch_scc1 P_GO
    s_lshl_b32 s56, s70, 8
    s_add_u32 s56, s56, 116992
    s_waitcnt vmcnt(2)
    v_mov_b64 v[204:205], v[180:181]
    v_mov_b64 v[206:207], v[182:183]
    s_call_b64 s[36:37], CMP
    v_writelane_b32 v212, s57, 0
    v_writelane_b32 v212, s58, 1
    s_cmp_le_u32 s47, 1
    s_cbranch_scc1 LATE_D
    s_add_u32 s56, s56, 512
    v_mov_b64 v[204:205], v[184:185]
    v_mov_b64 v[206:207], v[186:187]
    s_call_b64 s[36:37], CMP
    v_writelane_b32 v212, s57, 2
    v_writelane_b32 v212, s58, 3
    s_cmp_le_u32 s47, 2
    s_cbranch_scc1 LATE_D
    s_add_u32 s56, s56, 512
    v_mov_b64 v[204:205], v[188:189]
    v_mov_b64 v[206:207], v[190:191]
    s_call_b64 s[36:37], CMP
    v_writelane_b32 v212, s57, 4
    v_writelane_b32 v212, s58, 5
    s_cmp_le_u32 s47, 3
    s_cbranch_scc1 LATE_D
    s_add_u32 s56, s56, 512
    v_mov_b64 v[204:205], v[192:193]
    v_mov_b64 v[206:207], v[194:195]
    s_call_b64 s[36:37], CMP
    v_writelane_b32 v212, s57, 6
    v_writelane_b32 v212, s58, 7
    s_cmp_le_u32 s47, 4
    s_cbranch_scc1 LATE_D
    s_add_u32 s56, s56, 512
    v_mov_b64 v[204:205], v[196:197]
    v_mov_b64 v[206:207], v[198:199]
    s_call_b64 s[36:37], CMP
    v_writelane_b32 v212, s57, 8
    v_writelane_b32 v212, s58, 9
    s_cmp_le_u32 s47, 5
    s_cbranch_scc1 LATE_D
    s_add_u32 s56, s56, 512
    v_mov_b64 v[204:205], v[200:201]
    v_mov_b64 v[206:207], v[202:203]
    s_call_b64 s[36:37], CMP
    v_writelane_b32 v212, s57, 10
    v_writelane_b32 v212, s58, 11
LATE_D:
    v_add_u32 v4, s70, v176
    s_lshl_b32 s56, s47, 1
    v_and_b32 v5, 0xff, v212
    v_add_u32 v5, 15, v5
    v_lshrrev_b32 v212, 8, v212
    v_and_b32 v6, 15, v5
    v_lshl_or_b32 v212, v6, 12, v212
    v_lshrrev_b32 v5, 4, v5
    v_max_u32 v5, 2, v5
    v_or_b32 v212, v212, v4
    v_cmp_gt_u32 vcc, 64, v4
    v_lshl_or_b32 v6, v5, 8, v212
    v_lshlrev_b32 v4, 2, v4
    s_bfm_b64 s[66:67], s56, 0
    s_and_b64 exec, s[66:67], vcc
    ds_write_b32 v4, v6 offset:17152
    s_mov_b64 exec, -1
P_GO:
    ds_read_b128 v[180:183], v251 offset:0
    ds_read_b128 v[184:187], v251 offset:1024
    ds_read_b128 v[196:199], v251 offset:4096
    ds_read_b128 v[200:203], v251 offset:5120
    ds_read_b128 v[212:215], v251 offset:8192
    ds_read_b128 v[216:219], v251 offset:9216
    ds_read_b128 v[188:191], v251 offset:2048
    ds_read_b128 v[192:195], v251 offset:3072
    ds_read_b128 v[204:207], v251 offset:6144
    ds_read_b128 v[208:211], v251 offset:7168
    ds_read_b128 v[220:223], v251 offset:10240
    ds_read_b128 v[224:227], v251 offset:11264
    ds_read_b128 v[228:231], v251 offset:14336
    ds_read_b128 v[232:235], v251 offset:15360
    v_lshlrev_b32 v40, 16, v88
    v_and_b32 v41, 0xffff0000, v88
    v_lshlrev_b32 v42, 16, v89
    v_and_b32 v43, 0xffff0000, v89
    v_lshlrev_b32 v44, 16, v90
    v_and_b32 v45, 0xffff0000, v90
    v_lshlrev_b32 v46, 16, v91
    v_and_b32 v47, 0xffff0000, v91
    v_lshlrev_b32 v48, 16, v92
    v_and_b32 v49, 0xffff0000, v92
    v_lshlrev_b32 v50, 16, v93
    v_and_b32 v51, 0xffff0000, v93
    v_lshlrev_b32 v52, 16, v94
    v_and_b32 v53, 0xffff0000, v94
    v_lshlrev_b32 v54, 16, v95
    v_and_b32 v55, 0xffff0000, v95
    v_lshlrev_b32 v56, 16, v96
    v_and_b32 v57, 0xffff0000, v96
    v_lshlrev_b32 v58, 16, v97
    v_and_b32 v59, 0xffff0000, v97
    v_lshlrev_b32 v60, 16, v98
    v_and_b32 v61, 0xffff0000, v98
    v_lshlrev_b32 v62, 16, v99
    v_and_b32 v63, 0xffff0000, v99
    v_lshlrev_b32 v64, 16, v100
    v_and_b32 v65, 0xffff0000, v100
    v_lshlrev_b32 v66, 16, v101
    v_and_b32 v67, 0xffff0000, v101
    v_lshlrev_b32 v68, 16, v102
    v_and_b32 v69, 0xffff0000, v102
    v_lshlrev_b32 v70, 16, v103
    v_and_b32 v71, 0xffff0000, v103
    v_mov_b64 v[176:177], 0
    v_mov_b64 v[178:179], 0
    s_sub_u32 s50, s50, 2
    s_cbranch_scc1 DRAW_P
DRET_P:
    s_waitcnt vmcnt(4)
    ds_read_b128 v[152:155], v242
    ds_read_b128 v[156:159], v243
    s_branch BPF
U_0:
    v_mfma_f32_16x16x32_bf16 v[104:107], v[72:75], v[152:155], v[136:139]
    s_add_u32 m0, s54, 6144
    v_rcp_f32 v2, v2
    v_mfma_f32_16x16x32_bf16 v[104:107], v[76:79], v[156:159], v[104:107]
    s_mov_b32 s73, 0
    v_rcp_f32 v3, v3
    v_mfma_f32_16x16x32_bf16 v[108:111], v[80:83], v[152:155], v[140:143]
    s_sub_u32 s50, s50, 1
    v_fma_f32 v0, v0, v2, s44
    v_fmac_f32 v0, v1, v3
    v_mfma_f32_16x16x32_bf16 v[108:111], v[84:87], v[156:159], v[108:111]
    s_cbranch_scc1 PEV
    v_add_u32 v246, 16, v246
RET_0:
    v_cvt_pk_bf16_f32 v0, v0, v0
    v_mfma_f32_16x16x32_bf16 v[112:115], v[88:91], v[152:155], v[144:147]
    v_exp_f32 v104, v104
    v_mfma_f32_16x16x32_bf16 v[112:115], v[92:95], v[156:159], v[112:115]
    v_exp_f32 v105, v105
    v_mfma_f32_16x16x32_bf16 v[116:119], v[96:99], v[152:155], v[148:151]
    s_sub_u32 s62, s62, 1
    v_exp_f32 v106, v106
    v_mfma_f32_16x16x32_bf16 v[116:119], v[100:103], v[156:159], v[116:119]
    v_exp_f32 v107, v107
    ds_write_b16 v249, v0
    ds_read_b64 v[236:237], v248
    ds_read_b64_tr_b16 v[160:161], v244 offset:0
    ds_read_b64_tr_b16 v[162:163], v245 offset:512
    ds_read_b64_tr_b16 v[164:165], v244 offset:1024
    ds_read_b64_tr_b16 v[166:167], v245 offset:1536
    ds_read_u8 v238, v246 offset:0
    ds_read_u8 v240, v246 offset:8
    v_exp_f32 v108, v108
    v_exp_f32 v109, v109
    v_exp_f32 v110, v110
    v_exp_f32 v111, v111
    s_waitcnt lgkmcnt(6)
    v_mfma_f32_4x4x4_16b_bf16 v[176:179], v[236:237], v[168:169], v[176:179] cbsz:4 abid:0
    v_exp_f32 v112, v112
    v_exp_f32 v113, v113
    v_mfma_f32_4x4x4_16b_bf16 v[176:179], v[236:237], v[170:171], v[176:179] cbsz:4 abid:1
    v_exp_f32 v114, v114
    v_exp_f32 v115, v115
    v_mfma_f32_4x4x4_16b_bf16 v[176:179], v[236:237], v[172:173], v[176:179] cbsz:4 abid:2
    v_exp_f32 v116, v116
    v_exp_f32 v117, v117
    v_mfma_f32_4x4x4_16b_bf16 v[176:179], v[236:237], v[174:175], v[176:179] cbsz:4 abid:3
    v_exp_f32 v118, v118
    v_exp_f32 v119, v119
    s_waitcnt lgkmcnt(0)
    buffer_load_dwordx4 v[238:239], s[20:23], s72 idxen offen nt lds
    buffer_load_dwordx4 v[240:241], s[20:23], s51 idxen offen offset:1024 nt lds
    s_waitcnt vmcnt(4)
    ds_read_b128 v[152:155], v242 offset:2048
    ds_read_b128 v[156:159], v243 offset:2048
    s_cselect_b64 exec, s[78:79], -1
    .p2align 3
    v_pk_fma_f32 v[2:3], v[104:105], s[42:43], s[42:43] op_sel_hi:[1,0,0]
    v_pk_fma_f32 v[0:1], v[120:121], v[106:107], v[120:121]
    v_pk_fma_f32 v[0:1], v[122:123], v[2:3], v[0:1]
    v_pk_fma_f32 v[2:3], v[106:107], v[2:3], v[2:3]
    v_pk_fma_f32 v[0:1], v[108:109], v[0:1], v[0:1]
    v_pk_fma_f32 v[0:1], v[124:125], v[2:3], v[0:1]
    v_pk_fma_f32 v[2:3], v[108:109], v[2:3], v[2:3]
    v_pk_fma_f32 v[0:1], v[110:111], v[0:1], v[0:1]
    v_pk_fma_f32 v[0:1], v[126:127], v[2:3], v[0:1]
    v_pk_fma_f32 v[2:3], v[110:111], v[2:3], v[2:3]
    v_pk_fma_f32 v[0:1], v[112:113], v[0:1], v[0:1]
    v_pk_fma_f32 v[0:1], v[128:129], v[2:3], v[0:1]
    v_pk_fma_f32 v[2:3], v[112:113], v[2:3], v[2:3]
    v_pk_fma_f32 v[0:1], v[114:115], v[0:1], v[0:1]
    v_pk_fma_f32 v[0:1], v[130:131], v[2:3], v[0:1]
    v_pk_fma_f32 v[2:3], v[114:115], v[2:3], v[2:3]
    v_pk_fma_f32 v[0:1], v[116:117], v[0:1], v[0:1]
    v_pk_fma_f32 v[0:1], v[132:133], v[2:3], v[0:1]
    v_pk_fma_f32 v[2:3], v[116:117], v[2:3], v[2:3]
    v_pk_fma_f32 v[0:1], v[118:119], v[0:1], v[0:1]
    v_pk_fma_f32 v[0:1], v[134:135], v[2:3], v[0:1]
    v_pk_fma_f32 v[2:3], v[118:119], v[2:3], v[2:3]
    s_mov_b64 exec, -1
    s_waitcnt lgkmcnt(0)
    s_cbranch_scc1 CEV
U_1:
    v_mfma_f32_16x16x32_bf16 v[104:107], v[72:75], v[152:155], v[136:139]
    s_add_u32 m0, s54, 0
    v_rcp_f32 v2, v2
    v_mfma_f32_16x16x32_bf16 v[104:107], v[76:79], v[156:159], v[104:107]
    s_mov_b32 s73, 1
    v_rcp_f32 v3, v3
    v_mfma_f32_16x16x32_bf16 v[108:111], v[80:83], v[152:155], v[140:143]
    s_sub_u32 s50, s50, 1
    v_fma_f32 v0, v0, v2, s44
    v_fmac_f32 v0, v1, v3
    v_mfma_f32_16x16x32_bf16 v[108:111], v[84:87], v[156:159], v[108:111]
    s_cbranch_scc1 PEV
    v_add_u32 v246, 16, v246
RET_1:
    v_cvt_pk_bf16_f32 v0, v0, v0
    v_mfma_f32_16x16x32_bf16 v[112:115], v[88:91], v[152:155], v[144:147]
    v_exp_f32 v104, v104
    v_mfma_f32_16x16x32_bf16 v[112:115], v[92:95], v[156:159], v[112:115]
    v_exp_f32 v105, v105
    v_mfma_f32_16x16x32_bf16 v[116:119], v[96:99], v[152:155], v[148:151]
    s_sub_u32 s62, s62, 1
    v_exp_f32 v106, v106
    v_mfma_f32_16x16x32_bf16 v[116:119], v[100:103], v[156:159], v[116:119]
    v_exp_f32 v107, v107
    ds_write_b16 v249, v0
    ds_read_b64 v[236:237], v248
    ds_read_b64_tr_b16 v[168:169], v244 offset:2048
    ds_read_b64_tr_b16 v[170:171], v245 offset:2560
    ds_read_b64_tr_b16 v[172:173], v244 offset:3072
    ds_read_b64_tr_b16 v[174:175], v245 offset:3584
    ds_read_u8 v238, v246 offset:0
    ds_read_u8 v240, v246 offset:8
    v_exp_f32 v108, v108
    v_exp_f32 v109, v109
    v_exp_f32 v110, v110
    v_exp_f32 v111, v111
    s_waitcnt lgkmcnt(6)
    v_mfma_f32_4x4x4_16b_bf16 v[176:179], v[236:237], v[160:161], v[176:179] cbsz:4 abid:0
    v_exp_f32 v112, v112
    v_exp_f32 v113, v113
    v_mfma_f32_4x4x4_16b_bf16 v[176:179], v[236:237], v[162:163], v[176:179] cbsz:4 abid:1
    v_exp_f32 v114, v114
    v_exp_f32 v115, v115
    v_mfma_f32_4x4x4_16b_bf16 v[176:179], v[236:237], v[164:165], v[176:179] cbsz:4 abid:2
    v_exp_f32 v116, v116
    v_exp_f32 v117, v117
    v_mfma_f32_4x4x4_16b_bf16 v[176:179], v[236:237], v[166:167], v[176:179] cbsz:4 abid:3
    v_exp_f32 v118, v118
    v_exp_f32 v119, v119
    s_waitcnt lgkmcnt(0)
    buffer_load_dwordx4 v[238:239], s[20:23], s72 idxen offen nt lds
    buffer_load_dwordx4 v[240:241], s[20:23], s51 idxen offen offset:1024 nt lds
    s_waitcnt vmcnt(4)
    ds_read_b128 v[152:155], v242 offset:4096
    ds_read_b128 v[156:159], v243 offset:4096
    s_cselect_b64 exec, s[78:79], -1
    .p2align 3
    v_pk_fma_f32 v[2:3], v[104:105], s[42:43], s[42:43] op_sel_hi:[1,0,0]
    v_pk_fma_f32 v[0:1], v[120:121], v[106:107], v[120:121]
    v_pk_fma_f32 v[0:1], v[122:123], v[2:3], v[0:1]
    v_pk_fma_f32 v[2:3], v[106:107], v[2:3], v[2:3]
    v_pk_fma_f32 v[0:1], v[108:109], v[0:1], v[0:1]
    v_pk_fma_f32 v[0:1], v[124:125], v[2:3], v[0:1]
    v_pk_fma_f32 v[2:3], v[108:109], v[2:3], v[2:3]
    v_pk_fma_f32 v[0:1], v[110:111], v[0:1], v[0:1]
    v_pk_fma_f32 v[0:1], v[126:127], v[2:3], v[0:1]
    v_pk_fma_f32 v[2:3], v[110:111], v[2:3], v[2:3]
    v_pk_fma_f32 v[0:1], v[112:113], v[0:1], v[0:1]
    v_pk_fma_f32 v[0:1], v[128:129], v[2:3], v[0:1]
    v_pk_fma_f32 v[2:3], v[112:113], v[2:3], v[2:3]
    v_pk_fma_f32 v[0:1], v[114:115], v[0:1], v[0:1]
    v_pk_fma_f32 v[0:1], v[130:131], v[2:3], v[0:1]
    v_pk_fma_f32 v[2:3], v[114:115], v[2:3], v[2:3]
    v_pk_fma_f32 v[0:1], v[116:117], v[0:1], v[0:1]
    v_pk_fma_f32 v[0:1], v[132:133], v[2:3], v[0:1]
    v_pk_fma_f32 v[2:3], v[116:117], v[2:3], v[2:3]
    v_pk_fma_f32 v[0:1], v[118:119], v[0:1], v[0:1]
    v_pk_fma_f32 v[0:1], v[134:135], v[2:3], v[0:1]
    v_pk_fma_f32 v[2:3], v[118:119], v[2:3], v[2:3]
    s_mov_b64 exec, -1
    s_waitcnt lgkmcnt(0)
    s_cbranch_scc1 CEV
U_2:
    v_mfma_f32_16x16x32_bf16 v[104:107], v[72:75], v[152:155], v[136:139]
    s_add_u32 m0, s54, 2048
    v_rcp_f32 v2, v2
    v_mfma_f32_16x16x32_bf16 v[104:107], v[76:79], v[156:159], v[104:107]
    s_mov_b32 s73, 2
    v_rcp_f32 v3, v3
    v_mfma_f32_16x16x32_bf16 v[108:111], v[80:83], v[152:155], v[140:143]
    s_sub_u32 s50, s50, 1
    v_fma_f32 v0, v0, v2, s44
    v_fmac_f32 v0, v1, v3
    v_mfma_f32_16x16x32_bf16 v[108:111], v[84:87], v[156:159], v[108:111]
    s_cbranch_scc1 PEV
    v_add_u32 v246, 16, v246
RET_2:
    v_cvt_pk_bf16_f32 v0, v0, v0
    v_mfma_f32_16x16x32_bf16 v[112:115], v[88:91], v[152:155], v[144:147]
    v_exp_f32 v104, v104
    v_mfma_f32_16x16x32_bf16 v[112:115], v[92:95], v[156:159], v[112:115]
    v_exp_f32 v105, v105
    v_mfma_f32_16x16x32_bf16 v[116:119], v[96:99], v[152:155], v[148:151]
    s_sub_u32 s62, s62, 1
    v_exp_f32 v106, v106
    v_mfma_f32_16x16x32_bf16 v[116:119], v[100:103], v[156:159], v[116:119]
    v_exp_f32 v107, v107
    ds_write_b16 v249, v0
    ds_read_b64 v[236:237], v248
    ds_read_b64_tr_b16 v[160:161], v244 offset:4096
    ds_read_b64_tr_b16 v[162:163], v245 offset:4608
    ds_read_b64_tr_b16 v[164:165], v244 offset:5120
    ds_read_b64_tr_b16 v[166:167], v245 offset:5632
    ds_read_u8 v238, v246 offset:0
    ds_read_u8 v240, v246 offset:8
    v_exp_f32 v108, v108
    v_exp_f32 v109, v109
    v_exp_f32 v110, v110
    v_exp_f32 v111, v111
    s_waitcnt lgkmcnt(6)
    v_mfma_f32_4x4x4_16b_bf16 v[176:179], v[236:237], v[168:169], v[176:179] cbsz:4 abid:0
    v_exp_f32 v112, v112
    v_exp_f32 v113, v113
    v_mfma_f32_4x4x4_16b_bf16 v[176:179], v[236:237], v[170:171], v[176:179] cbsz:4 abid:1
    v_exp_f32 v114, v114
    v_exp_f32 v115, v115
    v_mfma_f32_4x4x4_16b_bf16 v[176:179], v[236:237], v[172:173], v[176:179] cbsz:4 abid:2
    v_exp_f32 v116, v116
    v_exp_f32 v117, v117
    v_mfma_f32_4x4x4_16b_bf16 v[176:179], v[236:237], v[174:175], v[176:179] cbsz:4 abid:3
    v_exp_f32 v118, v118
    v_exp_f32 v119, v119
    s_waitcnt lgkmcnt(0)
    buffer_load_dwordx4 v[238:239], s[20:23], s72 idxen offen nt lds
    buffer_load_dwordx4 v[240:241], s[20:23], s51 idxen offen offset:1024 nt lds
    s_waitcnt vmcnt(4)
    ds_read_b128 v[152:155], v242 offset:6144
    ds_read_b128 v[156:159], v243 offset:6144
    s_cselect_b64 exec, s[78:79], -1
    .p2align 3
    v_pk_fma_f32 v[2:3], v[104:105], s[42:43], s[42:43] op_sel_hi:[1,0,0]
    v_pk_fma_f32 v[0:1], v[120:121], v[106:107], v[120:121]
    v_pk_fma_f32 v[0:1], v[122:123], v[2:3], v[0:1]
    v_pk_fma_f32 v[2:3], v[106:107], v[2:3], v[2:3]
    v_pk_fma_f32 v[0:1], v[108:109], v[0:1], v[0:1]
    v_pk_fma_f32 v[0:1], v[124:125], v[2:3], v[0:1]
    v_pk_fma_f32 v[2:3], v[108:109], v[2:3], v[2:3]
    v_pk_fma_f32 v[0:1], v[110:111], v[0:1], v[0:1]
    v_pk_fma_f32 v[0:1], v[126:127], v[2:3], v[0:1]
    v_pk_fma_f32 v[2:3], v[110:111], v[2:3], v[2:3]
    v_pk_fma_f32 v[0:1], v[112:113], v[0:1], v[0:1]
    v_pk_fma_f32 v[0:1], v[128:129], v[2:3], v[0:1]
    v_pk_fma_f32 v[2:3], v[112:113], v[2:3], v[2:3]
    v_pk_fma_f32 v[0:1], v[114:115], v[0:1], v[0:1]
    v_pk_fma_f32 v[0:1], v[130:131], v[2:3], v[0:1]
    v_pk_fma_f32 v[2:3], v[114:115], v[2:3], v[2:3]
    v_pk_fma_f32 v[0:1], v[116:117], v[0:1], v[0:1]
    v_pk_fma_f32 v[0:1], v[132:133], v[2:3], v[0:1]
    v_pk_fma_f32 v[2:3], v[116:117], v[2:3], v[2:3]
    v_pk_fma_f32 v[0:1], v[118:119], v[0:1], v[0:1]
    v_pk_fma_f32 v[0:1], v[134:135], v[2:3], v[0:1]
    v_pk_fma_f32 v[2:3], v[118:119], v[2:3], v[2:3]
    s_mov_b64 exec, -1
    s_waitcnt lgkmcnt(0)
    s_cbranch_scc1 CEV
U_3:
    v_mfma_f32_16x16x32_bf16 v[104:107], v[72:75], v[152:155], v[136:139]
    s_add_u32 m0, s54, 4096
    v_rcp_f32 v2, v2
    v_mfma_f32_16x16x32_bf16 v[104:107], v[76:79], v[156:159], v[104:107]
    s_mov_b32 s73, 3
    v_rcp_f32 v3, v3
    v_mfma_f32_16x16x32_bf16 v[108:111], v[80:83], v[152:155], v[140:143]
    s_sub_u32 s50, s50, 1
    v_fma_f32 v0, v0, v2, s44
    v_fmac_f32 v0, v1, v3
    v_mfma_f32_16x16x32_bf16 v[108:111], v[84:87], v[156:159], v[108:111]
    s_cbranch_scc1 PEV
    v_add_u32 v246, 16, v246
RET_3:
    v_cvt_pk_bf16_f32 v0, v0, v0
    v_mfma_f32_16x16x32_bf16 v[112:115], v[88:91], v[152:155], v[144:147]
    v_exp_f32 v104, v104
    v_mfma_f32_16x16x32_bf16 v[112:115], v[92:95], v[156:159], v[112:115]
    v_exp_f32 v105, v105
    v_mfma_f32_16x16x32_bf16 v[116:119], v[96:99], v[152:155], v[148:151]
    s_sub_u32 s62, s62, 1
    v_exp_f32 v106, v106
    v_mfma_f32_16x16x32_bf16 v[116:119], v[100:103], v[156:159], v[116:119]
    v_exp_f32 v107, v107
    ds_write_b16 v249, v0
    ds_read_b64 v[236:237], v248
    ds_read_b64_tr_b16 v[168:169], v244 offset:6144
    ds_read_b64_tr_b16 v[170:171], v245 offset:6656
    ds_read_b64_tr_b16 v[172:173], v244 offset:7168
    ds_read_b64_tr_b16 v[174:175], v245 offset:7680
    ds_read_u8 v238, v246 offset:0
    ds_read_u8 v240, v246 offset:8
    v_exp_f32 v108, v108
    v_exp_f32 v109, v109
    v_exp_f32 v110, v110
    v_exp_f32 v111, v111
    s_waitcnt lgkmcnt(6)
    v_mfma_f32_4x4x4_16b_bf16 v[176:179], v[236:237], v[160:161], v[176:179] cbsz:4 abid:0
    v_exp_f32 v112, v112
    v_exp_f32 v113, v113
    v_mfma_f32_4x4x4_16b_bf16 v[176:179], v[236:237], v[162:163], v[176:179] cbsz:4 abid:1
    v_exp_f32 v114, v114
    v_exp_f32 v115, v115
    v_mfma_f32_4x4x4_16b_bf16 v[176:179], v[236:237], v[164:165], v[176:179] cbsz:4 abid:2
    v_exp_f32 v116, v116
    v_exp_f32 v117, v117
    v_mfma_f32_4x4x4_16b_bf16 v[176:179], v[236:237], v[166:167], v[176:179] cbsz:4 abid:3
    v_exp_f32 v118, v118
    v_exp_f32 v119, v119
    s_waitcnt lgkmcnt(0)
    buffer_load_dwordx4 v[238:239], s[20:23], s72 idxen offen nt lds
    buffer_load_dwordx4 v[240:241], s[20:23], s51 idxen offen offset:1024 nt lds
    s_waitcnt vmcnt(4)
    ds_read_b128 v[152:155], v242 offset:0
    ds_read_b128 v[156:159], v243 offset:0
    s_cselect_b64 exec, s[78:79], -1
    .p2align 3
    v_pk_fma_f32 v[2:3], v[104:105], s[42:43], s[42:43] op_sel_hi:[1,0,0]
    v_pk_fma_f32 v[0:1], v[120:121], v[106:107], v[120:121]
    v_pk_fma_f32 v[0:1], v[122:123], v[2:3], v[0:1]
    v_pk_fma_f32 v[2:3], v[106:107], v[2:3], v[2:3]
    v_pk_fma_f32 v[0:1], v[108:109], v[0:1], v[0:1]
    v_pk_fma_f32 v[0:1], v[124:125], v[2:3], v[0:1]
    v_pk_fma_f32 v[2:3], v[108:109], v[2:3], v[2:3]
    v_pk_fma_f32 v[0:1], v[110:111], v[0:1], v[0:1]
    v_pk_fma_f32 v[0:1], v[126:127], v[2:3], v[0:1]
    v_pk_fma_f32 v[2:3], v[110:111], v[2:3], v[2:3]
    v_pk_fma_f32 v[0:1], v[112:113], v[0:1], v[0:1]
    v_pk_fma_f32 v[0:1], v[128:129], v[2:3], v[0:1]
    v_pk_fma_f32 v[2:3], v[112:113], v[2:3], v[2:3]
    v_pk_fma_f32 v[0:1], v[114:115], v[0:1], v[0:1]
    v_pk_fma_f32 v[0:1], v[130:131], v[2:3], v[0:1]
    v_pk_fma_f32 v[2:3], v[114:115], v[2:3], v[2:3]
    v_pk_fma_f32 v[0:1], v[116:117], v[0:1], v[0:1]
    v_pk_fma_f32 v[0:1], v[132:133], v[2:3], v[0:1]
    v_pk_fma_f32 v[2:3], v[116:117], v[2:3], v[2:3]
    v_pk_fma_f32 v[0:1], v[118:119], v[0:1], v[0:1]
    v_pk_fma_f32 v[0:1], v[134:135], v[2:3], v[0:1]
    v_pk_fma_f32 v[2:3], v[118:119], v[2:3], v[2:3]
    s_mov_b64 exec, -1
    s_waitcnt lgkmcnt(0)
    s_cbranch_scc0 U_0
CEV:
    s_cmp_eq_u32 s76, 0
    s_cbranch_scc1 EPI
    s_mov_b32 s53, s52
    s_and_b32 s52, s68, 0xffff
    s_lshr_b64 s[68:69], s[68:69], 16
    s_sub_u32 s75, s75, 16
    s_bitcmp1_b32 s52, 6
    s_cbranch_scc1 DRAIN
BPF:
    s_and_b32 s57, s52, 63
    s_mul_i32 s57, s57, 528
    s_add_u32 s57, s57, 83200
    v_lshl_add_u32 v6, v252, 1, s57
    v_add_u32 v7, s57, v252
    ds_read_b128 v[104:107], v6 offset:0
    ds_read_b128 v[108:111], v6 offset:16
    ds_read_b128 v[144:147], v251 offset:12288
    ds_read_b128 v[148:151], v251 offset:13312
    ds_read_b128 v[112:115], v6 offset:128
    ds_read_b128 v[116:119], v6 offset:144
    s_mov_b32 s62, 0
    s_mov_b32 s76, 0
    s_mov_b64 s[78:79], -1
    s_cmp_lg_u32 s77, 0
    s_waitcnt lgkmcnt(4)
    .p2align 3
    v_pk_fma_f32 v[136:137], v[8:9], v[104:105], v[180:181]
    v_pk_fma_f32 v[138:139], v[10:11], v[106:107], v[182:183]
    v_pk_fma_f32 v[140:141], v[12:13], v[108:109], v[184:185]
    v_pk_fma_f32 v[142:143], v[14:15], v[110:111], v[186:187]
    v_cvt_pk_bf16_f32 v72, v136, v137
    v_cvt_pk_bf16_f32 v73, v138, v139
    v_cvt_pk_bf16_f32 v74, v140, v141
    v_cvt_pk_bf16_f32 v75, v142, v143
    v_pk_fma_f32 v[136:137], v[24:25], v[104:105], v[196:197]
    v_pk_fma_f32 v[138:139], v[26:27], v[106:107], v[198:199]
    v_pk_fma_f32 v[140:141], v[28:29], v[108:109], v[200:201]
    v_pk_fma_f32 v[142:143], v[30:31], v[110:111], v[202:203]
    v_cvt_pk_bf16_f32 v80, v136, v137
    v_cvt_pk_bf16_f32 v81, v138, v139
    v_cvt_pk_bf16_f32 v82, v140, v141
    v_cvt_pk_bf16_f32 v83, v142, v143
    v_pk_fma_f32 v[136:137], v[40:41], v[104:105], v[212:213]
    v_pk_fma_f32 v[138:139], v[42:43], v[106:107], v[214:215]
    v_pk_fma_f32 v[140:141], v[44:45], v[108:109], v[216:217]
    v_pk_fma_f32 v[142:143], v[46:47], v[110:111], v[218:219]
    v_cvt_pk_bf16_f32 v88, v136, v137
    v_cvt_pk_bf16_f32 v89, v138, v139
    v_cvt_pk_bf16_f32 v90, v140, v141
    v_cvt_pk_bf16_f32 v91, v142, v143
    s_waitcnt lgkmcnt(0)
    .p2align 3
    v_pk_fma_f32 v[144:145], v[56:57], v[104:105], v[144:145]
    v_pk_fma_f32 v[146:147], v[58:59], v[106:107], v[146:147]
    v_pk_fma_f32 v[148:149], v[60:61], v[108:109], v[148:149]
    v_pk_fma_f32 v[150:151], v[62:63], v[110:111], v[150:151]
    v_cvt_pk_bf16_f32 v96, v144, v145
    v_cvt_pk_bf16_f32 v97, v146, v147
    v_cvt_pk_bf16_f32 v98, v148, v149
    v_cvt_pk_bf16_f32 v99, v150, v151
    ds_read_b128 v[136:139], v7 offset:256
    ds_read_b128 v[140:143], v7 offset:320
    ds_read_b128 v[144:147], v7 offset:384
    ds_read_b128 v[148:151], v7 offset:448
    v_pk_fma_f32 v[104:105], v[16:17], v[112:113], v[188:189]
    v_pk_fma_f32 v[106:107], v[18:19], v[114:115], v[190:191]
    v_pk_fma_f32 v[108:109], v[20:21], v[116:117], v[192:193]
    v_pk_fma_f32 v[110:111], v[22:23], v[118:119], v[194:195]
    v_cvt_pk_bf16_f32 v76, v104, v105
    v_cvt_pk_bf16_f32 v77, v106, v107
    v_cvt_pk_bf16_f32 v78, v108, v109
    v_cvt_pk_bf16_f32 v79, v110, v111
    v_pk_fma_f32 v[104:105], v[32:33], v[112:113], v[204:205]
    v_pk_fma_f32 v[106:107], v[34:35], v[114:115], v[206:207]
    v_pk_fma_f32 v[108:109], v[36:37], v[116:117], v[208:209]
    v_pk_fma_f32 v[110:111], v[38:39], v[118:119], v[210:211]
    v_cvt_pk_bf16_f32 v84, v104, v105
    v_cvt_pk_bf16_f32 v85, v106, v107
    v_cvt_pk_bf16_f32 v86, v108, v109
    v_cvt_pk_bf16_f32 v87, v110, v111
    v_pk_fma_f32 v[104:105], v[48:49], v[112:113], v[220:221]
    v_pk_fma_f32 v[106:107], v[50:51], v[114:115], v[222:223]
    v_pk_fma_f32 v[108:109], v[52:53], v[116:117], v[224:225]
    v_pk_fma_f32 v[110:111], v[54:55], v[118:119], v[226:227]
    v_cvt_pk_bf16_f32 v92, v104, v105
    v_cvt_pk_bf16_f32 v93, v106, v107
    v_cvt_pk_bf16_f32 v94, v108, v109
    v_cvt_pk_bf16_f32 v95, v110, v111
    v_pk_fma_f32 v[104:105], v[64:65], v[112:113], v[228:229]
    v_pk_fma_f32 v[106:107], v[66:67], v[114:115], v[230:231]
    v_pk_fma_f32 v[108:109], v[68:69], v[116:117], v[232:233]
    v_pk_fma_f32 v[110:111], v[70:71], v[118:119], v[234:235]
    v_cvt_pk_bf16_f32 v100, v104, v105
    v_cvt_pk_bf16_f32 v101, v106, v107
    v_cvt_pk_bf16_f32 v102, v108, v109
    v_cvt_pk_bf16_f32 v103, v110, v111
    s_waitcnt lgkmcnt(0)
    s_cbranch_scc1 BP_X
NEXT:
    s_cmp_eq_u32 s73, 0
    s_cbranch_scc1 U_1
    s_cmp_eq_u32 s73, 1
    s_cbranch_scc1 U_2
    s_cmp_eq_u32 s73, 2
    s_cbranch_scc1 U_3
    s_branch U_0
EPI:
    s_and_b32 s56, s53, 0x7f
    v_pk_add_f32 v[4:5], v[176:177], v[178:179]
    v_add_f32 v4, v4, v5
    v_lshl_add_u32 v5, s56, 8, v250
    v_mul_f32 v4, s46, v4
    s_bitcmp1_b32 s53, 7
    v_cmp_class_f32_e64 vcc, v4, s45
    v_mov_b64 v[176:177], 0
    v_mov_b64 v[178:179], 0
    ds_write_b32 v5, v4
    s_cbranch_scc1 SLOW
    s_cbranch_vccnz SLOW
EPI_R:
    s_bitcmp1_b32 s52, 6
    s_cbranch_scc1 L_DONE
EPI_C:
    s_bfe_u32 s62, s52, 0x40008
    s_sub_u32 s62, s62, 2
    s_mov_b32 s76, 1
    s_lshr_b32 s56, s52, 12
    s_lshl_b32 s78, 0x20002, s56
    s_sub_u32 s78, s78, 0x10001
    s_mov_b32 s79, s78
    s_cmp_eq_u32 s73, 0
    s_cbranch_scc1 U_1
    s_cmp_eq_u32 s73, 1
    s_cbranch_scc1 U_2
    s_cmp_eq_u32 s73, 2
    s_cbranch_scc1 U_3
    s_branch U_0
PEV:
    s_cmp_eq_u32 s55, 0
    s_cbranch_scc1 P_DR
    ds_read_b32 v254, v253
    s_waitcnt lgkmcnt(0)
ADV:
    v_readfirstlane_b32 s66, v254
    s_mov_b32 s67, 0
    s_and_b32 s56, s66, 63
    s_bfe_u32 s50, s66, 0x40008
    s_cbranch_scc0 AW
    s_lshr_b32 s57, s56, 3
    s_mul_i32 s51, s56, 25600
    s_mul_i32 s57, s57, 52224000
    s_add_u32 s51, s51, s57
    v_lshl_add_u32 v246, s56, 8, v247
    s_add_u32 s51, s51, s49
    s_add_u32 s72, s51, 1024
    s_lshl_b64 s[64:65], s[66:67], s75
    s_or_b64 s[68:69], s[68:69], s[64:65]
    s_add_u32 s75, s75, 16
    s_mov_b32 s55, 0
    s_sub_u32 s50, s50, 3
    s_cbranch_scc1 P_2
P_RET:
    s_cmp_eq_u32 s73, 0
    s_cbranch_scc1 RET_0
    s_cmp_eq_u32 s73, 1
    s_cbranch_scc1 RET_1
    s_cmp_eq_u32 s73, 2
    s_cbranch_scc1 RET_2
    s_branch RET_3
P_DR:
    v_add_u32 v246, 16, v246
P_D2:
    s_mov_b64 exec, 1
    v_mov_b32 v253, 4
    ds_add_rtn_u32 v253, v251, v253 offset:17600
    s_mov_b64 exec, -1
    s_mov_b32 s50, 1
    s_mov_b32 s55, 1
    s_cmp_eq_u32 s73, 0
    s_cbranch_scc1 RET_0
    s_cmp_eq_u32 s73, 1
    s_cbranch_scc1 RET_1
    s_cmp_eq_u32 s73, 2
    s_cbranch_scc1 RET_2
    s_branch RET_3
P_2:
    s_bitcmp1_b32 s66, 6
    s_cbranch_scc0 P_D2
    v_mov_b32 v246, 16896
    s_movk_i32 s50, 0x100
    s_branch P_RET
DRAIN:
    v_rcp_f32 v2, v2
    v_rcp_f32 v3, v3
    v_fma_f32 v0, v0, v2, s44
    v_fmac_f32 v0, v1, v3
    v_cvt_pk_bf16_f32 v0, v0, v0
    s_bitcmp1_b32 s73, 0
    ds_write_b16 v249, v0
    ds_read_b64 v[236:237], v248
    s_waitcnt lgkmcnt(0)
    s_cbranch_scc1 DRAIN1
    v_mfma_f32_4x4x4_16b_bf16 v[176:179], v[236:237], v[160:161], v[176:179] cbsz:4 abid:0
    s_nop 1
    v_mfma_f32_4x4x4_16b_bf16 v[176:179], v[236:237], v[162:163], v[176:179] cbsz:4 abid:1
    s_nop 1
    v_mfma_f32_4x4x4_16b_bf16 v[176:179], v[236:237], v[164:165], v[176:179] cbsz:4 abid:2
    s_nop 1
    v_mfma_f32_4x4x4_16b_bf16 v[176:179], v[236:237], v[166:167], v[176:179] cbsz:4 abid:3
    s_nop 2
    s_branch EPI
DRAIN1:
    v_mfma_f32_4x4x4_16b_bf16 v[176:179], v[236:237], v[168:169], v[176:179] cbsz:4 abid:0
    s_nop 1
    v_mfma_f32_4x4x4_16b_bf16 v[176:179], v[236:237], v[170:171], v[176:179] cbsz:4 abid:1
    s_nop 1
    v_mfma_f32_4x4x4_16b_bf16 v[176:179], v[236:237], v[172:173], v[176:179] cbsz:4 abid:2
    s_nop 1
    v_mfma_f32_4x4x4_16b_bf16 v[176:179], v[236:237], v[174:175], v[176:179] cbsz:4 abid:3
    s_nop 2
    s_branch EPI
L_DONE:
    s_lshl_b32 s56, s48, 11
    s_add_u32 s56, s56, 133376
    v_lshl_add_u32 v0, v251, 1, s56
    s_lshl_b32 s56, s48, 18
    s_waitcnt lgkmcnt(0)
    s_barrier
    ds_read_b128 v[104:107], v0 offset:0
    ds_read_b128 v[108:111], v0 offset:16
    s_waitcnt lgkmcnt(0)
    v_cvt_pk_bf16_f32 v152, v104, v105
    v_cvt_pk_bf16_f32 v153, v106, v107
    v_cvt_pk_bf16_f32 v154, v108, v109
    v_cvt_pk_bf16_f32 v155, v110, v111
    buffer_store_dwordx4 v[152:155], v251, s[28:31], s56 offen nt
L_FIN:
    s_endpgm
AW:
    s_sleep 1
    ds_read_b32 v254, v253
    s_waitcnt lgkmcnt(0)
    s_branch ADV
DRAW_P:
    s_mov_b64 exec, 1
    v_mov_b32 v253, 4
    ds_add_rtn_u32 v253, v251, v253 offset:17600
    s_mov_b64 exec, -1
    s_add_u32 s50, s50, 2
    s_mov_b32 s55, 1
    s_waitcnt lgkmcnt(0)
    ds_read_b32 v254, v253
    s_branch DRET_P
BP_X:
    s_cmp_eq_u32 s77, 1
    s_mov_b32 s77, 0
    s_cbranch_scc1 SLOW_W
    s_branch EPI_C
SLOW:
    s_bitcmp1_b32 s53, 6
    s_cbranch_scc1 EPI_R
    s_mov_b32 s74, s52
    s_mov_b32 s52, s53
    s_mov_b32 s77, 1
    ds_write_b32 v5, v176
    s_branch BPF
SLOW_W:
    s_mov_b32 s52, s74
    s_and_b32 s56, s53, 63
    s_mov_b32 s57, 0
    s_bfe_u32 s59, s53, 0x40008
    s_lshl4_add_u32 s57, s56, s57
    s_lshl_b32 s57, s57, 4
    s_add_u32 s74, s57, 116992
    s_bitcmp1_b32 s53, 7
    s_cselect_b64 s[66:67], -1, 0
    s_cselect_b32 s59, 13, s59
    v_bfe_u32 v204, v251, 4, 4
    v_mov_b32 v207, v252
    v_mov_b64 v[180:181], 0
    v_mov_b64 v[182:183], 0
    v_mov_b64 v[184:185], 0
    v_mov_b64 v[186:187], 0
    v_mov_b64 v[188:189], 0
    v_mov_b64 v[190:191], 0
    v_mov_b64 v[192:193], 0
    v_mov_b64 v[194:195], 0
    s_lshr_b32 s58, s56, 3
    s_mul_i32 s57, s56, 25600
    s_mul_i32 s58, s58, 52224000
    s_add_u32 s57, s57, s58
    s_add_u32 s57, s57, s49
    s_lshr_b32 s64, s56, 3
    s_mul_i32 s58, s56, 400
    s_mul_i32 s64, s64, 816000
    s_add_u32 s58, s58, s64
SLOW_L:
    v_add_u32 v205, s74, v204
    ds_read_u8 v206, v205
    s_waitcnt lgkmcnt(0)
    v_cndmask_b32_e64 v206, v206, v204, s[66:67]
    v_lshlrev_b32 v205, 1, v206
    buffer_load_dwordx4 v[196:199], v[206:207], s[20:23], s57 idxen offen offset:1024
    buffer_load_dwordx4 v[200:203], v[206:207], s[20:23], s57 idxen offen offset:1088
    buffer_load_ushort v205, v205, s[24:27], s58 offen
    v_cmp_gt_u32 vcc, 200, v206
    v_add_u32 v204, 16, v204
    s_waitcnt vmcnt(0)
    v_mfma_f32_16x16x32_bf16 v[104:107], v[72:75], v[196:199], v[136:139]
    v_mfma_f32_16x16x32_bf16 v[104:107], v[76:79], v[200:203], v[104:107]
    v_mfma_f32_16x16x32_bf16 v[108:111], v[80:83], v[196:199], v[140:143]
    v_mfma_f32_16x16x32_bf16 v[108:111], v[84:87], v[200:203], v[108:111]
    v_mfma_f32_16x16x32_bf16 v[112:115], v[88:91], v[196:199], v[144:147]
    v_mfma_f32_16x16x32_bf16 v[112:115], v[92:95], v[200:203], v[112:115]
    v_mfma_f32_16x16x32_bf16 v[116:119], v[96:99], v[196:199], v[148:151]
    v_mfma_f32_16x16x32_bf16 v[116:119], v[100:103], v[200:203], v[116:119]
    v_lshlrev_b32 v205, 16, v205
    v_cndmask_b32 v205, 0, v205, vcc
    s_nop 7
    v_exp_f32 v104, v104
    v_exp_f32 v105, v105
    v_exp_f32 v106, v106
    v_exp_f32 v107, v107
    v_exp_f32 v108, v108
    v_exp_f32 v109, v109
    v_exp_f32 v110, v110
    v_exp_f32 v111, v111
    v_exp_f32 v112, v112
    v_exp_f32 v113, v113
    v_exp_f32 v114, v114
    v_exp_f32 v115, v115
    v_exp_f32 v116, v116
    v_exp_f32 v117, v117
    v_exp_f32 v118, v118
    v_exp_f32 v119, v119
    v_add_f32 v104, 1.0, v104
    v_add_f32 v105, 1.0, v105
    v_add_f32 v106, 1.0, v106
    v_add_f32 v107, 1.0, v107
    v_add_f32 v108, 1.0, v108
    v_add_f32 v109, 1.0, v109
    v_add_f32 v110, 1.0, v110
    v_add_f32 v111, 1.0, v111
    v_add_f32 v112, 1.0, v112
    v_add_f32 v113, 1.0, v113
    v_add_f32 v114, 1.0, v114
    v_add_f32 v115, 1.0, v115
    v_add_f32 v116, 1.0, v116
    v_add_f32 v117, 1.0, v117
    v_add_f32 v118, 1.0, v118
    v_add_f32 v119, 1.0, v119
    v_rcp_f32 v104, v104
    v_rcp_f32 v105, v105
    v_rcp_f32 v106, v106
    v_rcp_f32 v107, v107
    v_rcp_f32 v108, v108
    v_rcp_f32 v109, v109
    v_rcp_f32 v110, v110
    v_rcp_f32 v111, v111
    v_rcp_f32 v112, v112
    v_rcp_f32 v113, v113
    v_rcp_f32 v114, v114
    v_rcp_f32 v115, v115
    v_rcp_f32 v116, v116
    v_rcp_f32 v117, v117
    v_rcp_f32 v118, v118
    v_rcp_f32 v119, v119
    v_mul_f32 v208, v104, v120
    v_fmac_f32 v208, v105, v121
    v_ldexp_f32 v208, v208, 60
    v_fmac_f32 v208, v106, v122
    v_fmac_f32 v208, v107, v123
    v_fmac_f32 v208, v108, v124
    v_fmac_f32 v208, v109, v125
    v_fmac_f32 v208, v110, v126
    v_fmac_f32 v208, v111, v127
    v_fmac_f32 v208, v112, v128
    v_fmac_f32 v208, v113, v129
    v_fmac_f32 v208, v114, v130
    v_fmac_f32 v208, v115, v131
    v_fmac_f32 v208, v116, v132
    v_fmac_f32 v208, v117, v133
    v_fmac_f32 v208, v118, v134
    v_fmac_f32 v208, v119, v135
    v_mov_b32 v209, v208
    s_nop 1
    v_permlane32_swap_b32 v208, v209
    v_add_f32 v208, v208, v209
    v_mov_b32 v209, v208
    s_nop 1
    v_permlane16_swap_b32 v208, v209
    v_add_f32 v208, v208, v209
    v_mul_f32 v208, s46, v208
    v_add_f32 v208, s63, v208
    v_mul_f32 v208, v208, v205
    v_lshlrev_b32 v209, 16, v196
    v_and_b32 v210, 0xffff0000, v196
    v_fmac_f32 v180, v208, v209
    v_fmac_f32 v181, v208, v210
    v_lshlrev_b32 v209, 16, v197
    v_and_b32 v210, 0xffff0000, v197
    v_fmac_f32 v182, v208, v209
    v_fmac_f32 v183, v208, v210
    v_lshlrev_b32 v209, 16, v198
    v_and_b32 v210, 0xffff0000, v198
    v_fmac_f32 v184, v208, v209
    v_fmac_f32 v185, v208, v210
    v_lshlrev_b32 v209, 16, v199
    v_and_b32 v210, 0xffff0000, v199
    v_fmac_f32 v186, v208, v209
    v_fmac_f32 v187, v208, v210
    v_lshlrev_b32 v209, 16, v200
    v_and_b32 v210, 0xffff0000, v200
    v_fmac_f32 v188, v208, v209
    v_fmac_f32 v189, v208, v210
    v_lshlrev_b32 v209, 16, v201
    v_and_b32 v210, 0xffff0000, v201
    v_fmac_f32 v190, v208, v209
    v_fmac_f32 v191, v208, v210
    v_lshlrev_b32 v209, 16, v202
    v_and_b32 v210, 0xffff0000, v202
    v_fmac_f32 v192, v208, v209
    v_fmac_f32 v193, v208, v210
    v_lshlrev_b32 v209, 16, v203
    v_and_b32 v210, 0xffff0000, v203
    v_fmac_f32 v194, v208, v209
    v_fmac_f32 v195, v208, v210
    s_sub_u32 s59, s59, 1
    s_cmp_lg_u32 s59, 0
    s_cbranch_scc1 SLOW_L
    v_readfirstlane_b32 s56, v5
    s_nop 1
    v_lshl_add_u32 v208, v252, 1, s56
    ds_add_f32 v208, v180 offset:0
    ds_add_f32 v208, v181 offset:4
    ds_add_f32 v208, v182 offset:8
    ds_add_f32 v208, v183 offset:12
    ds_add_f32 v208, v184 offset:16
    ds_add_f32 v208, v185 offset:20
    ds_add_f32 v208, v186 offset:24
    ds_add_f32 v208, v187 offset:28
    ds_add_f32 v208, v188 offset:128
    ds_add_f32 v208, v189 offset:132
    ds_add_f32 v208, v190 offset:136
    ds_add_f32 v208, v191 offset:140
    ds_add_f32 v208, v192 offset:144
    ds_add_f32 v208, v193 offset:148
    ds_add_f32 v208, v194 offset:152
    ds_add_f32 v208, v195 offset:156
    s_waitcnt lgkmcnt(0)
    s_bitcmp1_b32 s52, 6
    s_cbranch_scc1 L_DONE
    ds_read_b128 v[180:183], v251 offset:0
    ds_read_b128 v[184:187], v251 offset:1024
    ds_read_b128 v[196:199], v251 offset:4096
    ds_read_b128 v[200:203], v251 offset:5120
    ds_read_b128 v[212:215], v251 offset:8192
    ds_read_b128 v[216:219], v251 offset:9216
    ds_read_b128 v[188:191], v251 offset:2048
    ds_read_b128 v[192:195], v251 offset:3072
    ds_read_b128 v[204:207], v251 offset:6144
    ds_read_b128 v[208:211], v251 offset:7168
    ds_read_b128 v[220:223], v251 offset:10240
    ds_read_b128 v[224:227], v251 offset:11264
    ds_read_b128 v[228:231], v251 offset:14336
    ds_read_b128 v[232:235], v251 offset:15360
    s_mov_b32 s77, 2
    s_branch BPF
L_END:
    s_endpgm
.section .rodata,"a"
.p2align 6
.amdhsa_kernel standalone__sequential_behavior_din__recsys_kernel
  .amdhsa_next_free_vgpr 255
  .amdhsa_next_free_sgpr 80
  .amdhsa_accum_offset 256
  .amdhsa_group_segment_fixed_size 0
  .amdhsa_kernarg_size 80
  .amdhsa_user_sgpr_count 2
  .amdhsa_user_sgpr_kernarg_segment_ptr 1
  .amdhsa_system_sgpr_workgroup_id_x 1
.end_amdhsa_kernel
```

```asm
; @launch grid=(256,1,1) block=(512,1,1) lds=153856
.amdgcn_target "amdgcn-amd-amdhsa--gfx950"
.text
.globl standalone__sequential_behavior_din__recsys_kernel
.p2align 8
.type standalone__sequential_behavior_din__recsys_kernel,@function
standalone__sequential_behavior_din__recsys_kernel:
    s_cmpk_ge_u32 s2, 256
    s_cbranch_scc1 L_END
    s_load_dwordx16 s[4:19], s[0:1], 0
    s_setprio 3
    v_lshrrev_b32 v1, 6, v0
    v_and_b32 v176, 63, v0
    v_readfirstlane_b32 s48, v1
    s_getpc_b64 s[40:41]
L_PC:
    s_cmp_lt_u32 s48, 5
    s_cbranch_scc1 P_NC
    s_mov_b32 s42, L_END-L_PC
    s_mov_b32 s43, 0x20000
    v_subrev_u32 v150, 320, v0
    v_lshlrev_b32 v150, 6, v150
    buffer_load_dword v150, v150, s[40:43], 0 offen
P_NC:
    v_and_b32 v2, 31, v0
    v_bfe_u32 v3, v0, 5, 1
    v_cmp_gt_u32 vcc, 25, v2
    v_mul_u32_u24 v4, 400, v3
    v_lshl_add_u32 v179, v2, 4, v4
    v_bfrev_b32 v4, 8
    v_cndmask_b32 v179, v4, v179, vcc
    s_mul_i32 s57, s2, 3200
    s_sub_u32 s26, 6553600, s57
    s_lshr_b32 s59, s48, 2
    s_mul_i32 s71, s48, 800
    s_mul_i32 s59, s59, 816000
    s_add_u32 s71, s71, s59
    s_mov_b32 s27, 0x20000
    s_lshl_b32 s74, s48, 12
    s_lshl_b32 s53, s2, 10
    v_lshlrev_b32 v251, 4, v176
    v_lshlrev_b32 v120, 1, v176
    v_and_b32 v120, 32, v120
    v_xor_b32 v120, v120, v251
    v_xor_b32 v121, 64, v120
    s_mov_b32 s38, 32768
    s_mov_b32 s39, s27
    s_lshl_b32 s58, s48, 18
    s_sub_u32 s34, 2097152, s53
    s_mov_b32 s35, s27
    s_add_u32 m0, s74, 121088
    v_and_b32 v178, 15, v176
    v_lshrrev_b32 v177, 4, v176
    v_lshlrev_b32 v252, 4, v177
    v_mul_u32_u24 v208, 0x80008, v2
    v_lshrrev_b32 v238, 3, v176
    v_add_u32 v208, 0x10000, v208
    v_cmp_gt_u32 vcc, 32, v176
    s_waitcnt lgkmcnt(0)
    s_add_u32 s24, s8, s57
    s_addc_u32 s25, s9, 0
    s_mov_b64 s[36:37], s[10:11]
    buffer_load_dwordx4 v[204:207], v179, s[24:27], s71 offen offset:0 nt
    s_setprio 0
    s_add_u32 s32, s4, s53
    s_addc_u32 s33, s5, 0
    s_load_dword s63, s[16:17], 0
    s_cmp_lg_u32 s48, 0
    s_cbranch_scc1 P_LJ
    v_mov_b32 v146, s12
    v_mov_b32 v147, s13
    v_mov_b32 v148, s14
    v_mov_b32 v149, s15
    v_lshlrev_b32 v4, 2, v2
    v_cndmask_b32 v146, v146, v148, vcc
    v_cndmask_b32 v147, v147, v149, vcc
    v_add_co_u32 v146, vcc, v146, v4
    s_nop 1
    v_addc_co_u32 v147, vcc, 0, v147, vcc
    global_load_dword v146, v[146:147], off
P_LJ:
    buffer_load_dwordx4 v[124:127], v251, s[32:35], s58 offen nt
    buffer_load_dwordx4 v120, s[36:39], s74 offen offset:0 lds
    buffer_load_dwordx4 v121, s[36:39], s74 offen offset:1024 lds
    s_lshl1_add_u32 s54, s74, 17664
    s_mul_i32 s49, s2, 204800
    s_lshl_b32 s57, s48, 9
    v_add_u32 v247, 116992, v238
    v_add_u32 v246, s57, v247
    s_add_u32 s56, s57, 116992
    v_add_u32 v209, 0x20002, v208
    v_add_u32 v210, 0x40004, v208
    v_add_u32 v211, 0x60006, v208
    s_sub_u32 s20, s6, 1024
    s_subb_u32 s21, s7, 0
    s_or_b32 s21, s21, 0x800000
    s_movk_i32 s22, 200
    s_mov_b32 s23, s27
    s_movk_i32 s61, 0x3f80
    v_lshrrev_b32 v216, 1, v251
    v_and_b32 v213, 0x100, v216
    v_mov_b64 v[214:215], -1
    v_lshlrev_b32 v250, 2, v176
    v_bfrev_b32 v2, v238
    v_lshrrev_b32 v2, 28, v2
    v_and_b32 v2, 6, v2
    v_xor_b32 v2, v2, v176
    v_and_b32 v2, 7, v2
    v_mul_u32_u24 v143, 528, v238
    v_lshlrev_b32 v239, 4, v2
    v_lshlrev_b32 v241, 4, v2
    v_lshlrev_b32 v153, 4, v2
    v_lshlrev_b32 v155, 4, v2
    s_add_u32 s28, s18, s53
    s_addc_u32 s29, s19, 0
    s_sub_u32 s30, 2097152, s53
    s_mov_b32 s31, s27
    s_mov_b32 s60, 0xbfb8aa3b
    s_mov_b32 s42, 0x21800000
    s_mov_b32 s46, 0x2b800000
    s_lshr_b32 s59, s48, 2
    s_mul_i32 s51, s48, 51200
    s_mul_i32 s59, s59, 52224000
    s_add_u32 s51, s51, s59
    s_add_u32 s51, s51, s49
    s_add_u32 s72, s51, 1024
    v_bfrev_b32 v2, v178
    v_lshrrev_b32 v2, 28, v2
    v_and_b32 v2, 6, v2
    v_xor_b32 v2, v2, v177
    v_lshl_add_u32 v2, v2, 4, s54
    v_lshl_add_u32 v242, v178, 7, v2
    v_xor_b32 v243, 64, v242
    v_and_b32 v3, 3, v176
    v_bfe_u32 v2, v176, 2, 2
    v_lshlrev_b32 v7, 3, v3
    v_lshl_add_u32 v7, v2, 7, v7
    v_and_b32 v6, 8, v176
    v_lshlrev_b32 v6, 3, v6
    v_lshl_add_u32 v244, v177, 5, v7
    v_xor_b32 v244, v244, v6
    v_add_u32 v244, s54, v244
    v_xor_b32 v245, 32, v244
    s_lshl_b32 s57, s48, 7
    s_add_u32 s57, s57, 150016
    v_lshl_add_u32 v249, v2, 2, v177
    v_lshl_add_u32 v249, v249, 2, v3
    v_lshl_add_u32 v249, v249, 1, s57
    v_lshl_add_u32 v248, v178, 3, s57
    v_and_b32 v6, 0x60, v250
    v_or_b32 v6, v6, v7
    v_lshl_add_u32 v136, v177, 10, v6
    s_mul_i32 s57, s48, 0x1010
    s_and_b32 s57, s57, 0x1060
    v_xor_b32 v144, s57, v136
    v_add_u32 v136, 121088, v136
    v_add_u32 v144, 121088, v144
    v_xor_b32 v137, 32, v136
    v_xor_b32 v138, 64, v136
    v_xor_b32 v139, 96, v136
    s_and_b32 s59, s48, 4
    s_lshl_b32 s59, s59, 4
    v_xor_b32 v140, s59, v136
    v_xor_b32 v141, 32, v140
    s_and_b32 s57, s48, 3
    s_mul_i32 s57, s57, 8448
    s_lshl1_add_u32 s57, s59, s57
    s_add_u32 s57, s57, 83200
    v_mul_u32_u24 v145, 528, v178
    v_add3_u32 v145, v145, v252, s57
    v_lshl_add_u32 v142, s59, 1, v252
    s_mul_i32 s57, s48, 4224
    s_add_u32 s57, s57, 83200
    v_and_b32 v3, 0x70, v251
    v_add3_u32 v143, v143, v3, s57
    v_add_u32 v3, v143, v3
    s_lshl_b32 s57, s48, 11
    v_add_u32 v151, s57, v251
    s_mov_b32 s66, 0x1b0a0100
    s_mov_b32 s67, 0x966d4c33
    s_lshl_b32 s57, s48, 3
    s_lshr_b64 s[66:67], s[66:67], s57
    s_and_b32 s47, s66, 7
    s_bfe_u32 s70, s66, 0x50003
    s_lshl1_add_u32 s70, s70, 16
    s_mul_i32 s71, s70, 400
    buffer_load_dwordx4 v120, s[36:39], s74 offen offset:2048 lds
    buffer_load_dwordx4 v121, s[36:39], s74 offen offset:3072 lds
    s_cmp_eq_u32 s48, 0
    s_waitcnt vmcnt(6) lgkmcnt(0)
    s_cbranch_scc1 P_M0
    s_waitcnt vmcnt(5)
P_M0:
    s_call_b64 s[36:37], CMP
    s_branch P_C
    .p2align 3
CMP:
    v_bcnt_u32_b32 v7, v204, 0
    v_bcnt_u32_b32 v7, v205, v7
    v_bcnt_u32_b32 v7, v206, v7
    v_bcnt_u32_b32 v7, v207, v7
    v_add_u32 v4, s56, v216
    v_mov_b32 v6, v7
    ds_write_b64 v4, v[214:215]
    v_cmp_eq_u16_e64 s[4:5], s61, v204
    v_cmp_eq_u16_sdwa s[6:7], v204, s61 src0_sel:WORD_1 src1_sel:WORD_0
    v_add_u32_dpp v6, v6, v6 row_shr:1 row_mask:0xf bank_mask:0xf bound_ctrl:0
    v_cmp_eq_u16_e64 s[8:9], s61, v205
    v_cmp_eq_u16_sdwa s[10:11], v205, s61 src0_sel:WORD_1 src1_sel:WORD_0
    v_add_u32_dpp v6, v6, v6 row_shr:2 row_mask:0xf bank_mask:0xf bound_ctrl:0
    v_cmp_eq_u16_e64 s[12:13], s61, v206
    v_cmp_eq_u16_sdwa s[14:15], v206, s61 src0_sel:WORD_1 src1_sel:WORD_0
    v_add_u32_dpp v6, v6, v6 row_shr:4 row_mask:0xf bank_mask:0xf bound_ctrl:0
    v_cmp_eq_u16_e64 s[16:17], s61, v207
    v_cmp_eq_u16_sdwa s[18:19], v207, s61 src0_sel:WORD_1 src1_sel:WORD_0
    v_add_u32_dpp v6, v6, v6 row_shr:8 row_mask:0xf bank_mask:0xf bound_ctrl:0
    s_nop 1
    v_add_u32_dpp v6, v6, v6 row_bcast:15 row_mask:0xa bank_mask:0xf
    v_sub_u32 v6, v6, v7
    v_mul_u32_u24 v6, 9363, v6
    v_lshrrev_b32 v6, 16, v6
    v_min_u32 v6, 200, v6
    v_add3_u32 v226, v6, v213, s56
    v_readlane_b32 s59, v6, 31
    v_readlane_b32 s58, v6, 63
    v_addc_co_u32_e64 v227, vcc, 0, v226, s[4:5]
    v_addc_co_u32_e64 v228, vcc, 0, v227, s[6:7]
    v_addc_co_u32_e64 v229, vcc, 0, v228, s[8:9]
    v_addc_co_u32_e64 v230, vcc, 0, v229, s[10:11]
    v_addc_co_u32_e64 v231, vcc, 0, v230, s[12:13]
    v_addc_co_u32_e64 v232, vcc, 0, v231, s[14:15]
    v_addc_co_u32_e64 v233, vcc, 0, v232, s[16:17]
    v_addc_co_u32_e64 v234, vcc, 0, v233, s[18:19]
    s_mov_b64 exec, s[4:5]
    ds_write_b8 v226, v208
    s_mov_b64 exec, s[6:7]
    ds_write_b8_d16_hi v227, v208
    s_mov_b64 exec, s[8:9]
    ds_write_b8 v228, v209
    s_mov_b64 exec, s[10:11]
    ds_write_b8_d16_hi v229, v209
    s_mov_b64 exec, s[12:13]
    ds_write_b8 v230, v210
    s_mov_b64 exec, s[14:15]
    ds_write_b8_d16_hi v231, v210
    s_mov_b64 exec, s[16:17]
    ds_write_b8 v232, v211
    s_mov_b64 exec, s[18:19]
    ds_write_b8_d16_hi v233, v211
    s_mov_b64 exec, -1
    v_sub_u32 v6, v234, v226
    v_mul_u32_u24 v6, 7, v6
    v_cmp_ne_u32 vcc, v6, v7
    s_min_u32 s64, vcc_lo, 1
    s_min_u32 s65, vcc_hi, 1
    s_lshl_b64 s[64:65], s[64:65], 15
    s_or_b32 s57, s59, s64
    s_or_b32 s58, s58, s65
    s_setpc_b64 s[36:37]
P_C:
    ds_read_u8 v238, v246 offset:0
    ds_read_u8 v240, v246 offset:8
    ds_read_u8 v152, v246 offset:16
    ds_read_u8 v154, v246 offset:24
    s_add_u32 m0, s54, 0
    s_waitcnt lgkmcnt(3)
    buffer_load_dwordx4 v[238:239], s[20:23], s72 idxen offen nt lds
    s_waitcnt lgkmcnt(2)
    buffer_load_dwordx4 v[240:241], s[20:23], s51 idxen offen offset:1024 nt lds
    s_add_u32 m0, s54, 2048
    s_waitcnt lgkmcnt(1)
    buffer_load_dwordx4 v[152:153], s[20:23], s72 idxen offen nt lds
    s_waitcnt lgkmcnt(0)
    buffer_load_dwordx4 v[154:155], s[20:23], s51 idxen offen offset:1024 nt lds
    s_lshl_b32 s63, s63, 16
    s_cmp_lg_u32 s48, 0
    s_waitcnt vmcnt(8)
    s_cbranch_scc1 P_SW_J
    v_lshlrev_b32 v148, 16, v146
    v_and_b32 v149, 0xffff0000, v146
    v_mov_b32 v4, -1
    v_mov_b32 v5, 0
    v_mov_b32 v6, 0x240
    v_lshrrev_b32 v0, 1, v251
    ds_write2st64_b32 v250, v4, v5 offset0:66 offset1:67
    s_mov_b32 exec_hi, 0
    v_max3_f32 v2, abs(v148), abs(v149), abs(s63)
    v_ldexp_f32 v148, v148, 40
    v_ldexp_f32 v149, v149, 40
    v_cmp_le_f32 vcc, 0x33800000, v2
    s_mov_b32 exec_lo, 0x55
    v_mul_f32 v148, s42, v148
    v_mul_f32 v149, s42, v149
    s_mov_b32 exec_lo, -1
    ds_write_b32 v250, v6 offset:17408
    s_mov_b32 exec_hi, -1
    s_movk_i32 s56, 0x3ff
    s_cmp_lg_u64 vcc, 0
    s_cmovk_i32 s56, 0x207
    v_mov_b32 v6, 17184
    v_mov_b32 v7, s56
    ds_write_b64 v0, v[148:149] offset:16384
    ds_write_b64 v5, v[6:7] offset:17600
P_SW_J:
    ds_write_b128 v143, v[124:127] offset:256
    ds_write_b128 v143, v[124:127] offset:384
    s_waitcnt vmcnt(4) lgkmcnt(0)
    s_barrier
    ds_read_b64_tr_b16 v[218:219], v144 offset:0
    ds_read_b64_tr_b16 v[220:221], v144 offset:512
    ds_read_b64_tr_b16 v[222:223], v144 offset:16384
    ds_read_b64_tr_b16 v[224:225], v144 offset:16896
    ds_read_b128 v[160:163], v145 offset:256
    ds_read_b128 v[164:167], v145 offset:320
    ds_read_b128 v[104:107], v142 offset:16640
    ds_read_b128 v[108:111], v142 offset:16704
    ds_read_b64_tr_b16 v[40:41], v140 offset:8192
    ds_read_b64_tr_b16 v[42:43], v140 offset:8704
    ds_read_b64_tr_b16 v[44:45], v141 offset:8192
    ds_read_b64_tr_b16 v[46:47], v141 offset:8704
    ds_read_b64_tr_b16 v[48:49], v140 offset:12288
    ds_read_b64_tr_b16 v[50:51], v140 offset:12800
    ds_read_b64_tr_b16 v[52:53], v141 offset:12288
    ds_read_b64_tr_b16 v[54:55], v141 offset:12800
    ds_read_b64_tr_b16 v[56:57], v140 offset:16384
    ds_read_b64_tr_b16 v[58:59], v140 offset:16896
    ds_read_b64_tr_b16 v[60:61], v141 offset:16384
    ds_read_b64_tr_b16 v[62:63], v141 offset:16896
    ds_read_b64_tr_b16 v[64:65], v140 offset:20480
    ds_read_b64_tr_b16 v[66:67], v140 offset:20992
    ds_read_b64_tr_b16 v[68:69], v141 offset:20480
    ds_read_b64_tr_b16 v[70:71], v141 offset:20992
    s_and_b32 s59, s57, 0xff
    s_lshr_b32 s57, s57, 8
    s_add_u32 s59, s59, 15
    s_and_b32 s52, s59, 15
    s_lshl_b32 s52, s52, 12
    s_or_b32 s57, s57, s52
    s_lshr_b32 s59, s59, 4
    s_max_u32 s59, s59, 3
    s_lshl1_add_u32 s52, s48, s57
    s_lshl_b32 s57, s59, 8
    s_or_b32 s52, s52, s57
    s_sub_u32 s50, s59, 3
    s_and_b32 s59, s58, 0xff
    s_lshr_b32 s58, s58, 8
    s_add_u32 s59, s59, 15
    s_and_b32 s74, s59, 15
    s_lshl_b32 s74, s74, 12
    s_or_b32 s58, s58, s74
    s_lshr_b32 s59, s59, 4
    s_max_u32 s59, s59, 2
    s_lshl1_add_u32 s74, s48, s58
    s_lshl_b32 s58, s59, 8
    s_or_b32 s74, s74, s58
    s_or_b32 s74, s74, 1
    v_lshlrev_b32 v24, 16, v124
    v_and_b32 v25, 0xffff0000, v124
    v_lshlrev_b32 v26, 16, v125
    v_and_b32 v27, 0xffff0000, v125
    v_lshlrev_b32 v28, 16, v126
    v_and_b32 v29, 0xffff0000, v126
    v_lshlrev_b32 v30, 16, v127
    v_and_b32 v31, 0xffff0000, v127
    v_mul_f32 v24, s60, v24
    v_mul_f32 v25, s60, v25
    v_mul_f32 v26, s60, v26
    v_mul_f32 v27, s60, v27
    v_mul_f32 v28, s60, v28
    v_mul_f32 v29, s60, v29
    v_mul_f32 v30, s60, v30
    v_mul_f32 v31, s60, v31
    s_waitcnt lgkmcnt(15)
    v_lshlrev_b32 v8, 16, v218
    v_and_b32 v9, 0xffff0000, v218
    v_lshlrev_b32 v16, 16, v222
    v_and_b32 v17, 0xffff0000, v222
    v_lshlrev_b32 v10, 16, v219
    v_and_b32 v11, 0xffff0000, v219
    v_lshlrev_b32 v18, 16, v223
    v_and_b32 v19, 0xffff0000, v223
    v_lshlrev_b32 v12, 16, v220
    v_and_b32 v13, 0xffff0000, v220
    v_lshlrev_b32 v20, 16, v224
    v_and_b32 v21, 0xffff0000, v224
    v_lshlrev_b32 v14, 16, v221
    v_and_b32 v15, 0xffff0000, v221
    v_lshlrev_b32 v22, 16, v225
    v_and_b32 v23, 0xffff0000, v225
    v_xor_b32 v168, 0x80008000, v160
    v_xor_b32 v169, 0x80008000, v161
    v_xor_b32 v170, 0x80008000, v162
    v_xor_b32 v171, 0x80008000, v163
    v_xor_b32 v172, 0x80008000, v164
    v_xor_b32 v173, 0x80008000, v165
    v_xor_b32 v174, 0x80008000, v166
    v_xor_b32 v175, 0x80008000, v167
    s_waitcnt lgkmcnt(12)
    v_mfma_f32_16x16x32_bf16 v[104:107], v[40:43], v[160:163], v[104:107]
    v_mfma_f32_16x16x32_bf16 v[108:111], v[44:47], v[160:163], v[108:111]
    v_add_f32 v112, v8, v16
    v_add_f32 v113, v9, v17
    s_waitcnt lgkmcnt(8)
    v_mfma_f32_16x16x32_bf16 v[104:107], v[48:51], v[164:167], v[104:107]
    v_mfma_f32_16x16x32_bf16 v[108:111], v[52:55], v[164:167], v[108:111]
    v_add_f32 v114, v10, v18
    v_add_f32 v115, v11, v19
    s_waitcnt lgkmcnt(4)
    v_mfma_f32_16x16x32_bf16 v[104:107], v[56:59], v[168:171], v[104:107]
    v_mfma_f32_16x16x32_bf16 v[108:111], v[60:63], v[168:171], v[108:111]
    v_add_f32 v116, v12, v20
    v_add_f32 v117, v13, v21
    s_waitcnt lgkmcnt(0)
    v_mfma_f32_16x16x32_bf16 v[104:107], v[64:67], v[172:175], v[104:107]
    v_mfma_f32_16x16x32_bf16 v[108:111], v[68:71], v[172:175], v[108:111]
    v_add_f32 v118, v14, v22
    v_add_f32 v119, v15, v23
    ds_read_b64_tr_b16 v[72:73], v136 offset:24576
    ds_read_b64_tr_b16 v[74:75], v136 offset:25088
    ds_read_b64_tr_b16 v[76:77], v136 offset:28672
    ds_read_b64_tr_b16 v[78:79], v136 offset:29184
    ds_read_b64_tr_b16 v[80:81], v137 offset:24576
    ds_read_b64_tr_b16 v[82:83], v137 offset:25088
    ds_read_b64_tr_b16 v[84:85], v137 offset:28672
    ds_read_b64_tr_b16 v[86:87], v137 offset:29184
    ds_read_b64_tr_b16 v[88:89], v138 offset:24576
    ds_read_b64_tr_b16 v[90:91], v138 offset:25088
    ds_read_b64_tr_b16 v[92:93], v138 offset:28672
    ds_read_b64_tr_b16 v[94:95], v138 offset:29184
    ds_read_b64_tr_b16 v[96:97], v139 offset:24576
    ds_read_b64_tr_b16 v[98:99], v139 offset:25088
    ds_read_b64_tr_b16 v[100:101], v139 offset:28672
    ds_read_b64_tr_b16 v[102:103], v139 offset:29184
    s_cmp_le_u32 s47, 0
    s_cbranch_scc1 P_MJ
    s_lshr_b32 s56, s70, 1
    s_lshr_b32 s59, s56, 2
    s_mul_i32 s71, s56, 800
    s_mul_i32 s59, s59, 816000
    s_add_u32 s71, s71, s59
    buffer_load_dwordx4 v[180:183], v179, s[24:27], s71 offen offset:0 nt
    s_cmp_le_u32 s47, 1
    s_cbranch_scc1 P_MJ
    s_lshr_b32 s56, s70, 1
    s_add_u32 s56, s56, 1
    s_lshr_b32 s59, s56, 2
    s_mul_i32 s71, s56, 800
    s_mul_i32 s59, s59, 816000
    s_add_u32 s71, s71, s59
    buffer_load_dwordx4 v[184:187], v179, s[24:27], s71 offen offset:0 nt
    s_cmp_le_u32 s47, 2
    s_cbranch_scc1 P_MJ
    s_lshr_b32 s56, s70, 1
    s_add_u32 s56, s56, 2
    s_lshr_b32 s59, s56, 2
    s_mul_i32 s71, s56, 800
    s_mul_i32 s59, s59, 816000
    s_add_u32 s71, s71, s59
    buffer_load_dwordx4 v[188:191], v179, s[24:27], s71 offen offset:0 nt
    s_cmp_le_u32 s47, 3
    s_cbranch_scc1 P_MJ
    s_lshr_b32 s56, s70, 1
    s_add_u32 s56, s56, 3
    s_lshr_b32 s59, s56, 2
    s_mul_i32 s71, s56, 800
    s_mul_i32 s59, s59, 816000
    s_add_u32 s71, s71, s59
    buffer_load_dwordx4 v[192:195], v179, s[24:27], s71 offen offset:0 nt
    s_cmp_le_u32 s47, 4
    s_cbranch_scc1 P_MJ
    s_lshr_b32 s56, s70, 1
    s_add_u32 s56, s56, 4
    s_lshr_b32 s59, s56, 2
    s_mul_i32 s71, s56, 800
    s_mul_i32 s59, s59, 816000
    s_add_u32 s71, s71, s59
    buffer_load_dwordx4 v[196:199], v179, s[24:27], s71 offen offset:0 nt
    s_cmp_le_u32 s47, 5
    s_cbranch_scc1 P_MJ
    s_lshr_b32 s56, s70, 1
    s_add_u32 s56, s56, 5
    s_lshr_b32 s59, s56, 2
    s_mul_i32 s71, s56, 800
    s_mul_i32 s59, s59, 816000
    s_add_u32 s71, s71, s59
    buffer_load_dwordx4 v[200:203], v179, s[24:27], s71 offen offset:0 nt
P_MJ:
    v_mul_f32 v112, s60, v112
    v_mul_f32 v113, s60, v113
    v_mul_f32 v114, s60, v114
    v_mul_f32 v115, s60, v115
    v_mul_f32 v116, s60, v116
    v_mul_f32 v117, s60, v117
    v_mul_f32 v118, s60, v118
    v_mul_f32 v119, s60, v119
    ds_write_b128 v151, v[112:115] offset:0
    ds_write_b128 v151, v[116:119] offset:1024
    v_mul_f32 v104, s60, v104
    v_mul_f32 v105, s60, v105
    v_mul_f32 v106, s60, v106
    v_mul_f32 v107, s60, v107
    v_mul_f32 v108, s60, v108
    v_mul_f32 v109, s60, v109
    v_mul_f32 v110, s60, v110
    v_mul_f32 v111, s60, v111
    ds_write_b128 v145, v[104:107] offset:256
    ds_write_b128 v145, v[108:111] offset:320
    ds_write_b128 v3, v[24:27] offset:0
    ds_write_b128 v3, v[28:31] offset:16
    ds_read_b128 v[120:123], v252 offset:16384
    ds_read_b128 v[124:127], v252 offset:16448
    ds_read_b128 v[128:131], v252 offset:16512
    ds_read_b128 v[132:135], v252 offset:16576
    ds_read_b32 v150, v252 offset:17604
    s_lshl2_add_u32 s56, s48, 17184
    v_mov_b32 v253, s56
    v_mov_b32 v254, s74
    ds_write_b32 v253, v254
    v_ldexp_f32 v2, s63, 38
    v_add_u32 v250, 133376, v250
    v_mov_b64 v[168:169], 0
    v_mov_b64 v[170:171], 0
    v_mov_b64 v[172:173], 0
    v_mov_b64 v[174:175], 0
    v_readfirstlane_b32 s44, v2
    s_waitcnt lgkmcnt(15)
    v_lshlrev_b32 v8, 16, v72
    v_and_b32 v9, 0xffff0000, v72
    v_lshlrev_b32 v10, 16, v73
    v_and_b32 v11, 0xffff0000, v73
    v_lshlrev_b32 v12, 16, v74
    v_and_b32 v13, 0xffff0000, v74
    v_lshlrev_b32 v14, 16, v75
    v_and_b32 v15, 0xffff0000, v75
    v_lshlrev_b32 v16, 16, v76
    v_and_b32 v17, 0xffff0000, v76
    v_lshlrev_b32 v18, 16, v77
    v_and_b32 v19, 0xffff0000, v77
    v_lshlrev_b32 v20, 16, v78
    v_and_b32 v21, 0xffff0000, v78
    v_lshlrev_b32 v22, 16, v79
    v_and_b32 v23, 0xffff0000, v79
    v_lshlrev_b32 v24, 16, v80
    v_and_b32 v25, 0xffff0000, v80
    v_lshlrev_b32 v26, 16, v81
    v_and_b32 v27, 0xffff0000, v81
    v_lshlrev_b32 v28, 16, v82
    v_and_b32 v29, 0xffff0000, v82
    v_lshlrev_b32 v30, 16, v83
    v_and_b32 v31, 0xffff0000, v83
    v_lshlrev_b32 v32, 16, v84
    v_and_b32 v33, 0xffff0000, v84
    v_lshlrev_b32 v34, 16, v85
    v_and_b32 v35, 0xffff0000, v85
    v_lshlrev_b32 v36, 16, v86
    v_and_b32 v37, 0xffff0000, v86
    v_lshlrev_b32 v38, 16, v87
    v_and_b32 v39, 0xffff0000, v87
    ds_read_u8 v238, v246 offset:32
    ds_read_u8 v240, v246 offset:40
    s_add_u32 m0, s54, 4096
    v_add_u32 v246, 32, v246
    s_mov_b64 s[68:69], 0
    s_mov_b32 s75, 0
    s_movk_i32 s53, 0x1040
    s_mov_b32 s73, 3
    s_mov_b32 s77, 0
    s_mov_b32 s55, 0
    v_mov_b64 v[0:1], 0
    v_mov_b32 v2, 1.0
    v_mov_b32 v3, 1.0
    s_waitcnt lgkmcnt(0)
    s_barrier
    v_readfirstlane_b32 s45, v150
    buffer_load_dwordx4 v[238:239], s[20:23], s72 idxen offen nt lds
    buffer_load_dwordx4 v[240:241], s[20:23], s51 idxen offen offset:1024 nt lds
    s_cmp_eq_u32 s47, 0
    s_cbranch_scc1 P_GO
    s_lshl_b32 s56, s70, 8
    s_add_u32 s56, s56, 116992
    s_waitcnt vmcnt(2)
    v_mov_b64 v[204:205], v[180:181]
    v_mov_b64 v[206:207], v[182:183]
    s_call_b64 s[36:37], CMP
    v_writelane_b32 v212, s57, 0
    v_writelane_b32 v212, s58, 1
    s_cmp_le_u32 s47, 1
    s_cbranch_scc1 LATE_D
    s_add_u32 s56, s56, 512
    v_mov_b64 v[204:205], v[184:185]
    v_mov_b64 v[206:207], v[186:187]
    s_call_b64 s[36:37], CMP
    v_writelane_b32 v212, s57, 2
    v_writelane_b32 v212, s58, 3
    s_cmp_le_u32 s47, 2
    s_cbranch_scc1 LATE_D
    s_add_u32 s56, s56, 512
    v_mov_b64 v[204:205], v[188:189]
    v_mov_b64 v[206:207], v[190:191]
    s_call_b64 s[36:37], CMP
    v_writelane_b32 v212, s57, 4
    v_writelane_b32 v212, s58, 5
    s_cmp_le_u32 s47, 3
    s_cbranch_scc1 LATE_D
    s_add_u32 s56, s56, 512
    v_mov_b64 v[204:205], v[192:193]
    v_mov_b64 v[206:207], v[194:195]
    s_call_b64 s[36:37], CMP
    v_writelane_b32 v212, s57, 6
    v_writelane_b32 v212, s58, 7
    s_cmp_le_u32 s47, 4
    s_cbranch_scc1 LATE_D
    s_add_u32 s56, s56, 512
    v_mov_b64 v[204:205], v[196:197]
    v_mov_b64 v[206:207], v[198:199]
    s_call_b64 s[36:37], CMP
    v_writelane_b32 v212, s57, 8
    v_writelane_b32 v212, s58, 9
    s_cmp_le_u32 s47, 5
    s_cbranch_scc1 LATE_D
    s_add_u32 s56, s56, 512
    v_mov_b64 v[204:205], v[200:201]
    v_mov_b64 v[206:207], v[202:203]
    s_call_b64 s[36:37], CMP
    v_writelane_b32 v212, s57, 10
    v_writelane_b32 v212, s58, 11
LATE_D:
    v_add_u32 v4, s70, v176
    s_lshl_b32 s56, s47, 1
    v_and_b32 v5, 0xff, v212
    v_add_u32 v5, 15, v5
    v_lshrrev_b32 v212, 8, v212
    v_and_b32 v6, 15, v5
    v_lshl_or_b32 v212, v6, 12, v212
    v_lshrrev_b32 v5, 4, v5
    v_max_u32 v5, 2, v5
    v_or_b32 v212, v212, v4
    v_cmp_gt_u32 vcc, 64, v4
    v_lshl_or_b32 v6, v5, 8, v212
    v_lshlrev_b32 v4, 2, v4
    s_bfm_b64 s[66:67], s56, 0
    s_and_b64 exec, s[66:67], vcc
    ds_write_b32 v4, v6 offset:17152
    s_mov_b64 exec, -1
P_GO:
    ds_read_b128 v[180:183], v251 offset:0
    ds_read_b128 v[184:187], v251 offset:1024
    ds_read_b128 v[196:199], v251 offset:4096
    ds_read_b128 v[200:203], v251 offset:5120
    ds_read_b128 v[212:215], v251 offset:8192
    ds_read_b128 v[216:219], v251 offset:9216
    ds_read_b128 v[188:191], v251 offset:2048
    ds_read_b128 v[192:195], v251 offset:3072
    ds_read_b128 v[204:207], v251 offset:6144
    ds_read_b128 v[208:211], v251 offset:7168
    ds_read_b128 v[220:223], v251 offset:10240
    ds_read_b128 v[224:227], v251 offset:11264
    ds_read_b128 v[228:231], v251 offset:14336
    ds_read_b128 v[232:235], v251 offset:15360
    v_lshlrev_b32 v40, 16, v88
    v_and_b32 v41, 0xffff0000, v88
    v_lshlrev_b32 v42, 16, v89
    v_and_b32 v43, 0xffff0000, v89
    v_lshlrev_b32 v44, 16, v90
    v_and_b32 v45, 0xffff0000, v90
    v_lshlrev_b32 v46, 16, v91
    v_and_b32 v47, 0xffff0000, v91
    v_lshlrev_b32 v48, 16, v92
    v_and_b32 v49, 0xffff0000, v92
    v_lshlrev_b32 v50, 16, v93
    v_and_b32 v51, 0xffff0000, v93
    v_lshlrev_b32 v52, 16, v94
    v_and_b32 v53, 0xffff0000, v94
    v_lshlrev_b32 v54, 16, v95
    v_and_b32 v55, 0xffff0000, v95
    v_lshlrev_b32 v56, 16, v96
    v_and_b32 v57, 0xffff0000, v96
    v_lshlrev_b32 v58, 16, v97
    v_and_b32 v59, 0xffff0000, v97
    v_lshlrev_b32 v60, 16, v98
    v_and_b32 v61, 0xffff0000, v98
    v_lshlrev_b32 v62, 16, v99
    v_and_b32 v63, 0xffff0000, v99
    v_lshlrev_b32 v64, 16, v100
    v_and_b32 v65, 0xffff0000, v100
    v_lshlrev_b32 v66, 16, v101
    v_and_b32 v67, 0xffff0000, v101
    v_lshlrev_b32 v68, 16, v102
    v_and_b32 v69, 0xffff0000, v102
    v_lshlrev_b32 v70, 16, v103
    v_and_b32 v71, 0xffff0000, v103
    v_mov_b64 v[176:177], 0
    v_mov_b64 v[178:179], 0
    s_sub_u32 s50, s50, 2
    s_cbranch_scc1 DRAW_P
DRET_P:
    s_waitcnt vmcnt(4)
    ds_read_b128 v[152:155], v242
    ds_read_b128 v[156:159], v243
    s_branch BPF
U_0:
    v_mfma_f32_16x16x32_bf16 v[104:107], v[72:75], v[152:155], v[136:139]
    s_add_u32 m0, s54, 6144
    v_rcp_f32 v2, v2
    v_mfma_f32_16x16x32_bf16 v[104:107], v[76:79], v[156:159], v[104:107]
    s_mov_b32 s73, 0
    v_rcp_f32 v3, v3
    v_mfma_f32_16x16x32_bf16 v[108:111], v[80:83], v[152:155], v[140:143]
    s_sub_u32 s50, s50, 1
    v_fma_f32 v0, v0, v2, s44
    v_fmac_f32 v0, v1, v3
    v_mfma_f32_16x16x32_bf16 v[108:111], v[84:87], v[156:159], v[108:111]
    s_cbranch_scc1 PEV
    v_add_u32 v246, 16, v246
RET_0:
    v_cvt_pk_bf16_f32 v0, v0, v0
    v_mfma_f32_16x16x32_bf16 v[112:115], v[88:91], v[152:155], v[144:147]
    v_exp_f32 v104, v104
    v_mfma_f32_16x16x32_bf16 v[112:115], v[92:95], v[156:159], v[112:115]
    v_exp_f32 v105, v105
    v_mfma_f32_16x16x32_bf16 v[116:119], v[96:99], v[152:155], v[148:151]
    s_sub_u32 s62, s62, 1
    v_exp_f32 v106, v106
    v_mfma_f32_16x16x32_bf16 v[116:119], v[100:103], v[156:159], v[116:119]
    s_waitcnt vmcnt(2)
    v_exp_f32 v107, v107
    ds_write_b16 v249, v0
    ds_read_b64 v[236:237], v248
    ds_read_b64_tr_b16 v[160:161], v244 offset:0
    ds_read_b64_tr_b16 v[162:163], v245 offset:512
    ds_read_b64_tr_b16 v[164:165], v244 offset:1024
    ds_read_b64_tr_b16 v[166:167], v245 offset:1536
    ds_read_u8 v238, v246 offset:0
    ds_read_u8 v240, v246 offset:8
    ds_read_b128 v[152:155], v242 offset:2048
    ds_read_b128 v[156:159], v243 offset:2048
    v_exp_f32 v108, v108
    v_exp_f32 v109, v109
    v_exp_f32 v110, v110
    v_exp_f32 v111, v111
    s_waitcnt lgkmcnt(8)
    v_mfma_f32_4x4x4_16b_bf16 v[176:179], v[236:237], v[168:169], v[176:179] cbsz:4 abid:0
    v_exp_f32 v112, v112
    v_exp_f32 v113, v113
    v_mfma_f32_4x4x4_16b_bf16 v[176:179], v[236:237], v[170:171], v[176:179] cbsz:4 abid:1
    v_exp_f32 v114, v114
    v_exp_f32 v115, v115
    v_mfma_f32_4x4x4_16b_bf16 v[176:179], v[236:237], v[172:173], v[176:179] cbsz:4 abid:2
    v_exp_f32 v116, v116
    v_exp_f32 v117, v117
    v_mfma_f32_4x4x4_16b_bf16 v[176:179], v[236:237], v[174:175], v[176:179] cbsz:4 abid:3
    v_exp_f32 v118, v118
    v_exp_f32 v119, v119
    s_cselect_b64 exec, s[78:79], -1
    .p2align 3
    v_pk_fma_f32 v[2:3], v[104:105], s[42:43], s[42:43] op_sel_hi:[1,0,0]
    v_pk_fma_f32 v[0:1], v[120:121], v[106:107], v[120:121]
    v_pk_fma_f32 v[0:1], v[122:123], v[2:3], v[0:1]
    v_pk_fma_f32 v[2:3], v[106:107], v[2:3], v[2:3]
    v_pk_fma_f32 v[0:1], v[108:109], v[0:1], v[0:1]
    v_pk_fma_f32 v[0:1], v[124:125], v[2:3], v[0:1]
    v_pk_fma_f32 v[2:3], v[108:109], v[2:3], v[2:3]
    v_pk_fma_f32 v[0:1], v[110:111], v[0:1], v[0:1]
    v_pk_fma_f32 v[0:1], v[126:127], v[2:3], v[0:1]
    v_pk_fma_f32 v[2:3], v[110:111], v[2:3], v[2:3]
    v_pk_fma_f32 v[0:1], v[112:113], v[0:1], v[0:1]
    v_pk_fma_f32 v[0:1], v[128:129], v[2:3], v[0:1]
    v_pk_fma_f32 v[2:3], v[112:113], v[2:3], v[2:3]
    v_pk_fma_f32 v[0:1], v[114:115], v[0:1], v[0:1]
    v_pk_fma_f32 v[0:1], v[130:131], v[2:3], v[0:1]
    v_pk_fma_f32 v[2:3], v[114:115], v[2:3], v[2:3]
    v_pk_fma_f32 v[0:1], v[116:117], v[0:1], v[0:1]
    v_pk_fma_f32 v[0:1], v[132:133], v[2:3], v[0:1]
    v_pk_fma_f32 v[2:3], v[116:117], v[2:3], v[2:3]
    v_pk_fma_f32 v[0:1], v[118:119], v[0:1], v[0:1]
    v_pk_fma_f32 v[0:1], v[134:135], v[2:3], v[0:1]
    v_pk_fma_f32 v[2:3], v[118:119], v[2:3], v[2:3]
    s_mov_b64 exec, -1
    s_waitcnt lgkmcnt(0)
    buffer_load_dwordx4 v[238:239], s[20:23], s72 idxen offen nt lds
    buffer_load_dwordx4 v[240:241], s[20:23], s51 idxen offen offset:1024 nt lds
    s_cbranch_scc1 CEV
U_1:
    v_mfma_f32_16x16x32_bf16 v[104:107], v[72:75], v[152:155], v[136:139]
    s_add_u32 m0, s54, 0
    v_rcp_f32 v2, v2
    v_mfma_f32_16x16x32_bf16 v[104:107], v[76:79], v[156:159], v[104:107]
    s_mov_b32 s73, 1
    v_rcp_f32 v3, v3
    v_mfma_f32_16x16x32_bf16 v[108:111], v[80:83], v[152:155], v[140:143]
    s_sub_u32 s50, s50, 1
    v_fma_f32 v0, v0, v2, s44
    v_fmac_f32 v0, v1, v3
    v_mfma_f32_16x16x32_bf16 v[108:111], v[84:87], v[156:159], v[108:111]
    s_cbranch_scc1 PEV
    v_add_u32 v246, 16, v246
RET_1:
    v_cvt_pk_bf16_f32 v0, v0, v0
    v_mfma_f32_16x16x32_bf16 v[112:115], v[88:91], v[152:155], v[144:147]
    v_exp_f32 v104, v104
    v_mfma_f32_16x16x32_bf16 v[112:115], v[92:95], v[156:159], v[112:115]
    v_exp_f32 v105, v105
    v_mfma_f32_16x16x32_bf16 v[116:119], v[96:99], v[152:155], v[148:151]
    s_sub_u32 s62, s62, 1
    v_exp_f32 v106, v106
    v_mfma_f32_16x16x32_bf16 v[116:119], v[100:103], v[156:159], v[116:119]
    s_waitcnt vmcnt(2)
    v_exp_f32 v107, v107
    ds_write_b16 v249, v0
    ds_read_b64 v[236:237], v248
    ds_read_b64_tr_b16 v[168:169], v244 offset:2048
    ds_read_b64_tr_b16 v[170:171], v245 offset:2560
    ds_read_b64_tr_b16 v[172:173], v244 offset:3072
    ds_read_b64_tr_b16 v[174:175], v245 offset:3584
    ds_read_u8 v238, v246 offset:0
    ds_read_u8 v240, v246 offset:8
    ds_read_b128 v[152:155], v242 offset:4096
    ds_read_b128 v[156:159], v243 offset:4096
    v_exp_f32 v108, v108
    v_exp_f32 v109, v109
    v_exp_f32 v110, v110
    v_exp_f32 v111, v111
    s_waitcnt lgkmcnt(8)
    v_mfma_f32_4x4x4_16b_bf16 v[176:179], v[236:237], v[160:161], v[176:179] cbsz:4 abid:0
    v_exp_f32 v112, v112
    v_exp_f32 v113, v113
    v_mfma_f32_4x4x4_16b_bf16 v[176:179], v[236:237], v[162:163], v[176:179] cbsz:4 abid:1
    v_exp_f32 v114, v114
    v_exp_f32 v115, v115
    v_mfma_f32_4x4x4_16b_bf16 v[176:179], v[236:237], v[164:165], v[176:179] cbsz:4 abid:2
    v_exp_f32 v116, v116
    v_exp_f32 v117, v117
    v_mfma_f32_4x4x4_16b_bf16 v[176:179], v[236:237], v[166:167], v[176:179] cbsz:4 abid:3
    v_exp_f32 v118, v118
    v_exp_f32 v119, v119
    s_cselect_b64 exec, s[78:79], -1
    .p2align 3
    v_pk_fma_f32 v[2:3], v[104:105], s[42:43], s[42:43] op_sel_hi:[1,0,0]
    v_pk_fma_f32 v[0:1], v[120:121], v[106:107], v[120:121]
    v_pk_fma_f32 v[0:1], v[122:123], v[2:3], v[0:1]
    v_pk_fma_f32 v[2:3], v[106:107], v[2:3], v[2:3]
    v_pk_fma_f32 v[0:1], v[108:109], v[0:1], v[0:1]
    v_pk_fma_f32 v[0:1], v[124:125], v[2:3], v[0:1]
    v_pk_fma_f32 v[2:3], v[108:109], v[2:3], v[2:3]
    v_pk_fma_f32 v[0:1], v[110:111], v[0:1], v[0:1]
    v_pk_fma_f32 v[0:1], v[126:127], v[2:3], v[0:1]
    v_pk_fma_f32 v[2:3], v[110:111], v[2:3], v[2:3]
    v_pk_fma_f32 v[0:1], v[112:113], v[0:1], v[0:1]
    v_pk_fma_f32 v[0:1], v[128:129], v[2:3], v[0:1]
    v_pk_fma_f32 v[2:3], v[112:113], v[2:3], v[2:3]
    v_pk_fma_f32 v[0:1], v[114:115], v[0:1], v[0:1]
    v_pk_fma_f32 v[0:1], v[130:131], v[2:3], v[0:1]
    v_pk_fma_f32 v[2:3], v[114:115], v[2:3], v[2:3]
    v_pk_fma_f32 v[0:1], v[116:117], v[0:1], v[0:1]
    v_pk_fma_f32 v[0:1], v[132:133], v[2:3], v[0:1]
    v_pk_fma_f32 v[2:3], v[116:117], v[2:3], v[2:3]
    v_pk_fma_f32 v[0:1], v[118:119], v[0:1], v[0:1]
    v_pk_fma_f32 v[0:1], v[134:135], v[2:3], v[0:1]
    v_pk_fma_f32 v[2:3], v[118:119], v[2:3], v[2:3]
    s_mov_b64 exec, -1
    s_waitcnt lgkmcnt(0)
    buffer_load_dwordx4 v[238:239], s[20:23], s72 idxen offen nt lds
    buffer_load_dwordx4 v[240:241], s[20:23], s51 idxen offen offset:1024 nt lds
    s_cbranch_scc1 CEV
U_2:
    v_mfma_f32_16x16x32_bf16 v[104:107], v[72:75], v[152:155], v[136:139]
    s_add_u32 m0, s54, 2048
    v_rcp_f32 v2, v2
    v_mfma_f32_16x16x32_bf16 v[104:107], v[76:79], v[156:159], v[104:107]
    s_mov_b32 s73, 2
    v_rcp_f32 v3, v3
    v_mfma_f32_16x16x32_bf16 v[108:111], v[80:83], v[152:155], v[140:143]
    s_sub_u32 s50, s50, 1
    v_fma_f32 v0, v0, v2, s44
    v_fmac_f32 v0, v1, v3
    v_mfma_f32_16x16x32_bf16 v[108:111], v[84:87], v[156:159], v[108:111]
    s_cbranch_scc1 PEV
    v_add_u32 v246, 16, v246
RET_2:
    v_cvt_pk_bf16_f32 v0, v0, v0
    v_mfma_f32_16x16x32_bf16 v[112:115], v[88:91], v[152:155], v[144:147]
    v_exp_f32 v104, v104
    v_mfma_f32_16x16x32_bf16 v[112:115], v[92:95], v[156:159], v[112:115]
    v_exp_f32 v105, v105
    v_mfma_f32_16x16x32_bf16 v[116:119], v[96:99], v[152:155], v[148:151]
    s_sub_u32 s62, s62, 1
    v_exp_f32 v106, v106
    v_mfma_f32_16x16x32_bf16 v[116:119], v[100:103], v[156:159], v[116:119]
    s_waitcnt vmcnt(2)
    v_exp_f32 v107, v107
    ds_write_b16 v249, v0
    ds_read_b64 v[236:237], v248
    ds_read_b64_tr_b16 v[160:161], v244 offset:4096
    ds_read_b64_tr_b16 v[162:163], v245 offset:4608
    ds_read_b64_tr_b16 v[164:165], v244 offset:5120
    ds_read_b64_tr_b16 v[166:167], v245 offset:5632
    ds_read_u8 v238, v246 offset:0
    ds_read_u8 v240, v246 offset:8
    ds_read_b128 v[152:155], v242 offset:6144
    ds_read_b128 v[156:159], v243 offset:6144
    v_exp_f32 v108, v108
    v_exp_f32 v109, v109
    v_exp_f32 v110, v110
    v_exp_f32 v111, v111
    s_waitcnt lgkmcnt(8)
    v_mfma_f32_4x4x4_16b_bf16 v[176:179], v[236:237], v[168:169], v[176:179] cbsz:4 abid:0
    v_exp_f32 v112, v112
    v_exp_f32 v113, v113
    v_mfma_f32_4x4x4_16b_bf16 v[176:179], v[236:237], v[170:171], v[176:179] cbsz:4 abid:1
    v_exp_f32 v114, v114
    v_exp_f32 v115, v115
    v_mfma_f32_4x4x4_16b_bf16 v[176:179], v[236:237], v[172:173], v[176:179] cbsz:4 abid:2
    v_exp_f32 v116, v116
    v_exp_f32 v117, v117
    v_mfma_f32_4x4x4_16b_bf16 v[176:179], v[236:237], v[174:175], v[176:179] cbsz:4 abid:3
    v_exp_f32 v118, v118
    v_exp_f32 v119, v119
    s_cselect_b64 exec, s[78:79], -1
    .p2align 3
    v_pk_fma_f32 v[2:3], v[104:105], s[42:43], s[42:43] op_sel_hi:[1,0,0]
    v_pk_fma_f32 v[0:1], v[120:121], v[106:107], v[120:121]
    v_pk_fma_f32 v[0:1], v[122:123], v[2:3], v[0:1]
    v_pk_fma_f32 v[2:3], v[106:107], v[2:3], v[2:3]
    v_pk_fma_f32 v[0:1], v[108:109], v[0:1], v[0:1]
    v_pk_fma_f32 v[0:1], v[124:125], v[2:3], v[0:1]
    v_pk_fma_f32 v[2:3], v[108:109], v[2:3], v[2:3]
    v_pk_fma_f32 v[0:1], v[110:111], v[0:1], v[0:1]
    v_pk_fma_f32 v[0:1], v[126:127], v[2:3], v[0:1]
    v_pk_fma_f32 v[2:3], v[110:111], v[2:3], v[2:3]
    v_pk_fma_f32 v[0:1], v[112:113], v[0:1], v[0:1]
    v_pk_fma_f32 v[0:1], v[128:129], v[2:3], v[0:1]
    v_pk_fma_f32 v[2:3], v[112:113], v[2:3], v[2:3]
    v_pk_fma_f32 v[0:1], v[114:115], v[0:1], v[0:1]
    v_pk_fma_f32 v[0:1], v[130:131], v[2:3], v[0:1]
    v_pk_fma_f32 v[2:3], v[114:115], v[2:3], v[2:3]
    v_pk_fma_f32 v[0:1], v[116:117], v[0:1], v[0:1]
    v_pk_fma_f32 v[0:1], v[132:133], v[2:3], v[0:1]
    v_pk_fma_f32 v[2:3], v[116:117], v[2:3], v[2:3]
    v_pk_fma_f32 v[0:1], v[118:119], v[0:1], v[0:1]
    v_pk_fma_f32 v[0:1], v[134:135], v[2:3], v[0:1]
    v_pk_fma_f32 v[2:3], v[118:119], v[2:3], v[2:3]
    s_mov_b64 exec, -1
    s_waitcnt lgkmcnt(0)
    buffer_load_dwordx4 v[238:239], s[20:23], s72 idxen offen nt lds
    buffer_load_dwordx4 v[240:241], s[20:23], s51 idxen offen offset:1024 nt lds
    s_cbranch_scc1 CEV
U_3:
    v_mfma_f32_16x16x32_bf16 v[104:107], v[72:75], v[152:155], v[136:139]
    s_add_u32 m0, s54, 4096
    v_rcp_f32 v2, v2
    v_mfma_f32_16x16x32_bf16 v[104:107], v[76:79], v[156:159], v[104:107]
    s_mov_b32 s73, 3
    v_rcp_f32 v3, v3
    v_mfma_f32_16x16x32_bf16 v[108:111], v[80:83], v[152:155], v[140:143]
    s_sub_u32 s50, s50, 1
    v_fma_f32 v0, v0, v2, s44
    v_fmac_f32 v0, v1, v3
    v_mfma_f32_16x16x32_bf16 v[108:111], v[84:87], v[156:159], v[108:111]
    s_cbranch_scc1 PEV
    v_add_u32 v246, 16, v246
RET_3:
    v_cvt_pk_bf16_f32 v0, v0, v0
    v_mfma_f32_16x16x32_bf16 v[112:115], v[88:91], v[152:155], v[144:147]
    v_exp_f32 v104, v104
    v_mfma_f32_16x16x32_bf16 v[112:115], v[92:95], v[156:159], v[112:115]
    v_exp_f32 v105, v105
    v_mfma_f32_16x16x32_bf16 v[116:119], v[96:99], v[152:155], v[148:151]
    s_sub_u32 s62, s62, 1
    v_exp_f32 v106, v106
    v_mfma_f32_16x16x32_bf16 v[116:119], v[100:103], v[156:159], v[116:119]
    s_waitcnt vmcnt(2)
    v_exp_f32 v107, v107
    ds_write_b16 v249, v0
    ds_read_b64 v[236:237], v248
    ds_read_b64_tr_b16 v[168:169], v244 offset:6144
    ds_read_b64_tr_b16 v[170:171], v245 offset:6656
    ds_read_b64_tr_b16 v[172:173], v244 offset:7168
    ds_read_b64_tr_b16 v[174:175], v245 offset:7680
    ds_read_u8 v238, v246 offset:0
    ds_read_u8 v240, v246 offset:8
    ds_read_b128 v[152:155], v242 offset:0
    ds_read_b128 v[156:159], v243 offset:0
    v_exp_f32 v108, v108
    v_exp_f32 v109, v109
    v_exp_f32 v110, v110
    v_exp_f32 v111, v111
    s_waitcnt lgkmcnt(8)
    v_mfma_f32_4x4x4_16b_bf16 v[176:179], v[236:237], v[160:161], v[176:179] cbsz:4 abid:0
    v_exp_f32 v112, v112
    v_exp_f32 v113, v113
    v_mfma_f32_4x4x4_16b_bf16 v[176:179], v[236:237], v[162:163], v[176:179] cbsz:4 abid:1
    v_exp_f32 v114, v114
    v_exp_f32 v115, v115
    v_mfma_f32_4x4x4_16b_bf16 v[176:179], v[236:237], v[164:165], v[176:179] cbsz:4 abid:2
    v_exp_f32 v116, v116
    v_exp_f32 v117, v117
    v_mfma_f32_4x4x4_16b_bf16 v[176:179], v[236:237], v[166:167], v[176:179] cbsz:4 abid:3
    v_exp_f32 v118, v118
    v_exp_f32 v119, v119
    s_cselect_b64 exec, s[78:79], -1
    .p2align 3
    v_pk_fma_f32 v[2:3], v[104:105], s[42:43], s[42:43] op_sel_hi:[1,0,0]
    v_pk_fma_f32 v[0:1], v[120:121], v[106:107], v[120:121]
    v_pk_fma_f32 v[0:1], v[122:123], v[2:3], v[0:1]
    v_pk_fma_f32 v[2:3], v[106:107], v[2:3], v[2:3]
    v_pk_fma_f32 v[0:1], v[108:109], v[0:1], v[0:1]
    v_pk_fma_f32 v[0:1], v[124:125], v[2:3], v[0:1]
    v_pk_fma_f32 v[2:3], v[108:109], v[2:3], v[2:3]
    v_pk_fma_f32 v[0:1], v[110:111], v[0:1], v[0:1]
    v_pk_fma_f32 v[0:1], v[126:127], v[2:3], v[0:1]
    v_pk_fma_f32 v[2:3], v[110:111], v[2:3], v[2:3]
    v_pk_fma_f32 v[0:1], v[112:113], v[0:1], v[0:1]
    v_pk_fma_f32 v[0:1], v[128:129], v[2:3], v[0:1]
    v_pk_fma_f32 v[2:3], v[112:113], v[2:3], v[2:3]
    v_pk_fma_f32 v[0:1], v[114:115], v[0:1], v[0:1]
    v_pk_fma_f32 v[0:1], v[130:131], v[2:3], v[0:1]
    v_pk_fma_f32 v[2:3], v[114:115], v[2:3], v[2:3]
    v_pk_fma_f32 v[0:1], v[116:117], v[0:1], v[0:1]
    v_pk_fma_f32 v[0:1], v[132:133], v[2:3], v[0:1]
    v_pk_fma_f32 v[2:3], v[116:117], v[2:3], v[2:3]
    v_pk_fma_f32 v[0:1], v[118:119], v[0:1], v[0:1]
    v_pk_fma_f32 v[0:1], v[134:135], v[2:3], v[0:1]
    v_pk_fma_f32 v[2:3], v[118:119], v[2:3], v[2:3]
    s_mov_b64 exec, -1
    s_waitcnt lgkmcnt(0)
    buffer_load_dwordx4 v[238:239], s[20:23], s72 idxen offen nt lds
    buffer_load_dwordx4 v[240:241], s[20:23], s51 idxen offen offset:1024 nt lds
    s_cbranch_scc0 U_0
CEV:
    s_cmp_eq_u32 s76, 0
    s_cbranch_scc1 EPI
    s_mov_b32 s53, s52
    s_and_b32 s52, s68, 0xffff
    s_lshr_b64 s[68:69], s[68:69], 16
    s_sub_u32 s75, s75, 16
    s_bitcmp1_b32 s52, 6
    s_cbranch_scc1 DRAIN
BPF:
    s_and_b32 s57, s52, 63
    s_mul_i32 s57, s57, 528
    s_add_u32 s57, s57, 83200
    v_lshl_add_u32 v6, v252, 1, s57
    v_add_u32 v7, s57, v252
    ds_read_b128 v[104:107], v6 offset:0
    ds_read_b128 v[108:111], v6 offset:16
    ds_read_b128 v[144:147], v251 offset:12288
    ds_read_b128 v[148:151], v251 offset:13312
    ds_read_b128 v[112:115], v6 offset:128
    ds_read_b128 v[116:119], v6 offset:144
    s_mov_b32 s62, 0
    s_mov_b32 s76, 0
    s_mov_b64 s[78:79], -1
    s_cmp_lg_u32 s77, 0
    s_waitcnt lgkmcnt(4)
    .p2align 3
    v_pk_fma_f32 v[136:137], v[8:9], v[104:105], v[180:181]
    v_pk_fma_f32 v[138:139], v[10:11], v[106:107], v[182:183]
    v_pk_fma_f32 v[140:141], v[12:13], v[108:109], v[184:185]
    v_pk_fma_f32 v[142:143], v[14:15], v[110:111], v[186:187]
    v_cvt_pk_bf16_f32 v72, v136, v137
    v_cvt_pk_bf16_f32 v73, v138, v139
    v_cvt_pk_bf16_f32 v74, v140, v141
    v_cvt_pk_bf16_f32 v75, v142, v143
    v_pk_fma_f32 v[136:137], v[24:25], v[104:105], v[196:197]
    v_pk_fma_f32 v[138:139], v[26:27], v[106:107], v[198:199]
    v_pk_fma_f32 v[140:141], v[28:29], v[108:109], v[200:201]
    v_pk_fma_f32 v[142:143], v[30:31], v[110:111], v[202:203]
    v_cvt_pk_bf16_f32 v80, v136, v137
    v_cvt_pk_bf16_f32 v81, v138, v139
    v_cvt_pk_bf16_f32 v82, v140, v141
    v_cvt_pk_bf16_f32 v83, v142, v143
    v_pk_fma_f32 v[136:137], v[40:41], v[104:105], v[212:213]
    v_pk_fma_f32 v[138:139], v[42:43], v[106:107], v[214:215]
    v_pk_fma_f32 v[140:141], v[44:45], v[108:109], v[216:217]
    v_pk_fma_f32 v[142:143], v[46:47], v[110:111], v[218:219]
    v_cvt_pk_bf16_f32 v88, v136, v137
    v_cvt_pk_bf16_f32 v89, v138, v139
    v_cvt_pk_bf16_f32 v90, v140, v141
    v_cvt_pk_bf16_f32 v91, v142, v143
    s_waitcnt lgkmcnt(0)
    .p2align 3
    v_pk_fma_f32 v[144:145], v[56:57], v[104:105], v[144:145]
    v_pk_fma_f32 v[146:147], v[58:59], v[106:107], v[146:147]
    v_pk_fma_f32 v[148:149], v[60:61], v[108:109], v[148:149]
    v_pk_fma_f32 v[150:151], v[62:63], v[110:111], v[150:151]
    v_cvt_pk_bf16_f32 v96, v144, v145
    v_cvt_pk_bf16_f32 v97, v146, v147
    v_cvt_pk_bf16_f32 v98, v148, v149
    v_cvt_pk_bf16_f32 v99, v150, v151
    ds_read_b128 v[136:139], v7 offset:256
    ds_read_b128 v[140:143], v7 offset:320
    ds_read_b128 v[144:147], v7 offset:384
    ds_read_b128 v[148:151], v7 offset:448
    v_pk_fma_f32 v[104:105], v[16:17], v[112:113], v[188:189]
    v_pk_fma_f32 v[106:107], v[18:19], v[114:115], v[190:191]
    v_pk_fma_f32 v[108:109], v[20:21], v[116:117], v[192:193]
    v_pk_fma_f32 v[110:111], v[22:23], v[118:119], v[194:195]
    v_cvt_pk_bf16_f32 v76, v104, v105
    v_cvt_pk_bf16_f32 v77, v106, v107
    v_cvt_pk_bf16_f32 v78, v108, v109
    v_cvt_pk_bf16_f32 v79, v110, v111
    v_pk_fma_f32 v[104:105], v[32:33], v[112:113], v[204:205]
    v_pk_fma_f32 v[106:107], v[34:35], v[114:115], v[206:207]
    v_pk_fma_f32 v[108:109], v[36:37], v[116:117], v[208:209]
    v_pk_fma_f32 v[110:111], v[38:39], v[118:119], v[210:211]
    v_cvt_pk_bf16_f32 v84, v104, v105
    v_cvt_pk_bf16_f32 v85, v106, v107
    v_cvt_pk_bf16_f32 v86, v108, v109
    v_cvt_pk_bf16_f32 v87, v110, v111
    v_pk_fma_f32 v[104:105], v[48:49], v[112:113], v[220:221]
    v_pk_fma_f32 v[106:107], v[50:51], v[114:115], v[222:223]
    v_pk_fma_f32 v[108:109], v[52:53], v[116:117], v[224:225]
    v_pk_fma_f32 v[110:111], v[54:55], v[118:119], v[226:227]
    v_cvt_pk_bf16_f32 v92, v104, v105
    v_cvt_pk_bf16_f32 v93, v106, v107
    v_cvt_pk_bf16_f32 v94, v108, v109
    v_cvt_pk_bf16_f32 v95, v110, v111
    v_pk_fma_f32 v[104:105], v[64:65], v[112:113], v[228:229]
    v_pk_fma_f32 v[106:107], v[66:67], v[114:115], v[230:231]
    v_pk_fma_f32 v[108:109], v[68:69], v[116:117], v[232:233]
    v_pk_fma_f32 v[110:111], v[70:71], v[118:119], v[234:235]
    v_cvt_pk_bf16_f32 v100, v104, v105
    v_cvt_pk_bf16_f32 v101, v106, v107
    v_cvt_pk_bf16_f32 v102, v108, v109
    v_cvt_pk_bf16_f32 v103, v110, v111
    s_waitcnt lgkmcnt(0)
    s_cbranch_scc1 BP_X
NEXT:
    s_cmp_eq_u32 s73, 0
    s_cbranch_scc1 U_1
    s_cmp_eq_u32 s73, 1
    s_cbranch_scc1 U_2
    s_cmp_eq_u32 s73, 2
    s_cbranch_scc1 U_3
    s_branch U_0
EPI:
    s_and_b32 s56, s53, 0x7f
    v_pk_add_f32 v[4:5], v[176:177], v[178:179]
    v_add_f32 v4, v4, v5
    v_lshl_add_u32 v5, s56, 8, v250
    v_mul_f32 v4, s46, v4
    s_bitcmp1_b32 s53, 7
    v_cmp_class_f32_e64 vcc, v4, s45
    v_mov_b64 v[176:177], 0
    v_mov_b64 v[178:179], 0
    ds_write_b32 v5, v4
    s_cbranch_scc1 SLOW
    s_cbranch_vccnz SLOW
EPI_R:
    s_bitcmp1_b32 s52, 6
    s_cbranch_scc1 L_DONE
EPI_C:
    s_bfe_u32 s62, s52, 0x40008
    s_sub_u32 s62, s62, 2
    s_mov_b32 s76, 1
    s_lshr_b32 s56, s52, 12
    s_lshl_b32 s78, 0x20002, s56
    s_sub_u32 s78, s78, 0x10001
    s_mov_b32 s79, s78
    s_cmp_eq_u32 s73, 0
    s_cbranch_scc1 U_1
    s_cmp_eq_u32 s73, 1
    s_cbranch_scc1 U_2
    s_cmp_eq_u32 s73, 2
    s_cbranch_scc1 U_3
    s_branch U_0
PEV:
    s_cmp_eq_u32 s55, 0
    s_cbranch_scc1 P_DR
    ds_read_b32 v254, v253
    s_waitcnt lgkmcnt(0)
ADV:
    v_readfirstlane_b32 s66, v254
    s_mov_b32 s67, 0
    s_and_b32 s56, s66, 63
    s_bfe_u32 s50, s66, 0x40008
    s_cbranch_scc0 AW
    s_lshr_b32 s57, s56, 3
    s_mul_i32 s51, s56, 25600
    s_mul_i32 s57, s57, 52224000
    s_add_u32 s51, s51, s57
    v_lshl_add_u32 v246, s56, 8, v247
    s_add_u32 s51, s51, s49
    s_add_u32 s72, s51, 1024
    s_lshl_b64 s[64:65], s[66:67], s75
    s_or_b64 s[68:69], s[68:69], s[64:65]
    s_add_u32 s75, s75, 16
    s_mov_b32 s55, 0
    s_sub_u32 s50, s50, 3
    s_cbranch_scc1 P_2
P_RET:
    s_cmp_eq_u32 s73, 0
    s_cbranch_scc1 RET_0
    s_cmp_eq_u32 s73, 1
    s_cbranch_scc1 RET_1
    s_cmp_eq_u32 s73, 2
    s_cbranch_scc1 RET_2
    s_branch RET_3
P_DR:
    v_add_u32 v246, 16, v246
P_D2:
    s_mov_b64 exec, 1
    v_mov_b32 v253, 4
    ds_add_rtn_u32 v253, v251, v253 offset:17600
    s_mov_b64 exec, -1
    s_mov_b32 s50, 1
    s_mov_b32 s55, 1
    s_cmp_eq_u32 s73, 0
    s_cbranch_scc1 RET_0
    s_cmp_eq_u32 s73, 1
    s_cbranch_scc1 RET_1
    s_cmp_eq_u32 s73, 2
    s_cbranch_scc1 RET_2
    s_branch RET_3
P_2:
    s_bitcmp1_b32 s66, 6
    s_cbranch_scc0 P_D2
    v_mov_b32 v246, 16896
    s_movk_i32 s50, 0x100
    s_branch P_RET
DRAIN:
    v_rcp_f32 v2, v2
    v_rcp_f32 v3, v3
    v_fma_f32 v0, v0, v2, s44
    v_fmac_f32 v0, v1, v3
    v_cvt_pk_bf16_f32 v0, v0, v0
    s_bitcmp1_b32 s73, 0
    ds_write_b16 v249, v0
    ds_read_b64 v[236:237], v248
    s_waitcnt lgkmcnt(0)
    s_cbranch_scc1 DRAIN1
    v_mfma_f32_4x4x4_16b_bf16 v[176:179], v[236:237], v[160:161], v[176:179] cbsz:4 abid:0
    s_nop 1
    v_mfma_f32_4x4x4_16b_bf16 v[176:179], v[236:237], v[162:163], v[176:179] cbsz:4 abid:1
    s_nop 1
    v_mfma_f32_4x4x4_16b_bf16 v[176:179], v[236:237], v[164:165], v[176:179] cbsz:4 abid:2
    s_nop 1
    v_mfma_f32_4x4x4_16b_bf16 v[176:179], v[236:237], v[166:167], v[176:179] cbsz:4 abid:3
    s_nop 2
    s_branch EPI
DRAIN1:
    v_mfma_f32_4x4x4_16b_bf16 v[176:179], v[236:237], v[168:169], v[176:179] cbsz:4 abid:0
    s_nop 1
    v_mfma_f32_4x4x4_16b_bf16 v[176:179], v[236:237], v[170:171], v[176:179] cbsz:4 abid:1
    s_nop 1
    v_mfma_f32_4x4x4_16b_bf16 v[176:179], v[236:237], v[172:173], v[176:179] cbsz:4 abid:2
    s_nop 1
    v_mfma_f32_4x4x4_16b_bf16 v[176:179], v[236:237], v[174:175], v[176:179] cbsz:4 abid:3
    s_nop 2
    s_branch EPI
L_DONE:
    s_lshl_b32 s56, s48, 11
    s_add_u32 s56, s56, 133376
    v_lshl_add_u32 v0, v251, 1, s56
    s_lshl_b32 s56, s48, 18
    s_waitcnt lgkmcnt(0)
    s_barrier
    ds_read_b128 v[104:107], v0 offset:0
    ds_read_b128 v[108:111], v0 offset:16
    s_waitcnt lgkmcnt(0)
    v_cvt_pk_bf16_f32 v152, v104, v105
    v_cvt_pk_bf16_f32 v153, v106, v107
    v_cvt_pk_bf16_f32 v154, v108, v109
    v_cvt_pk_bf16_f32 v155, v110, v111
    buffer_store_dwordx4 v[152:155], v251, s[28:31], s56 offen nt
L_FIN:
    s_endpgm
AW:
    s_sleep 1
    ds_read_b32 v254, v253
    s_waitcnt lgkmcnt(0)
    s_branch ADV
DRAW_P:
    s_mov_b64 exec, 1
    v_mov_b32 v253, 4
    ds_add_rtn_u32 v253, v251, v253 offset:17600
    s_mov_b64 exec, -1
    s_add_u32 s50, s50, 2
    s_mov_b32 s55, 1
    s_branch DRET_P
BP_X:
    s_cmp_eq_u32 s77, 1
    s_mov_b32 s77, 0
    s_cbranch_scc1 SLOW_W
    s_branch EPI_C
SLOW:
    s_bitcmp1_b32 s53, 6
    s_cbranch_scc1 EPI_R
    s_mov_b32 s74, s52
    s_mov_b32 s52, s53
    s_mov_b32 s77, 1
    ds_write_b32 v5, v176
    s_branch BPF
SLOW_W:
    s_mov_b32 s52, s74
    s_and_b32 s56, s53, 63
    s_mov_b32 s57, 0
    s_bfe_u32 s59, s53, 0x40008
    s_lshl4_add_u32 s57, s56, s57
    s_lshl_b32 s57, s57, 4
    s_add_u32 s74, s57, 116992
    s_bitcmp1_b32 s53, 7
    s_cselect_b64 s[66:67], -1, 0
    s_cselect_b32 s59, 13, s59
    v_bfe_u32 v204, v251, 4, 4
    v_mov_b32 v207, v252
    v_mov_b64 v[180:181], 0
    v_mov_b64 v[182:183], 0
    v_mov_b64 v[184:185], 0
    v_mov_b64 v[186:187], 0
    v_mov_b64 v[188:189], 0
    v_mov_b64 v[190:191], 0
    v_mov_b64 v[192:193], 0
    v_mov_b64 v[194:195], 0
    s_lshr_b32 s58, s56, 3
    s_mul_i32 s57, s56, 25600
    s_mul_i32 s58, s58, 52224000
    s_add_u32 s57, s57, s58
    s_add_u32 s57, s57, s49
    s_lshr_b32 s64, s56, 3
    s_mul_i32 s58, s56, 400
    s_mul_i32 s64, s64, 816000
    s_add_u32 s58, s58, s64
SLOW_L:
    v_add_u32 v205, s74, v204
    ds_read_u8 v206, v205
    s_waitcnt lgkmcnt(0)
    v_cndmask_b32_e64 v206, v206, v204, s[66:67]
    v_lshlrev_b32 v205, 1, v206
    buffer_load_dwordx4 v[196:199], v[206:207], s[20:23], s57 idxen offen offset:1024
    buffer_load_dwordx4 v[200:203], v[206:207], s[20:23], s57 idxen offen offset:1088
    buffer_load_ushort v205, v205, s[24:27], s58 offen
    v_cmp_gt_u32 vcc, 200, v206
    v_add_u32 v204, 16, v204
    s_waitcnt vmcnt(0)
    v_mfma_f32_16x16x32_bf16 v[104:107], v[72:75], v[196:199], v[136:139]
    v_mfma_f32_16x16x32_bf16 v[104:107], v[76:79], v[200:203], v[104:107]
    v_mfma_f32_16x16x32_bf16 v[108:111], v[80:83], v[196:199], v[140:143]
    v_mfma_f32_16x16x32_bf16 v[108:111], v[84:87], v[200:203], v[108:111]
    v_mfma_f32_16x16x32_bf16 v[112:115], v[88:91], v[196:199], v[144:147]
    v_mfma_f32_16x16x32_bf16 v[112:115], v[92:95], v[200:203], v[112:115]
    v_mfma_f32_16x16x32_bf16 v[116:119], v[96:99], v[196:199], v[148:151]
    v_mfma_f32_16x16x32_bf16 v[116:119], v[100:103], v[200:203], v[116:119]
    v_lshlrev_b32 v205, 16, v205
    v_cndmask_b32 v205, 0, v205, vcc
    s_nop 7
    v_exp_f32 v104, v104
    v_exp_f32 v105, v105
    v_exp_f32 v106, v106
    v_exp_f32 v107, v107
    v_exp_f32 v108, v108
    v_exp_f32 v109, v109
    v_exp_f32 v110, v110
    v_exp_f32 v111, v111
    v_exp_f32 v112, v112
    v_exp_f32 v113, v113
    v_exp_f32 v114, v114
    v_exp_f32 v115, v115
    v_exp_f32 v116, v116
    v_exp_f32 v117, v117
    v_exp_f32 v118, v118
    v_exp_f32 v119, v119
    v_add_f32 v104, 1.0, v104
    v_add_f32 v105, 1.0, v105
    v_add_f32 v106, 1.0, v106
    v_add_f32 v107, 1.0, v107
    v_add_f32 v108, 1.0, v108
    v_add_f32 v109, 1.0, v109
    v_add_f32 v110, 1.0, v110
    v_add_f32 v111, 1.0, v111
    v_add_f32 v112, 1.0, v112
    v_add_f32 v113, 1.0, v113
    v_add_f32 v114, 1.0, v114
    v_add_f32 v115, 1.0, v115
    v_add_f32 v116, 1.0, v116
    v_add_f32 v117, 1.0, v117
    v_add_f32 v118, 1.0, v118
    v_add_f32 v119, 1.0, v119
    v_rcp_f32 v104, v104
    v_rcp_f32 v105, v105
    v_rcp_f32 v106, v106
    v_rcp_f32 v107, v107
    v_rcp_f32 v108, v108
    v_rcp_f32 v109, v109
    v_rcp_f32 v110, v110
    v_rcp_f32 v111, v111
    v_rcp_f32 v112, v112
    v_rcp_f32 v113, v113
    v_rcp_f32 v114, v114
    v_rcp_f32 v115, v115
    v_rcp_f32 v116, v116
    v_rcp_f32 v117, v117
    v_rcp_f32 v118, v118
    v_rcp_f32 v119, v119
    v_mul_f32 v208, v104, v120
    v_fmac_f32 v208, v105, v121
    v_ldexp_f32 v208, v208, 60
    v_fmac_f32 v208, v106, v122
    v_fmac_f32 v208, v107, v123
    v_fmac_f32 v208, v108, v124
    v_fmac_f32 v208, v109, v125
    v_fmac_f32 v208, v110, v126
    v_fmac_f32 v208, v111, v127
    v_fmac_f32 v208, v112, v128
    v_fmac_f32 v208, v113, v129
    v_fmac_f32 v208, v114, v130
    v_fmac_f32 v208, v115, v131
    v_fmac_f32 v208, v116, v132
    v_fmac_f32 v208, v117, v133
    v_fmac_f32 v208, v118, v134
    v_fmac_f32 v208, v119, v135
    v_mov_b32 v209, v208
    s_nop 1
    v_permlane32_swap_b32 v208, v209
    v_add_f32 v208, v208, v209
    v_mov_b32 v209, v208
    s_nop 1
    v_permlane16_swap_b32 v208, v209
    v_add_f32 v208, v208, v209
    v_mul_f32 v208, s46, v208
    v_add_f32 v208, s63, v208
    v_mul_f32 v208, v208, v205
    v_lshlrev_b32 v209, 16, v196
    v_and_b32 v210, 0xffff0000, v196
    v_fmac_f32 v180, v208, v209
    v_fmac_f32 v181, v208, v210
    v_lshlrev_b32 v209, 16, v197
    v_and_b32 v210, 0xffff0000, v197
    v_fmac_f32 v182, v208, v209
    v_fmac_f32 v183, v208, v210
    v_lshlrev_b32 v209, 16, v198
    v_and_b32 v210, 0xffff0000, v198
    v_fmac_f32 v184, v208, v209
    v_fmac_f32 v185, v208, v210
    v_lshlrev_b32 v209, 16, v199
    v_and_b32 v210, 0xffff0000, v199
    v_fmac_f32 v186, v208, v209
    v_fmac_f32 v187, v208, v210
    v_lshlrev_b32 v209, 16, v200
    v_and_b32 v210, 0xffff0000, v200
    v_fmac_f32 v188, v208, v209
    v_fmac_f32 v189, v208, v210
    v_lshlrev_b32 v209, 16, v201
    v_and_b32 v210, 0xffff0000, v201
    v_fmac_f32 v190, v208, v209
    v_fmac_f32 v191, v208, v210
    v_lshlrev_b32 v209, 16, v202
    v_and_b32 v210, 0xffff0000, v202
    v_fmac_f32 v192, v208, v209
    v_fmac_f32 v193, v208, v210
    v_lshlrev_b32 v209, 16, v203
    v_and_b32 v210, 0xffff0000, v203
    v_fmac_f32 v194, v208, v209
    v_fmac_f32 v195, v208, v210
    s_sub_u32 s59, s59, 1
    s_cmp_lg_u32 s59, 0
    s_cbranch_scc1 SLOW_L
    v_readfirstlane_b32 s56, v5
    s_nop 1
    v_lshl_add_u32 v208, v252, 1, s56
    ds_add_f32 v208, v180 offset:0
    ds_add_f32 v208, v181 offset:4
    ds_add_f32 v208, v182 offset:8
    ds_add_f32 v208, v183 offset:12
    ds_add_f32 v208, v184 offset:16
    ds_add_f32 v208, v185 offset:20
    ds_add_f32 v208, v186 offset:24
    ds_add_f32 v208, v187 offset:28
    ds_add_f32 v208, v188 offset:128
    ds_add_f32 v208, v189 offset:132
    ds_add_f32 v208, v190 offset:136
    ds_add_f32 v208, v191 offset:140
    ds_add_f32 v208, v192 offset:144
    ds_add_f32 v208, v193 offset:148
    ds_add_f32 v208, v194 offset:152
    ds_add_f32 v208, v195 offset:156
    s_waitcnt lgkmcnt(0)
    s_bitcmp1_b32 s52, 6
    s_cbranch_scc1 L_DONE
    ds_read_b128 v[180:183], v251 offset:0
    ds_read_b128 v[184:187], v251 offset:1024
    ds_read_b128 v[196:199], v251 offset:4096
    ds_read_b128 v[200:203], v251 offset:5120
    ds_read_b128 v[212:215], v251 offset:8192
    ds_read_b128 v[216:219], v251 offset:9216
    ds_read_b128 v[188:191], v251 offset:2048
    ds_read_b128 v[192:195], v251 offset:3072
    ds_read_b128 v[204:207], v251 offset:6144
    ds_read_b128 v[208:211], v251 offset:7168
    ds_read_b128 v[220:223], v251 offset:10240
    ds_read_b128 v[224:227], v251 offset:11264
    ds_read_b128 v[228:231], v251 offset:14336
    ds_read_b128 v[232:235], v251 offset:15360
    s_mov_b32 s77, 2
    s_branch BPF
L_END:
    s_endpgm
.section .rodata,"a"
.p2align 6
.amdhsa_kernel standalone__sequential_behavior_din__recsys_kernel
  .amdhsa_next_free_vgpr 255
  .amdhsa_next_free_sgpr 80
  .amdhsa_accum_offset 256
  .amdhsa_group_segment_fixed_size 0
  .amdhsa_kernarg_size 80
  .amdhsa_user_sgpr_count 2
  .amdhsa_user_sgpr_kernarg_segment_ptr 1
  .amdhsa_system_sgpr_workgroup_id_x 1
.end_amdhsa_kernel
```

```asm
; @launch grid=(256,1,1) block=(512,1,1) lds=153856
.amdgcn_target "amdgcn-amd-amdhsa--gfx950"
.text
.globl standalone__sequential_behavior_din__recsys_kernel
.p2align 8
.type standalone__sequential_behavior_din__recsys_kernel,@function
standalone__sequential_behavior_din__recsys_kernel:
    s_cmpk_ge_u32 s2, 256
    s_cbranch_scc1 L_END
    s_load_dwordx16 s[4:19], s[0:1], 0
    s_setprio 3
    v_lshrrev_b32 v1, 6, v0
    v_and_b32 v176, 63, v0
    v_readfirstlane_b32 s48, v1
    s_getpc_b64 s[40:41]
L_PC:
    s_cmp_lt_u32 s48, 5
    s_cbranch_scc1 P_NC
    s_mov_b32 s42, L_END-L_PC
    s_mov_b32 s43, 0x20000
    v_subrev_u32 v150, 320, v0
    v_lshlrev_b32 v150, 6, v150
    buffer_load_dword v150, v150, s[40:43], 0 offen
P_NC:
    v_and_b32 v2, 31, v0
    v_bfe_u32 v3, v0, 5, 1
    v_cmp_gt_u32 vcc, 25, v2
    v_mul_u32_u24 v4, 400, v3
    v_lshl_add_u32 v179, v2, 4, v4
    v_bfrev_b32 v4, 8
    v_cndmask_b32 v179, v4, v179, vcc
    s_mul_i32 s57, s2, 3200
    s_sub_u32 s26, 6553600, s57
    s_lshr_b32 s59, s48, 2
    s_mul_i32 s71, s48, 800
    s_mul_i32 s59, s59, 816000
    s_add_u32 s71, s71, s59
    s_mov_b32 s27, 0x20000
    s_lshl_b32 s74, s48, 12
    s_lshl_b32 s53, s2, 10
    v_lshlrev_b32 v251, 4, v176
    v_lshlrev_b32 v120, 1, v176
    v_and_b32 v120, 32, v120
    v_xor_b32 v120, v120, v251
    v_xor_b32 v121, 64, v120
    s_mov_b32 s38, 32768
    s_mov_b32 s39, s27
    s_lshl_b32 s58, s48, 18
    s_sub_u32 s34, 2097152, s53
    s_mov_b32 s35, s27
    s_add_u32 m0, s74, 121088
    v_and_b32 v178, 15, v176
    v_lshrrev_b32 v177, 4, v176
    v_lshlrev_b32 v252, 4, v177
    v_mul_u32_u24 v208, 0x80008, v2
    v_lshrrev_b32 v238, 3, v176
    v_add_u32 v208, 0x10000, v208
    v_cmp_gt_u32 vcc, 32, v176
    s_waitcnt lgkmcnt(0)
    s_add_u32 s24, s8, s57
    s_addc_u32 s25, s9, 0
    s_mov_b64 s[36:37], s[10:11]
    buffer_load_dwordx4 v[204:207], v179, s[24:27], s71 offen offset:0 nt
    s_setprio 0
    s_add_u32 s32, s4, s53
    s_addc_u32 s33, s5, 0
    s_load_dword s63, s[16:17], 0
    s_cmp_lg_u32 s48, 0
    s_cbranch_scc1 P_LJ
    v_mov_b32 v146, s12
    v_mov_b32 v147, s13
    v_mov_b32 v148, s14
    v_mov_b32 v149, s15
    v_lshlrev_b32 v4, 2, v2
    v_cndmask_b32 v146, v146, v148, vcc
    v_cndmask_b32 v147, v147, v149, vcc
    v_add_co_u32 v146, vcc, v146, v4
    s_nop 1
    v_addc_co_u32 v147, vcc, 0, v147, vcc
    global_load_dword v146, v[146:147], off
P_LJ:
    buffer_load_dwordx4 v[124:127], v251, s[32:35], s58 offen nt
    buffer_load_dwordx4 v120, s[36:39], s74 offen offset:0 lds
    buffer_load_dwordx4 v121, s[36:39], s74 offen offset:1024 lds
    s_lshl1_add_u32 s54, s74, 17664
    s_mul_i32 s49, s2, 204800
    s_lshl_b32 s57, s48, 9
    v_add_u32 v247, 116992, v238
    v_add_u32 v246, s57, v247
    s_add_u32 s56, s57, 116992
    v_add_u32 v209, 0x20002, v208
    v_add_u32 v210, 0x40004, v208
    v_add_u32 v211, 0x60006, v208
    s_sub_u32 s20, s6, 1024
    s_subb_u32 s21, s7, 0
    s_or_b32 s21, s21, 0x800000
    s_movk_i32 s22, 200
    s_mov_b32 s23, s27
    s_movk_i32 s61, 0x3f80
    v_lshrrev_b32 v216, 1, v251
    v_and_b32 v213, 0x100, v216
    v_mov_b64 v[214:215], -1
    v_lshlrev_b32 v250, 2, v176
    v_bfrev_b32 v2, v238
    v_lshrrev_b32 v2, 28, v2
    v_and_b32 v2, 6, v2
    v_xor_b32 v2, v2, v176
    v_and_b32 v2, 7, v2
    v_mul_u32_u24 v143, 528, v238
    v_lshlrev_b32 v239, 4, v2
    v_lshlrev_b32 v241, 4, v2
    v_lshlrev_b32 v153, 4, v2
    v_lshlrev_b32 v155, 4, v2
    s_add_u32 s28, s18, s53
    s_addc_u32 s29, s19, 0
    s_sub_u32 s30, 2097152, s53
    s_mov_b32 s31, s27
    s_mov_b32 s60, 0xbfb8aa3b
    s_mov_b32 s42, 0x21800000
    s_mov_b32 s46, 0x2b800000
    s_lshr_b32 s59, s48, 2
    s_mul_i32 s51, s48, 51200
    s_mul_i32 s59, s59, 52224000
    s_add_u32 s51, s51, s59
    s_add_u32 s51, s51, s49
    s_add_u32 s72, s51, 1024
    v_bfrev_b32 v2, v178
    v_lshrrev_b32 v2, 28, v2
    v_and_b32 v2, 6, v2
    v_xor_b32 v2, v2, v177
    v_lshl_add_u32 v2, v2, 4, s54
    v_lshl_add_u32 v242, v178, 7, v2
    v_xor_b32 v243, 64, v242
    v_and_b32 v3, 3, v176
    v_bfe_u32 v2, v176, 2, 2
    v_lshlrev_b32 v7, 3, v3
    v_lshl_add_u32 v7, v2, 7, v7
    v_and_b32 v6, 8, v176
    v_lshlrev_b32 v6, 3, v6
    v_lshl_add_u32 v244, v177, 5, v7
    v_xor_b32 v244, v244, v6
    v_add_u32 v244, s54, v244
    v_xor_b32 v245, 32, v244
    s_lshl_b32 s57, s48, 7
    s_add_u32 s57, s57, 150016
    v_lshl_add_u32 v249, v2, 2, v177
    v_lshl_add_u32 v249, v249, 2, v3
    v_lshl_add_u32 v249, v249, 1, s57
    v_lshl_add_u32 v248, v178, 3, s57
    v_and_b32 v6, 0x60, v250
    v_or_b32 v6, v6, v7
    v_lshl_add_u32 v136, v177, 10, v6
    s_mul_i32 s57, s48, 0x1010
    s_and_b32 s57, s57, 0x1060
    v_xor_b32 v144, s57, v136
    v_add_u32 v136, 121088, v136
    v_add_u32 v144, 121088, v144
    v_xor_b32 v137, 32, v136
    v_xor_b32 v138, 64, v136
    v_xor_b32 v139, 96, v136
    s_and_b32 s59, s48, 4
    s_lshl_b32 s59, s59, 4
    v_xor_b32 v140, s59, v136
    v_xor_b32 v141, 32, v140
    s_and_b32 s57, s48, 3
    s_mul_i32 s57, s57, 8448
    s_lshl1_add_u32 s57, s59, s57
    s_add_u32 s57, s57, 83200
    v_mul_u32_u24 v145, 528, v178
    v_add3_u32 v145, v145, v252, s57
    v_lshl_add_u32 v142, s59, 1, v252
    s_mul_i32 s57, s48, 4224
    s_add_u32 s57, s57, 83200
    v_and_b32 v3, 0x70, v251
    v_add3_u32 v143, v143, v3, s57
    v_add_u32 v3, v143, v3
    s_lshl_b32 s57, s48, 11
    v_add_u32 v151, s57, v251
    s_mov_b32 s66, 0x1b0a0100
    s_mov_b32 s67, 0x966d4c33
    s_lshl_b32 s57, s48, 3
    s_lshr_b64 s[66:67], s[66:67], s57
    s_and_b32 s47, s66, 7
    s_bfe_u32 s70, s66, 0x50003
    s_lshl1_add_u32 s70, s70, 16
    s_mul_i32 s71, s70, 400
    buffer_load_dwordx4 v120, s[36:39], s74 offen offset:2048 lds
    buffer_load_dwordx4 v121, s[36:39], s74 offen offset:3072 lds
    s_cmp_eq_u32 s48, 0
    s_waitcnt vmcnt(6) lgkmcnt(0)
    s_cbranch_scc1 P_M0
    s_waitcnt vmcnt(5)
P_M0:
    s_call_b64 s[36:37], CMP
    s_branch P_C
    .p2align 3
CMP:
    v_bcnt_u32_b32 v7, v204, 0
    v_bcnt_u32_b32 v7, v205, v7
    v_bcnt_u32_b32 v7, v206, v7
    v_bcnt_u32_b32 v7, v207, v7
    v_add_u32 v4, s56, v216
    v_mov_b32 v6, v7
    ds_write_b64 v4, v[214:215]
    v_cmp_eq_u16_e64 s[4:5], s61, v204
    v_cmp_eq_u16_sdwa s[6:7], v204, s61 src0_sel:WORD_1 src1_sel:WORD_0
    v_add_u32_dpp v6, v6, v6 row_shr:1 row_mask:0xf bank_mask:0xf bound_ctrl:0
    v_cmp_eq_u16_e64 s[8:9], s61, v205
    v_cmp_eq_u16_sdwa s[10:11], v205, s61 src0_sel:WORD_1 src1_sel:WORD_0
    v_add_u32_dpp v6, v6, v6 row_shr:2 row_mask:0xf bank_mask:0xf bound_ctrl:0
    v_cmp_eq_u16_e64 s[12:13], s61, v206
    v_cmp_eq_u16_sdwa s[14:15], v206, s61 src0_sel:WORD_1 src1_sel:WORD_0
    v_add_u32_dpp v6, v6, v6 row_shr:4 row_mask:0xf bank_mask:0xf bound_ctrl:0
    v_cmp_eq_u16_e64 s[16:17], s61, v207
    v_cmp_eq_u16_sdwa s[18:19], v207, s61 src0_sel:WORD_1 src1_sel:WORD_0
    v_add_u32_dpp v6, v6, v6 row_shr:8 row_mask:0xf bank_mask:0xf bound_ctrl:0
    s_nop 1
    v_add_u32_dpp v6, v6, v6 row_bcast:15 row_mask:0xa bank_mask:0xf
    v_sub_u32 v6, v6, v7
    v_mul_u32_u24 v6, 9363, v6
    v_lshrrev_b32 v6, 16, v6
    v_min_u32 v6, 200, v6
    v_add3_u32 v226, v6, v213, s56
    v_readlane_b32 s59, v6, 31
    v_readlane_b32 s58, v6, 63
    v_addc_co_u32_e64 v227, vcc, 0, v226, s[4:5]
    v_addc_co_u32_e64 v228, vcc, 0, v227, s[6:7]
    v_addc_co_u32_e64 v229, vcc, 0, v228, s[8:9]
    v_addc_co_u32_e64 v230, vcc, 0, v229, s[10:11]
    v_addc_co_u32_e64 v231, vcc, 0, v230, s[12:13]
    v_addc_co_u32_e64 v232, vcc, 0, v231, s[14:15]
    v_addc_co_u32_e64 v233, vcc, 0, v232, s[16:17]
    v_addc_co_u32_e64 v234, vcc, 0, v233, s[18:19]
    s_mov_b64 exec, s[4:5]
    ds_write_b8 v226, v208
    s_mov_b64 exec, s[6:7]
    ds_write_b8_d16_hi v227, v208
    s_mov_b64 exec, s[8:9]
    ds_write_b8 v228, v209
    s_mov_b64 exec, s[10:11]
    ds_write_b8_d16_hi v229, v209
    s_mov_b64 exec, s[12:13]
    ds_write_b8 v230, v210
    s_mov_b64 exec, s[14:15]
    ds_write_b8_d16_hi v231, v210
    s_mov_b64 exec, s[16:17]
    ds_write_b8 v232, v211
    s_mov_b64 exec, s[18:19]
    ds_write_b8_d16_hi v233, v211
    s_mov_b64 exec, -1
    v_sub_u32 v6, v234, v226
    v_mul_u32_u24 v6, 7, v6
    v_cmp_ne_u32 vcc, v6, v7
    s_min_u32 s64, vcc_lo, 1
    s_min_u32 s65, vcc_hi, 1
    s_lshl_b64 s[64:65], s[64:65], 15
    s_or_b32 s57, s59, s64
    s_or_b32 s58, s58, s65
    s_setpc_b64 s[36:37]
P_C:
    ds_read_u8 v238, v246 offset:0
    ds_read_u8 v240, v246 offset:8
    ds_read_u8 v152, v246 offset:16
    ds_read_u8 v154, v246 offset:24
    s_add_u32 m0, s54, 0
    s_waitcnt lgkmcnt(3)
    buffer_load_dwordx4 v[238:239], s[20:23], s72 idxen offen nt lds
    s_waitcnt lgkmcnt(2)
    buffer_load_dwordx4 v[240:241], s[20:23], s51 idxen offen offset:1024 nt lds
    s_add_u32 m0, s54, 2048
    s_waitcnt lgkmcnt(1)
    buffer_load_dwordx4 v[152:153], s[20:23], s72 idxen offen nt lds
    s_waitcnt lgkmcnt(0)
    buffer_load_dwordx4 v[154:155], s[20:23], s51 idxen offen offset:1024 nt lds
    s_lshl_b32 s63, s63, 16
    s_cmp_lg_u32 s48, 0
    s_waitcnt vmcnt(8)
    s_cbranch_scc1 P_SW_J
    v_lshlrev_b32 v148, 16, v146
    v_and_b32 v149, 0xffff0000, v146
    v_mov_b32 v4, -1
    v_mov_b32 v5, 0
    v_mov_b32 v6, 0x240
    v_lshrrev_b32 v0, 1, v251
    ds_write2st64_b32 v250, v4, v5 offset0:66 offset1:67
    s_mov_b32 exec_hi, 0
    v_max3_f32 v2, abs(v148), abs(v149), abs(s63)
    v_ldexp_f32 v148, v148, 40
    v_ldexp_f32 v149, v149, 40
    v_cmp_le_f32 vcc, 0x33800000, v2
    s_mov_b32 exec_lo, 0x55
    v_mul_f32 v148, s42, v148
    v_mul_f32 v149, s42, v149
    s_mov_b32 exec_lo, -1
    ds_write_b32 v250, v6 offset:17408
    s_mov_b32 exec_hi, -1
    s_movk_i32 s56, 0x3ff
    s_cmp_lg_u64 vcc, 0
    s_cmovk_i32 s56, 0x207
    v_mov_b32 v6, 17184
    v_mov_b32 v7, s56
    ds_write_b64 v0, v[148:149] offset:16384
    ds_write_b64 v5, v[6:7] offset:17600
P_SW_J:
    ds_write_b128 v143, v[124:127] offset:256
    ds_write_b128 v143, v[124:127] offset:384
    s_waitcnt vmcnt(4) lgkmcnt(0)
    s_barrier
    ds_read_b64_tr_b16 v[218:219], v144 offset:0
    ds_read_b64_tr_b16 v[220:221], v144 offset:512
    ds_read_b64_tr_b16 v[222:223], v144 offset:16384
    ds_read_b64_tr_b16 v[224:225], v144 offset:16896
    ds_read_b128 v[160:163], v145 offset:256
    ds_read_b128 v[164:167], v145 offset:320
    ds_read_b128 v[104:107], v142 offset:16640
    ds_read_b128 v[108:111], v142 offset:16704
    ds_read_b64_tr_b16 v[40:41], v140 offset:8192
    ds_read_b64_tr_b16 v[42:43], v140 offset:8704
    ds_read_b64_tr_b16 v[44:45], v141 offset:8192
    ds_read_b64_tr_b16 v[46:47], v141 offset:8704
    ds_read_b64_tr_b16 v[48:49], v140 offset:12288
    ds_read_b64_tr_b16 v[50:51], v140 offset:12800
    ds_read_b64_tr_b16 v[52:53], v141 offset:12288
    ds_read_b64_tr_b16 v[54:55], v141 offset:12800
    ds_read_b64_tr_b16 v[56:57], v140 offset:16384
    ds_read_b64_tr_b16 v[58:59], v140 offset:16896
    ds_read_b64_tr_b16 v[60:61], v141 offset:16384
    ds_read_b64_tr_b16 v[62:63], v141 offset:16896
    ds_read_b64_tr_b16 v[64:65], v140 offset:20480
    ds_read_b64_tr_b16 v[66:67], v140 offset:20992
    ds_read_b64_tr_b16 v[68:69], v141 offset:20480
    ds_read_b64_tr_b16 v[70:71], v141 offset:20992
    s_and_b32 s59, s57, 0xff
    s_lshr_b32 s57, s57, 8
    s_add_u32 s59, s59, 15
    s_and_b32 s52, s59, 15
    s_lshl_b32 s52, s52, 12
    s_or_b32 s57, s57, s52
    s_lshr_b32 s59, s59, 4
    s_max_u32 s59, s59, 3
    s_lshl1_add_u32 s52, s48, s57
    s_lshl_b32 s57, s59, 8
    s_or_b32 s52, s52, s57
    s_sub_u32 s50, s59, 3
    s_and_b32 s59, s58, 0xff
    s_lshr_b32 s58, s58, 8
    s_add_u32 s59, s59, 15
    s_and_b32 s74, s59, 15
    s_lshl_b32 s74, s74, 12
    s_or_b32 s58, s58, s74
    s_lshr_b32 s59, s59, 4
    s_max_u32 s59, s59, 2
    s_lshl1_add_u32 s74, s48, s58
    s_lshl_b32 s58, s59, 8
    s_or_b32 s74, s74, s58
    s_or_b32 s74, s74, 1
    v_lshlrev_b32 v24, 16, v124
    v_and_b32 v25, 0xffff0000, v124
    v_lshlrev_b32 v26, 16, v125
    v_and_b32 v27, 0xffff0000, v125
    v_lshlrev_b32 v28, 16, v126
    v_and_b32 v29, 0xffff0000, v126
    v_lshlrev_b32 v30, 16, v127
    v_and_b32 v31, 0xffff0000, v127
    v_mul_f32 v24, s60, v24
    v_mul_f32 v25, s60, v25
    v_mul_f32 v26, s60, v26
    v_mul_f32 v27, s60, v27
    v_mul_f32 v28, s60, v28
    v_mul_f32 v29, s60, v29
    v_mul_f32 v30, s60, v30
    v_mul_f32 v31, s60, v31
    s_waitcnt lgkmcnt(15)
    v_lshlrev_b32 v8, 16, v218
    v_and_b32 v9, 0xffff0000, v218
    v_lshlrev_b32 v16, 16, v222
    v_and_b32 v17, 0xffff0000, v222
    v_lshlrev_b32 v10, 16, v219
    v_and_b32 v11, 0xffff0000, v219
    v_lshlrev_b32 v18, 16, v223
    v_and_b32 v19, 0xffff0000, v223
    v_lshlrev_b32 v12, 16, v220
    v_and_b32 v13, 0xffff0000, v220
    v_lshlrev_b32 v20, 16, v224
    v_and_b32 v21, 0xffff0000, v224
    v_lshlrev_b32 v14, 16, v221
    v_and_b32 v15, 0xffff0000, v221
    v_lshlrev_b32 v22, 16, v225
    v_and_b32 v23, 0xffff0000, v225
    v_xor_b32 v168, 0x80008000, v160
    v_xor_b32 v169, 0x80008000, v161
    v_xor_b32 v170, 0x80008000, v162
    v_xor_b32 v171, 0x80008000, v163
    v_xor_b32 v172, 0x80008000, v164
    v_xor_b32 v173, 0x80008000, v165
    v_xor_b32 v174, 0x80008000, v166
    v_xor_b32 v175, 0x80008000, v167
    s_waitcnt lgkmcnt(12)
    v_mfma_f32_16x16x32_bf16 v[104:107], v[40:43], v[160:163], v[104:107]
    v_mfma_f32_16x16x32_bf16 v[108:111], v[44:47], v[160:163], v[108:111]
    v_add_f32 v112, v8, v16
    v_add_f32 v113, v9, v17
    s_waitcnt lgkmcnt(8)
    v_mfma_f32_16x16x32_bf16 v[104:107], v[48:51], v[164:167], v[104:107]
    v_mfma_f32_16x16x32_bf16 v[108:111], v[52:55], v[164:167], v[108:111]
    v_add_f32 v114, v10, v18
    v_add_f32 v115, v11, v19
    s_waitcnt lgkmcnt(4)
    v_mfma_f32_16x16x32_bf16 v[104:107], v[56:59], v[168:171], v[104:107]
    v_mfma_f32_16x16x32_bf16 v[108:111], v[60:63], v[168:171], v[108:111]
    v_add_f32 v116, v12, v20
    v_add_f32 v117, v13, v21
    s_waitcnt lgkmcnt(0)
    v_mfma_f32_16x16x32_bf16 v[104:107], v[64:67], v[172:175], v[104:107]
    v_mfma_f32_16x16x32_bf16 v[108:111], v[68:71], v[172:175], v[108:111]
    v_add_f32 v118, v14, v22
    v_add_f32 v119, v15, v23
    ds_read_b64_tr_b16 v[72:73], v136 offset:24576
    ds_read_b64_tr_b16 v[74:75], v136 offset:25088
    ds_read_b64_tr_b16 v[76:77], v136 offset:28672
    ds_read_b64_tr_b16 v[78:79], v136 offset:29184
    ds_read_b64_tr_b16 v[80:81], v137 offset:24576
    ds_read_b64_tr_b16 v[82:83], v137 offset:25088
    ds_read_b64_tr_b16 v[84:85], v137 offset:28672
    ds_read_b64_tr_b16 v[86:87], v137 offset:29184
    ds_read_b64_tr_b16 v[88:89], v138 offset:24576
    ds_read_b64_tr_b16 v[90:91], v138 offset:25088
    ds_read_b64_tr_b16 v[92:93], v138 offset:28672
    ds_read_b64_tr_b16 v[94:95], v138 offset:29184
    ds_read_b64_tr_b16 v[96:97], v139 offset:24576
    ds_read_b64_tr_b16 v[98:99], v139 offset:25088
    ds_read_b64_tr_b16 v[100:101], v139 offset:28672
    ds_read_b64_tr_b16 v[102:103], v139 offset:29184
    s_cmp_le_u32 s47, 0
    s_cbranch_scc1 P_MJ
    s_lshr_b32 s56, s70, 1
    s_lshr_b32 s59, s56, 2
    s_mul_i32 s71, s56, 800
    s_mul_i32 s59, s59, 816000
    s_add_u32 s71, s71, s59
    buffer_load_dwordx4 v[180:183], v179, s[24:27], s71 offen offset:0 nt
    s_cmp_le_u32 s47, 1
    s_cbranch_scc1 P_MJ
    s_lshr_b32 s56, s70, 1
    s_add_u32 s56, s56, 1
    s_lshr_b32 s59, s56, 2
    s_mul_i32 s71, s56, 800
    s_mul_i32 s59, s59, 816000
    s_add_u32 s71, s71, s59
    buffer_load_dwordx4 v[184:187], v179, s[24:27], s71 offen offset:0 nt
    s_cmp_le_u32 s47, 2
    s_cbranch_scc1 P_MJ
    s_lshr_b32 s56, s70, 1
    s_add_u32 s56, s56, 2
    s_lshr_b32 s59, s56, 2
    s_mul_i32 s71, s56, 800
    s_mul_i32 s59, s59, 816000
    s_add_u32 s71, s71, s59
    buffer_load_dwordx4 v[188:191], v179, s[24:27], s71 offen offset:0 nt
    s_cmp_le_u32 s47, 3
    s_cbranch_scc1 P_MJ
    s_lshr_b32 s56, s70, 1
    s_add_u32 s56, s56, 3
    s_lshr_b32 s59, s56, 2
    s_mul_i32 s71, s56, 800
    s_mul_i32 s59, s59, 816000
    s_add_u32 s71, s71, s59
    buffer_load_dwordx4 v[192:195], v179, s[24:27], s71 offen offset:0 nt
    s_cmp_le_u32 s47, 4
    s_cbranch_scc1 P_MJ
    s_lshr_b32 s56, s70, 1
    s_add_u32 s56, s56, 4
    s_lshr_b32 s59, s56, 2
    s_mul_i32 s71, s56, 800
    s_mul_i32 s59, s59, 816000
    s_add_u32 s71, s71, s59
    buffer_load_dwordx4 v[196:199], v179, s[24:27], s71 offen offset:0 nt
    s_cmp_le_u32 s47, 5
    s_cbranch_scc1 P_MJ
    s_lshr_b32 s56, s70, 1
    s_add_u32 s56, s56, 5
    s_lshr_b32 s59, s56, 2
    s_mul_i32 s71, s56, 800
    s_mul_i32 s59, s59, 816000
    s_add_u32 s71, s71, s59
    buffer_load_dwordx4 v[200:203], v179, s[24:27], s71 offen offset:0 nt
P_MJ:
    v_mul_f32 v112, s60, v112
    v_mul_f32 v113, s60, v113
    v_mul_f32 v114, s60, v114
    v_mul_f32 v115, s60, v115
    v_mul_f32 v116, s60, v116
    v_mul_f32 v117, s60, v117
    v_mul_f32 v118, s60, v118
    v_mul_f32 v119, s60, v119
    ds_write_b128 v151, v[112:115] offset:0
    ds_write_b128 v151, v[116:119] offset:1024
    v_mul_f32 v104, s60, v104
    v_mul_f32 v105, s60, v105
    v_mul_f32 v106, s60, v106
    v_mul_f32 v107, s60, v107
    v_mul_f32 v108, s60, v108
    v_mul_f32 v109, s60, v109
    v_mul_f32 v110, s60, v110
    v_mul_f32 v111, s60, v111
    ds_write_b128 v145, v[104:107] offset:256
    ds_write_b128 v145, v[108:111] offset:320
    ds_write_b128 v3, v[24:27] offset:0
    ds_write_b128 v3, v[28:31] offset:16
    ds_read_b128 v[120:123], v252 offset:16384
    ds_read_b128 v[124:127], v252 offset:16448
    ds_read_b128 v[128:131], v252 offset:16512
    ds_read_b128 v[132:135], v252 offset:16576
    ds_read_b32 v150, v252 offset:17604
    s_lshl2_add_u32 s56, s48, 17184
    v_mov_b32 v253, s56
    v_mov_b32 v254, s74
    ds_write_b32 v253, v254
    v_ldexp_f32 v2, s63, 38
    v_add_u32 v250, 133376, v250
    v_mov_b64 v[168:169], 0
    v_mov_b64 v[170:171], 0
    v_mov_b64 v[172:173], 0
    v_mov_b64 v[174:175], 0
    v_readfirstlane_b32 s44, v2
    s_waitcnt lgkmcnt(15)
    v_lshlrev_b32 v8, 16, v72
    v_and_b32 v9, 0xffff0000, v72
    v_lshlrev_b32 v10, 16, v73
    v_and_b32 v11, 0xffff0000, v73
    v_lshlrev_b32 v12, 16, v74
    v_and_b32 v13, 0xffff0000, v74
    v_lshlrev_b32 v14, 16, v75
    v_and_b32 v15, 0xffff0000, v75
    v_lshlrev_b32 v16, 16, v76
    v_and_b32 v17, 0xffff0000, v76
    v_lshlrev_b32 v18, 16, v77
    v_and_b32 v19, 0xffff0000, v77
    v_lshlrev_b32 v20, 16, v78
    v_and_b32 v21, 0xffff0000, v78
    v_lshlrev_b32 v22, 16, v79
    v_and_b32 v23, 0xffff0000, v79
    v_lshlrev_b32 v24, 16, v80
    v_and_b32 v25, 0xffff0000, v80
    v_lshlrev_b32 v26, 16, v81
    v_and_b32 v27, 0xffff0000, v81
    v_lshlrev_b32 v28, 16, v82
    v_and_b32 v29, 0xffff0000, v82
    v_lshlrev_b32 v30, 16, v83
    v_and_b32 v31, 0xffff0000, v83
    v_lshlrev_b32 v32, 16, v84
    v_and_b32 v33, 0xffff0000, v84
    v_lshlrev_b32 v34, 16, v85
    v_and_b32 v35, 0xffff0000, v85
    v_lshlrev_b32 v36, 16, v86
    v_and_b32 v37, 0xffff0000, v86
    v_lshlrev_b32 v38, 16, v87
    v_and_b32 v39, 0xffff0000, v87
    ds_read_u8 v238, v246 offset:32
    ds_read_u8 v240, v246 offset:40
    s_add_u32 m0, s54, 4096
    v_add_u32 v246, 32, v246
    s_mov_b64 s[68:69], 0
    s_mov_b32 s75, 0
    s_movk_i32 s53, 0x1040
    s_mov_b32 s73, 3
    s_mov_b32 s77, 0
    s_mov_b32 s55, 0
    v_mov_b64 v[0:1], 0
    v_mov_b32 v2, 1.0
    v_mov_b32 v3, 1.0
    s_waitcnt lgkmcnt(0)
    s_barrier
    v_readfirstlane_b32 s45, v150
    buffer_load_dwordx4 v[238:239], s[20:23], s72 idxen offen nt lds
    buffer_load_dwordx4 v[240:241], s[20:23], s51 idxen offen offset:1024 nt lds
    s_cmp_eq_u32 s47, 0
    s_cbranch_scc1 P_GO
    s_lshl_b32 s56, s70, 8
    s_add_u32 s56, s56, 116992
    s_waitcnt vmcnt(2)
    v_mov_b64 v[204:205], v[180:181]
    v_mov_b64 v[206:207], v[182:183]
    s_call_b64 s[36:37], CMP
    v_writelane_b32 v212, s57, 0
    v_writelane_b32 v212, s58, 1
    s_cmp_le_u32 s47, 1
    s_cbranch_scc1 LATE_D
    s_add_u32 s56, s56, 512
    v_mov_b64 v[204:205], v[184:185]
    v_mov_b64 v[206:207], v[186:187]
    s_call_b64 s[36:37], CMP
    v_writelane_b32 v212, s57, 2
    v_writelane_b32 v212, s58, 3
    s_cmp_le_u32 s47, 2
    s_cbranch_scc1 LATE_D
    s_add_u32 s56, s56, 512
    v_mov_b64 v[204:205], v[188:189]
    v_mov_b64 v[206:207], v[190:191]
    s_call_b64 s[36:37], CMP
    v_writelane_b32 v212, s57, 4
    v_writelane_b32 v212, s58, 5
    s_cmp_le_u32 s47, 3
    s_cbranch_scc1 LATE_D
    s_add_u32 s56, s56, 512
    v_mov_b64 v[204:205], v[192:193]
    v_mov_b64 v[206:207], v[194:195]
    s_call_b64 s[36:37], CMP
    v_writelane_b32 v212, s57, 6
    v_writelane_b32 v212, s58, 7
    s_cmp_le_u32 s47, 4
    s_cbranch_scc1 LATE_D
    s_add_u32 s56, s56, 512
    v_mov_b64 v[204:205], v[196:197]
    v_mov_b64 v[206:207], v[198:199]
    s_call_b64 s[36:37], CMP
    v_writelane_b32 v212, s57, 8
    v_writelane_b32 v212, s58, 9
    s_cmp_le_u32 s47, 5
    s_cbranch_scc1 LATE_D
    s_add_u32 s56, s56, 512
    v_mov_b64 v[204:205], v[200:201]
    v_mov_b64 v[206:207], v[202:203]
    s_call_b64 s[36:37], CMP
    v_writelane_b32 v212, s57, 10
    v_writelane_b32 v212, s58, 11
LATE_D:
    v_add_u32 v4, s70, v176
    s_lshl_b32 s56, s47, 1
    v_and_b32 v5, 0xff, v212
    v_add_u32 v5, 15, v5
    v_lshrrev_b32 v212, 8, v212
    v_and_b32 v6, 15, v5
    v_lshl_or_b32 v212, v6, 12, v212
    v_lshrrev_b32 v5, 4, v5
    v_max_u32 v5, 2, v5
    v_or_b32 v212, v212, v4
    v_cmp_gt_u32 vcc, 64, v4
    v_lshl_or_b32 v6, v5, 8, v212
    v_lshlrev_b32 v4, 2, v4
    s_bfm_b64 s[66:67], s56, 0
    s_and_b64 exec, s[66:67], vcc
    ds_write_b32 v4, v6 offset:17152
    s_mov_b64 exec, -1
P_GO:
    ds_read_b128 v[180:183], v251 offset:0
    ds_read_b128 v[184:187], v251 offset:1024
    ds_read_b128 v[196:199], v251 offset:4096
    ds_read_b128 v[200:203], v251 offset:5120
    ds_read_b128 v[212:215], v251 offset:8192
    ds_read_b128 v[216:219], v251 offset:9216
    ds_read_b128 v[188:191], v251 offset:2048
    ds_read_b128 v[192:195], v251 offset:3072
    ds_read_b128 v[204:207], v251 offset:6144
    ds_read_b128 v[208:211], v251 offset:7168
    ds_read_b128 v[220:223], v251 offset:10240
    ds_read_b128 v[224:227], v251 offset:11264
    ds_read_b128 v[228:231], v251 offset:14336
    ds_read_b128 v[232:235], v251 offset:15360
    v_lshlrev_b32 v40, 16, v88
    v_and_b32 v41, 0xffff0000, v88
    v_lshlrev_b32 v42, 16, v89
    v_and_b32 v43, 0xffff0000, v89
    v_lshlrev_b32 v44, 16, v90
    v_and_b32 v45, 0xffff0000, v90
    v_lshlrev_b32 v46, 16, v91
    v_and_b32 v47, 0xffff0000, v91
    v_lshlrev_b32 v48, 16, v92
    v_and_b32 v49, 0xffff0000, v92
    v_lshlrev_b32 v50, 16, v93
    v_and_b32 v51, 0xffff0000, v93
    v_lshlrev_b32 v52, 16, v94
    v_and_b32 v53, 0xffff0000, v94
    v_lshlrev_b32 v54, 16, v95
    v_and_b32 v55, 0xffff0000, v95
    v_lshlrev_b32 v56, 16, v96
    v_and_b32 v57, 0xffff0000, v96
    v_lshlrev_b32 v58, 16, v97
    v_and_b32 v59, 0xffff0000, v97
    v_lshlrev_b32 v60, 16, v98
    v_and_b32 v61, 0xffff0000, v98
    v_lshlrev_b32 v62, 16, v99
    v_and_b32 v63, 0xffff0000, v99
    v_lshlrev_b32 v64, 16, v100
    v_and_b32 v65, 0xffff0000, v100
    v_lshlrev_b32 v66, 16, v101
    v_and_b32 v67, 0xffff0000, v101
    v_lshlrev_b32 v68, 16, v102
    v_and_b32 v69, 0xffff0000, v102
    v_lshlrev_b32 v70, 16, v103
    v_and_b32 v71, 0xffff0000, v103
    v_mov_b64 v[176:177], 0
    v_mov_b64 v[178:179], 0
    s_sub_u32 s50, s50, 2
    s_cbranch_scc1 DRAW_P
DRET_P:
    s_waitcnt vmcnt(4)
    ds_read_b128 v[152:155], v242
    ds_read_b128 v[156:159], v243
    s_branch BPF
U_0:
    v_mfma_f32_16x16x32_bf16 v[104:107], v[72:75], v[152:155], v[136:139]
    s_add_u32 m0, s54, 6144
    v_rcp_f32 v2, v2
    v_mfma_f32_16x16x32_bf16 v[104:107], v[76:79], v[156:159], v[104:107]
    s_mov_b32 s73, 0
    v_rcp_f32 v3, v3
    v_mfma_f32_16x16x32_bf16 v[108:111], v[80:83], v[152:155], v[140:143]
    s_sub_u32 s50, s50, 1
    v_fma_f32 v0, v0, v2, s44
    v_fmac_f32 v0, v1, v3
    v_mfma_f32_16x16x32_bf16 v[108:111], v[84:87], v[156:159], v[108:111]
    s_cbranch_scc1 PEV
    v_add_u32 v246, 16, v246
RET_0:
    v_cvt_pk_bf16_f32 v0, v0, v0
    v_mfma_f32_16x16x32_bf16 v[112:115], v[88:91], v[152:155], v[144:147]
    v_exp_f32 v104, v104
    v_mfma_f32_16x16x32_bf16 v[112:115], v[92:95], v[156:159], v[112:115]
    v_exp_f32 v105, v105
    v_mfma_f32_16x16x32_bf16 v[116:119], v[96:99], v[152:155], v[148:151]
    s_sub_u32 s62, s62, 1
    v_exp_f32 v106, v106
    v_mfma_f32_16x16x32_bf16 v[116:119], v[100:103], v[156:159], v[116:119]
    s_waitcnt vmcnt(2)
    v_exp_f32 v107, v107
    ds_write_b16 v249, v0
    ds_read_b64 v[236:237], v248
    ds_read_b64_tr_b16 v[160:161], v244 offset:0
    ds_read_b64_tr_b16 v[162:163], v245 offset:512
    ds_read_b64_tr_b16 v[164:165], v244 offset:1024
    ds_read_b64_tr_b16 v[166:167], v245 offset:1536
    ds_read_u8 v238, v246 offset:0
    ds_read_u8 v240, v246 offset:8
    ds_read_b128 v[152:155], v242 offset:2048
    ds_read_b128 v[156:159], v243 offset:2048
    v_exp_f32 v108, v108
    v_exp_f32 v109, v109
    v_exp_f32 v110, v110
    v_exp_f32 v111, v111
    s_waitcnt lgkmcnt(8)
    v_mfma_f32_4x4x4_16b_bf16 v[176:179], v[236:237], v[168:169], v[176:179] cbsz:4 abid:0
    v_exp_f32 v112, v112
    v_exp_f32 v113, v113
    v_mfma_f32_4x4x4_16b_bf16 v[176:179], v[236:237], v[170:171], v[176:179] cbsz:4 abid:1
    v_exp_f32 v114, v114
    v_exp_f32 v115, v115
    v_mfma_f32_4x4x4_16b_bf16 v[176:179], v[236:237], v[172:173], v[176:179] cbsz:4 abid:2
    v_exp_f32 v116, v116
    v_exp_f32 v117, v117
    v_mfma_f32_4x4x4_16b_bf16 v[176:179], v[236:237], v[174:175], v[176:179] cbsz:4 abid:3
    v_exp_f32 v118, v118
    v_exp_f32 v119, v119
    s_waitcnt lgkmcnt(0)
    buffer_load_dwordx4 v[238:239], s[20:23], s72 idxen offen nt lds
    buffer_load_dwordx4 v[240:241], s[20:23], s51 idxen offen offset:1024 nt lds
    s_cselect_b64 exec, s[78:79], -1
    .p2align 3
    v_pk_fma_f32 v[2:3], v[104:105], s[42:43], s[42:43] op_sel_hi:[1,0,0]
    v_pk_fma_f32 v[0:1], v[120:121], v[106:107], v[120:121]
    v_pk_fma_f32 v[0:1], v[122:123], v[2:3], v[0:1]
    v_pk_fma_f32 v[2:3], v[106:107], v[2:3], v[2:3]
    v_pk_fma_f32 v[0:1], v[108:109], v[0:1], v[0:1]
    v_pk_fma_f32 v[0:1], v[124:125], v[2:3], v[0:1]
    v_pk_fma_f32 v[2:3], v[108:109], v[2:3], v[2:3]
    v_pk_fma_f32 v[0:1], v[110:111], v[0:1], v[0:1]
    v_pk_fma_f32 v[0:1], v[126:127], v[2:3], v[0:1]
    v_pk_fma_f32 v[2:3], v[110:111], v[2:3], v[2:3]
    v_pk_fma_f32 v[0:1], v[112:113], v[0:1], v[0:1]
    v_pk_fma_f32 v[0:1], v[128:129], v[2:3], v[0:1]
    v_pk_fma_f32 v[2:3], v[112:113], v[2:3], v[2:3]
    v_pk_fma_f32 v[0:1], v[114:115], v[0:1], v[0:1]
    v_pk_fma_f32 v[0:1], v[130:131], v[2:3], v[0:1]
    v_pk_fma_f32 v[2:3], v[114:115], v[2:3], v[2:3]
    v_pk_fma_f32 v[0:1], v[116:117], v[0:1], v[0:1]
    v_pk_fma_f32 v[0:1], v[132:133], v[2:3], v[0:1]
    v_pk_fma_f32 v[2:3], v[116:117], v[2:3], v[2:3]
    v_pk_fma_f32 v[0:1], v[118:119], v[0:1], v[0:1]
    v_pk_fma_f32 v[0:1], v[134:135], v[2:3], v[0:1]
    v_pk_fma_f32 v[2:3], v[118:119], v[2:3], v[2:3]
    s_mov_b64 exec, -1
    s_cbranch_scc1 CEV
U_1:
    v_mfma_f32_16x16x32_bf16 v[104:107], v[72:75], v[152:155], v[136:139]
    s_add_u32 m0, s54, 0
    v_rcp_f32 v2, v2
    v_mfma_f32_16x16x32_bf16 v[104:107], v[76:79], v[156:159], v[104:107]
    s_mov_b32 s73, 1
    v_rcp_f32 v3, v3
    v_mfma_f32_16x16x32_bf16 v[108:111], v[80:83], v[152:155], v[140:143]
    s_sub_u32 s50, s50, 1
    v_fma_f32 v0, v0, v2, s44
    v_fmac_f32 v0, v1, v3
    v_mfma_f32_16x16x32_bf16 v[108:111], v[84:87], v[156:159], v[108:111]
    s_cbranch_scc1 PEV
    v_add_u32 v246, 16, v246
RET_1:
    v_cvt_pk_bf16_f32 v0, v0, v0
    v_mfma_f32_16x16x32_bf16 v[112:115], v[88:91], v[152:155], v[144:147]
    v_exp_f32 v104, v104
    v_mfma_f32_16x16x32_bf16 v[112:115], v[92:95], v[156:159], v[112:115]
    v_exp_f32 v105, v105
    v_mfma_f32_16x16x32_bf16 v[116:119], v[96:99], v[152:155], v[148:151]
    s_sub_u32 s62, s62, 1
    v_exp_f32 v106, v106
    v_mfma_f32_16x16x32_bf16 v[116:119], v[100:103], v[156:159], v[116:119]
    s_waitcnt vmcnt(2)
    v_exp_f32 v107, v107
    ds_write_b16 v249, v0
    ds_read_b64 v[236:237], v248
    ds_read_b64_tr_b16 v[168:169], v244 offset:2048
    ds_read_b64_tr_b16 v[170:171], v245 offset:2560
    ds_read_b64_tr_b16 v[172:173], v244 offset:3072
    ds_read_b64_tr_b16 v[174:175], v245 offset:3584
    ds_read_u8 v238, v246 offset:0
    ds_read_u8 v240, v246 offset:8
    ds_read_b128 v[152:155], v242 offset:4096
    ds_read_b128 v[156:159], v243 offset:4096
    v_exp_f32 v108, v108
    v_exp_f32 v109, v109
    v_exp_f32 v110, v110
    v_exp_f32 v111, v111
    s_waitcnt lgkmcnt(8)
    v_mfma_f32_4x4x4_16b_bf16 v[176:179], v[236:237], v[160:161], v[176:179] cbsz:4 abid:0
    v_exp_f32 v112, v112
    v_exp_f32 v113, v113
    v_mfma_f32_4x4x4_16b_bf16 v[176:179], v[236:237], v[162:163], v[176:179] cbsz:4 abid:1
    v_exp_f32 v114, v114
    v_exp_f32 v115, v115
    v_mfma_f32_4x4x4_16b_bf16 v[176:179], v[236:237], v[164:165], v[176:179] cbsz:4 abid:2
    v_exp_f32 v116, v116
    v_exp_f32 v117, v117
    v_mfma_f32_4x4x4_16b_bf16 v[176:179], v[236:237], v[166:167], v[176:179] cbsz:4 abid:3
    v_exp_f32 v118, v118
    v_exp_f32 v119, v119
    s_waitcnt lgkmcnt(0)
    buffer_load_dwordx4 v[238:239], s[20:23], s72 idxen offen nt lds
    buffer_load_dwordx4 v[240:241], s[20:23], s51 idxen offen offset:1024 nt lds
    s_cselect_b64 exec, s[78:79], -1
    .p2align 3
    v_pk_fma_f32 v[2:3], v[104:105], s[42:43], s[42:43] op_sel_hi:[1,0,0]
    v_pk_fma_f32 v[0:1], v[120:121], v[106:107], v[120:121]
    v_pk_fma_f32 v[0:1], v[122:123], v[2:3], v[0:1]
    v_pk_fma_f32 v[2:3], v[106:107], v[2:3], v[2:3]
    v_pk_fma_f32 v[0:1], v[108:109], v[0:1], v[0:1]
    v_pk_fma_f32 v[0:1], v[124:125], v[2:3], v[0:1]
    v_pk_fma_f32 v[2:3], v[108:109], v[2:3], v[2:3]
    v_pk_fma_f32 v[0:1], v[110:111], v[0:1], v[0:1]
    v_pk_fma_f32 v[0:1], v[126:127], v[2:3], v[0:1]
    v_pk_fma_f32 v[2:3], v[110:111], v[2:3], v[2:3]
    v_pk_fma_f32 v[0:1], v[112:113], v[0:1], v[0:1]
    v_pk_fma_f32 v[0:1], v[128:129], v[2:3], v[0:1]
    v_pk_fma_f32 v[2:3], v[112:113], v[2:3], v[2:3]
    v_pk_fma_f32 v[0:1], v[114:115], v[0:1], v[0:1]
    v_pk_fma_f32 v[0:1], v[130:131], v[2:3], v[0:1]
    v_pk_fma_f32 v[2:3], v[114:115], v[2:3], v[2:3]
    v_pk_fma_f32 v[0:1], v[116:117], v[0:1], v[0:1]
    v_pk_fma_f32 v[0:1], v[132:133], v[2:3], v[0:1]
    v_pk_fma_f32 v[2:3], v[116:117], v[2:3], v[2:3]
    v_pk_fma_f32 v[0:1], v[118:119], v[0:1], v[0:1]
    v_pk_fma_f32 v[0:1], v[134:135], v[2:3], v[0:1]
    v_pk_fma_f32 v[2:3], v[118:119], v[2:3], v[2:3]
    s_mov_b64 exec, -1
    s_cbranch_scc1 CEV
U_2:
    v_mfma_f32_16x16x32_bf16 v[104:107], v[72:75], v[152:155], v[136:139]
    s_add_u32 m0, s54, 2048
    v_rcp_f32 v2, v2
    v_mfma_f32_16x16x32_bf16 v[104:107], v[76:79], v[156:159], v[104:107]
    s_mov_b32 s73, 2
    v_rcp_f32 v3, v3
    v_mfma_f32_16x16x32_bf16 v[108:111], v[80:83], v[152:155], v[140:143]
    s_sub_u32 s50, s50, 1
    v_fma_f32 v0, v0, v2, s44
    v_fmac_f32 v0, v1, v3
    v_mfma_f32_16x16x32_bf16 v[108:111], v[84:87], v[156:159], v[108:111]
    s_cbranch_scc1 PEV
    v_add_u32 v246, 16, v246
RET_2:
    v_cvt_pk_bf16_f32 v0, v0, v0
    v_mfma_f32_16x16x32_bf16 v[112:115], v[88:91], v[152:155], v[144:147]
    v_exp_f32 v104, v104
    v_mfma_f32_16x16x32_bf16 v[112:115], v[92:95], v[156:159], v[112:115]
    v_exp_f32 v105, v105
    v_mfma_f32_16x16x32_bf16 v[116:119], v[96:99], v[152:155], v[148:151]
    s_sub_u32 s62, s62, 1
    v_exp_f32 v106, v106
    v_mfma_f32_16x16x32_bf16 v[116:119], v[100:103], v[156:159], v[116:119]
    s_waitcnt vmcnt(2)
    v_exp_f32 v107, v107
    ds_write_b16 v249, v0
    ds_read_b64 v[236:237], v248
    ds_read_b64_tr_b16 v[160:161], v244 offset:4096
    ds_read_b64_tr_b16 v[162:163], v245 offset:4608
    ds_read_b64_tr_b16 v[164:165], v244 offset:5120
    ds_read_b64_tr_b16 v[166:167], v245 offset:5632
    ds_read_u8 v238, v246 offset:0
    ds_read_u8 v240, v246 offset:8
    ds_read_b128 v[152:155], v242 offset:6144
    ds_read_b128 v[156:159], v243 offset:6144
    v_exp_f32 v108, v108
    v_exp_f32 v109, v109
    v_exp_f32 v110, v110
    v_exp_f32 v111, v111
    s_waitcnt lgkmcnt(8)
    v_mfma_f32_4x4x4_16b_bf16 v[176:179], v[236:237], v[168:169], v[176:179] cbsz:4 abid:0
    v_exp_f32 v112, v112
    v_exp_f32 v113, v113
    v_mfma_f32_4x4x4_16b_bf16 v[176:179], v[236:237], v[170:171], v[176:179] cbsz:4 abid:1
    v_exp_f32 v114, v114
    v_exp_f32 v115, v115
    v_mfma_f32_4x4x4_16b_bf16 v[176:179], v[236:237], v[172:173], v[176:179] cbsz:4 abid:2
    v_exp_f32 v116, v116
    v_exp_f32 v117, v117
    v_mfma_f32_4x4x4_16b_bf16 v[176:179], v[236:237], v[174:175], v[176:179] cbsz:4 abid:3
    v_exp_f32 v118, v118
    v_exp_f32 v119, v119
    s_waitcnt lgkmcnt(0)
    buffer_load_dwordx4 v[238:239], s[20:23], s72 idxen offen nt lds
    buffer_load_dwordx4 v[240:241], s[20:23], s51 idxen offen offset:1024 nt lds
    s_cselect_b64 exec, s[78:79], -1
    .p2align 3
    v_pk_fma_f32 v[2:3], v[104:105], s[42:43], s[42:43] op_sel_hi:[1,0,0]
    v_pk_fma_f32 v[0:1], v[120:121], v[106:107], v[120:121]
    v_pk_fma_f32 v[0:1], v[122:123], v[2:3], v[0:1]
    v_pk_fma_f32 v[2:3], v[106:107], v[2:3], v[2:3]
    v_pk_fma_f32 v[0:1], v[108:109], v[0:1], v[0:1]
    v_pk_fma_f32 v[0:1], v[124:125], v[2:3], v[0:1]
    v_pk_fma_f32 v[2:3], v[108:109], v[2:3], v[2:3]
    v_pk_fma_f32 v[0:1], v[110:111], v[0:1], v[0:1]
    v_pk_fma_f32 v[0:1], v[126:127], v[2:3], v[0:1]
    v_pk_fma_f32 v[2:3], v[110:111], v[2:3], v[2:3]
    v_pk_fma_f32 v[0:1], v[112:113], v[0:1], v[0:1]
    v_pk_fma_f32 v[0:1], v[128:129], v[2:3], v[0:1]
    v_pk_fma_f32 v[2:3], v[112:113], v[2:3], v[2:3]
    v_pk_fma_f32 v[0:1], v[114:115], v[0:1], v[0:1]
    v_pk_fma_f32 v[0:1], v[130:131], v[2:3], v[0:1]
    v_pk_fma_f32 v[2:3], v[114:115], v[2:3], v[2:3]
    v_pk_fma_f32 v[0:1], v[116:117], v[0:1], v[0:1]
    v_pk_fma_f32 v[0:1], v[132:133], v[2:3], v[0:1]
    v_pk_fma_f32 v[2:3], v[116:117], v[2:3], v[2:3]
    v_pk_fma_f32 v[0:1], v[118:119], v[0:1], v[0:1]
    v_pk_fma_f32 v[0:1], v[134:135], v[2:3], v[0:1]
    v_pk_fma_f32 v[2:3], v[118:119], v[2:3], v[2:3]
    s_mov_b64 exec, -1
    s_cbranch_scc1 CEV
U_3:
    v_mfma_f32_16x16x32_bf16 v[104:107], v[72:75], v[152:155], v[136:139]
    s_add_u32 m0, s54, 4096
    v_rcp_f32 v2, v2
    v_mfma_f32_16x16x32_bf16 v[104:107], v[76:79], v[156:159], v[104:107]
    s_mov_b32 s73, 3
    v_rcp_f32 v3, v3
    v_mfma_f32_16x16x32_bf16 v[108:111], v[80:83], v[152:155], v[140:143]
    s_sub_u32 s50, s50, 1
    v_fma_f32 v0, v0, v2, s44
    v_fmac_f32 v0, v1, v3
    v_mfma_f32_16x16x32_bf16 v[108:111], v[84:87], v[156:159], v[108:111]
    s_cbranch_scc1 PEV
    v_add_u32 v246, 16, v246
RET_3:
    v_cvt_pk_bf16_f32 v0, v0, v0
    v_mfma_f32_16x16x32_bf16 v[112:115], v[88:91], v[152:155], v[144:147]
    v_exp_f32 v104, v104
    v_mfma_f32_16x16x32_bf16 v[112:115], v[92:95], v[156:159], v[112:115]
    v_exp_f32 v105, v105
    v_mfma_f32_16x16x32_bf16 v[116:119], v[96:99], v[152:155], v[148:151]
    s_sub_u32 s62, s62, 1
    v_exp_f32 v106, v106
    v_mfma_f32_16x16x32_bf16 v[116:119], v[100:103], v[156:159], v[116:119]
    s_waitcnt vmcnt(2)
    v_exp_f32 v107, v107
    ds_write_b16 v249, v0
    ds_read_b64 v[236:237], v248
    ds_read_b64_tr_b16 v[168:169], v244 offset:6144
    ds_read_b64_tr_b16 v[170:171], v245 offset:6656
    ds_read_b64_tr_b16 v[172:173], v244 offset:7168
    ds_read_b64_tr_b16 v[174:175], v245 offset:7680
    ds_read_u8 v238, v246 offset:0
    ds_read_u8 v240, v246 offset:8
    ds_read_b128 v[152:155], v242 offset:0
    ds_read_b128 v[156:159], v243 offset:0
    v_exp_f32 v108, v108
    v_exp_f32 v109, v109
    v_exp_f32 v110, v110
    v_exp_f32 v111, v111
    s_waitcnt lgkmcnt(8)
    v_mfma_f32_4x4x4_16b_bf16 v[176:179], v[236:237], v[160:161], v[176:179] cbsz:4 abid:0
    v_exp_f32 v112, v112
    v_exp_f32 v113, v113
    v_mfma_f32_4x4x4_16b_bf16 v[176:179], v[236:237], v[162:163], v[176:179] cbsz:4 abid:1
    v_exp_f32 v114, v114
    v_exp_f32 v115, v115
    v_mfma_f32_4x4x4_16b_bf16 v[176:179], v[236:237], v[164:165], v[176:179] cbsz:4 abid:2
    v_exp_f32 v116, v116
    v_exp_f32 v117, v117
    v_mfma_f32_4x4x4_16b_bf16 v[176:179], v[236:237], v[166:167], v[176:179] cbsz:4 abid:3
    v_exp_f32 v118, v118
    v_exp_f32 v119, v119
    s_waitcnt lgkmcnt(0)
    buffer_load_dwordx4 v[238:239], s[20:23], s72 idxen offen nt lds
    buffer_load_dwordx4 v[240:241], s[20:23], s51 idxen offen offset:1024 nt lds
    s_cselect_b64 exec, s[78:79], -1
    .p2align 3
    v_pk_fma_f32 v[2:3], v[104:105], s[42:43], s[42:43] op_sel_hi:[1,0,0]
    v_pk_fma_f32 v[0:1], v[120:121], v[106:107], v[120:121]
    v_pk_fma_f32 v[0:1], v[122:123], v[2:3], v[0:1]
    v_pk_fma_f32 v[2:3], v[106:107], v[2:3], v[2:3]
    v_pk_fma_f32 v[0:1], v[108:109], v[0:1], v[0:1]
    v_pk_fma_f32 v[0:1], v[124:125], v[2:3], v[0:1]
    v_pk_fma_f32 v[2:3], v[108:109], v[2:3], v[2:3]
    v_pk_fma_f32 v[0:1], v[110:111], v[0:1], v[0:1]
    v_pk_fma_f32 v[0:1], v[126:127], v[2:3], v[0:1]
    v_pk_fma_f32 v[2:3], v[110:111], v[2:3], v[2:3]
    v_pk_fma_f32 v[0:1], v[112:113], v[0:1], v[0:1]
    v_pk_fma_f32 v[0:1], v[128:129], v[2:3], v[0:1]
    v_pk_fma_f32 v[2:3], v[112:113], v[2:3], v[2:3]
    v_pk_fma_f32 v[0:1], v[114:115], v[0:1], v[0:1]
    v_pk_fma_f32 v[0:1], v[130:131], v[2:3], v[0:1]
    v_pk_fma_f32 v[2:3], v[114:115], v[2:3], v[2:3]
    v_pk_fma_f32 v[0:1], v[116:117], v[0:1], v[0:1]
    v_pk_fma_f32 v[0:1], v[132:133], v[2:3], v[0:1]
    v_pk_fma_f32 v[2:3], v[116:117], v[2:3], v[2:3]
    v_pk_fma_f32 v[0:1], v[118:119], v[0:1], v[0:1]
    v_pk_fma_f32 v[0:1], v[134:135], v[2:3], v[0:1]
    v_pk_fma_f32 v[2:3], v[118:119], v[2:3], v[2:3]
    s_mov_b64 exec, -1
    s_cbranch_scc0 U_0
CEV:
    s_cmp_eq_u32 s76, 0
    s_cbranch_scc1 EPI
    s_mov_b32 s53, s52
    s_and_b32 s52, s68, 0xffff
    s_lshr_b64 s[68:69], s[68:69], 16
    s_sub_u32 s75, s75, 16
    s_bitcmp1_b32 s52, 6
    s_cbranch_scc1 DRAIN
BPF:
    s_and_b32 s57, s52, 63
    s_mul_i32 s57, s57, 528
    s_add_u32 s57, s57, 83200
    v_lshl_add_u32 v6, v252, 1, s57
    v_add_u32 v7, s57, v252
    ds_read_b128 v[104:107], v6 offset:0
    ds_read_b128 v[108:111], v6 offset:16
    ds_read_b128 v[144:147], v251 offset:12288
    ds_read_b128 v[148:151], v251 offset:13312
    ds_read_b128 v[112:115], v6 offset:128
    ds_read_b128 v[116:119], v6 offset:144
    s_mov_b32 s62, 0
    s_mov_b32 s76, 0
    s_mov_b64 s[78:79], -1
    s_cmp_lg_u32 s77, 0
    s_waitcnt lgkmcnt(4)
    .p2align 3
    v_pk_fma_f32 v[136:137], v[8:9], v[104:105], v[180:181]
    v_pk_fma_f32 v[138:139], v[10:11], v[106:107], v[182:183]
    v_pk_fma_f32 v[140:141], v[12:13], v[108:109], v[184:185]
    v_pk_fma_f32 v[142:143], v[14:15], v[110:111], v[186:187]
    v_cvt_pk_bf16_f32 v72, v136, v137
    v_cvt_pk_bf16_f32 v73, v138, v139
    v_cvt_pk_bf16_f32 v74, v140, v141
    v_cvt_pk_bf16_f32 v75, v142, v143
    v_pk_fma_f32 v[136:137], v[24:25], v[104:105], v[196:197]
    v_pk_fma_f32 v[138:139], v[26:27], v[106:107], v[198:199]
    v_pk_fma_f32 v[140:141], v[28:29], v[108:109], v[200:201]
    v_pk_fma_f32 v[142:143], v[30:31], v[110:111], v[202:203]
    v_cvt_pk_bf16_f32 v80, v136, v137
    v_cvt_pk_bf16_f32 v81, v138, v139
    v_cvt_pk_bf16_f32 v82, v140, v141
    v_cvt_pk_bf16_f32 v83, v142, v143
    v_pk_fma_f32 v[136:137], v[40:41], v[104:105], v[212:213]
    v_pk_fma_f32 v[138:139], v[42:43], v[106:107], v[214:215]
    v_pk_fma_f32 v[140:141], v[44:45], v[108:109], v[216:217]
    v_pk_fma_f32 v[142:143], v[46:47], v[110:111], v[218:219]
    v_cvt_pk_bf16_f32 v88, v136, v137
    v_cvt_pk_bf16_f32 v89, v138, v139
    v_cvt_pk_bf16_f32 v90, v140, v141
    v_cvt_pk_bf16_f32 v91, v142, v143
    s_waitcnt lgkmcnt(0)
    .p2align 3
    v_pk_fma_f32 v[144:145], v[56:57], v[104:105], v[144:145]
    v_pk_fma_f32 v[146:147], v[58:59], v[106:107], v[146:147]
    v_pk_fma_f32 v[148:149], v[60:61], v[108:109], v[148:149]
    v_pk_fma_f32 v[150:151], v[62:63], v[110:111], v[150:151]
    v_cvt_pk_bf16_f32 v96, v144, v145
    v_cvt_pk_bf16_f32 v97, v146, v147
    v_cvt_pk_bf16_f32 v98, v148, v149
    v_cvt_pk_bf16_f32 v99, v150, v151
    ds_read_b128 v[136:139], v7 offset:256
    ds_read_b128 v[140:143], v7 offset:320
    ds_read_b128 v[144:147], v7 offset:384
    ds_read_b128 v[148:151], v7 offset:448
    v_pk_fma_f32 v[104:105], v[16:17], v[112:113], v[188:189]
    v_pk_fma_f32 v[106:107], v[18:19], v[114:115], v[190:191]
    v_pk_fma_f32 v[108:109], v[20:21], v[116:117], v[192:193]
    v_pk_fma_f32 v[110:111], v[22:23], v[118:119], v[194:195]
    v_cvt_pk_bf16_f32 v76, v104, v105
    v_cvt_pk_bf16_f32 v77, v106, v107
    v_cvt_pk_bf16_f32 v78, v108, v109
    v_cvt_pk_bf16_f32 v79, v110, v111
    v_pk_fma_f32 v[104:105], v[32:33], v[112:113], v[204:205]
    v_pk_fma_f32 v[106:107], v[34:35], v[114:115], v[206:207]
    v_pk_fma_f32 v[108:109], v[36:37], v[116:117], v[208:209]
    v_pk_fma_f32 v[110:111], v[38:39], v[118:119], v[210:211]
    v_cvt_pk_bf16_f32 v84, v104, v105
    v_cvt_pk_bf16_f32 v85, v106, v107
    v_cvt_pk_bf16_f32 v86, v108, v109
    v_cvt_pk_bf16_f32 v87, v110, v111
    v_pk_fma_f32 v[104:105], v[48:49], v[112:113], v[220:221]
    v_pk_fma_f32 v[106:107], v[50:51], v[114:115], v[222:223]
    v_pk_fma_f32 v[108:109], v[52:53], v[116:117], v[224:225]
    v_pk_fma_f32 v[110:111], v[54:55], v[118:119], v[226:227]
    v_cvt_pk_bf16_f32 v92, v104, v105
    v_cvt_pk_bf16_f32 v93, v106, v107
    v_cvt_pk_bf16_f32 v94, v108, v109
    v_cvt_pk_bf16_f32 v95, v110, v111
    v_pk_fma_f32 v[104:105], v[64:65], v[112:113], v[228:229]
    v_pk_fma_f32 v[106:107], v[66:67], v[114:115], v[230:231]
    v_pk_fma_f32 v[108:109], v[68:69], v[116:117], v[232:233]
    v_pk_fma_f32 v[110:111], v[70:71], v[118:119], v[234:235]
    v_cvt_pk_bf16_f32 v100, v104, v105
    v_cvt_pk_bf16_f32 v101, v106, v107
    v_cvt_pk_bf16_f32 v102, v108, v109
    v_cvt_pk_bf16_f32 v103, v110, v111
    s_waitcnt lgkmcnt(0)
    s_cbranch_scc1 BP_X
NEXT:
    s_cmp_eq_u32 s73, 0
    s_cbranch_scc1 U_1
    s_cmp_eq_u32 s73, 1
    s_cbranch_scc1 U_2
    s_cmp_eq_u32 s73, 2
    s_cbranch_scc1 U_3
    s_branch U_0
EPI:
    s_and_b32 s56, s53, 0x7f
    v_pk_add_f32 v[4:5], v[176:177], v[178:179]
    v_add_f32 v4, v4, v5
    v_lshl_add_u32 v5, s56, 8, v250
    v_mul_f32 v4, s46, v4
    s_bitcmp1_b32 s53, 7
    v_cmp_class_f32_e64 vcc, v4, s45
    v_mov_b64 v[176:177], 0
    v_mov_b64 v[178:179], 0
    ds_write_b32 v5, v4
    s_cbranch_scc1 SLOW
    s_cbranch_vccnz SLOW
EPI_R:
    s_bitcmp1_b32 s52, 6
    s_cbranch_scc1 L_DONE
EPI_C:
    s_bfe_u32 s62, s52, 0x40008
    s_sub_u32 s62, s62, 2
    s_mov_b32 s76, 1
    s_lshr_b32 s56, s52, 12
    s_lshl_b32 s78, 0x20002, s56
    s_sub_u32 s78, s78, 0x10001
    s_mov_b32 s79, s78
    s_cmp_eq_u32 s73, 0
    s_cbranch_scc1 U_1
    s_cmp_eq_u32 s73, 1
    s_cbranch_scc1 U_2
    s_cmp_eq_u32 s73, 2
    s_cbranch_scc1 U_3
    s_branch U_0
PEV:
    s_cmp_eq_u32 s55, 0
    s_cbranch_scc1 P_DR
    ds_read_b32 v254, v253
    s_waitcnt lgkmcnt(0)
ADV:
    v_readfirstlane_b32 s66, v254
    s_mov_b32 s67, 0
    s_and_b32 s56, s66, 63
    s_bfe_u32 s50, s66, 0x40008
    s_cbranch_scc0 AW
    s_lshr_b32 s57, s56, 3
    s_mul_i32 s51, s56, 25600
    s_mul_i32 s57, s57, 52224000
    s_add_u32 s51, s51, s57
    v_lshl_add_u32 v246, s56, 8, v247
    s_add_u32 s51, s51, s49
    s_add_u32 s72, s51, 1024
    s_lshl_b64 s[64:65], s[66:67], s75
    s_or_b64 s[68:69], s[68:69], s[64:65]
    s_add_u32 s75, s75, 16
    s_mov_b32 s55, 0
    s_sub_u32 s50, s50, 3
    s_cbranch_scc1 P_2
P_RET:
    s_cmp_eq_u32 s73, 0
    s_cbranch_scc1 RET_0
    s_cmp_eq_u32 s73, 1
    s_cbranch_scc1 RET_1
    s_cmp_eq_u32 s73, 2
    s_cbranch_scc1 RET_2
    s_branch RET_3
P_DR:
    v_add_u32 v246, 16, v246
P_D2:
    s_mov_b64 exec, 1
    v_mov_b32 v253, 4
    ds_add_rtn_u32 v253, v251, v253 offset:17600
    s_mov_b64 exec, -1
    s_mov_b32 s50, 1
    s_mov_b32 s55, 1
    s_cmp_eq_u32 s73, 0
    s_cbranch_scc1 RET_0
    s_cmp_eq_u32 s73, 1
    s_cbranch_scc1 RET_1
    s_cmp_eq_u32 s73, 2
    s_cbranch_scc1 RET_2
    s_branch RET_3
P_2:
    s_bitcmp1_b32 s66, 6
    s_cbranch_scc0 P_D2
    v_mov_b32 v246, 16896
    s_movk_i32 s50, 0x100
    s_branch P_RET
DRAIN:
    v_rcp_f32 v2, v2
    v_rcp_f32 v3, v3
    v_fma_f32 v0, v0, v2, s44
    v_fmac_f32 v0, v1, v3
    v_cvt_pk_bf16_f32 v0, v0, v0
    s_bitcmp1_b32 s73, 0
    ds_write_b16 v249, v0
    ds_read_b64 v[236:237], v248
    s_waitcnt lgkmcnt(0)
    s_cbranch_scc1 DRAIN1
    v_mfma_f32_4x4x4_16b_bf16 v[176:179], v[236:237], v[160:161], v[176:179] cbsz:4 abid:0
    s_nop 1
    v_mfma_f32_4x4x4_16b_bf16 v[176:179], v[236:237], v[162:163], v[176:179] cbsz:4 abid:1
    s_nop 1
    v_mfma_f32_4x4x4_16b_bf16 v[176:179], v[236:237], v[164:165], v[176:179] cbsz:4 abid:2
    s_nop 1
    v_mfma_f32_4x4x4_16b_bf16 v[176:179], v[236:237], v[166:167], v[176:179] cbsz:4 abid:3
    s_nop 2
    s_branch EPI
DRAIN1:
    v_mfma_f32_4x4x4_16b_bf16 v[176:179], v[236:237], v[168:169], v[176:179] cbsz:4 abid:0
    s_nop 1
    v_mfma_f32_4x4x4_16b_bf16 v[176:179], v[236:237], v[170:171], v[176:179] cbsz:4 abid:1
    s_nop 1
    v_mfma_f32_4x4x4_16b_bf16 v[176:179], v[236:237], v[172:173], v[176:179] cbsz:4 abid:2
    s_nop 1
    v_mfma_f32_4x4x4_16b_bf16 v[176:179], v[236:237], v[174:175], v[176:179] cbsz:4 abid:3
    s_nop 2
    s_branch EPI
L_DONE:
    s_lshl_b32 s56, s48, 11
    s_add_u32 s56, s56, 133376
    v_lshl_add_u32 v0, v251, 1, s56
    s_lshl_b32 s56, s48, 18
    s_waitcnt lgkmcnt(0)
    s_barrier
    ds_read_b128 v[104:107], v0 offset:0
    ds_read_b128 v[108:111], v0 offset:16
    s_waitcnt lgkmcnt(0)
    v_cvt_pk_bf16_f32 v152, v104, v105
    v_cvt_pk_bf16_f32 v153, v106, v107
    v_cvt_pk_bf16_f32 v154, v108, v109
    v_cvt_pk_bf16_f32 v155, v110, v111
    buffer_store_dwordx4 v[152:155], v251, s[28:31], s56 offen nt
L_FIN:
    s_endpgm
AW:
    s_sleep 1
    ds_read_b32 v254, v253
    s_waitcnt lgkmcnt(0)
    s_branch ADV
DRAW_P:
    s_mov_b64 exec, 1
    v_mov_b32 v253, 4
    ds_add_rtn_u32 v253, v251, v253 offset:17600
    s_mov_b64 exec, -1
    s_add_u32 s50, s50, 2
    s_mov_b32 s55, 1
    s_branch DRET_P
BP_X:
    s_cmp_eq_u32 s77, 1
    s_mov_b32 s77, 0
    s_cbranch_scc1 SLOW_W
    s_branch EPI_C
SLOW:
    s_bitcmp1_b32 s53, 6
    s_cbranch_scc1 EPI_R
    s_mov_b32 s74, s52
    s_mov_b32 s52, s53
    s_mov_b32 s77, 1
    ds_write_b32 v5, v176
    s_branch BPF
SLOW_W:
    s_mov_b32 s52, s74
    s_and_b32 s56, s53, 63
    s_mov_b32 s57, 0
    s_bfe_u32 s59, s53, 0x40008
    s_lshl4_add_u32 s57, s56, s57
    s_lshl_b32 s57, s57, 4
    s_add_u32 s74, s57, 116992
    s_bitcmp1_b32 s53, 7
    s_cselect_b64 s[66:67], -1, 0
    s_cselect_b32 s59, 13, s59
    v_bfe_u32 v204, v251, 4, 4
    v_mov_b32 v207, v252
    v_mov_b64 v[180:181], 0
    v_mov_b64 v[182:183], 0
    v_mov_b64 v[184:185], 0
    v_mov_b64 v[186:187], 0
    v_mov_b64 v[188:189], 0
    v_mov_b64 v[190:191], 0
    v_mov_b64 v[192:193], 0
    v_mov_b64 v[194:195], 0
    s_lshr_b32 s58, s56, 3
    s_mul_i32 s57, s56, 25600
    s_mul_i32 s58, s58, 52224000
    s_add_u32 s57, s57, s58
    s_add_u32 s57, s57, s49
    s_lshr_b32 s64, s56, 3
    s_mul_i32 s58, s56, 400
    s_mul_i32 s64, s64, 816000
    s_add_u32 s58, s58, s64
SLOW_L:
    v_add_u32 v205, s74, v204
    ds_read_u8 v206, v205
    s_waitcnt lgkmcnt(0)
    v_cndmask_b32_e64 v206, v206, v204, s[66:67]
    v_lshlrev_b32 v205, 1, v206
    buffer_load_dwordx4 v[196:199], v[206:207], s[20:23], s57 idxen offen offset:1024
    buffer_load_dwordx4 v[200:203], v[206:207], s[20:23], s57 idxen offen offset:1088
    buffer_load_ushort v205, v205, s[24:27], s58 offen
    v_cmp_gt_u32 vcc, 200, v206
    v_add_u32 v204, 16, v204
    s_waitcnt vmcnt(0)
    v_mfma_f32_16x16x32_bf16 v[104:107], v[72:75], v[196:199], v[136:139]
    v_mfma_f32_16x16x32_bf16 v[104:107], v[76:79], v[200:203], v[104:107]
    v_mfma_f32_16x16x32_bf16 v[108:111], v[80:83], v[196:199], v[140:143]
    v_mfma_f32_16x16x32_bf16 v[108:111], v[84:87], v[200:203], v[108:111]
    v_mfma_f32_16x16x32_bf16 v[112:115], v[88:91], v[196:199], v[144:147]
    v_mfma_f32_16x16x32_bf16 v[112:115], v[92:95], v[200:203], v[112:115]
    v_mfma_f32_16x16x32_bf16 v[116:119], v[96:99], v[196:199], v[148:151]
    v_mfma_f32_16x16x32_bf16 v[116:119], v[100:103], v[200:203], v[116:119]
    v_lshlrev_b32 v205, 16, v205
    v_cndmask_b32 v205, 0, v205, vcc
    s_nop 7
    v_exp_f32 v104, v104
    v_exp_f32 v105, v105
    v_exp_f32 v106, v106
    v_exp_f32 v107, v107
    v_exp_f32 v108, v108
    v_exp_f32 v109, v109
    v_exp_f32 v110, v110
    v_exp_f32 v111, v111
    v_exp_f32 v112, v112
    v_exp_f32 v113, v113
    v_exp_f32 v114, v114
    v_exp_f32 v115, v115
    v_exp_f32 v116, v116
    v_exp_f32 v117, v117
    v_exp_f32 v118, v118
    v_exp_f32 v119, v119
    v_add_f32 v104, 1.0, v104
    v_add_f32 v105, 1.0, v105
    v_add_f32 v106, 1.0, v106
    v_add_f32 v107, 1.0, v107
    v_add_f32 v108, 1.0, v108
    v_add_f32 v109, 1.0, v109
    v_add_f32 v110, 1.0, v110
    v_add_f32 v111, 1.0, v111
    v_add_f32 v112, 1.0, v112
    v_add_f32 v113, 1.0, v113
    v_add_f32 v114, 1.0, v114
    v_add_f32 v115, 1.0, v115
    v_add_f32 v116, 1.0, v116
    v_add_f32 v117, 1.0, v117
    v_add_f32 v118, 1.0, v118
    v_add_f32 v119, 1.0, v119
    v_rcp_f32 v104, v104
    v_rcp_f32 v105, v105
    v_rcp_f32 v106, v106
    v_rcp_f32 v107, v107
    v_rcp_f32 v108, v108
    v_rcp_f32 v109, v109
    v_rcp_f32 v110, v110
    v_rcp_f32 v111, v111
    v_rcp_f32 v112, v112
    v_rcp_f32 v113, v113
    v_rcp_f32 v114, v114
    v_rcp_f32 v115, v115
    v_rcp_f32 v116, v116
    v_rcp_f32 v117, v117
    v_rcp_f32 v118, v118
    v_rcp_f32 v119, v119
    v_mul_f32 v208, v104, v120
    v_fmac_f32 v208, v105, v121
    v_ldexp_f32 v208, v208, 60
    v_fmac_f32 v208, v106, v122
    v_fmac_f32 v208, v107, v123
    v_fmac_f32 v208, v108, v124
    v_fmac_f32 v208, v109, v125
    v_fmac_f32 v208, v110, v126
    v_fmac_f32 v208, v111, v127
    v_fmac_f32 v208, v112, v128
    v_fmac_f32 v208, v113, v129
    v_fmac_f32 v208, v114, v130
    v_fmac_f32 v208, v115, v131
    v_fmac_f32 v208, v116, v132
    v_fmac_f32 v208, v117, v133
    v_fmac_f32 v208, v118, v134
    v_fmac_f32 v208, v119, v135
    v_mov_b32 v209, v208
    s_nop 1
    v_permlane32_swap_b32 v208, v209
    v_add_f32 v208, v208, v209
    v_mov_b32 v209, v208
    s_nop 1
    v_permlane16_swap_b32 v208, v209
    v_add_f32 v208, v208, v209
    v_mul_f32 v208, s46, v208
    v_add_f32 v208, s63, v208
    v_mul_f32 v208, v208, v205
    v_lshlrev_b32 v209, 16, v196
    v_and_b32 v210, 0xffff0000, v196
    v_fmac_f32 v180, v208, v209
    v_fmac_f32 v181, v208, v210
    v_lshlrev_b32 v209, 16, v197
    v_and_b32 v210, 0xffff0000, v197
    v_fmac_f32 v182, v208, v209
    v_fmac_f32 v183, v208, v210
    v_lshlrev_b32 v209, 16, v198
    v_and_b32 v210, 0xffff0000, v198
    v_fmac_f32 v184, v208, v209
    v_fmac_f32 v185, v208, v210
    v_lshlrev_b32 v209, 16, v199
    v_and_b32 v210, 0xffff0000, v199
    v_fmac_f32 v186, v208, v209
    v_fmac_f32 v187, v208, v210
    v_lshlrev_b32 v209, 16, v200
    v_and_b32 v210, 0xffff0000, v200
    v_fmac_f32 v188, v208, v209
    v_fmac_f32 v189, v208, v210
    v_lshlrev_b32 v209, 16, v201
    v_and_b32 v210, 0xffff0000, v201
    v_fmac_f32 v190, v208, v209
    v_fmac_f32 v191, v208, v210
    v_lshlrev_b32 v209, 16, v202
    v_and_b32 v210, 0xffff0000, v202
    v_fmac_f32 v192, v208, v209
    v_fmac_f32 v193, v208, v210
    v_lshlrev_b32 v209, 16, v203
    v_and_b32 v210, 0xffff0000, v203
    v_fmac_f32 v194, v208, v209
    v_fmac_f32 v195, v208, v210
    s_sub_u32 s59, s59, 1
    s_cmp_lg_u32 s59, 0
    s_cbranch_scc1 SLOW_L
    v_readfirstlane_b32 s56, v5
    s_nop 1
    v_lshl_add_u32 v208, v252, 1, s56
    ds_add_f32 v208, v180 offset:0
    ds_add_f32 v208, v181 offset:4
    ds_add_f32 v208, v182 offset:8
    ds_add_f32 v208, v183 offset:12
    ds_add_f32 v208, v184 offset:16
    ds_add_f32 v208, v185 offset:20
    ds_add_f32 v208, v186 offset:24
    ds_add_f32 v208, v187 offset:28
    ds_add_f32 v208, v188 offset:128
    ds_add_f32 v208, v189 offset:132
    ds_add_f32 v208, v190 offset:136
    ds_add_f32 v208, v191 offset:140
    ds_add_f32 v208, v192 offset:144
    ds_add_f32 v208, v193 offset:148
    ds_add_f32 v208, v194 offset:152
    ds_add_f32 v208, v195 offset:156
    s_waitcnt lgkmcnt(0)
    s_bitcmp1_b32 s52, 6
    s_cbranch_scc1 L_DONE
    ds_read_b128 v[180:183], v251 offset:0
    ds_read_b128 v[184:187], v251 offset:1024
    ds_read_b128 v[196:199], v251 offset:4096
    ds_read_b128 v[200:203], v251 offset:5120
    ds_read_b128 v[212:215], v251 offset:8192
    ds_read_b128 v[216:219], v251 offset:9216
    ds_read_b128 v[188:191], v251 offset:2048
    ds_read_b128 v[192:195], v251 offset:3072
    ds_read_b128 v[204:207], v251 offset:6144
    ds_read_b128 v[208:211], v251 offset:7168
    ds_read_b128 v[220:223], v251 offset:10240
    ds_read_b128 v[224:227], v251 offset:11264
    ds_read_b128 v[228:231], v251 offset:14336
    ds_read_b128 v[232:235], v251 offset:15360
    s_mov_b32 s77, 2
    s_branch BPF
L_END:
    s_endpgm
.section .rodata,"a"
.p2align 6
.amdhsa_kernel standalone__sequential_behavior_din__recsys_kernel
  .amdhsa_next_free_vgpr 255
  .amdhsa_next_free_sgpr 80
  .amdhsa_accum_offset 256
  .amdhsa_group_segment_fixed_size 0
  .amdhsa_kernarg_size 80
  .amdhsa_user_sgpr_count 2
  .amdhsa_user_sgpr_kernarg_segment_ptr 1
  .amdhsa_system_sgpr_workgroup_id_x 1
.end_amdhsa_kernel
```

```asm
; @launch grid=(256,1,1) block=(512,1,1) lds=153856
.amdgcn_target "amdgcn-amd-amdhsa--gfx950"
.text
.globl standalone__sequential_behavior_din__recsys_kernel
.p2align 8
.type standalone__sequential_behavior_din__recsys_kernel,@function
standalone__sequential_behavior_din__recsys_kernel:
    s_cmpk_ge_u32 s2, 256
    s_cbranch_scc1 L_END
    s_load_dwordx16 s[4:19], s[0:1], 0
    s_setprio 3
    v_lshrrev_b32 v1, 6, v0
    v_and_b32 v176, 63, v0
    v_readfirstlane_b32 s48, v1
    s_getpc_b64 s[40:41]
L_PC:
    s_cmp_lt_u32 s48, 5
    s_cbranch_scc1 P_NC
    s_mov_b32 s42, L_END-L_PC
    s_mov_b32 s43, 0x20000
    v_subrev_u32 v150, 320, v0
    v_lshlrev_b32 v150, 6, v150
    buffer_load_dword v150, v150, s[40:43], 0 offen
P_NC:
    v_and_b32 v2, 31, v0
    v_bfe_u32 v3, v0, 5, 1
    v_cmp_gt_u32 vcc, 25, v2
    v_mul_u32_u24 v4, 400, v3
    v_lshl_add_u32 v179, v2, 4, v4
    v_bfrev_b32 v4, 8
    v_cndmask_b32 v179, v4, v179, vcc
    s_mul_i32 s57, s2, 3200
    s_sub_u32 s26, 6553600, s57
    s_lshr_b32 s59, s48, 2
    s_mul_i32 s71, s48, 800
    s_mul_i32 s59, s59, 816000
    s_add_u32 s71, s71, s59
    s_mov_b32 s27, 0x20000
    s_lshl_b32 s74, s48, 12
    s_lshl_b32 s53, s2, 10
    v_lshlrev_b32 v251, 4, v176
    v_lshlrev_b32 v120, 1, v176
    v_and_b32 v120, 32, v120
    v_xor_b32 v120, v120, v251
    v_xor_b32 v121, 64, v120
    s_mov_b32 s38, 32768
    s_mov_b32 s39, s27
    s_lshl_b32 s58, s48, 18
    s_sub_u32 s34, 2097152, s53
    s_mov_b32 s35, s27
    s_add_u32 m0, s74, 121088
    v_and_b32 v178, 15, v176
    v_lshrrev_b32 v177, 4, v176
    v_lshlrev_b32 v252, 4, v177
    v_mul_u32_u24 v208, 0x80008, v2
    v_lshrrev_b32 v238, 3, v176
    v_add_u32 v208, 0x10000, v208
    v_cmp_gt_u32 vcc, 32, v176
    s_waitcnt lgkmcnt(0)
    s_add_u32 s24, s8, s57
    s_addc_u32 s25, s9, 0
    s_mov_b64 s[36:37], s[10:11]
    buffer_load_dwordx4 v[204:207], v179, s[24:27], s71 offen offset:0 nt
    s_setprio 0
    s_add_u32 s32, s4, s53
    s_addc_u32 s33, s5, 0
    s_load_dword s63, s[16:17], 0
    s_cmp_lg_u32 s48, 0
    s_cbranch_scc1 P_LJ
    v_mov_b32 v146, s12
    v_mov_b32 v147, s13
    v_mov_b32 v148, s14
    v_mov_b32 v149, s15
    v_lshlrev_b32 v4, 2, v2
    v_cndmask_b32 v146, v146, v148, vcc
    v_cndmask_b32 v147, v147, v149, vcc
    v_add_co_u32 v146, vcc, v146, v4
    s_nop 1
    v_addc_co_u32 v147, vcc, 0, v147, vcc
    global_load_dword v146, v[146:147], off
P_LJ:
    buffer_load_dwordx4 v[124:127], v251, s[32:35], s58 offen nt
    buffer_load_dwordx4 v120, s[36:39], s74 offen offset:0 lds
    buffer_load_dwordx4 v121, s[36:39], s74 offen offset:1024 lds
    s_lshl1_add_u32 s54, s74, 17664
    s_mul_i32 s49, s2, 204800
    s_lshl_b32 s57, s48, 9
    v_add_u32 v247, 116992, v238
    v_add_u32 v246, s57, v247
    s_add_u32 s56, s57, 116992
    v_add_u32 v209, 0x20002, v208
    v_add_u32 v210, 0x40004, v208
    v_add_u32 v211, 0x60006, v208
    s_sub_u32 s20, s6, 1024
    s_subb_u32 s21, s7, 0
    s_or_b32 s21, s21, 0x800000
    s_movk_i32 s22, 200
    s_mov_b32 s23, s27
    s_movk_i32 s61, 0x3f80
    v_lshrrev_b32 v216, 1, v251
    v_and_b32 v213, 0x100, v216
    v_mov_b64 v[214:215], -1
    v_lshlrev_b32 v250, 2, v176
    v_bfrev_b32 v2, v238
    v_lshrrev_b32 v2, 28, v2
    v_and_b32 v2, 6, v2
    v_xor_b32 v2, v2, v176
    v_and_b32 v2, 7, v2
    v_mul_u32_u24 v143, 528, v238
    v_lshlrev_b32 v239, 4, v2
    v_lshlrev_b32 v241, 4, v2
    v_lshlrev_b32 v153, 4, v2
    v_lshlrev_b32 v155, 4, v2
    s_add_u32 s28, s18, s53
    s_addc_u32 s29, s19, 0
    s_sub_u32 s30, 2097152, s53
    s_mov_b32 s31, s27
    s_mov_b32 s60, 0xbfb8aa3b
    s_mov_b32 s42, 0x21800000
    s_mov_b32 s46, 0x2b800000
    s_lshr_b32 s59, s48, 2
    s_mul_i32 s51, s48, 51200
    s_mul_i32 s59, s59, 52224000
    s_add_u32 s51, s51, s59
    s_add_u32 s51, s51, s49
    s_add_u32 s72, s51, 1024
    v_bfrev_b32 v2, v178
    v_lshrrev_b32 v2, 28, v2
    v_and_b32 v2, 6, v2
    v_xor_b32 v2, v2, v177
    v_lshl_add_u32 v2, v2, 4, s54
    v_lshl_add_u32 v242, v178, 7, v2
    v_xor_b32 v243, 64, v242
    v_and_b32 v3, 3, v176
    v_bfe_u32 v2, v176, 2, 2
    v_lshlrev_b32 v7, 3, v3
    v_lshl_add_u32 v7, v2, 7, v7
    v_and_b32 v6, 8, v176
    v_lshlrev_b32 v6, 3, v6
    v_lshl_add_u32 v244, v177, 5, v7
    v_xor_b32 v244, v244, v6
    v_add_u32 v244, s54, v244
    v_xor_b32 v245, 32, v244
    s_lshl_b32 s57, s48, 7
    s_add_u32 s57, s57, 150016
    v_lshl_add_u32 v249, v2, 2, v177
    v_lshl_add_u32 v249, v249, 2, v3
    v_lshl_add_u32 v249, v249, 1, s57
    v_lshl_add_u32 v248, v178, 3, s57
    v_and_b32 v6, 0x60, v250
    v_or_b32 v6, v6, v7
    v_lshl_add_u32 v136, v177, 10, v6
    s_mul_i32 s57, s48, 0x1010
    s_and_b32 s57, s57, 0x1060
    v_xor_b32 v144, s57, v136
    v_add_u32 v136, 121088, v136
    v_add_u32 v144, 121088, v144
    v_xor_b32 v137, 32, v136
    v_xor_b32 v138, 64, v136
    v_xor_b32 v139, 96, v136
    s_and_b32 s59, s48, 4
    s_lshl_b32 s59, s59, 4
    v_xor_b32 v140, s59, v136
    v_xor_b32 v141, 32, v140
    s_and_b32 s57, s48, 3
    s_mul_i32 s57, s57, 8448
    s_lshl1_add_u32 s57, s59, s57
    s_add_u32 s57, s57, 83200
    v_mul_u32_u24 v145, 528, v178
    v_add3_u32 v145, v145, v252, s57
    v_lshl_add_u32 v142, s59, 1, v252
    s_mul_i32 s57, s48, 4224
    s_add_u32 s57, s57, 83200
    v_and_b32 v3, 0x70, v251
    v_add3_u32 v143, v143, v3, s57
    v_add_u32 v3, v143, v3
    s_lshl_b32 s57, s48, 11
    v_add_u32 v151, s57, v251
    s_mov_b32 s66, 0x1b0a0100
    s_mov_b32 s67, 0x966d4c33
    s_lshl_b32 s57, s48, 3
    s_lshr_b64 s[66:67], s[66:67], s57
    s_and_b32 s47, s66, 7
    s_bfe_u32 s70, s66, 0x50003
    s_lshl1_add_u32 s70, s70, 16
    s_mul_i32 s71, s70, 400
    buffer_load_dwordx4 v120, s[36:39], s74 offen offset:2048 lds
    buffer_load_dwordx4 v121, s[36:39], s74 offen offset:3072 lds
    s_cmp_eq_u32 s48, 0
    s_waitcnt vmcnt(6) lgkmcnt(0)
    s_cbranch_scc1 P_M0
    s_waitcnt vmcnt(5)
P_M0:
    s_call_b64 s[36:37], CMP
    s_branch P_C
    .p2align 3
CMP:
    v_bcnt_u32_b32 v7, v204, 0
    v_bcnt_u32_b32 v7, v205, v7
    v_bcnt_u32_b32 v7, v206, v7
    v_bcnt_u32_b32 v7, v207, v7
    v_add_u32 v4, s56, v216
    v_mov_b32 v6, v7
    ds_write_b64 v4, v[214:215]
    v_cmp_eq_u16_e64 s[4:5], s61, v204
    v_cmp_eq_u16_sdwa s[6:7], v204, s61 src0_sel:WORD_1 src1_sel:WORD_0
    v_add_u32_dpp v6, v6, v6 row_shr:1 row_mask:0xf bank_mask:0xf bound_ctrl:0
    v_cmp_eq_u16_e64 s[8:9], s61, v205
    v_cmp_eq_u16_sdwa s[10:11], v205, s61 src0_sel:WORD_1 src1_sel:WORD_0
    v_add_u32_dpp v6, v6, v6 row_shr:2 row_mask:0xf bank_mask:0xf bound_ctrl:0
    v_cmp_eq_u16_e64 s[12:13], s61, v206
    v_cmp_eq_u16_sdwa s[14:15], v206, s61 src0_sel:WORD_1 src1_sel:WORD_0
    v_add_u32_dpp v6, v6, v6 row_shr:4 row_mask:0xf bank_mask:0xf bound_ctrl:0
    v_cmp_eq_u16_e64 s[16:17], s61, v207
    v_cmp_eq_u16_sdwa s[18:19], v207, s61 src0_sel:WORD_1 src1_sel:WORD_0
    v_add_u32_dpp v6, v6, v6 row_shr:8 row_mask:0xf bank_mask:0xf bound_ctrl:0
    s_nop 1
    v_add_u32_dpp v6, v6, v6 row_bcast:15 row_mask:0xa bank_mask:0xf
    v_sub_u32 v6, v6, v7
    v_mul_u32_u24 v6, 9363, v6
    v_lshrrev_b32 v6, 16, v6
    v_min_u32 v6, 200, v6
    v_add3_u32 v226, v6, v213, s56
    v_readlane_b32 s59, v6, 31
    v_readlane_b32 s58, v6, 63
    v_addc_co_u32_e64 v227, vcc, 0, v226, s[4:5]
    v_addc_co_u32_e64 v228, vcc, 0, v227, s[6:7]
    v_addc_co_u32_e64 v229, vcc, 0, v228, s[8:9]
    v_addc_co_u32_e64 v230, vcc, 0, v229, s[10:11]
    v_addc_co_u32_e64 v231, vcc, 0, v230, s[12:13]
    v_addc_co_u32_e64 v232, vcc, 0, v231, s[14:15]
    v_addc_co_u32_e64 v233, vcc, 0, v232, s[16:17]
    v_addc_co_u32_e64 v234, vcc, 0, v233, s[18:19]
    s_mov_b64 exec, s[4:5]
    ds_write_b8 v226, v208
    s_mov_b64 exec, s[6:7]
    ds_write_b8_d16_hi v227, v208
    s_mov_b64 exec, s[8:9]
    ds_write_b8 v228, v209
    s_mov_b64 exec, s[10:11]
    ds_write_b8_d16_hi v229, v209
    s_mov_b64 exec, s[12:13]
    ds_write_b8 v230, v210
    s_mov_b64 exec, s[14:15]
    ds_write_b8_d16_hi v231, v210
    s_mov_b64 exec, s[16:17]
    ds_write_b8 v232, v211
    s_mov_b64 exec, s[18:19]
    ds_write_b8_d16_hi v233, v211
    s_mov_b64 exec, -1
    v_sub_u32 v6, v234, v226
    v_mul_u32_u24 v6, 7, v6
    v_cmp_ne_u32 vcc, v6, v7
    s_min_u32 s64, vcc_lo, 1
    s_min_u32 s65, vcc_hi, 1
    s_lshl_b64 s[64:65], s[64:65], 15
    s_or_b32 s57, s59, s64
    s_or_b32 s58, s58, s65
    s_setpc_b64 s[36:37]
P_C:
    ds_read_u8 v238, v246 offset:0
    ds_read_u8 v240, v246 offset:8
    ds_read_u8 v152, v246 offset:16
    ds_read_u8 v154, v246 offset:24
    s_add_u32 m0, s54, 0
    s_waitcnt lgkmcnt(3)
    buffer_load_dwordx4 v[238:239], s[20:23], s72 idxen offen nt lds
    s_waitcnt lgkmcnt(2)
    buffer_load_dwordx4 v[240:241], s[20:23], s51 idxen offen offset:1024 nt lds
    s_add_u32 m0, s54, 2048
    s_waitcnt lgkmcnt(1)
    buffer_load_dwordx4 v[152:153], s[20:23], s72 idxen offen nt lds
    s_waitcnt lgkmcnt(0)
    buffer_load_dwordx4 v[154:155], s[20:23], s51 idxen offen offset:1024 nt lds
    s_lshl_b32 s63, s63, 16
    s_cmp_lg_u32 s48, 0
    s_waitcnt vmcnt(8)
    s_cbranch_scc1 P_SW_J
    v_lshlrev_b32 v148, 16, v146
    v_and_b32 v149, 0xffff0000, v146
    v_mov_b32 v4, -1
    v_mov_b32 v5, 0
    v_mov_b32 v6, 0x240
    v_lshrrev_b32 v0, 1, v251
    ds_write2st64_b32 v250, v4, v5 offset0:66 offset1:67
    s_mov_b32 exec_hi, 0
    v_max3_f32 v2, abs(v148), abs(v149), abs(s63)
    v_ldexp_f32 v148, v148, 40
    v_ldexp_f32 v149, v149, 40
    v_cmp_le_f32 vcc, 0x33800000, v2
    s_mov_b32 exec_lo, 0x55
    v_mul_f32 v148, s42, v148
    v_mul_f32 v149, s42, v149
    s_mov_b32 exec_lo, -1
    ds_write_b32 v250, v6 offset:17408
    s_mov_b32 exec_hi, -1
    s_movk_i32 s56, 0x3ff
    s_cmp_lg_u64 vcc, 0
    s_cmovk_i32 s56, 0x207
    v_mov_b32 v6, 17184
    v_mov_b32 v7, s56
    ds_write_b64 v0, v[148:149] offset:16384
    ds_write_b64 v5, v[6:7] offset:17600
P_SW_J:
    ds_write_b128 v143, v[124:127] offset:256
    ds_write_b128 v143, v[124:127] offset:384
    s_waitcnt vmcnt(4) lgkmcnt(0)
    s_barrier
    ds_read_b64_tr_b16 v[218:219], v144 offset:0
    ds_read_b64_tr_b16 v[220:221], v144 offset:512
    ds_read_b64_tr_b16 v[222:223], v144 offset:16384
    ds_read_b64_tr_b16 v[224:225], v144 offset:16896
    ds_read_b128 v[160:163], v145 offset:256
    ds_read_b128 v[164:167], v145 offset:320
    ds_read_b128 v[104:107], v142 offset:16640
    ds_read_b128 v[108:111], v142 offset:16704
    ds_read_b64_tr_b16 v[40:41], v140 offset:8192
    ds_read_b64_tr_b16 v[42:43], v140 offset:8704
    ds_read_b64_tr_b16 v[44:45], v141 offset:8192
    ds_read_b64_tr_b16 v[46:47], v141 offset:8704
    ds_read_b64_tr_b16 v[48:49], v140 offset:12288
    ds_read_b64_tr_b16 v[50:51], v140 offset:12800
    ds_read_b64_tr_b16 v[52:53], v141 offset:12288
    ds_read_b64_tr_b16 v[54:55], v141 offset:12800
    ds_read_b64_tr_b16 v[56:57], v140 offset:16384
    ds_read_b64_tr_b16 v[58:59], v140 offset:16896
    ds_read_b64_tr_b16 v[60:61], v141 offset:16384
    ds_read_b64_tr_b16 v[62:63], v141 offset:16896
    ds_read_b64_tr_b16 v[64:65], v140 offset:20480
    ds_read_b64_tr_b16 v[66:67], v140 offset:20992
    ds_read_b64_tr_b16 v[68:69], v141 offset:20480
    ds_read_b64_tr_b16 v[70:71], v141 offset:20992
    s_and_b32 s59, s57, 0xff
    s_lshr_b32 s57, s57, 8
    s_add_u32 s59, s59, 15
    s_and_b32 s52, s59, 15
    s_lshl_b32 s52, s52, 12
    s_or_b32 s57, s57, s52
    s_lshr_b32 s59, s59, 4
    s_max_u32 s59, s59, 3
    s_lshl1_add_u32 s52, s48, s57
    s_lshl_b32 s57, s59, 8
    s_or_b32 s52, s52, s57
    s_sub_u32 s50, s59, 3
    s_and_b32 s59, s58, 0xff
    s_lshr_b32 s58, s58, 8
    s_add_u32 s59, s59, 15
    s_and_b32 s74, s59, 15
    s_lshl_b32 s74, s74, 12
    s_or_b32 s58, s58, s74
    s_lshr_b32 s59, s59, 4
    s_max_u32 s59, s59, 2
    s_lshl1_add_u32 s74, s48, s58
    s_lshl_b32 s58, s59, 8
    s_or_b32 s74, s74, s58
    s_or_b32 s74, s74, 1
    v_lshlrev_b32 v24, 16, v124
    v_and_b32 v25, 0xffff0000, v124
    v_lshlrev_b32 v26, 16, v125
    v_and_b32 v27, 0xffff0000, v125
    v_lshlrev_b32 v28, 16, v126
    v_and_b32 v29, 0xffff0000, v126
    v_lshlrev_b32 v30, 16, v127
    v_and_b32 v31, 0xffff0000, v127
    v_mul_f32 v24, s60, v24
    v_mul_f32 v25, s60, v25
    v_mul_f32 v26, s60, v26
    v_mul_f32 v27, s60, v27
    v_mul_f32 v28, s60, v28
    v_mul_f32 v29, s60, v29
    v_mul_f32 v30, s60, v30
    v_mul_f32 v31, s60, v31
    s_waitcnt lgkmcnt(15)
    v_lshlrev_b32 v8, 16, v218
    v_and_b32 v9, 0xffff0000, v218
    v_lshlrev_b32 v16, 16, v222
    v_and_b32 v17, 0xffff0000, v222
    v_lshlrev_b32 v10, 16, v219
    v_and_b32 v11, 0xffff0000, v219
    v_lshlrev_b32 v18, 16, v223
    v_and_b32 v19, 0xffff0000, v223
    v_lshlrev_b32 v12, 16, v220
    v_and_b32 v13, 0xffff0000, v220
    v_lshlrev_b32 v20, 16, v224
    v_and_b32 v21, 0xffff0000, v224
    v_lshlrev_b32 v14, 16, v221
    v_and_b32 v15, 0xffff0000, v221
    v_lshlrev_b32 v22, 16, v225
    v_and_b32 v23, 0xffff0000, v225
    v_xor_b32 v168, 0x80008000, v160
    v_xor_b32 v169, 0x80008000, v161
    v_xor_b32 v170, 0x80008000, v162
    v_xor_b32 v171, 0x80008000, v163
    v_xor_b32 v172, 0x80008000, v164
    v_xor_b32 v173, 0x80008000, v165
    v_xor_b32 v174, 0x80008000, v166
    v_xor_b32 v175, 0x80008000, v167
    s_waitcnt lgkmcnt(12)
    v_mfma_f32_16x16x32_bf16 v[104:107], v[40:43], v[160:163], v[104:107]
    v_mfma_f32_16x16x32_bf16 v[108:111], v[44:47], v[160:163], v[108:111]
    v_add_f32 v112, v8, v16
    v_add_f32 v113, v9, v17
    s_waitcnt lgkmcnt(8)
    v_mfma_f32_16x16x32_bf16 v[104:107], v[48:51], v[164:167], v[104:107]
    v_mfma_f32_16x16x32_bf16 v[108:111], v[52:55], v[164:167], v[108:111]
    v_add_f32 v114, v10, v18
    v_add_f32 v115, v11, v19
    s_waitcnt lgkmcnt(4)
    v_mfma_f32_16x16x32_bf16 v[104:107], v[56:59], v[168:171], v[104:107]
    v_mfma_f32_16x16x32_bf16 v[108:111], v[60:63], v[168:171], v[108:111]
    v_add_f32 v116, v12, v20
    v_add_f32 v117, v13, v21
    s_waitcnt lgkmcnt(0)
    v_mfma_f32_16x16x32_bf16 v[104:107], v[64:67], v[172:175], v[104:107]
    v_mfma_f32_16x16x32_bf16 v[108:111], v[68:71], v[172:175], v[108:111]
    v_add_f32 v118, v14, v22
    v_add_f32 v119, v15, v23
    ds_read_b64_tr_b16 v[72:73], v136 offset:24576
    ds_read_b64_tr_b16 v[74:75], v136 offset:25088
    ds_read_b64_tr_b16 v[76:77], v136 offset:28672
    ds_read_b64_tr_b16 v[78:79], v136 offset:29184
    ds_read_b64_tr_b16 v[80:81], v137 offset:24576
    ds_read_b64_tr_b16 v[82:83], v137 offset:25088
    ds_read_b64_tr_b16 v[84:85], v137 offset:28672
    ds_read_b64_tr_b16 v[86:87], v137 offset:29184
    ds_read_b64_tr_b16 v[88:89], v138 offset:24576
    ds_read_b64_tr_b16 v[90:91], v138 offset:25088
    ds_read_b64_tr_b16 v[92:93], v138 offset:28672
    ds_read_b64_tr_b16 v[94:95], v138 offset:29184
    ds_read_b64_tr_b16 v[96:97], v139 offset:24576
    ds_read_b64_tr_b16 v[98:99], v139 offset:25088
    ds_read_b64_tr_b16 v[100:101], v139 offset:28672
    ds_read_b64_tr_b16 v[102:103], v139 offset:29184
    s_cmp_le_u32 s47, 0
    s_cbranch_scc1 P_MJ
    s_lshr_b32 s56, s70, 1
    s_lshr_b32 s59, s56, 2
    s_mul_i32 s71, s56, 800
    s_mul_i32 s59, s59, 816000
    s_add_u32 s71, s71, s59
    buffer_load_dwordx4 v[180:183], v179, s[24:27], s71 offen offset:0 nt
    s_cmp_le_u32 s47, 1
    s_cbranch_scc1 P_MJ
    s_lshr_b32 s56, s70, 1
    s_add_u32 s56, s56, 1
    s_lshr_b32 s59, s56, 2
    s_mul_i32 s71, s56, 800
    s_mul_i32 s59, s59, 816000
    s_add_u32 s71, s71, s59
    buffer_load_dwordx4 v[184:187], v179, s[24:27], s71 offen offset:0 nt
    s_cmp_le_u32 s47, 2
    s_cbranch_scc1 P_MJ
    s_lshr_b32 s56, s70, 1
    s_add_u32 s56, s56, 2
    s_lshr_b32 s59, s56, 2
    s_mul_i32 s71, s56, 800
    s_mul_i32 s59, s59, 816000
    s_add_u32 s71, s71, s59
    buffer_load_dwordx4 v[188:191], v179, s[24:27], s71 offen offset:0 nt
    s_cmp_le_u32 s47, 3
    s_cbranch_scc1 P_MJ
    s_lshr_b32 s56, s70, 1
    s_add_u32 s56, s56, 3
    s_lshr_b32 s59, s56, 2
    s_mul_i32 s71, s56, 800
    s_mul_i32 s59, s59, 816000
    s_add_u32 s71, s71, s59
    buffer_load_dwordx4 v[192:195], v179, s[24:27], s71 offen offset:0 nt
    s_cmp_le_u32 s47, 4
    s_cbranch_scc1 P_MJ
    s_lshr_b32 s56, s70, 1
    s_add_u32 s56, s56, 4
    s_lshr_b32 s59, s56, 2
    s_mul_i32 s71, s56, 800
    s_mul_i32 s59, s59, 816000
    s_add_u32 s71, s71, s59
    buffer_load_dwordx4 v[196:199], v179, s[24:27], s71 offen offset:0 nt
    s_cmp_le_u32 s47, 5
    s_cbranch_scc1 P_MJ
    s_lshr_b32 s56, s70, 1
    s_add_u32 s56, s56, 5
    s_lshr_b32 s59, s56, 2
    s_mul_i32 s71, s56, 800
    s_mul_i32 s59, s59, 816000
    s_add_u32 s71, s71, s59
    buffer_load_dwordx4 v[200:203], v179, s[24:27], s71 offen offset:0 nt
P_MJ:
    v_mul_f32 v112, s60, v112
    v_mul_f32 v113, s60, v113
    v_mul_f32 v114, s60, v114
    v_mul_f32 v115, s60, v115
    v_mul_f32 v116, s60, v116
    v_mul_f32 v117, s60, v117
    v_mul_f32 v118, s60, v118
    v_mul_f32 v119, s60, v119
    ds_write_b128 v151, v[112:115] offset:0
    ds_write_b128 v151, v[116:119] offset:1024
    v_mul_f32 v104, s60, v104
    v_mul_f32 v105, s60, v105
    v_mul_f32 v106, s60, v106
    v_mul_f32 v107, s60, v107
    v_mul_f32 v108, s60, v108
    v_mul_f32 v109, s60, v109
    v_mul_f32 v110, s60, v110
    v_mul_f32 v111, s60, v111
    ds_write_b128 v145, v[104:107] offset:256
    ds_write_b128 v145, v[108:111] offset:320
    ds_write_b128 v3, v[24:27] offset:0
    ds_write_b128 v3, v[28:31] offset:16
    ds_read_b128 v[120:123], v252 offset:16384
    ds_read_b128 v[124:127], v252 offset:16448
    ds_read_b128 v[128:131], v252 offset:16512
    ds_read_b128 v[132:135], v252 offset:16576
    ds_read_b32 v150, v252 offset:17604
    s_lshl2_add_u32 s56, s48, 17184
    v_mov_b32 v253, s56
    v_mov_b32 v254, s74
    ds_write_b32 v253, v254
    v_ldexp_f32 v2, s63, 38
    v_add_u32 v250, 133376, v250
    v_mov_b64 v[168:169], 0
    v_mov_b64 v[170:171], 0
    v_mov_b64 v[172:173], 0
    v_mov_b64 v[174:175], 0
    v_readfirstlane_b32 s44, v2
    s_waitcnt lgkmcnt(15)
    v_lshlrev_b32 v8, 16, v72
    v_and_b32 v9, 0xffff0000, v72
    v_lshlrev_b32 v10, 16, v73
    v_and_b32 v11, 0xffff0000, v73
    v_lshlrev_b32 v12, 16, v74
    v_and_b32 v13, 0xffff0000, v74
    v_lshlrev_b32 v14, 16, v75
    v_and_b32 v15, 0xffff0000, v75
    v_lshlrev_b32 v16, 16, v76
    v_and_b32 v17, 0xffff0000, v76
    v_lshlrev_b32 v18, 16, v77
    v_and_b32 v19, 0xffff0000, v77
    v_lshlrev_b32 v20, 16, v78
    v_and_b32 v21, 0xffff0000, v78
    v_lshlrev_b32 v22, 16, v79
    v_and_b32 v23, 0xffff0000, v79
    v_lshlrev_b32 v24, 16, v80
    v_and_b32 v25, 0xffff0000, v80
    v_lshlrev_b32 v26, 16, v81
    v_and_b32 v27, 0xffff0000, v81
    v_lshlrev_b32 v28, 16, v82
    v_and_b32 v29, 0xffff0000, v82
    v_lshlrev_b32 v30, 16, v83
    v_and_b32 v31, 0xffff0000, v83
    v_lshlrev_b32 v32, 16, v84
    v_and_b32 v33, 0xffff0000, v84
    v_lshlrev_b32 v34, 16, v85
    v_and_b32 v35, 0xffff0000, v85
    v_lshlrev_b32 v36, 16, v86
    v_and_b32 v37, 0xffff0000, v86
    v_lshlrev_b32 v38, 16, v87
    v_and_b32 v39, 0xffff0000, v87
    ds_read_u8 v238, v246 offset:32
    ds_read_u8 v240, v246 offset:40
    s_add_u32 m0, s54, 4096
    v_add_u32 v246, 32, v246
    s_mov_b64 s[68:69], 0
    s_mov_b32 s75, 0
    s_movk_i32 s53, 0x1040
    s_mov_b32 s73, 3
    s_mov_b32 s77, 0
    s_mov_b32 s55, 0
    v_mov_b64 v[0:1], 0
    v_mov_b32 v2, 1.0
    v_mov_b32 v3, 1.0
    s_waitcnt lgkmcnt(0)
    s_barrier
    v_readfirstlane_b32 s45, v150
    buffer_load_dwordx4 v[238:239], s[20:23], s72 idxen offen nt lds
    buffer_load_dwordx4 v[240:241], s[20:23], s51 idxen offen offset:1024 nt lds
    s_cmp_eq_u32 s47, 0
    s_cbranch_scc1 P_GO
    s_lshl_b32 s56, s70, 8
    s_add_u32 s56, s56, 116992
    s_waitcnt vmcnt(2)
    v_mov_b64 v[204:205], v[180:181]
    v_mov_b64 v[206:207], v[182:183]
    s_call_b64 s[36:37], CMP
    v_writelane_b32 v212, s57, 0
    v_writelane_b32 v212, s58, 1
    s_cmp_le_u32 s47, 1
    s_cbranch_scc1 LATE_D
    s_add_u32 s56, s56, 512
    v_mov_b64 v[204:205], v[184:185]
    v_mov_b64 v[206:207], v[186:187]
    s_call_b64 s[36:37], CMP
    v_writelane_b32 v212, s57, 2
    v_writelane_b32 v212, s58, 3
    s_cmp_le_u32 s47, 2
    s_cbranch_scc1 LATE_D
    s_add_u32 s56, s56, 512
    v_mov_b64 v[204:205], v[188:189]
    v_mov_b64 v[206:207], v[190:191]
    s_call_b64 s[36:37], CMP
    v_writelane_b32 v212, s57, 4
    v_writelane_b32 v212, s58, 5
    s_cmp_le_u32 s47, 3
    s_cbranch_scc1 LATE_D
    s_add_u32 s56, s56, 512
    v_mov_b64 v[204:205], v[192:193]
    v_mov_b64 v[206:207], v[194:195]
    s_call_b64 s[36:37], CMP
    v_writelane_b32 v212, s57, 6
    v_writelane_b32 v212, s58, 7
    s_cmp_le_u32 s47, 4
    s_cbranch_scc1 LATE_D
    s_add_u32 s56, s56, 512
    v_mov_b64 v[204:205], v[196:197]
    v_mov_b64 v[206:207], v[198:199]
    s_call_b64 s[36:37], CMP
    v_writelane_b32 v212, s57, 8
    v_writelane_b32 v212, s58, 9
    s_cmp_le_u32 s47, 5
    s_cbranch_scc1 LATE_D
    s_add_u32 s56, s56, 512
    v_mov_b64 v[204:205], v[200:201]
    v_mov_b64 v[206:207], v[202:203]
    s_call_b64 s[36:37], CMP
    v_writelane_b32 v212, s57, 10
    v_writelane_b32 v212, s58, 11
LATE_D:
    v_add_u32 v4, s70, v176
    s_lshl_b32 s56, s47, 1
    v_and_b32 v5, 0xff, v212
    v_add_u32 v5, 15, v5
    v_lshrrev_b32 v212, 8, v212
    v_and_b32 v6, 15, v5
    v_lshl_or_b32 v212, v6, 12, v212
    v_lshrrev_b32 v5, 4, v5
    v_max_u32 v5, 2, v5
    v_or_b32 v212, v212, v4
    v_cmp_gt_u32 vcc, 64, v4
    v_lshl_or_b32 v6, v5, 8, v212
    v_lshlrev_b32 v4, 2, v4
    s_bfm_b64 s[66:67], s56, 0
    s_and_b64 exec, s[66:67], vcc
    ds_write_b32 v4, v6 offset:17152
    s_mov_b64 exec, -1
P_GO:
    ds_read_b128 v[180:183], v251 offset:0
    ds_read_b128 v[184:187], v251 offset:1024
    ds_read_b128 v[196:199], v251 offset:4096
    ds_read_b128 v[200:203], v251 offset:5120
    ds_read_b128 v[212:215], v251 offset:8192
    ds_read_b128 v[216:219], v251 offset:9216
    ds_read_b128 v[188:191], v251 offset:2048
    ds_read_b128 v[192:195], v251 offset:3072
    ds_read_b128 v[204:207], v251 offset:6144
    ds_read_b128 v[208:211], v251 offset:7168
    ds_read_b128 v[220:223], v251 offset:10240
    ds_read_b128 v[224:227], v251 offset:11264
    ds_read_b128 v[228:231], v251 offset:14336
    ds_read_b128 v[232:235], v251 offset:15360
    v_lshlrev_b32 v40, 16, v88
    v_and_b32 v41, 0xffff0000, v88
    v_lshlrev_b32 v42, 16, v89
    v_and_b32 v43, 0xffff0000, v89
    v_lshlrev_b32 v44, 16, v90
    v_and_b32 v45, 0xffff0000, v90
    v_lshlrev_b32 v46, 16, v91
    v_and_b32 v47, 0xffff0000, v91
    v_lshlrev_b32 v48, 16, v92
    v_and_b32 v49, 0xffff0000, v92
    v_lshlrev_b32 v50, 16, v93
    v_and_b32 v51, 0xffff0000, v93
    v_lshlrev_b32 v52, 16, v94
    v_and_b32 v53, 0xffff0000, v94
    v_lshlrev_b32 v54, 16, v95
    v_and_b32 v55, 0xffff0000, v95
    v_lshlrev_b32 v56, 16, v96
    v_and_b32 v57, 0xffff0000, v96
    v_lshlrev_b32 v58, 16, v97
    v_and_b32 v59, 0xffff0000, v97
    v_lshlrev_b32 v60, 16, v98
    v_and_b32 v61, 0xffff0000, v98
    v_lshlrev_b32 v62, 16, v99
    v_and_b32 v63, 0xffff0000, v99
    v_lshlrev_b32 v64, 16, v100
    v_and_b32 v65, 0xffff0000, v100
    v_lshlrev_b32 v66, 16, v101
    v_and_b32 v67, 0xffff0000, v101
    v_lshlrev_b32 v68, 16, v102
    v_and_b32 v69, 0xffff0000, v102
    v_lshlrev_b32 v70, 16, v103
    v_and_b32 v71, 0xffff0000, v103
    v_mov_b64 v[176:177], 0
    v_mov_b64 v[178:179], 0
    s_sub_u32 s50, s50, 2
    s_cbranch_scc1 DRAW_P
DRET_P:
    s_waitcnt vmcnt(4)
    ds_read_b128 v[152:155], v242
    ds_read_b128 v[156:159], v243
    s_branch BPF
U_0:
    v_mfma_f32_16x16x32_bf16 v[104:107], v[72:75], v[152:155], v[136:139]
    s_add_u32 m0, s54, 6144
    v_rcp_f32 v2, v2
    v_mfma_f32_16x16x32_bf16 v[104:107], v[76:79], v[156:159], v[104:107]
    s_mov_b32 s73, 0
    v_rcp_f32 v3, v3
    v_mfma_f32_16x16x32_bf16 v[108:111], v[80:83], v[152:155], v[140:143]
    s_sub_u32 s50, s50, 1
    v_fma_f32 v0, v0, v2, s44
    v_fmac_f32 v0, v1, v3
    v_mfma_f32_16x16x32_bf16 v[108:111], v[84:87], v[156:159], v[108:111]
    s_cbranch_scc1 PEV
    v_add_u32 v246, 16, v246
RET_0:
    v_cvt_pk_bf16_f32 v0, v0, v0
    v_mfma_f32_16x16x32_bf16 v[112:115], v[88:91], v[152:155], v[144:147]
    v_exp_f32 v104, v104
    v_mfma_f32_16x16x32_bf16 v[112:115], v[92:95], v[156:159], v[112:115]
    v_exp_f32 v105, v105
    v_mfma_f32_16x16x32_bf16 v[116:119], v[96:99], v[152:155], v[148:151]
    s_sub_u32 s62, s62, 1
    v_exp_f32 v106, v106
    v_mfma_f32_16x16x32_bf16 v[116:119], v[100:103], v[156:159], v[116:119]
    s_waitcnt vmcnt(2)
    v_exp_f32 v107, v107
    ds_write_b16 v249, v0
    ds_read_b64 v[236:237], v248
    ds_read_b64_tr_b16 v[160:161], v244 offset:0
    ds_read_b64_tr_b16 v[162:163], v245 offset:512
    ds_read_b64_tr_b16 v[164:165], v244 offset:1024
    ds_read_b64_tr_b16 v[166:167], v245 offset:1536
    ds_read_u8 v238, v246 offset:0
    ds_read_u8 v240, v246 offset:8
    ds_read_b128 v[152:155], v242 offset:2048
    ds_read_b128 v[156:159], v243 offset:2048
    v_exp_f32 v108, v108
    v_exp_f32 v109, v109
    v_exp_f32 v110, v110
    v_exp_f32 v111, v111
    s_waitcnt lgkmcnt(8)
    v_mfma_f32_4x4x4_16b_bf16 v[176:179], v[236:237], v[168:169], v[176:179] cbsz:4 abid:0
    v_exp_f32 v112, v112
    v_exp_f32 v113, v113
    v_mfma_f32_4x4x4_16b_bf16 v[176:179], v[236:237], v[170:171], v[176:179] cbsz:4 abid:1
    v_exp_f32 v114, v114
    v_exp_f32 v115, v115
    v_mfma_f32_4x4x4_16b_bf16 v[176:179], v[236:237], v[172:173], v[176:179] cbsz:4 abid:2
    v_exp_f32 v116, v116
    v_exp_f32 v117, v117
    v_mfma_f32_4x4x4_16b_bf16 v[176:179], v[236:237], v[174:175], v[176:179] cbsz:4 abid:3
    v_exp_f32 v118, v118
    v_exp_f32 v119, v119
    s_waitcnt lgkmcnt(0)
    buffer_load_dwordx4 v[238:239], s[20:23], s72 idxen offen nt lds
    buffer_load_dwordx4 v[240:241], s[20:23], s51 idxen offen offset:1024 nt lds
    s_cselect_b64 exec, s[78:79], -1
    .p2align 3
    v_pk_fma_f32 v[2:3], v[104:105], s[42:43], s[42:43] op_sel_hi:[1,0,0]
    v_pk_fma_f32 v[0:1], v[120:121], v[106:107], v[120:121]
    v_pk_fma_f32 v[0:1], v[122:123], v[2:3], v[0:1]
    v_pk_fma_f32 v[2:3], v[106:107], v[2:3], v[2:3]
    v_pk_fma_f32 v[0:1], v[108:109], v[0:1], v[0:1]
    v_pk_fma_f32 v[0:1], v[124:125], v[2:3], v[0:1]
    v_pk_fma_f32 v[2:3], v[108:109], v[2:3], v[2:3]
    v_pk_fma_f32 v[0:1], v[110:111], v[0:1], v[0:1]
    v_pk_fma_f32 v[0:1], v[126:127], v[2:3], v[0:1]
    v_pk_fma_f32 v[2:3], v[110:111], v[2:3], v[2:3]
    v_pk_fma_f32 v[0:1], v[112:113], v[0:1], v[0:1]
    v_pk_fma_f32 v[0:1], v[128:129], v[2:3], v[0:1]
    v_pk_fma_f32 v[2:3], v[112:113], v[2:3], v[2:3]
    v_pk_fma_f32 v[0:1], v[114:115], v[0:1], v[0:1]
    v_pk_fma_f32 v[0:1], v[130:131], v[2:3], v[0:1]
    v_pk_fma_f32 v[2:3], v[114:115], v[2:3], v[2:3]
    v_pk_fma_f32 v[0:1], v[116:117], v[0:1], v[0:1]
    v_pk_fma_f32 v[0:1], v[132:133], v[2:3], v[0:1]
    v_pk_fma_f32 v[2:3], v[116:117], v[2:3], v[2:3]
    v_pk_fma_f32 v[0:1], v[118:119], v[0:1], v[0:1]
    v_pk_fma_f32 v[0:1], v[134:135], v[2:3], v[0:1]
    v_pk_fma_f32 v[2:3], v[118:119], v[2:3], v[2:3]
    s_mov_b64 exec, -1
    s_cbranch_scc1 CEV
U_1:
    v_mfma_f32_16x16x32_bf16 v[104:107], v[72:75], v[152:155], v[136:139]
    s_add_u32 m0, s54, 0
    v_rcp_f32 v2, v2
    v_mfma_f32_16x16x32_bf16 v[104:107], v[76:79], v[156:159], v[104:107]
    s_mov_b32 s73, 1
    v_rcp_f32 v3, v3
    v_mfma_f32_16x16x32_bf16 v[108:111], v[80:83], v[152:155], v[140:143]
    s_sub_u32 s50, s50, 1
    v_fma_f32 v0, v0, v2, s44
    v_fmac_f32 v0, v1, v3
    v_mfma_f32_16x16x32_bf16 v[108:111], v[84:87], v[156:159], v[108:111]
    s_cbranch_scc1 PEV
    v_add_u32 v246, 16, v246
RET_1:
    v_cvt_pk_bf16_f32 v0, v0, v0
    v_mfma_f32_16x16x32_bf16 v[112:115], v[88:91], v[152:155], v[144:147]
    v_exp_f32 v104, v104
    v_mfma_f32_16x16x32_bf16 v[112:115], v[92:95], v[156:159], v[112:115]
    v_exp_f32 v105, v105
    v_mfma_f32_16x16x32_bf16 v[116:119], v[96:99], v[152:155], v[148:151]
    s_sub_u32 s62, s62, 1
    v_exp_f32 v106, v106
    v_mfma_f32_16x16x32_bf16 v[116:119], v[100:103], v[156:159], v[116:119]
    s_waitcnt vmcnt(2)
    v_exp_f32 v107, v107
    ds_write_b16 v249, v0
    ds_read_b64 v[236:237], v248
    ds_read_b64_tr_b16 v[168:169], v244 offset:2048
    ds_read_b64_tr_b16 v[170:171], v245 offset:2560
    ds_read_b64_tr_b16 v[172:173], v244 offset:3072
    ds_read_b64_tr_b16 v[174:175], v245 offset:3584
    ds_read_u8 v238, v246 offset:0
    ds_read_u8 v240, v246 offset:8
    ds_read_b128 v[152:155], v242 offset:4096
    ds_read_b128 v[156:159], v243 offset:4096
    v_exp_f32 v108, v108
    v_exp_f32 v109, v109
    v_exp_f32 v110, v110
    v_exp_f32 v111, v111
    s_waitcnt lgkmcnt(8)
    v_mfma_f32_4x4x4_16b_bf16 v[176:179], v[236:237], v[160:161], v[176:179] cbsz:4 abid:0
    v_exp_f32 v112, v112
    v_exp_f32 v113, v113
    v_mfma_f32_4x4x4_16b_bf16 v[176:179], v[236:237], v[162:163], v[176:179] cbsz:4 abid:1
    v_exp_f32 v114, v114
    v_exp_f32 v115, v115
    v_mfma_f32_4x4x4_16b_bf16 v[176:179], v[236:237], v[164:165], v[176:179] cbsz:4 abid:2
    v_exp_f32 v116, v116
    v_exp_f32 v117, v117
    v_mfma_f32_4x4x4_16b_bf16 v[176:179], v[236:237], v[166:167], v[176:179] cbsz:4 abid:3
    v_exp_f32 v118, v118
    v_exp_f32 v119, v119
    s_waitcnt lgkmcnt(0)
    buffer_load_dwordx4 v[238:239], s[20:23], s72 idxen offen nt lds
    buffer_load_dwordx4 v[240:241], s[20:23], s51 idxen offen offset:1024 nt lds
    s_cselect_b64 exec, s[78:79], -1
    .p2align 3
    v_pk_fma_f32 v[2:3], v[104:105], s[42:43], s[42:43] op_sel_hi:[1,0,0]
    v_pk_fma_f32 v[0:1], v[120:121], v[106:107], v[120:121]
    v_pk_fma_f32 v[0:1], v[122:123], v[2:3], v[0:1]
    v_pk_fma_f32 v[2:3], v[106:107], v[2:3], v[2:3]
    v_pk_fma_f32 v[0:1], v[108:109], v[0:1], v[0:1]
    v_pk_fma_f32 v[0:1], v[124:125], v[2:3], v[0:1]
    v_pk_fma_f32 v[2:3], v[108:109], v[2:3], v[2:3]
    v_pk_fma_f32 v[0:1], v[110:111], v[0:1], v[0:1]
    v_pk_fma_f32 v[0:1], v[126:127], v[2:3], v[0:1]
    v_pk_fma_f32 v[2:3], v[110:111], v[2:3], v[2:3]
    v_pk_fma_f32 v[0:1], v[112:113], v[0:1], v[0:1]
    v_pk_fma_f32 v[0:1], v[128:129], v[2:3], v[0:1]
    v_pk_fma_f32 v[2:3], v[112:113], v[2:3], v[2:3]
    v_pk_fma_f32 v[0:1], v[114:115], v[0:1], v[0:1]
    v_pk_fma_f32 v[0:1], v[130:131], v[2:3], v[0:1]
    v_pk_fma_f32 v[2:3], v[114:115], v[2:3], v[2:3]
    v_pk_fma_f32 v[0:1], v[116:117], v[0:1], v[0:1]
    v_pk_fma_f32 v[0:1], v[132:133], v[2:3], v[0:1]
    v_pk_fma_f32 v[2:3], v[116:117], v[2:3], v[2:3]
    v_pk_fma_f32 v[0:1], v[118:119], v[0:1], v[0:1]
    v_pk_fma_f32 v[0:1], v[134:135], v[2:3], v[0:1]
    v_pk_fma_f32 v[2:3], v[118:119], v[2:3], v[2:3]
    s_mov_b64 exec, -1
    s_cbranch_scc1 CEV
U_2:
    v_mfma_f32_16x16x32_bf16 v[104:107], v[72:75], v[152:155], v[136:139]
    s_add_u32 m0, s54, 2048
    v_rcp_f32 v2, v2
    v_mfma_f32_16x16x32_bf16 v[104:107], v[76:79], v[156:159], v[104:107]
    s_mov_b32 s73, 2
    v_rcp_f32 v3, v3
    v_mfma_f32_16x16x32_bf16 v[108:111], v[80:83], v[152:155], v[140:143]
    s_sub_u32 s50, s50, 1
    v_fma_f32 v0, v0, v2, s44
    v_fmac_f32 v0, v1, v3
    v_mfma_f32_16x16x32_bf16 v[108:111], v[84:87], v[156:159], v[108:111]
    s_cbranch_scc1 PEV
    v_add_u32 v246, 16, v246
RET_2:
    v_cvt_pk_bf16_f32 v0, v0, v0
    v_mfma_f32_16x16x32_bf16 v[112:115], v[88:91], v[152:155], v[144:147]
    v_exp_f32 v104, v104
    v_mfma_f32_16x16x32_bf16 v[112:115], v[92:95], v[156:159], v[112:115]
    v_exp_f32 v105, v105
    v_mfma_f32_16x16x32_bf16 v[116:119], v[96:99], v[152:155], v[148:151]
    s_sub_u32 s62, s62, 1
    v_exp_f32 v106, v106
    v_mfma_f32_16x16x32_bf16 v[116:119], v[100:103], v[156:159], v[116:119]
    s_waitcnt vmcnt(2)
    v_exp_f32 v107, v107
    ds_write_b16 v249, v0
    ds_read_b64 v[236:237], v248
    ds_read_b64_tr_b16 v[160:161], v244 offset:4096
    ds_read_b64_tr_b16 v[162:163], v245 offset:4608
    ds_read_b64_tr_b16 v[164:165], v244 offset:5120
    ds_read_b64_tr_b16 v[166:167], v245 offset:5632
    ds_read_u8 v238, v246 offset:0
    ds_read_u8 v240, v246 offset:8
    ds_read_b128 v[152:155], v242 offset:6144
    ds_read_b128 v[156:159], v243 offset:6144
    v_exp_f32 v108, v108
    v_exp_f32 v109, v109
    v_exp_f32 v110, v110
    v_exp_f32 v111, v111
    s_waitcnt lgkmcnt(8)
    v_mfma_f32_4x4x4_16b_bf16 v[176:179], v[236:237], v[168:169], v[176:179] cbsz:4 abid:0
    v_exp_f32 v112, v112
    v_exp_f32 v113, v113
    v_mfma_f32_4x4x4_16b_bf16 v[176:179], v[236:237], v[170:171], v[176:179] cbsz:4 abid:1
    v_exp_f32 v114, v114
    v_exp_f32 v115, v115
    v_mfma_f32_4x4x4_16b_bf16 v[176:179], v[236:237], v[172:173], v[176:179] cbsz:4 abid:2
    v_exp_f32 v116, v116
    v_exp_f32 v117, v117
    v_mfma_f32_4x4x4_16b_bf16 v[176:179], v[236:237], v[174:175], v[176:179] cbsz:4 abid:3
    v_exp_f32 v118, v118
    v_exp_f32 v119, v119
    s_waitcnt lgkmcnt(0)
    buffer_load_dwordx4 v[238:239], s[20:23], s72 idxen offen nt lds
    buffer_load_dwordx4 v[240:241], s[20:23], s51 idxen offen offset:1024 nt lds
    s_cselect_b64 exec, s[78:79], -1
    .p2align 3
    v_pk_fma_f32 v[2:3], v[104:105], s[42:43], s[42:43] op_sel_hi:[1,0,0]
    v_pk_fma_f32 v[0:1], v[120:121], v[106:107], v[120:121]
    v_pk_fma_f32 v[0:1], v[122:123], v[2:3], v[0:1]
    v_pk_fma_f32 v[2:3], v[106:107], v[2:3], v[2:3]
    v_pk_fma_f32 v[0:1], v[108:109], v[0:1], v[0:1]
    v_pk_fma_f32 v[0:1], v[124:125], v[2:3], v[0:1]
    v_pk_fma_f32 v[2:3], v[108:109], v[2:3], v[2:3]
    v_pk_fma_f32 v[0:1], v[110:111], v[0:1], v[0:1]
    v_pk_fma_f32 v[0:1], v[126:127], v[2:3], v[0:1]
    v_pk_fma_f32 v[2:3], v[110:111], v[2:3], v[2:3]
    v_pk_fma_f32 v[0:1], v[112:113], v[0:1], v[0:1]
    v_pk_fma_f32 v[0:1], v[128:129], v[2:3], v[0:1]
    v_pk_fma_f32 v[2:3], v[112:113], v[2:3], v[2:3]
    v_pk_fma_f32 v[0:1], v[114:115], v[0:1], v[0:1]
    v_pk_fma_f32 v[0:1], v[130:131], v[2:3], v[0:1]
    v_pk_fma_f32 v[2:3], v[114:115], v[2:3], v[2:3]
    v_pk_fma_f32 v[0:1], v[116:117], v[0:1], v[0:1]
    v_pk_fma_f32 v[0:1], v[132:133], v[2:3], v[0:1]
    v_pk_fma_f32 v[2:3], v[116:117], v[2:3], v[2:3]
    v_pk_fma_f32 v[0:1], v[118:119], v[0:1], v[0:1]
    v_pk_fma_f32 v[0:1], v[134:135], v[2:3], v[0:1]
    v_pk_fma_f32 v[2:3], v[118:119], v[2:3], v[2:3]
    s_mov_b64 exec, -1
    s_cbranch_scc1 CEV
U_3:
    v_mfma_f32_16x16x32_bf16 v[104:107], v[72:75], v[152:155], v[136:139]
    s_add_u32 m0, s54, 4096
    v_rcp_f32 v2, v2
    v_mfma_f32_16x16x32_bf16 v[104:107], v[76:79], v[156:159], v[104:107]
    s_mov_b32 s73, 3
    v_rcp_f32 v3, v3
    v_mfma_f32_16x16x32_bf16 v[108:111], v[80:83], v[152:155], v[140:143]
    s_sub_u32 s50, s50, 1
    v_fma_f32 v0, v0, v2, s44
    v_fmac_f32 v0, v1, v3
    v_mfma_f32_16x16x32_bf16 v[108:111], v[84:87], v[156:159], v[108:111]
    s_cbranch_scc1 PEV
    v_add_u32 v246, 16, v246
RET_3:
    v_cvt_pk_bf16_f32 v0, v0, v0
    v_mfma_f32_16x16x32_bf16 v[112:115], v[88:91], v[152:155], v[144:147]
    v_exp_f32 v104, v104
    v_mfma_f32_16x16x32_bf16 v[112:115], v[92:95], v[156:159], v[112:115]
    v_exp_f32 v105, v105
    v_mfma_f32_16x16x32_bf16 v[116:119], v[96:99], v[152:155], v[148:151]
    s_sub_u32 s62, s62, 1
    v_exp_f32 v106, v106
    v_mfma_f32_16x16x32_bf16 v[116:119], v[100:103], v[156:159], v[116:119]
    s_waitcnt vmcnt(2)
    v_exp_f32 v107, v107
    ds_write_b16 v249, v0
    ds_read_b64 v[236:237], v248
    ds_read_b64_tr_b16 v[168:169], v244 offset:6144
    ds_read_b64_tr_b16 v[170:171], v245 offset:6656
    ds_read_b64_tr_b16 v[172:173], v244 offset:7168
    ds_read_b64_tr_b16 v[174:175], v245 offset:7680
    ds_read_u8 v238, v246 offset:0
    ds_read_u8 v240, v246 offset:8
    ds_read_b128 v[152:155], v242 offset:0
    ds_read_b128 v[156:159], v243 offset:0
    v_exp_f32 v108, v108
    v_exp_f32 v109, v109
    v_exp_f32 v110, v110
    v_exp_f32 v111, v111
    s_waitcnt lgkmcnt(8)
    v_mfma_f32_4x4x4_16b_bf16 v[176:179], v[236:237], v[160:161], v[176:179] cbsz:4 abid:0
    v_exp_f32 v112, v112
    v_exp_f32 v113, v113
    v_mfma_f32_4x4x4_16b_bf16 v[176:179], v[236:237], v[162:163], v[176:179] cbsz:4 abid:1
    v_exp_f32 v114, v114
    v_exp_f32 v115, v115
    v_mfma_f32_4x4x4_16b_bf16 v[176:179], v[236:237], v[164:165], v[176:179] cbsz:4 abid:2
    v_exp_f32 v116, v116
    v_exp_f32 v117, v117
    v_mfma_f32_4x4x4_16b_bf16 v[176:179], v[236:237], v[166:167], v[176:179] cbsz:4 abid:3
    v_exp_f32 v118, v118
    v_exp_f32 v119, v119
    s_waitcnt lgkmcnt(0)
    buffer_load_dwordx4 v[238:239], s[20:23], s72 idxen offen nt lds
    buffer_load_dwordx4 v[240:241], s[20:23], s51 idxen offen offset:1024 nt lds
    s_cselect_b64 exec, s[78:79], -1
    .p2align 3
    v_pk_fma_f32 v[2:3], v[104:105], s[42:43], s[42:43] op_sel_hi:[1,0,0]
    v_pk_fma_f32 v[0:1], v[120:121], v[106:107], v[120:121]
    v_pk_fma_f32 v[0:1], v[122:123], v[2:3], v[0:1]
    v_pk_fma_f32 v[2:3], v[106:107], v[2:3], v[2:3]
    v_pk_fma_f32 v[0:1], v[108:109], v[0:1], v[0:1]
    v_pk_fma_f32 v[0:1], v[124:125], v[2:3], v[0:1]
    v_pk_fma_f32 v[2:3], v[108:109], v[2:3], v[2:3]
    v_pk_fma_f32 v[0:1], v[110:111], v[0:1], v[0:1]
    v_pk_fma_f32 v[0:1], v[126:127], v[2:3], v[0:1]
    v_pk_fma_f32 v[2:3], v[110:111], v[2:3], v[2:3]
    v_pk_fma_f32 v[0:1], v[112:113], v[0:1], v[0:1]
    v_pk_fma_f32 v[0:1], v[128:129], v[2:3], v[0:1]
    v_pk_fma_f32 v[2:3], v[112:113], v[2:3], v[2:3]
    v_pk_fma_f32 v[0:1], v[114:115], v[0:1], v[0:1]
    v_pk_fma_f32 v[0:1], v[130:131], v[2:3], v[0:1]
    v_pk_fma_f32 v[2:3], v[114:115], v[2:3], v[2:3]
    v_pk_fma_f32 v[0:1], v[116:117], v[0:1], v[0:1]
    v_pk_fma_f32 v[0:1], v[132:133], v[2:3], v[0:1]
    v_pk_fma_f32 v[2:3], v[116:117], v[2:3], v[2:3]
    v_pk_fma_f32 v[0:1], v[118:119], v[0:1], v[0:1]
    v_pk_fma_f32 v[0:1], v[134:135], v[2:3], v[0:1]
    v_pk_fma_f32 v[2:3], v[118:119], v[2:3], v[2:3]
    s_mov_b64 exec, -1
    s_cbranch_scc0 U_0
CEV:
    s_cmp_eq_u32 s76, 0
    s_cbranch_scc1 EPI
    s_mov_b32 s53, s52
    s_and_b32 s52, s68, 0xffff
    s_lshr_b64 s[68:69], s[68:69], 16
    s_sub_u32 s75, s75, 16
    s_bitcmp1_b32 s52, 6
    s_cbranch_scc1 DRAIN
BPF:
    s_and_b32 s57, s52, 63
    s_mul_i32 s57, s57, 528
    s_add_u32 s57, s57, 83200
    v_lshl_add_u32 v6, v252, 1, s57
    v_add_u32 v7, s57, v252
    ds_read_b128 v[104:107], v6 offset:0
    ds_read_b128 v[108:111], v6 offset:16
    ds_read_b128 v[144:147], v251 offset:12288
    ds_read_b128 v[148:151], v251 offset:13312
    ds_read_b128 v[112:115], v6 offset:128
    ds_read_b128 v[116:119], v6 offset:144
    s_mov_b32 s62, 0
    s_mov_b32 s76, 0
    s_mov_b64 s[78:79], -1
    s_cmp_lg_u32 s77, 0
    s_waitcnt lgkmcnt(4)
    .p2align 3
    v_pk_fma_f32 v[136:137], v[8:9], v[104:105], v[180:181]
    v_pk_fma_f32 v[138:139], v[10:11], v[106:107], v[182:183]
    v_pk_fma_f32 v[140:141], v[12:13], v[108:109], v[184:185]
    v_pk_fma_f32 v[142:143], v[14:15], v[110:111], v[186:187]
    v_cvt_pk_bf16_f32 v72, v136, v137
    v_cvt_pk_bf16_f32 v73, v138, v139
    v_cvt_pk_bf16_f32 v74, v140, v141
    v_cvt_pk_bf16_f32 v75, v142, v143
    v_pk_fma_f32 v[136:137], v[24:25], v[104:105], v[196:197]
    v_pk_fma_f32 v[138:139], v[26:27], v[106:107], v[198:199]
    v_pk_fma_f32 v[140:141], v[28:29], v[108:109], v[200:201]
    v_pk_fma_f32 v[142:143], v[30:31], v[110:111], v[202:203]
    v_cvt_pk_bf16_f32 v80, v136, v137
    v_cvt_pk_bf16_f32 v81, v138, v139
    v_cvt_pk_bf16_f32 v82, v140, v141
    v_cvt_pk_bf16_f32 v83, v142, v143
    v_pk_fma_f32 v[136:137], v[40:41], v[104:105], v[212:213]
    v_pk_fma_f32 v[138:139], v[42:43], v[106:107], v[214:215]
    v_pk_fma_f32 v[140:141], v[44:45], v[108:109], v[216:217]
    v_pk_fma_f32 v[142:143], v[46:47], v[110:111], v[218:219]
    v_cvt_pk_bf16_f32 v88, v136, v137
    v_cvt_pk_bf16_f32 v89, v138, v139
    v_cvt_pk_bf16_f32 v90, v140, v141
    v_cvt_pk_bf16_f32 v91, v142, v143
    s_waitcnt lgkmcnt(0)
    .p2align 3
    v_pk_fma_f32 v[144:145], v[56:57], v[104:105], v[144:145]
    v_pk_fma_f32 v[146:147], v[58:59], v[106:107], v[146:147]
    v_pk_fma_f32 v[148:149], v[60:61], v[108:109], v[148:149]
    v_pk_fma_f32 v[150:151], v[62:63], v[110:111], v[150:151]
    v_cvt_pk_bf16_f32 v96, v144, v145
    v_cvt_pk_bf16_f32 v97, v146, v147
    v_cvt_pk_bf16_f32 v98, v148, v149
    v_cvt_pk_bf16_f32 v99, v150, v151
    ds_read_b128 v[136:139], v7 offset:256
    ds_read_b128 v[140:143], v7 offset:320
    ds_read_b128 v[144:147], v7 offset:384
    ds_read_b128 v[148:151], v7 offset:448
    v_pk_fma_f32 v[104:105], v[16:17], v[112:113], v[188:189]
    v_pk_fma_f32 v[106:107], v[18:19], v[114:115], v[190:191]
    v_pk_fma_f32 v[108:109], v[20:21], v[116:117], v[192:193]
    v_pk_fma_f32 v[110:111], v[22:23], v[118:119], v[194:195]
    v_cvt_pk_bf16_f32 v76, v104, v105
    v_cvt_pk_bf16_f32 v77, v106, v107
    v_cvt_pk_bf16_f32 v78, v108, v109
    v_cvt_pk_bf16_f32 v79, v110, v111
    v_pk_fma_f32 v[104:105], v[32:33], v[112:113], v[204:205]
    v_pk_fma_f32 v[106:107], v[34:35], v[114:115], v[206:207]
    v_pk_fma_f32 v[108:109], v[36:37], v[116:117], v[208:209]
    v_pk_fma_f32 v[110:111], v[38:39], v[118:119], v[210:211]
    v_cvt_pk_bf16_f32 v84, v104, v105
    v_cvt_pk_bf16_f32 v85, v106, v107
    v_cvt_pk_bf16_f32 v86, v108, v109
    v_cvt_pk_bf16_f32 v87, v110, v111
    v_pk_fma_f32 v[104:105], v[48:49], v[112:113], v[220:221]
    v_pk_fma_f32 v[106:107], v[50:51], v[114:115], v[222:223]
    v_pk_fma_f32 v[108:109], v[52:53], v[116:117], v[224:225]
    v_pk_fma_f32 v[110:111], v[54:55], v[118:119], v[226:227]
    v_cvt_pk_bf16_f32 v92, v104, v105
    v_cvt_pk_bf16_f32 v93, v106, v107
    v_cvt_pk_bf16_f32 v94, v108, v109
    v_cvt_pk_bf16_f32 v95, v110, v111
    v_pk_fma_f32 v[104:105], v[64:65], v[112:113], v[228:229]
    v_pk_fma_f32 v[106:107], v[66:67], v[114:115], v[230:231]
    v_pk_fma_f32 v[108:109], v[68:69], v[116:117], v[232:233]
    v_pk_fma_f32 v[110:111], v[70:71], v[118:119], v[234:235]
    v_cvt_pk_bf16_f32 v100, v104, v105
    v_cvt_pk_bf16_f32 v101, v106, v107
    v_cvt_pk_bf16_f32 v102, v108, v109
    v_cvt_pk_bf16_f32 v103, v110, v111
    s_waitcnt lgkmcnt(0)
    s_cbranch_scc1 BP_X
NEXT:
    s_cmp_eq_u32 s73, 0
    s_cbranch_scc1 U_1
    s_cmp_eq_u32 s73, 1
    s_cbranch_scc1 U_2
    s_cmp_eq_u32 s73, 2
    s_cbranch_scc1 U_3
    s_branch U_0
EPI:
    s_and_b32 s56, s53, 0x7f
    v_pk_add_f32 v[4:5], v[176:177], v[178:179]
    v_add_f32 v4, v4, v5
    v_lshl_add_u32 v5, s56, 8, v250
    v_mul_f32 v4, s46, v4
    s_bitcmp1_b32 s53, 7
    v_cmp_class_f32_e64 vcc, v4, s45
    v_mov_b64 v[176:177], 0
    v_mov_b64 v[178:179], 0
    ds_write_b32 v5, v4
    s_cbranch_scc1 SLOW
    s_cbranch_vccnz SLOW
EPI_R:
    s_bitcmp1_b32 s52, 6
    s_cbranch_scc1 L_DONE
EPI_C:
    s_bfe_u32 s62, s52, 0x40008
    s_sub_u32 s62, s62, 2
    s_mov_b32 s76, 1
    s_lshr_b32 s56, s52, 12
    s_lshl_b32 s78, 0x20002, s56
    s_sub_u32 s78, s78, 0x10001
    s_mov_b32 s79, s78
    s_cmp_eq_u32 s73, 0
    s_cbranch_scc1 U_1
    s_cmp_eq_u32 s73, 1
    s_cbranch_scc1 U_2
    s_cmp_eq_u32 s73, 2
    s_cbranch_scc1 U_3
    s_branch U_0
PEV:
    s_cmp_eq_u32 s55, 0
    s_cbranch_scc1 P_DR
    ds_read_b32 v254, v253
    s_waitcnt lgkmcnt(0)
ADV:
    v_readfirstlane_b32 s66, v254
    s_mov_b32 s67, 0
    s_and_b32 s56, s66, 63
    s_bfe_u32 s50, s66, 0x40008
    s_cbranch_scc0 AW
    s_lshr_b32 s57, s56, 3
    s_mul_i32 s51, s56, 25600
    s_mul_i32 s57, s57, 52224000
    s_add_u32 s51, s51, s57
    v_lshl_add_u32 v246, s56, 8, v247
    s_add_u32 s51, s51, s49
    s_add_u32 s72, s51, 1024
    s_lshl_b64 s[64:65], s[66:67], s75
    s_or_b64 s[68:69], s[68:69], s[64:65]
    s_add_u32 s75, s75, 16
    s_mov_b32 s55, 0
    s_sub_u32 s50, s50, 3
    s_cbranch_scc1 P_2
P_RET:
    s_cmp_eq_u32 s73, 0
    s_cbranch_scc1 RET_0
    s_cmp_eq_u32 s73, 1
    s_cbranch_scc1 RET_1
    s_cmp_eq_u32 s73, 2
    s_cbranch_scc1 RET_2
    s_branch RET_3
P_DR:
    v_add_u32 v246, 16, v246
P_D2:
    s_mov_b64 exec, 1
    v_mov_b32 v253, 4
    ds_add_rtn_u32 v253, v251, v253 offset:17600
    s_mov_b64 exec, -1
    s_mov_b32 s50, 1
    s_mov_b32 s55, 1
    s_cmp_eq_u32 s73, 0
    s_cbranch_scc1 RET_0
    s_cmp_eq_u32 s73, 1
    s_cbranch_scc1 RET_1
    s_cmp_eq_u32 s73, 2
    s_cbranch_scc1 RET_2
    s_branch RET_3
P_2:
    s_bitcmp1_b32 s66, 6
    s_cbranch_scc0 P_D2
    v_mov_b32 v246, 16896
    s_movk_i32 s50, 0x100
    s_branch P_RET
DRAIN:
    v_rcp_f32 v2, v2
    v_rcp_f32 v3, v3
    v_fma_f32 v0, v0, v2, s44
    v_fmac_f32 v0, v1, v3
    v_cvt_pk_bf16_f32 v0, v0, v0
    s_bitcmp1_b32 s73, 0
    ds_write_b16 v249, v0
    ds_read_b64 v[236:237], v248
    s_waitcnt lgkmcnt(0)
    s_cbranch_scc1 DRAIN1
    v_mfma_f32_4x4x4_16b_bf16 v[176:179], v[236:237], v[160:161], v[176:179] cbsz:4 abid:0
    s_nop 1
    v_mfma_f32_4x4x4_16b_bf16 v[176:179], v[236:237], v[162:163], v[176:179] cbsz:4 abid:1
    s_nop 1
    v_mfma_f32_4x4x4_16b_bf16 v[176:179], v[236:237], v[164:165], v[176:179] cbsz:4 abid:2
    s_nop 1
    v_mfma_f32_4x4x4_16b_bf16 v[176:179], v[236:237], v[166:167], v[176:179] cbsz:4 abid:3
    s_nop 2
    s_branch EPI
DRAIN1:
    v_mfma_f32_4x4x4_16b_bf16 v[176:179], v[236:237], v[168:169], v[176:179] cbsz:4 abid:0
    s_nop 1
    v_mfma_f32_4x4x4_16b_bf16 v[176:179], v[236:237], v[170:171], v[176:179] cbsz:4 abid:1
    s_nop 1
    v_mfma_f32_4x4x4_16b_bf16 v[176:179], v[236:237], v[172:173], v[176:179] cbsz:4 abid:2
    s_nop 1
    v_mfma_f32_4x4x4_16b_bf16 v[176:179], v[236:237], v[174:175], v[176:179] cbsz:4 abid:3
    s_nop 2
    s_branch EPI
L_DONE:
    s_lshl_b32 s56, s48, 11
    s_add_u32 s56, s56, 133376
    v_lshl_add_u32 v0, v251, 1, s56
    s_lshl_b32 s56, s48, 18
    s_waitcnt lgkmcnt(0)
    s_barrier
    ds_read_b128 v[104:107], v0 offset:0
    ds_read_b128 v[108:111], v0 offset:16
    s_waitcnt lgkmcnt(0)
    v_cvt_pk_bf16_f32 v152, v104, v105
    v_cvt_pk_bf16_f32 v153, v106, v107
    v_cvt_pk_bf16_f32 v154, v108, v109
    v_cvt_pk_bf16_f32 v155, v110, v111
    buffer_store_dwordx4 v[152:155], v251, s[28:31], s56 offen nt
L_FIN:
    s_endpgm
AW:
    s_sleep 1
    ds_read_b32 v254, v253
    s_waitcnt lgkmcnt(0)
    s_branch ADV
DRAW_P:
    s_mov_b64 exec, 1
    v_mov_b32 v253, 4
    ds_add_rtn_u32 v253, v251, v253 offset:17600
    s_mov_b64 exec, -1
    s_add_u32 s50, s50, 2
    s_mov_b32 s55, 1
    s_branch DRET_P
BP_X:
    s_cmp_eq_u32 s77, 1
    s_mov_b32 s77, 0
    s_cbranch_scc1 SLOW_W
    s_branch EPI_C
SLOW:
    s_bitcmp1_b32 s53, 6
    s_cbranch_scc1 EPI_R
    s_mov_b32 s74, s52
    s_mov_b32 s52, s53
    s_mov_b32 s77, 1
    ds_write_b32 v5, v176
    s_branch BPF
SLOW_W:
    s_load_dwordx2 s[4:5], s[0:1], 40
    v_lshrrev_b32 v204, 1, v252
    s_waitcnt lgkmcnt(0)
    global_load_dwordx2 v[196:197], v204, s[4:5] offset:0
    global_load_dwordx2 v[198:199], v204, s[4:5] offset:32
    global_load_dwordx2 v[200:201], v204, s[4:5] offset:64
    global_load_dwordx2 v[202:203], v204, s[4:5] offset:96
    s_waitcnt vmcnt(0)
    v_lshlrev_b32 v212, 16, v196
    v_and_b32 v213, 0xffff0000, v196
    v_lshlrev_b32 v214, 16, v197
    v_and_b32 v215, 0xffff0000, v197
    v_lshlrev_b32 v216, 16, v198
    v_and_b32 v217, 0xffff0000, v198
    v_lshlrev_b32 v218, 16, v199
    v_and_b32 v219, 0xffff0000, v199
    v_lshlrev_b32 v220, 16, v200
    v_and_b32 v221, 0xffff0000, v200
    v_lshlrev_b32 v222, 16, v201
    v_and_b32 v223, 0xffff0000, v201
    v_lshlrev_b32 v224, 16, v202
    v_and_b32 v225, 0xffff0000, v202
    v_lshlrev_b32 v226, 16, v203
    v_and_b32 v227, 0xffff0000, v203
    s_mov_b32 s52, s74
    s_and_b32 s56, s53, 63
    s_mov_b32 s57, 0
    s_bfe_u32 s59, s53, 0x40008
    s_lshl4_add_u32 s57, s56, s57
    s_lshl_b32 s57, s57, 4
    s_add_u32 s74, s57, 116992
    s_bitcmp1_b32 s53, 7
    s_cselect_b64 s[66:67], -1, 0
    s_cselect_b32 s59, 13, s59
    v_bfe_u32 v204, v251, 4, 4
    v_mov_b32 v207, v252
    v_mov_b64 v[180:181], 0
    v_mov_b64 v[182:183], 0
    v_mov_b64 v[184:185], 0
    v_mov_b64 v[186:187], 0
    v_mov_b64 v[188:189], 0
    v_mov_b64 v[190:191], 0
    v_mov_b64 v[192:193], 0
    v_mov_b64 v[194:195], 0
    s_lshr_b32 s58, s56, 3
    s_mul_i32 s57, s56, 25600
    s_mul_i32 s58, s58, 52224000
    s_add_u32 s57, s57, s58
    s_add_u32 s57, s57, s49
    s_lshr_b32 s64, s56, 3
    s_mul_i32 s58, s56, 400
    s_mul_i32 s64, s64, 816000
    s_add_u32 s58, s58, s64
SLOW_L:
    v_add_u32 v205, s74, v204
    ds_read_u8 v206, v205
    s_waitcnt lgkmcnt(0)
    v_cndmask_b32_e64 v206, v206, v204, s[66:67]
    v_lshlrev_b32 v205, 1, v206
    buffer_load_dwordx4 v[196:199], v[206:207], s[20:23], s57 idxen offen offset:1024
    buffer_load_dwordx4 v[200:203], v[206:207], s[20:23], s57 idxen offen offset:1088
    buffer_load_ushort v205, v205, s[24:27], s58 offen
    v_cmp_gt_u32 vcc, 200, v206
    v_add_u32 v204, 16, v204
    s_waitcnt vmcnt(0)
    v_mfma_f32_16x16x32_bf16 v[104:107], v[72:75], v[196:199], v[136:139]
    v_mfma_f32_16x16x32_bf16 v[104:107], v[76:79], v[200:203], v[104:107]
    v_mfma_f32_16x16x32_bf16 v[108:111], v[80:83], v[196:199], v[140:143]
    v_mfma_f32_16x16x32_bf16 v[108:111], v[84:87], v[200:203], v[108:111]
    v_mfma_f32_16x16x32_bf16 v[112:115], v[88:91], v[196:199], v[144:147]
    v_mfma_f32_16x16x32_bf16 v[112:115], v[92:95], v[200:203], v[112:115]
    v_mfma_f32_16x16x32_bf16 v[116:119], v[96:99], v[196:199], v[148:151]
    v_mfma_f32_16x16x32_bf16 v[116:119], v[100:103], v[200:203], v[116:119]
    v_lshlrev_b32 v205, 16, v205
    v_cndmask_b32 v205, 0, v205, vcc
    s_nop 7
    v_exp_f32 v104, v104
    v_exp_f32 v105, v105
    v_exp_f32 v106, v106
    v_exp_f32 v107, v107
    v_exp_f32 v108, v108
    v_exp_f32 v109, v109
    v_exp_f32 v110, v110
    v_exp_f32 v111, v111
    v_exp_f32 v112, v112
    v_exp_f32 v113, v113
    v_exp_f32 v114, v114
    v_exp_f32 v115, v115
    v_exp_f32 v116, v116
    v_exp_f32 v117, v117
    v_exp_f32 v118, v118
    v_exp_f32 v119, v119
    v_add_f32 v104, 1.0, v104
    v_add_f32 v105, 1.0, v105
    v_add_f32 v106, 1.0, v106
    v_add_f32 v107, 1.0, v107
    v_add_f32 v108, 1.0, v108
    v_add_f32 v109, 1.0, v109
    v_add_f32 v110, 1.0, v110
    v_add_f32 v111, 1.0, v111
    v_add_f32 v112, 1.0, v112
    v_add_f32 v113, 1.0, v113
    v_add_f32 v114, 1.0, v114
    v_add_f32 v115, 1.0, v115
    v_add_f32 v116, 1.0, v116
    v_add_f32 v117, 1.0, v117
    v_add_f32 v118, 1.0, v118
    v_add_f32 v119, 1.0, v119
    v_rcp_f32 v104, v104
    v_rcp_f32 v105, v105
    v_rcp_f32 v106, v106
    v_rcp_f32 v107, v107
    v_rcp_f32 v108, v108
    v_rcp_f32 v109, v109
    v_rcp_f32 v110, v110
    v_rcp_f32 v111, v111
    v_rcp_f32 v112, v112
    v_rcp_f32 v113, v113
    v_rcp_f32 v114, v114
    v_rcp_f32 v115, v115
    v_rcp_f32 v116, v116
    v_rcp_f32 v117, v117
    v_rcp_f32 v118, v118
    v_rcp_f32 v119, v119
    v_mul_f32 v208, v104, v212
    v_fmac_f32 v208, v105, v213
    v_fmac_f32 v208, v106, v214
    v_fmac_f32 v208, v107, v215
    v_fmac_f32 v208, v108, v216
    v_fmac_f32 v208, v109, v217
    v_fmac_f32 v208, v110, v218
    v_fmac_f32 v208, v111, v219
    v_fmac_f32 v208, v112, v220
    v_fmac_f32 v208, v113, v221
    v_fmac_f32 v208, v114, v222
    v_fmac_f32 v208, v115, v223
    v_fmac_f32 v208, v116, v224
    v_fmac_f32 v208, v117, v225
    v_fmac_f32 v208, v118, v226
    v_fmac_f32 v208, v119, v227
    v_mov_b32 v209, v208
    s_nop 1
    v_permlane32_swap_b32 v208, v209
    v_add_f32 v208, v208, v209
    v_mov_b32 v209, v208
    s_nop 1
    v_permlane16_swap_b32 v208, v209
    v_add_f32 v208, v208, v209
    v_add_f32 v208, s63, v208
    v_mul_f32 v208, v208, v205
    v_lshlrev_b32 v209, 16, v196
    v_and_b32 v210, 0xffff0000, v196
    v_fmac_f32 v180, v208, v209
    v_fmac_f32 v181, v208, v210
    v_lshlrev_b32 v209, 16, v197
    v_and_b32 v210, 0xffff0000, v197
    v_fmac_f32 v182, v208, v209
    v_fmac_f32 v183, v208, v210
    v_lshlrev_b32 v209, 16, v198
    v_and_b32 v210, 0xffff0000, v198
    v_fmac_f32 v184, v208, v209
    v_fmac_f32 v185, v208, v210
    v_lshlrev_b32 v209, 16, v199
    v_and_b32 v210, 0xffff0000, v199
    v_fmac_f32 v186, v208, v209
    v_fmac_f32 v187, v208, v210
    v_lshlrev_b32 v209, 16, v200
    v_and_b32 v210, 0xffff0000, v200
    v_fmac_f32 v188, v208, v209
    v_fmac_f32 v189, v208, v210
    v_lshlrev_b32 v209, 16, v201
    v_and_b32 v210, 0xffff0000, v201
    v_fmac_f32 v190, v208, v209
    v_fmac_f32 v191, v208, v210
    v_lshlrev_b32 v209, 16, v202
    v_and_b32 v210, 0xffff0000, v202
    v_fmac_f32 v192, v208, v209
    v_fmac_f32 v193, v208, v210
    v_lshlrev_b32 v209, 16, v203
    v_and_b32 v210, 0xffff0000, v203
    v_fmac_f32 v194, v208, v209
    v_fmac_f32 v195, v208, v210
    s_sub_u32 s59, s59, 1
    s_cmp_lg_u32 s59, 0
    s_cbranch_scc1 SLOW_L
    v_readfirstlane_b32 s56, v5
    s_nop 1
    v_lshl_add_u32 v208, v252, 1, s56
    ds_add_f32 v208, v180 offset:0
    ds_add_f32 v208, v181 offset:4
    ds_add_f32 v208, v182 offset:8
    ds_add_f32 v208, v183 offset:12
    ds_add_f32 v208, v184 offset:16
    ds_add_f32 v208, v185 offset:20
    ds_add_f32 v208, v186 offset:24
    ds_add_f32 v208, v187 offset:28
    ds_add_f32 v208, v188 offset:128
    ds_add_f32 v208, v189 offset:132
    ds_add_f32 v208, v190 offset:136
    ds_add_f32 v208, v191 offset:140
    ds_add_f32 v208, v192 offset:144
    ds_add_f32 v208, v193 offset:148
    ds_add_f32 v208, v194 offset:152
    ds_add_f32 v208, v195 offset:156
    s_waitcnt lgkmcnt(0)
    s_bitcmp1_b32 s52, 6
    s_cbranch_scc1 L_DONE
    ds_read_b128 v[180:183], v251 offset:0
    ds_read_b128 v[184:187], v251 offset:1024
    ds_read_b128 v[196:199], v251 offset:4096
    ds_read_b128 v[200:203], v251 offset:5120
    ds_read_b128 v[212:215], v251 offset:8192
    ds_read_b128 v[216:219], v251 offset:9216
    ds_read_b128 v[188:191], v251 offset:2048
    ds_read_b128 v[192:195], v251 offset:3072
    ds_read_b128 v[204:207], v251 offset:6144
    ds_read_b128 v[208:211], v251 offset:7168
    ds_read_b128 v[220:223], v251 offset:10240
    ds_read_b128 v[224:227], v251 offset:11264
    ds_read_b128 v[228:231], v251 offset:14336
    ds_read_b128 v[232:235], v251 offset:15360
    s_mov_b32 s77, 2
    s_branch BPF
L_END:
    s_endpgm
.section .rodata,"a"
.p2align 6
.amdhsa_kernel standalone__sequential_behavior_din__recsys_kernel
  .amdhsa_next_free_vgpr 255
  .amdhsa_next_free_sgpr 80
  .amdhsa_accum_offset 256
  .amdhsa_group_segment_fixed_size 0
  .amdhsa_kernarg_size 80
  .amdhsa_user_sgpr_count 2
  .amdhsa_user_sgpr_kernarg_segment_ptr 1
  .amdhsa_system_sgpr_workgroup_id_x 1
.end_amdhsa_kernel
```

```asm
; @launch grid=(256,1,1) block=(512,1,1) lds=153856
.amdgcn_target "amdgcn-amd-amdhsa--gfx950"
.text
.globl standalone__sequential_behavior_din__recsys_kernel
.p2align 8
.type standalone__sequential_behavior_din__recsys_kernel,@function
standalone__sequential_behavior_din__recsys_kernel:
    s_cmpk_ge_u32 s2, 256
    s_cbranch_scc1 L_END
    s_load_dwordx16 s[4:19], s[0:1], 0
    s_setprio 3
    v_lshrrev_b32 v1, 6, v0
    v_and_b32 v176, 63, v0
    v_readfirstlane_b32 s48, v1
    s_getpc_b64 s[40:41]
L_PC:
    s_cmp_lt_u32 s48, 5
    s_cbranch_scc1 P_NC
    s_mov_b32 s42, L_END-L_PC
    s_mov_b32 s43, 0x20000
    v_subrev_u32 v150, 320, v0
    v_lshlrev_b32 v150, 6, v150
    buffer_load_dword v150, v150, s[40:43], 0 offen
P_NC:
    v_and_b32 v2, 31, v0
    v_bfe_u32 v3, v0, 5, 1
    v_cmp_gt_u32 vcc, 25, v2
    v_mul_u32_u24 v4, 400, v3
    v_lshl_add_u32 v179, v2, 4, v4
    v_bfrev_b32 v4, 8
    v_cndmask_b32 v179, v4, v179, vcc
    s_mul_i32 s57, s2, 3200
    s_sub_u32 s26, 6553600, s57
    s_lshr_b32 s59, s48, 2
    s_mul_i32 s71, s48, 800
    s_mul_i32 s59, s59, 816000
    s_add_u32 s71, s71, s59
    s_mov_b32 s27, 0x20000
    s_lshl_b32 s74, s48, 12
    s_lshl_b32 s53, s2, 10
    v_lshlrev_b32 v251, 4, v176
    v_lshlrev_b32 v120, 1, v176
    v_and_b32 v120, 32, v120
    v_xor_b32 v120, v120, v251
    v_xor_b32 v121, 64, v120
    s_mov_b32 s38, 32768
    s_mov_b32 s39, s27
    s_lshl_b32 s58, s48, 18
    s_sub_u32 s34, 2097152, s53
    s_mov_b32 s35, s27
    s_add_u32 m0, s74, 121088
    v_and_b32 v178, 15, v176
    v_lshrrev_b32 v177, 4, v176
    v_lshlrev_b32 v252, 4, v177
    v_mul_u32_u24 v208, 0x80008, v2
    v_lshrrev_b32 v238, 3, v176
    v_add_u32 v208, 0x10000, v208
    v_cmp_gt_u32 vcc, 32, v176
    s_waitcnt lgkmcnt(0)
    s_add_u32 s24, s8, s57
    s_addc_u32 s25, s9, 0
    s_mov_b64 s[36:37], s[10:11]
    buffer_load_dwordx4 v[204:207], v179, s[24:27], s71 offen offset:0 nt
    s_setprio 0
    s_add_u32 s32, s4, s53
    s_addc_u32 s33, s5, 0
    s_load_dword s63, s[16:17], 0
    s_cmp_lg_u32 s48, 0
    s_cbranch_scc1 P_LJ
    v_mov_b32 v146, s12
    v_mov_b32 v147, s13
    v_mov_b32 v148, s14
    v_mov_b32 v149, s15
    v_lshlrev_b32 v4, 2, v2
    v_cndmask_b32 v146, v146, v148, vcc
    v_cndmask_b32 v147, v147, v149, vcc
    v_add_co_u32 v146, vcc, v146, v4
    s_nop 1
    v_addc_co_u32 v147, vcc, 0, v147, vcc
    global_load_dword v146, v[146:147], off
P_LJ:
    buffer_load_dwordx4 v[124:127], v251, s[32:35], s58 offen nt
    buffer_load_dwordx4 v120, s[36:39], s74 offen offset:0 lds
    buffer_load_dwordx4 v121, s[36:39], s74 offen offset:1024 lds
    s_lshl1_add_u32 s54, s74, 17664
    s_mul_i32 s49, s2, 204800
    s_lshl_b32 s57, s48, 9
    v_add_u32 v247, 116992, v238
    v_add_u32 v246, s57, v247
    s_add_u32 s56, s57, 116992
    v_add_u32 v209, 0x20002, v208
    v_add_u32 v210, 0x40004, v208
    v_add_u32 v211, 0x60006, v208
    s_sub_u32 s20, s6, 1024
    s_subb_u32 s21, s7, 0
    s_or_b32 s21, s21, 0x800000
    s_movk_i32 s22, 200
    s_mov_b32 s23, s27
    s_movk_i32 s61, 0x3f80
    v_lshrrev_b32 v216, 1, v251
    v_and_b32 v213, 0x100, v216
    v_mov_b64 v[214:215], -1
    v_lshlrev_b32 v250, 2, v176
    v_bfrev_b32 v2, v238
    v_lshrrev_b32 v2, 28, v2
    v_and_b32 v2, 6, v2
    v_xor_b32 v2, v2, v176
    v_and_b32 v2, 7, v2
    v_mul_u32_u24 v143, 528, v238
    v_lshlrev_b32 v239, 4, v2
    v_lshlrev_b32 v241, 4, v2
    v_lshlrev_b32 v153, 4, v2
    v_lshlrev_b32 v155, 4, v2
    s_add_u32 s28, s18, s53
    s_addc_u32 s29, s19, 0
    s_sub_u32 s30, 2097152, s53
    s_mov_b32 s31, s27
    s_mov_b32 s60, 0xbfb8aa3b
    s_mov_b32 s42, 0x21800000
    s_mov_b32 s46, 0x2b800000
    s_lshr_b32 s59, s48, 2
    s_mul_i32 s51, s48, 51200
    s_mul_i32 s59, s59, 52224000
    s_add_u32 s51, s51, s59
    s_add_u32 s51, s51, s49
    s_add_u32 s72, s51, 1024
    v_bfrev_b32 v2, v178
    v_lshrrev_b32 v2, 28, v2
    v_and_b32 v2, 6, v2
    v_xor_b32 v2, v2, v177
    v_lshl_add_u32 v2, v2, 4, s54
    v_lshl_add_u32 v242, v178, 7, v2
    v_xor_b32 v243, 64, v242
    v_and_b32 v3, 3, v176
    v_bfe_u32 v2, v176, 2, 2
    v_lshlrev_b32 v7, 3, v3
    v_lshl_add_u32 v7, v2, 7, v7
    v_and_b32 v6, 8, v176
    v_lshlrev_b32 v6, 3, v6
    v_lshl_add_u32 v244, v177, 5, v7
    v_xor_b32 v244, v244, v6
    v_add_u32 v244, s54, v244
    v_xor_b32 v245, 32, v244
    s_lshl_b32 s57, s48, 7
    s_add_u32 s57, s57, 150016
    v_lshl_add_u32 v249, v2, 2, v177
    v_lshl_add_u32 v249, v249, 2, v3
    v_lshl_add_u32 v249, v249, 1, s57
    v_lshl_add_u32 v248, v178, 3, s57
    v_and_b32 v6, 0x60, v250
    v_or_b32 v6, v6, v7
    v_lshl_add_u32 v136, v177, 10, v6
    s_mul_i32 s57, s48, 0x1010
    s_and_b32 s57, s57, 0x1060
    v_xor_b32 v144, s57, v136
    v_add_u32 v136, 121088, v136
    v_add_u32 v144, 121088, v144
    v_xor_b32 v137, 32, v136
    v_xor_b32 v138, 64, v136
    v_xor_b32 v139, 96, v136
    s_and_b32 s59, s48, 4
    s_lshl_b32 s59, s59, 4
    v_xor_b32 v140, s59, v136
    v_xor_b32 v141, 32, v140
    s_and_b32 s57, s48, 3
    s_mul_i32 s57, s57, 8448
    s_lshl1_add_u32 s57, s59, s57
    s_add_u32 s57, s57, 83200
    v_mul_u32_u24 v145, 528, v178
    v_add3_u32 v145, v145, v252, s57
    v_lshl_add_u32 v142, s59, 1, v252
    s_mul_i32 s57, s48, 4224
    s_add_u32 s57, s57, 83200
    v_and_b32 v3, 0x70, v251
    v_add3_u32 v143, v143, v3, s57
    v_add_u32 v3, v143, v3
    s_lshl_b32 s57, s48, 11
    v_add_u32 v151, s57, v251
    s_mov_b32 s66, 0x1b0a0100
    s_mov_b32 s67, 0x966d4c33
    s_lshl_b32 s57, s48, 3
    s_lshr_b64 s[66:67], s[66:67], s57
    s_and_b32 s47, s66, 7
    s_bfe_u32 s70, s66, 0x50003
    s_lshl1_add_u32 s70, s70, 16
    s_mul_i32 s71, s70, 400
    buffer_load_dwordx4 v120, s[36:39], s74 offen offset:2048 lds
    buffer_load_dwordx4 v121, s[36:39], s74 offen offset:3072 lds
    s_cmp_eq_u32 s48, 0
    s_waitcnt vmcnt(6) lgkmcnt(0)
    s_cbranch_scc1 P_M0
    s_waitcnt vmcnt(5)
P_M0:
    s_call_b64 s[36:37], CMP
    s_branch P_C
    .p2align 3
CMP:
    v_bcnt_u32_b32 v7, v204, 0
    v_bcnt_u32_b32 v7, v205, v7
    v_bcnt_u32_b32 v7, v206, v7
    v_bcnt_u32_b32 v7, v207, v7
    v_add_u32 v4, s56, v216
    v_mov_b32 v6, v7
    ds_write_b64 v4, v[214:215]
    v_cmp_eq_u16_e64 s[4:5], s61, v204
    v_cmp_eq_u16_sdwa s[6:7], v204, s61 src0_sel:WORD_1 src1_sel:WORD_0
    v_add_u32_dpp v6, v6, v6 row_shr:1 row_mask:0xf bank_mask:0xf bound_ctrl:0
    v_cmp_eq_u16_e64 s[8:9], s61, v205
    v_cmp_eq_u16_sdwa s[10:11], v205, s61 src0_sel:WORD_1 src1_sel:WORD_0
    v_add_u32_dpp v6, v6, v6 row_shr:2 row_mask:0xf bank_mask:0xf bound_ctrl:0
    v_cmp_eq_u16_e64 s[12:13], s61, v206
    v_cmp_eq_u16_sdwa s[14:15], v206, s61 src0_sel:WORD_1 src1_sel:WORD_0
    v_add_u32_dpp v6, v6, v6 row_shr:4 row_mask:0xf bank_mask:0xf bound_ctrl:0
    v_cmp_eq_u16_e64 s[16:17], s61, v207
    v_cmp_eq_u16_sdwa s[18:19], v207, s61 src0_sel:WORD_1 src1_sel:WORD_0
    v_add_u32_dpp v6, v6, v6 row_shr:8 row_mask:0xf bank_mask:0xf bound_ctrl:0
    s_nop 1
    v_add_u32_dpp v6, v6, v6 row_bcast:15 row_mask:0xa bank_mask:0xf
    v_sub_u32 v6, v6, v7
    v_mul_u32_u24 v6, 9363, v6
    v_lshrrev_b32 v6, 16, v6
    v_min_u32 v6, 200, v6
    v_add3_u32 v226, v6, v213, s56
    v_readlane_b32 s59, v6, 31
    v_readlane_b32 s58, v6, 63
    v_addc_co_u32_e64 v227, vcc, 0, v226, s[4:5]
    v_addc_co_u32_e64 v228, vcc, 0, v227, s[6:7]
    v_addc_co_u32_e64 v229, vcc, 0, v228, s[8:9]
    v_addc_co_u32_e64 v230, vcc, 0, v229, s[10:11]
    v_addc_co_u32_e64 v231, vcc, 0, v230, s[12:13]
    v_addc_co_u32_e64 v232, vcc, 0, v231, s[14:15]
    v_addc_co_u32_e64 v233, vcc, 0, v232, s[16:17]
    v_addc_co_u32_e64 v234, vcc, 0, v233, s[18:19]
    s_mov_b64 exec, s[4:5]
    ds_write_b8 v226, v208
    s_mov_b64 exec, s[6:7]
    ds_write_b8_d16_hi v227, v208
    s_mov_b64 exec, s[8:9]
    ds_write_b8 v228, v209
    s_mov_b64 exec, s[10:11]
    ds_write_b8_d16_hi v229, v209
    s_mov_b64 exec, s[12:13]
    ds_write_b8 v230, v210
    s_mov_b64 exec, s[14:15]
    ds_write_b8_d16_hi v231, v210
    s_mov_b64 exec, s[16:17]
    ds_write_b8 v232, v211
    s_mov_b64 exec, s[18:19]
    ds_write_b8_d16_hi v233, v211
    s_mov_b64 exec, -1
    v_sub_u32 v6, v234, v226
    v_mul_u32_u24 v6, 7, v6
    v_cmp_ne_u32 vcc, v6, v7
    s_min_u32 s64, vcc_lo, 1
    s_min_u32 s65, vcc_hi, 1
    s_lshl_b64 s[64:65], s[64:65], 15
    s_or_b32 s57, s59, s64
    s_or_b32 s58, s58, s65
    s_setpc_b64 s[36:37]
P_C:
    ds_read_u8 v238, v246 offset:0
    ds_read_u8 v240, v246 offset:8
    ds_read_u8 v152, v246 offset:16
    ds_read_u8 v154, v246 offset:24
    s_add_u32 m0, s54, 0
    s_waitcnt lgkmcnt(3)
    buffer_load_dwordx4 v[238:239], s[20:23], s72 idxen offen nt lds
    s_waitcnt lgkmcnt(2)
    buffer_load_dwordx4 v[240:241], s[20:23], s51 idxen offen offset:1024 nt lds
    s_add_u32 m0, s54, 2048
    s_waitcnt lgkmcnt(1)
    buffer_load_dwordx4 v[152:153], s[20:23], s72 idxen offen nt lds
    s_waitcnt lgkmcnt(0)
    buffer_load_dwordx4 v[154:155], s[20:23], s51 idxen offen offset:1024 nt lds
    s_lshl_b32 s63, s63, 16
    s_cmp_lg_u32 s48, 0
    s_waitcnt vmcnt(8)
    s_cbranch_scc1 P_SW_J
    v_lshlrev_b32 v148, 16, v146
    v_and_b32 v149, 0xffff0000, v146
    v_mov_b32 v4, -1
    v_mov_b32 v5, 0
    v_mov_b32 v6, 0x240
    v_lshrrev_b32 v0, 1, v251
    ds_write2st64_b32 v250, v4, v5 offset0:66 offset1:67
    s_mov_b32 exec_hi, 0
    v_max3_f32 v2, abs(v148), abs(v149), abs(s63)
    v_ldexp_f32 v148, v148, 40
    v_ldexp_f32 v149, v149, 40
    v_cmp_le_f32 vcc, 0x33800000, v2
    s_mov_b32 exec_lo, 0x55
    v_mul_f32 v148, s42, v148
    v_mul_f32 v149, s42, v149
    s_mov_b32 exec_lo, -1
    ds_write_b32 v250, v6 offset:17408
    s_mov_b32 exec_hi, -1
    s_movk_i32 s56, 0x3ff
    s_cmp_lg_u64 vcc, 0
    s_cmovk_i32 s56, 0x207
    v_mov_b32 v6, 17184
    v_mov_b32 v7, s56
    ds_write_b64 v0, v[148:149] offset:16384
    ds_write_b64 v5, v[6:7] offset:17600
P_SW_J:
    ds_write_b128 v143, v[124:127] offset:256
    ds_write_b128 v143, v[124:127] offset:384
    s_waitcnt vmcnt(4) lgkmcnt(0)
    s_barrier
    ds_read_b64_tr_b16 v[218:219], v144 offset:0
    ds_read_b64_tr_b16 v[220:221], v144 offset:512
    ds_read_b64_tr_b16 v[222:223], v144 offset:16384
    ds_read_b64_tr_b16 v[224:225], v144 offset:16896
    ds_read_b128 v[160:163], v145 offset:256
    ds_read_b128 v[164:167], v145 offset:320
    ds_read_b128 v[104:107], v142 offset:16640
    ds_read_b128 v[108:111], v142 offset:16704
    ds_read_b64_tr_b16 v[40:41], v140 offset:8192
    ds_read_b64_tr_b16 v[42:43], v140 offset:8704
    ds_read_b64_tr_b16 v[44:45], v141 offset:8192
    ds_read_b64_tr_b16 v[46:47], v141 offset:8704
    ds_read_b64_tr_b16 v[48:49], v140 offset:12288
    ds_read_b64_tr_b16 v[50:51], v140 offset:12800
    ds_read_b64_tr_b16 v[52:53], v141 offset:12288
    ds_read_b64_tr_b16 v[54:55], v141 offset:12800
    ds_read_b64_tr_b16 v[56:57], v140 offset:16384
    ds_read_b64_tr_b16 v[58:59], v140 offset:16896
    ds_read_b64_tr_b16 v[60:61], v141 offset:16384
    ds_read_b64_tr_b16 v[62:63], v141 offset:16896
    ds_read_b64_tr_b16 v[64:65], v140 offset:20480
    ds_read_b64_tr_b16 v[66:67], v140 offset:20992
    ds_read_b64_tr_b16 v[68:69], v141 offset:20480
    ds_read_b64_tr_b16 v[70:71], v141 offset:20992
    s_and_b32 s59, s57, 0xff
    s_lshr_b32 s57, s57, 8
    s_add_u32 s59, s59, 15
    s_and_b32 s52, s59, 15
    s_lshl_b32 s52, s52, 12
    s_or_b32 s57, s57, s52
    s_lshr_b32 s59, s59, 4
    s_max_u32 s59, s59, 3
    s_lshl1_add_u32 s52, s48, s57
    s_lshl_b32 s57, s59, 8
    s_or_b32 s52, s52, s57
    s_sub_u32 s50, s59, 3
    s_and_b32 s59, s58, 0xff
    s_lshr_b32 s58, s58, 8
    s_add_u32 s59, s59, 15
    s_and_b32 s74, s59, 15
    s_lshl_b32 s74, s74, 12
    s_or_b32 s58, s58, s74
    s_lshr_b32 s59, s59, 4
    s_max_u32 s59, s59, 2
    s_lshl1_add_u32 s74, s48, s58
    s_lshl_b32 s58, s59, 8
    s_or_b32 s74, s74, s58
    s_or_b32 s74, s74, 1
    v_lshlrev_b32 v24, 16, v124
    v_and_b32 v25, 0xffff0000, v124
    v_lshlrev_b32 v26, 16, v125
    v_and_b32 v27, 0xffff0000, v125
    v_lshlrev_b32 v28, 16, v126
    v_and_b32 v29, 0xffff0000, v126
    v_lshlrev_b32 v30, 16, v127
    v_and_b32 v31, 0xffff0000, v127
    v_mul_f32 v24, s60, v24
    v_mul_f32 v25, s60, v25
    v_mul_f32 v26, s60, v26
    v_mul_f32 v27, s60, v27
    v_mul_f32 v28, s60, v28
    v_mul_f32 v29, s60, v29
    v_mul_f32 v30, s60, v30
    v_mul_f32 v31, s60, v31
    s_waitcnt lgkmcnt(15)
    v_lshlrev_b32 v8, 16, v218
    v_and_b32 v9, 0xffff0000, v218
    v_lshlrev_b32 v16, 16, v222
    v_and_b32 v17, 0xffff0000, v222
    v_lshlrev_b32 v10, 16, v219
    v_and_b32 v11, 0xffff0000, v219
    v_lshlrev_b32 v18, 16, v223
    v_and_b32 v19, 0xffff0000, v223
    v_lshlrev_b32 v12, 16, v220
    v_and_b32 v13, 0xffff0000, v220
    v_lshlrev_b32 v20, 16, v224
    v_and_b32 v21, 0xffff0000, v224
    v_lshlrev_b32 v14, 16, v221
    v_and_b32 v15, 0xffff0000, v221
    v_lshlrev_b32 v22, 16, v225
    v_and_b32 v23, 0xffff0000, v225
    v_xor_b32 v168, 0x80008000, v160
    v_xor_b32 v169, 0x80008000, v161
    v_xor_b32 v170, 0x80008000, v162
    v_xor_b32 v171, 0x80008000, v163
    v_xor_b32 v172, 0x80008000, v164
    v_xor_b32 v173, 0x80008000, v165
    v_xor_b32 v174, 0x80008000, v166
    v_xor_b32 v175, 0x80008000, v167
    s_waitcnt lgkmcnt(12)
    v_mfma_f32_16x16x32_bf16 v[104:107], v[40:43], v[160:163], v[104:107]
    v_mfma_f32_16x16x32_bf16 v[108:111], v[44:47], v[160:163], v[108:111]
    v_add_f32 v112, v8, v16
    v_add_f32 v113, v9, v17
    s_waitcnt lgkmcnt(8)
    v_mfma_f32_16x16x32_bf16 v[104:107], v[48:51], v[164:167], v[104:107]
    v_mfma_f32_16x16x32_bf16 v[108:111], v[52:55], v[164:167], v[108:111]
    v_add_f32 v114, v10, v18
    v_add_f32 v115, v11, v19
    s_waitcnt lgkmcnt(4)
    v_mfma_f32_16x16x32_bf16 v[104:107], v[56:59], v[168:171], v[104:107]
    v_mfma_f32_16x16x32_bf16 v[108:111], v[60:63], v[168:171], v[108:111]
    v_add_f32 v116, v12, v20
    v_add_f32 v117, v13, v21
    s_waitcnt lgkmcnt(0)
    v_mfma_f32_16x16x32_bf16 v[104:107], v[64:67], v[172:175], v[104:107]
    v_mfma_f32_16x16x32_bf16 v[108:111], v[68:71], v[172:175], v[108:111]
    v_add_f32 v118, v14, v22
    v_add_f32 v119, v15, v23
    ds_read_b64_tr_b16 v[72:73], v136 offset:24576
    ds_read_b64_tr_b16 v[74:75], v136 offset:25088
    ds_read_b64_tr_b16 v[76:77], v136 offset:28672
    ds_read_b64_tr_b16 v[78:79], v136 offset:29184
    ds_read_b64_tr_b16 v[80:81], v137 offset:24576
    ds_read_b64_tr_b16 v[82:83], v137 offset:25088
    ds_read_b64_tr_b16 v[84:85], v137 offset:28672
    ds_read_b64_tr_b16 v[86:87], v137 offset:29184
    ds_read_b64_tr_b16 v[88:89], v138 offset:24576
    ds_read_b64_tr_b16 v[90:91], v138 offset:25088
    ds_read_b64_tr_b16 v[92:93], v138 offset:28672
    ds_read_b64_tr_b16 v[94:95], v138 offset:29184
    ds_read_b64_tr_b16 v[96:97], v139 offset:24576
    ds_read_b64_tr_b16 v[98:99], v139 offset:25088
    ds_read_b64_tr_b16 v[100:101], v139 offset:28672
    ds_read_b64_tr_b16 v[102:103], v139 offset:29184
    s_cmp_le_u32 s47, 0
    s_cbranch_scc1 P_MJ
    s_lshr_b32 s56, s70, 1
    s_lshr_b32 s59, s56, 2
    s_mul_i32 s71, s56, 800
    s_mul_i32 s59, s59, 816000
    s_add_u32 s71, s71, s59
    buffer_load_dwordx4 v[180:183], v179, s[24:27], s71 offen offset:0 nt
    s_cmp_le_u32 s47, 1
    s_cbranch_scc1 P_MJ
    s_lshr_b32 s56, s70, 1
    s_add_u32 s56, s56, 1
    s_lshr_b32 s59, s56, 2
    s_mul_i32 s71, s56, 800
    s_mul_i32 s59, s59, 816000
    s_add_u32 s71, s71, s59
    buffer_load_dwordx4 v[184:187], v179, s[24:27], s71 offen offset:0 nt
    s_cmp_le_u32 s47, 2
    s_cbranch_scc1 P_MJ
    s_lshr_b32 s56, s70, 1
    s_add_u32 s56, s56, 2
    s_lshr_b32 s59, s56, 2
    s_mul_i32 s71, s56, 800
    s_mul_i32 s59, s59, 816000
    s_add_u32 s71, s71, s59
    buffer_load_dwordx4 v[188:191], v179, s[24:27], s71 offen offset:0 nt
    s_cmp_le_u32 s47, 3
    s_cbranch_scc1 P_MJ
    s_lshr_b32 s56, s70, 1
    s_add_u32 s56, s56, 3
    s_lshr_b32 s59, s56, 2
    s_mul_i32 s71, s56, 800
    s_mul_i32 s59, s59, 816000
    s_add_u32 s71, s71, s59
    buffer_load_dwordx4 v[192:195], v179, s[24:27], s71 offen offset:0 nt
    s_cmp_le_u32 s47, 4
    s_cbranch_scc1 P_MJ
    s_lshr_b32 s56, s70, 1
    s_add_u32 s56, s56, 4
    s_lshr_b32 s59, s56, 2
    s_mul_i32 s71, s56, 800
    s_mul_i32 s59, s59, 816000
    s_add_u32 s71, s71, s59
    buffer_load_dwordx4 v[196:199], v179, s[24:27], s71 offen offset:0 nt
    s_cmp_le_u32 s47, 5
    s_cbranch_scc1 P_MJ
    s_lshr_b32 s56, s70, 1
    s_add_u32 s56, s56, 5
    s_lshr_b32 s59, s56, 2
    s_mul_i32 s71, s56, 800
    s_mul_i32 s59, s59, 816000
    s_add_u32 s71, s71, s59
    buffer_load_dwordx4 v[200:203], v179, s[24:27], s71 offen offset:0 nt
P_MJ:
    v_mul_f32 v112, s60, v112
    v_mul_f32 v113, s60, v113
    v_mul_f32 v114, s60, v114
    v_mul_f32 v115, s60, v115
    v_mul_f32 v116, s60, v116
    v_mul_f32 v117, s60, v117
    v_mul_f32 v118, s60, v118
    v_mul_f32 v119, s60, v119
    ds_write_b128 v151, v[112:115] offset:0
    ds_write_b128 v151, v[116:119] offset:1024
    v_mul_f32 v104, s60, v104
    v_mul_f32 v105, s60, v105
    v_mul_f32 v106, s60, v106
    v_mul_f32 v107, s60, v107
    v_mul_f32 v108, s60, v108
    v_mul_f32 v109, s60, v109
    v_mul_f32 v110, s60, v110
    v_mul_f32 v111, s60, v111
    ds_write_b128 v145, v[104:107] offset:256
    ds_write_b128 v145, v[108:111] offset:320
    ds_write_b128 v3, v[24:27] offset:0
    ds_write_b128 v3, v[28:31] offset:16
    ds_read_b128 v[120:123], v252 offset:16384
    ds_read_b128 v[124:127], v252 offset:16448
    ds_read_b128 v[128:131], v252 offset:16512
    ds_read_b128 v[132:135], v252 offset:16576
    ds_read_b32 v150, v252 offset:17604
    s_lshl2_add_u32 s56, s48, 17184
    v_mov_b32 v253, s56
    v_mov_b32 v254, s74
    ds_write_b32 v253, v254
    v_ldexp_f32 v2, s63, 38
    v_add_u32 v250, 133376, v250
    v_mov_b64 v[168:169], 0
    v_mov_b64 v[170:171], 0
    v_mov_b64 v[172:173], 0
    v_mov_b64 v[174:175], 0
    v_readfirstlane_b32 s44, v2
    s_waitcnt lgkmcnt(15)
    v_lshlrev_b32 v8, 16, v72
    v_and_b32 v9, 0xffff0000, v72
    v_lshlrev_b32 v10, 16, v73
    v_and_b32 v11, 0xffff0000, v73
    v_lshlrev_b32 v12, 16, v74
    v_and_b32 v13, 0xffff0000, v74
    v_lshlrev_b32 v14, 16, v75
    v_and_b32 v15, 0xffff0000, v75
    v_lshlrev_b32 v16, 16, v76
    v_and_b32 v17, 0xffff0000, v76
    v_lshlrev_b32 v18, 16, v77
    v_and_b32 v19, 0xffff0000, v77
    v_lshlrev_b32 v20, 16, v78
    v_and_b32 v21, 0xffff0000, v78
    v_lshlrev_b32 v22, 16, v79
    v_and_b32 v23, 0xffff0000, v79
    v_lshlrev_b32 v24, 16, v80
    v_and_b32 v25, 0xffff0000, v80
    v_lshlrev_b32 v26, 16, v81
    v_and_b32 v27, 0xffff0000, v81
    v_lshlrev_b32 v28, 16, v82
    v_and_b32 v29, 0xffff0000, v82
    v_lshlrev_b32 v30, 16, v83
    v_and_b32 v31, 0xffff0000, v83
    v_lshlrev_b32 v32, 16, v84
    v_and_b32 v33, 0xffff0000, v84
    v_lshlrev_b32 v34, 16, v85
    v_and_b32 v35, 0xffff0000, v85
    v_lshlrev_b32 v36, 16, v86
    v_and_b32 v37, 0xffff0000, v86
    v_lshlrev_b32 v38, 16, v87
    v_and_b32 v39, 0xffff0000, v87
    ds_read_u8 v238, v246 offset:32
    ds_read_u8 v240, v246 offset:40
    s_add_u32 m0, s54, 4096
    v_add_u32 v246, 32, v246
    s_mov_b64 s[68:69], 0
    s_mov_b32 s75, 0
    s_movk_i32 s53, 0x1040
    s_mov_b32 s73, 3
    s_mov_b32 s77, 0
    s_mov_b32 s55, 0
    v_mov_b64 v[0:1], 0
    v_mov_b32 v2, 1.0
    v_mov_b32 v3, 1.0
    s_waitcnt lgkmcnt(0)
    s_barrier
    v_readfirstlane_b32 s45, v150
    buffer_load_dwordx4 v[238:239], s[20:23], s72 idxen offen nt lds
    buffer_load_dwordx4 v[240:241], s[20:23], s51 idxen offen offset:1024 nt lds
    s_cmp_eq_u32 s47, 0
    s_cbranch_scc1 P_GO
    s_lshl_b32 s56, s70, 8
    s_add_u32 s56, s56, 116992
    s_waitcnt vmcnt(2)
    v_mov_b64 v[204:205], v[180:181]
    v_mov_b64 v[206:207], v[182:183]
    s_call_b64 s[36:37], CMP
    v_writelane_b32 v212, s57, 0
    v_writelane_b32 v212, s58, 1
    s_cmp_le_u32 s47, 1
    s_cbranch_scc1 LATE_D
    s_add_u32 s56, s56, 512
    v_mov_b64 v[204:205], v[184:185]
    v_mov_b64 v[206:207], v[186:187]
    s_call_b64 s[36:37], CMP
    v_writelane_b32 v212, s57, 2
    v_writelane_b32 v212, s58, 3
    s_cmp_le_u32 s47, 2
    s_cbranch_scc1 LATE_D
    s_add_u32 s56, s56, 512
    v_mov_b64 v[204:205], v[188:189]
    v_mov_b64 v[206:207], v[190:191]
    s_call_b64 s[36:37], CMP
    v_writelane_b32 v212, s57, 4
    v_writelane_b32 v212, s58, 5
    s_cmp_le_u32 s47, 3
    s_cbranch_scc1 LATE_D
    s_add_u32 s56, s56, 512
    v_mov_b64 v[204:205], v[192:193]
    v_mov_b64 v[206:207], v[194:195]
    s_call_b64 s[36:37], CMP
    v_writelane_b32 v212, s57, 6
    v_writelane_b32 v212, s58, 7
    s_cmp_le_u32 s47, 4
    s_cbranch_scc1 LATE_D
    s_add_u32 s56, s56, 512
    v_mov_b64 v[204:205], v[196:197]
    v_mov_b64 v[206:207], v[198:199]
    s_call_b64 s[36:37], CMP
    v_writelane_b32 v212, s57, 8
    v_writelane_b32 v212, s58, 9
    s_cmp_le_u32 s47, 5
    s_cbranch_scc1 LATE_D
    s_add_u32 s56, s56, 512
    v_mov_b64 v[204:205], v[200:201]
    v_mov_b64 v[206:207], v[202:203]
    s_call_b64 s[36:37], CMP
    v_writelane_b32 v212, s57, 10
    v_writelane_b32 v212, s58, 11
LATE_D:
    v_add_u32 v4, s70, v176
    s_lshl_b32 s56, s47, 1
    v_and_b32 v5, 0xff, v212
    v_add_u32 v5, 15, v5
    v_lshrrev_b32 v212, 8, v212
    v_and_b32 v6, 15, v5
    v_lshl_or_b32 v212, v6, 12, v212
    v_lshrrev_b32 v5, 4, v5
    v_max_u32 v5, 2, v5
    v_or_b32 v212, v212, v4
    v_cmp_gt_u32 vcc, 64, v4
    v_lshl_or_b32 v6, v5, 8, v212
    v_lshlrev_b32 v4, 2, v4
    s_bfm_b64 s[66:67], s56, 0
    s_and_b64 exec, s[66:67], vcc
    ds_write_b32 v4, v6 offset:17152
    s_mov_b64 exec, -1
P_GO:
    ds_read_b128 v[180:183], v251 offset:0
    ds_read_b128 v[184:187], v251 offset:1024
    ds_read_b128 v[196:199], v251 offset:4096
    ds_read_b128 v[200:203], v251 offset:5120
    ds_read_b128 v[212:215], v251 offset:8192
    ds_read_b128 v[216:219], v251 offset:9216
    ds_read_b128 v[188:191], v251 offset:2048
    ds_read_b128 v[192:195], v251 offset:3072
    ds_read_b128 v[204:207], v251 offset:6144
    ds_read_b128 v[208:211], v251 offset:7168
    ds_read_b128 v[220:223], v251 offset:10240
    ds_read_b128 v[224:227], v251 offset:11264
    ds_read_b128 v[228:231], v251 offset:14336
    ds_read_b128 v[232:235], v251 offset:15360
    v_lshlrev_b32 v40, 16, v88
    v_and_b32 v41, 0xffff0000, v88
    v_lshlrev_b32 v42, 16, v89
    v_and_b32 v43, 0xffff0000, v89
    v_lshlrev_b32 v44, 16, v90
    v_and_b32 v45, 0xffff0000, v90
    v_lshlrev_b32 v46, 16, v91
    v_and_b32 v47, 0xffff0000, v91
    v_lshlrev_b32 v48, 16, v92
    v_and_b32 v49, 0xffff0000, v92
    v_lshlrev_b32 v50, 16, v93
    v_and_b32 v51, 0xffff0000, v93
    v_lshlrev_b32 v52, 16, v94
    v_and_b32 v53, 0xffff0000, v94
    v_lshlrev_b32 v54, 16, v95
    v_and_b32 v55, 0xffff0000, v95
    v_lshlrev_b32 v56, 16, v96
    v_and_b32 v57, 0xffff0000, v96
    v_lshlrev_b32 v58, 16, v97
    v_and_b32 v59, 0xffff0000, v97
    v_lshlrev_b32 v60, 16, v98
    v_and_b32 v61, 0xffff0000, v98
    v_lshlrev_b32 v62, 16, v99
    v_and_b32 v63, 0xffff0000, v99
    v_lshlrev_b32 v64, 16, v100
    v_and_b32 v65, 0xffff0000, v100
    v_lshlrev_b32 v66, 16, v101
    v_and_b32 v67, 0xffff0000, v101
    v_lshlrev_b32 v68, 16, v102
    v_and_b32 v69, 0xffff0000, v102
    v_lshlrev_b32 v70, 16, v103
    v_and_b32 v71, 0xffff0000, v103
    v_mov_b64 v[176:177], 0
    v_mov_b64 v[178:179], 0
    s_sub_u32 s50, s50, 2
    s_cbranch_scc1 DRAW_P
DRET_P:
    s_waitcnt vmcnt(4)
    ds_read_b128 v[152:155], v242
    ds_read_b128 v[156:159], v243
    s_branch BPF
U_0:
    v_mfma_f32_16x16x32_bf16 v[104:107], v[72:75], v[152:155], v[136:139]
    s_add_u32 m0, s54, 6144
    v_rcp_f32 v2, v2
    v_mfma_f32_16x16x32_bf16 v[104:107], v[76:79], v[156:159], v[104:107]
    s_mov_b32 s73, 0
    v_rcp_f32 v3, v3
    v_mfma_f32_16x16x32_bf16 v[108:111], v[80:83], v[152:155], v[140:143]
    s_sub_u32 s50, s50, 1
    v_fma_f32 v0, v0, v2, s44
    v_fmac_f32 v0, v1, v3
    v_mfma_f32_16x16x32_bf16 v[108:111], v[84:87], v[156:159], v[108:111]
    s_cbranch_scc1 PEV
    v_add_u32 v246, 16, v246
RET_0:
    v_cvt_pk_bf16_f32 v0, v0, v0
    v_mfma_f32_16x16x32_bf16 v[112:115], v[88:91], v[152:155], v[144:147]
    v_exp_f32 v104, v104
    v_mfma_f32_16x16x32_bf16 v[112:115], v[92:95], v[156:159], v[112:115]
    v_exp_f32 v105, v105
    v_mfma_f32_16x16x32_bf16 v[116:119], v[96:99], v[152:155], v[148:151]
    s_sub_u32 s62, s62, 1
    v_exp_f32 v106, v106
    v_mfma_f32_16x16x32_bf16 v[116:119], v[100:103], v[156:159], v[116:119]
    s_waitcnt vmcnt(2)
    v_exp_f32 v107, v107
    ds_write_b16 v249, v0
    ds_read_b64 v[236:237], v248
    ds_read_b64_tr_b16 v[160:161], v244 offset:0
    ds_read_b64_tr_b16 v[162:163], v245 offset:512
    ds_read_b64_tr_b16 v[164:165], v244 offset:1024
    ds_read_b64_tr_b16 v[166:167], v245 offset:1536
    ds_read_u8 v238, v246 offset:0
    ds_read_u8 v240, v246 offset:8
    ds_read_b128 v[152:155], v242 offset:2048
    ds_read_b128 v[156:159], v243 offset:2048
    v_exp_f32 v108, v108
    v_exp_f32 v109, v109
    v_exp_f32 v110, v110
    v_exp_f32 v111, v111
    s_waitcnt lgkmcnt(8)
    v_mfma_f32_4x4x4_16b_bf16 v[176:179], v[236:237], v[168:169], v[176:179] cbsz:4 abid:0
    v_exp_f32 v112, v112
    v_exp_f32 v113, v113
    v_mfma_f32_4x4x4_16b_bf16 v[176:179], v[236:237], v[170:171], v[176:179] cbsz:4 abid:1
    v_exp_f32 v114, v114
    v_exp_f32 v115, v115
    v_mfma_f32_4x4x4_16b_bf16 v[176:179], v[236:237], v[172:173], v[176:179] cbsz:4 abid:2
    v_exp_f32 v116, v116
    v_exp_f32 v117, v117
    v_mfma_f32_4x4x4_16b_bf16 v[176:179], v[236:237], v[174:175], v[176:179] cbsz:4 abid:3
    v_exp_f32 v118, v118
    v_exp_f32 v119, v119
    s_waitcnt lgkmcnt(0)
    buffer_load_dwordx4 v[238:239], s[20:23], s72 idxen offen nt lds
    buffer_load_dwordx4 v[240:241], s[20:23], s51 idxen offen offset:1024 nt lds
    s_cselect_b64 exec, s[78:79], -1
    .p2align 3
    v_pk_fma_f32 v[2:3], v[104:105], s[42:43], s[42:43] op_sel_hi:[1,0,0]
    v_pk_fma_f32 v[0:1], v[120:121], v[106:107], v[120:121]
    v_pk_fma_f32 v[0:1], v[122:123], v[2:3], v[0:1]
    v_pk_fma_f32 v[2:3], v[106:107], v[2:3], v[2:3]
    v_pk_fma_f32 v[0:1], v[108:109], v[0:1], v[0:1]
    v_pk_fma_f32 v[0:1], v[124:125], v[2:3], v[0:1]
    v_pk_fma_f32 v[2:3], v[108:109], v[2:3], v[2:3]
    v_pk_fma_f32 v[0:1], v[110:111], v[0:1], v[0:1]
    v_pk_fma_f32 v[0:1], v[126:127], v[2:3], v[0:1]
    v_pk_fma_f32 v[2:3], v[110:111], v[2:3], v[2:3]
    v_pk_fma_f32 v[0:1], v[112:113], v[0:1], v[0:1]
    v_pk_fma_f32 v[0:1], v[128:129], v[2:3], v[0:1]
    v_pk_fma_f32 v[2:3], v[112:113], v[2:3], v[2:3]
    v_pk_fma_f32 v[0:1], v[114:115], v[0:1], v[0:1]
    v_pk_fma_f32 v[0:1], v[130:131], v[2:3], v[0:1]
    v_pk_fma_f32 v[2:3], v[114:115], v[2:3], v[2:3]
    v_pk_fma_f32 v[0:1], v[116:117], v[0:1], v[0:1]
    v_pk_fma_f32 v[0:1], v[132:133], v[2:3], v[0:1]
    v_pk_fma_f32 v[2:3], v[116:117], v[2:3], v[2:3]
    v_pk_fma_f32 v[0:1], v[118:119], v[0:1], v[0:1]
    v_pk_fma_f32 v[0:1], v[134:135], v[2:3], v[0:1]
    v_pk_fma_f32 v[2:3], v[118:119], v[2:3], v[2:3]
    s_mov_b64 exec, -1
    s_cbranch_scc1 CEV
U_1:
    v_mfma_f32_16x16x32_bf16 v[104:107], v[72:75], v[152:155], v[136:139]
    s_add_u32 m0, s54, 0
    v_rcp_f32 v2, v2
    v_mfma_f32_16x16x32_bf16 v[104:107], v[76:79], v[156:159], v[104:107]
    s_mov_b32 s73, 1
    v_rcp_f32 v3, v3
    v_mfma_f32_16x16x32_bf16 v[108:111], v[80:83], v[152:155], v[140:143]
    s_sub_u32 s50, s50, 1
    v_fma_f32 v0, v0, v2, s44
    v_fmac_f32 v0, v1, v3
    v_mfma_f32_16x16x32_bf16 v[108:111], v[84:87], v[156:159], v[108:111]
    s_cbranch_scc1 PEV
    v_add_u32 v246, 16, v246
RET_1:
    v_cvt_pk_bf16_f32 v0, v0, v0
    v_mfma_f32_16x16x32_bf16 v[112:115], v[88:91], v[152:155], v[144:147]
    v_exp_f32 v104, v104
    v_mfma_f32_16x16x32_bf16 v[112:115], v[92:95], v[156:159], v[112:115]
    v_exp_f32 v105, v105
    v_mfma_f32_16x16x32_bf16 v[116:119], v[96:99], v[152:155], v[148:151]
    s_sub_u32 s62, s62, 1
    v_exp_f32 v106, v106
    v_mfma_f32_16x16x32_bf16 v[116:119], v[100:103], v[156:159], v[116:119]
    s_waitcnt vmcnt(2)
    v_exp_f32 v107, v107
    ds_write_b16 v249, v0
    ds_read_b64 v[236:237], v248
    ds_read_b64_tr_b16 v[168:169], v244 offset:2048
    ds_read_b64_tr_b16 v[170:171], v245 offset:2560
    ds_read_b64_tr_b16 v[172:173], v244 offset:3072
    ds_read_b64_tr_b16 v[174:175], v245 offset:3584
    ds_read_u8 v238, v246 offset:0
    ds_read_u8 v240, v246 offset:8
    ds_read_b128 v[152:155], v242 offset:4096
    ds_read_b128 v[156:159], v243 offset:4096
    v_exp_f32 v108, v108
    v_exp_f32 v109, v109
    v_exp_f32 v110, v110
    v_exp_f32 v111, v111
    s_waitcnt lgkmcnt(8)
    v_mfma_f32_4x4x4_16b_bf16 v[176:179], v[236:237], v[160:161], v[176:179] cbsz:4 abid:0
    v_exp_f32 v112, v112
    v_exp_f32 v113, v113
    v_mfma_f32_4x4x4_16b_bf16 v[176:179], v[236:237], v[162:163], v[176:179] cbsz:4 abid:1
    v_exp_f32 v114, v114
    v_exp_f32 v115, v115
    v_mfma_f32_4x4x4_16b_bf16 v[176:179], v[236:237], v[164:165], v[176:179] cbsz:4 abid:2
    v_exp_f32 v116, v116
    v_exp_f32 v117, v117
    v_mfma_f32_4x4x4_16b_bf16 v[176:179], v[236:237], v[166:167], v[176:179] cbsz:4 abid:3
    v_exp_f32 v118, v118
    v_exp_f32 v119, v119
    s_waitcnt lgkmcnt(0)
    buffer_load_dwordx4 v[238:239], s[20:23], s72 idxen offen nt lds
    buffer_load_dwordx4 v[240:241], s[20:23], s51 idxen offen offset:1024 nt lds
    s_cselect_b64 exec, s[78:79], -1
    .p2align 3
    v_pk_fma_f32 v[2:3], v[104:105], s[42:43], s[42:43] op_sel_hi:[1,0,0]
    v_pk_fma_f32 v[0:1], v[120:121], v[106:107], v[120:121]
    v_pk_fma_f32 v[0:1], v[122:123], v[2:3], v[0:1]
    v_pk_fma_f32 v[2:3], v[106:107], v[2:3], v[2:3]
    v_pk_fma_f32 v[0:1], v[108:109], v[0:1], v[0:1]
    v_pk_fma_f32 v[0:1], v[124:125], v[2:3], v[0:1]
    v_pk_fma_f32 v[2:3], v[108:109], v[2:3], v[2:3]
    v_pk_fma_f32 v[0:1], v[110:111], v[0:1], v[0:1]
    v_pk_fma_f32 v[0:1], v[126:127], v[2:3], v[0:1]
    v_pk_fma_f32 v[2:3], v[110:111], v[2:3], v[2:3]
    v_pk_fma_f32 v[0:1], v[112:113], v[0:1], v[0:1]
    v_pk_fma_f32 v[0:1], v[128:129], v[2:3], v[0:1]
    v_pk_fma_f32 v[2:3], v[112:113], v[2:3], v[2:3]
    v_pk_fma_f32 v[0:1], v[114:115], v[0:1], v[0:1]
    v_pk_fma_f32 v[0:1], v[130:131], v[2:3], v[0:1]
    v_pk_fma_f32 v[2:3], v[114:115], v[2:3], v[2:3]
    v_pk_fma_f32 v[0:1], v[116:117], v[0:1], v[0:1]
    v_pk_fma_f32 v[0:1], v[132:133], v[2:3], v[0:1]
    v_pk_fma_f32 v[2:3], v[116:117], v[2:3], v[2:3]
    v_pk_fma_f32 v[0:1], v[118:119], v[0:1], v[0:1]
    v_pk_fma_f32 v[0:1], v[134:135], v[2:3], v[0:1]
    v_pk_fma_f32 v[2:3], v[118:119], v[2:3], v[2:3]
    s_mov_b64 exec, -1
    s_cbranch_scc1 CEV
U_2:
    v_mfma_f32_16x16x32_bf16 v[104:107], v[72:75], v[152:155], v[136:139]
    s_add_u32 m0, s54, 2048
    v_rcp_f32 v2, v2
    v_mfma_f32_16x16x32_bf16 v[104:107], v[76:79], v[156:159], v[104:107]
    s_mov_b32 s73, 2
    v_rcp_f32 v3, v3
    v_mfma_f32_16x16x32_bf16 v[108:111], v[80:83], v[152:155], v[140:143]
    s_sub_u32 s50, s50, 1
    v_fma_f32 v0, v0, v2, s44
    v_fmac_f32 v0, v1, v3
    v_mfma_f32_16x16x32_bf16 v[108:111], v[84:87], v[156:159], v[108:111]
    s_cbranch_scc1 PEV
    v_add_u32 v246, 16, v246
RET_2:
    v_cvt_pk_bf16_f32 v0, v0, v0
    v_mfma_f32_16x16x32_bf16 v[112:115], v[88:91], v[152:155], v[144:147]
    v_exp_f32 v104, v104
    v_mfma_f32_16x16x32_bf16 v[112:115], v[92:95], v[156:159], v[112:115]
    v_exp_f32 v105, v105
    v_mfma_f32_16x16x32_bf16 v[116:119], v[96:99], v[152:155], v[148:151]
    s_sub_u32 s62, s62, 1
    v_exp_f32 v106, v106
    v_mfma_f32_16x16x32_bf16 v[116:119], v[100:103], v[156:159], v[116:119]
    s_waitcnt vmcnt(2)
    v_exp_f32 v107, v107
    ds_write_b16 v249, v0
    ds_read_b64 v[236:237], v248
    ds_read_b64_tr_b16 v[160:161], v244 offset:4096
    ds_read_b64_tr_b16 v[162:163], v245 offset:4608
    ds_read_b64_tr_b16 v[164:165], v244 offset:5120
    ds_read_b64_tr_b16 v[166:167], v245 offset:5632
    ds_read_u8 v238, v246 offset:0
    ds_read_u8 v240, v246 offset:8
    ds_read_b128 v[152:155], v242 offset:6144
    ds_read_b128 v[156:159], v243 offset:6144
    v_exp_f32 v108, v108
    v_exp_f32 v109, v109
    v_exp_f32 v110, v110
    v_exp_f32 v111, v111
    s_waitcnt lgkmcnt(8)
    v_mfma_f32_4x4x4_16b_bf16 v[176:179], v[236:237], v[168:169], v[176:179] cbsz:4 abid:0
    v_exp_f32 v112, v112
    v_exp_f32 v113, v113
    v_mfma_f32_4x4x4_16b_bf16 v[176:179], v[236:237], v[170:171], v[176:179] cbsz:4 abid:1
    v_exp_f32 v114, v114
    v_exp_f32 v115, v115
    v_mfma_f32_4x4x4_16b_bf16 v[176:179], v[236:237], v[172:173], v[176:179] cbsz:4 abid:2
    v_exp_f32 v116, v116
    v_exp_f32 v117, v117
    v_mfma_f32_4x4x4_16b_bf16 v[176:179], v[236:237], v[174:175], v[176:179] cbsz:4 abid:3
    v_exp_f32 v118, v118
    v_exp_f32 v119, v119
    s_waitcnt lgkmcnt(0)
    buffer_load_dwordx4 v[238:239], s[20:23], s72 idxen offen nt lds
    buffer_load_dwordx4 v[240:241], s[20:23], s51 idxen offen offset:1024 nt lds
    s_cselect_b64 exec, s[78:79], -1
    .p2align 3
    v_pk_fma_f32 v[2:3], v[104:105], s[42:43], s[42:43] op_sel_hi:[1,0,0]
    v_pk_fma_f32 v[0:1], v[120:121], v[106:107], v[120:121]
    v_pk_fma_f32 v[0:1], v[122:123], v[2:3], v[0:1]
    v_pk_fma_f32 v[2:3], v[106:107], v[2:3], v[2:3]
    v_pk_fma_f32 v[0:1], v[108:109], v[0:1], v[0:1]
    v_pk_fma_f32 v[0:1], v[124:125], v[2:3], v[0:1]
    v_pk_fma_f32 v[2:3], v[108:109], v[2:3], v[2:3]
    v_pk_fma_f32 v[0:1], v[110:111], v[0:1], v[0:1]
    v_pk_fma_f32 v[0:1], v[126:127], v[2:3], v[0:1]
    v_pk_fma_f32 v[2:3], v[110:111], v[2:3], v[2:3]
    v_pk_fma_f32 v[0:1], v[112:113], v[0:1], v[0:1]
    v_pk_fma_f32 v[0:1], v[128:129], v[2:3], v[0:1]
    v_pk_fma_f32 v[2:3], v[112:113], v[2:3], v[2:3]
    v_pk_fma_f32 v[0:1], v[114:115], v[0:1], v[0:1]
    v_pk_fma_f32 v[0:1], v[130:131], v[2:3], v[0:1]
    v_pk_fma_f32 v[2:3], v[114:115], v[2:3], v[2:3]
    v_pk_fma_f32 v[0:1], v[116:117], v[0:1], v[0:1]
    v_pk_fma_f32 v[0:1], v[132:133], v[2:3], v[0:1]
    v_pk_fma_f32 v[2:3], v[116:117], v[2:3], v[2:3]
    v_pk_fma_f32 v[0:1], v[118:119], v[0:1], v[0:1]
    v_pk_fma_f32 v[0:1], v[134:135], v[2:3], v[0:1]
    v_pk_fma_f32 v[2:3], v[118:119], v[2:3], v[2:3]
    s_mov_b64 exec, -1
    s_cbranch_scc1 CEV
U_3:
    v_mfma_f32_16x16x32_bf16 v[104:107], v[72:75], v[152:155], v[136:139]
    s_add_u32 m0, s54, 4096
    v_rcp_f32 v2, v2
    v_mfma_f32_16x16x32_bf16 v[104:107], v[76:79], v[156:159], v[104:107]
    s_mov_b32 s73, 3
    v_rcp_f32 v3, v3
    v_mfma_f32_16x16x32_bf16 v[108:111], v[80:83], v[152:155], v[140:143]
    s_sub_u32 s50, s50, 1
    v_fma_f32 v0, v0, v2, s44
    v_fmac_f32 v0, v1, v3
    v_mfma_f32_16x16x32_bf16 v[108:111], v[84:87], v[156:159], v[108:111]
    s_cbranch_scc1 PEV
    v_add_u32 v246, 16, v246
RET_3:
    v_cvt_pk_bf16_f32 v0, v0, v0
    v_mfma_f32_16x16x32_bf16 v[112:115], v[88:91], v[152:155], v[144:147]
    v_exp_f32 v104, v104
    v_mfma_f32_16x16x32_bf16 v[112:115], v[92:95], v[156:159], v[112:115]
    v_exp_f32 v105, v105
    v_mfma_f32_16x16x32_bf16 v[116:119], v[96:99], v[152:155], v[148:151]
    s_sub_u32 s62, s62, 1
    v_exp_f32 v106, v106
    v_mfma_f32_16x16x32_bf16 v[116:119], v[100:103], v[156:159], v[116:119]
    s_waitcnt vmcnt(2)
    v_exp_f32 v107, v107
    ds_write_b16 v249, v0
    ds_read_b64 v[236:237], v248
    ds_read_b64_tr_b16 v[168:169], v244 offset:6144
    ds_read_b64_tr_b16 v[170:171], v245 offset:6656
    ds_read_b64_tr_b16 v[172:173], v244 offset:7168
    ds_read_b64_tr_b16 v[174:175], v245 offset:7680
    ds_read_u8 v238, v246 offset:0
    ds_read_u8 v240, v246 offset:8
    ds_read_b128 v[152:155], v242 offset:0
    ds_read_b128 v[156:159], v243 offset:0
    v_exp_f32 v108, v108
    v_exp_f32 v109, v109
    v_exp_f32 v110, v110
    v_exp_f32 v111, v111
    s_waitcnt lgkmcnt(8)
    v_mfma_f32_4x4x4_16b_bf16 v[176:179], v[236:237], v[160:161], v[176:179] cbsz:4 abid:0
    v_exp_f32 v112, v112
    v_exp_f32 v113, v113
    v_mfma_f32_4x4x4_16b_bf16 v[176:179], v[236:237], v[162:163], v[176:179] cbsz:4 abid:1
    v_exp_f32 v114, v114
    v_exp_f32 v115, v115
    v_mfma_f32_4x4x4_16b_bf16 v[176:179], v[236:237], v[164:165], v[176:179] cbsz:4 abid:2
    v_exp_f32 v116, v116
    v_exp_f32 v117, v117
    v_mfma_f32_4x4x4_16b_bf16 v[176:179], v[236:237], v[166:167], v[176:179] cbsz:4 abid:3
    v_exp_f32 v118, v118
    v_exp_f32 v119, v119
    s_waitcnt lgkmcnt(0)
    buffer_load_dwordx4 v[238:239], s[20:23], s72 idxen offen nt lds
    buffer_load_dwordx4 v[240:241], s[20:23], s51 idxen offen offset:1024 nt lds
    s_cselect_b64 exec, s[78:79], -1
    .p2align 3
    v_pk_fma_f32 v[2:3], v[104:105], s[42:43], s[42:43] op_sel_hi:[1,0,0]
    v_pk_fma_f32 v[0:1], v[120:121], v[106:107], v[120:121]
    v_pk_fma_f32 v[0:1], v[122:123], v[2:3], v[0:1]
    v_pk_fma_f32 v[2:3], v[106:107], v[2:3], v[2:3]
    v_pk_fma_f32 v[0:1], v[108:109], v[0:1], v[0:1]
    v_pk_fma_f32 v[0:1], v[124:125], v[2:3], v[0:1]
    v_pk_fma_f32 v[2:3], v[108:109], v[2:3], v[2:3]
    v_pk_fma_f32 v[0:1], v[110:111], v[0:1], v[0:1]
    v_pk_fma_f32 v[0:1], v[126:127], v[2:3], v[0:1]
    v_pk_fma_f32 v[2:3], v[110:111], v[2:3], v[2:3]
    v_pk_fma_f32 v[0:1], v[112:113], v[0:1], v[0:1]
    v_pk_fma_f32 v[0:1], v[128:129], v[2:3], v[0:1]
    v_pk_fma_f32 v[2:3], v[112:113], v[2:3], v[2:3]
    v_pk_fma_f32 v[0:1], v[114:115], v[0:1], v[0:1]
    v_pk_fma_f32 v[0:1], v[130:131], v[2:3], v[0:1]
    v_pk_fma_f32 v[2:3], v[114:115], v[2:3], v[2:3]
    v_pk_fma_f32 v[0:1], v[116:117], v[0:1], v[0:1]
    v_pk_fma_f32 v[0:1], v[132:133], v[2:3], v[0:1]
    v_pk_fma_f32 v[2:3], v[116:117], v[2:3], v[2:3]
    v_pk_fma_f32 v[0:1], v[118:119], v[0:1], v[0:1]
    v_pk_fma_f32 v[0:1], v[134:135], v[2:3], v[0:1]
    v_pk_fma_f32 v[2:3], v[118:119], v[2:3], v[2:3]
    s_mov_b64 exec, -1
    s_cbranch_scc0 U_0
CEV:
    s_cmp_eq_u32 s76, 0
    s_cbranch_scc1 EPI
    s_mov_b32 s53, s52
    s_and_b32 s52, s68, 0xffff
    s_lshr_b64 s[68:69], s[68:69], 16
    s_sub_u32 s75, s75, 16
    s_bitcmp1_b32 s52, 6
    s_cbranch_scc1 DRAIN
BPF:
    s_and_b32 s57, s52, 63
    s_mul_i32 s57, s57, 528
    s_add_u32 s57, s57, 83200
    v_lshl_add_u32 v6, v252, 1, s57
    v_add_u32 v7, s57, v252
    ds_read_b128 v[104:107], v6 offset:0
    ds_read_b128 v[108:111], v6 offset:16
    ds_read_b128 v[144:147], v251 offset:12288
    ds_read_b128 v[148:151], v251 offset:13312
    ds_read_b128 v[112:115], v6 offset:128
    ds_read_b128 v[116:119], v6 offset:144
    s_mov_b32 s62, 0
    s_mov_b32 s76, 0
    s_mov_b64 s[78:79], -1
    s_cmp_lg_u32 s77, 0
    s_waitcnt lgkmcnt(4)
    .p2align 3
    v_pk_fma_f32 v[136:137], v[8:9], v[104:105], v[180:181]
    v_pk_fma_f32 v[138:139], v[10:11], v[106:107], v[182:183]
    v_pk_fma_f32 v[140:141], v[12:13], v[108:109], v[184:185]
    v_pk_fma_f32 v[142:143], v[14:15], v[110:111], v[186:187]
    v_cvt_pk_bf16_f32 v72, v136, v137
    v_cvt_pk_bf16_f32 v73, v138, v139
    v_cvt_pk_bf16_f32 v74, v140, v141
    v_cvt_pk_bf16_f32 v75, v142, v143
    v_pk_fma_f32 v[136:137], v[24:25], v[104:105], v[196:197]
    v_pk_fma_f32 v[138:139], v[26:27], v[106:107], v[198:199]
    v_pk_fma_f32 v[140:141], v[28:29], v[108:109], v[200:201]
    v_pk_fma_f32 v[142:143], v[30:31], v[110:111], v[202:203]
    v_cvt_pk_bf16_f32 v80, v136, v137
    v_cvt_pk_bf16_f32 v81, v138, v139
    v_cvt_pk_bf16_f32 v82, v140, v141
    v_cvt_pk_bf16_f32 v83, v142, v143
    v_pk_fma_f32 v[136:137], v[40:41], v[104:105], v[212:213]
    v_pk_fma_f32 v[138:139], v[42:43], v[106:107], v[214:215]
    v_pk_fma_f32 v[140:141], v[44:45], v[108:109], v[216:217]
    v_pk_fma_f32 v[142:143], v[46:47], v[110:111], v[218:219]
    v_cvt_pk_bf16_f32 v88, v136, v137
    v_cvt_pk_bf16_f32 v89, v138, v139
    v_cvt_pk_bf16_f32 v90, v140, v141
    v_cvt_pk_bf16_f32 v91, v142, v143
    s_waitcnt lgkmcnt(0)
    .p2align 3
    v_pk_fma_f32 v[144:145], v[56:57], v[104:105], v[144:145]
    v_pk_fma_f32 v[146:147], v[58:59], v[106:107], v[146:147]
    v_pk_fma_f32 v[148:149], v[60:61], v[108:109], v[148:149]
    v_pk_fma_f32 v[150:151], v[62:63], v[110:111], v[150:151]
    v_cvt_pk_bf16_f32 v96, v144, v145
    v_cvt_pk_bf16_f32 v97, v146, v147
    v_cvt_pk_bf16_f32 v98, v148, v149
    v_cvt_pk_bf16_f32 v99, v150, v151
    ds_read_b128 v[136:139], v7 offset:256
    ds_read_b128 v[140:143], v7 offset:320
    ds_read_b128 v[144:147], v7 offset:384
    ds_read_b128 v[148:151], v7 offset:448
    v_pk_fma_f32 v[104:105], v[16:17], v[112:113], v[188:189]
    v_pk_fma_f32 v[106:107], v[18:19], v[114:115], v[190:191]
    v_pk_fma_f32 v[108:109], v[20:21], v[116:117], v[192:193]
    v_pk_fma_f32 v[110:111], v[22:23], v[118:119], v[194:195]
    v_cvt_pk_bf16_f32 v76, v104, v105
    v_cvt_pk_bf16_f32 v77, v106, v107
    v_cvt_pk_bf16_f32 v78, v108, v109
    v_cvt_pk_bf16_f32 v79, v110, v111
    v_pk_fma_f32 v[104:105], v[32:33], v[112:113], v[204:205]
    v_pk_fma_f32 v[106:107], v[34:35], v[114:115], v[206:207]
    v_pk_fma_f32 v[108:109], v[36:37], v[116:117], v[208:209]
    v_pk_fma_f32 v[110:111], v[38:39], v[118:119], v[210:211]
    v_cvt_pk_bf16_f32 v84, v104, v105
    v_cvt_pk_bf16_f32 v85, v106, v107
    v_cvt_pk_bf16_f32 v86, v108, v109
    v_cvt_pk_bf16_f32 v87, v110, v111
    v_pk_fma_f32 v[104:105], v[48:49], v[112:113], v[220:221]
    v_pk_fma_f32 v[106:107], v[50:51], v[114:115], v[222:223]
    v_pk_fma_f32 v[108:109], v[52:53], v[116:117], v[224:225]
    v_pk_fma_f32 v[110:111], v[54:55], v[118:119], v[226:227]
    v_cvt_pk_bf16_f32 v92, v104, v105
    v_cvt_pk_bf16_f32 v93, v106, v107
    v_cvt_pk_bf16_f32 v94, v108, v109
    v_cvt_pk_bf16_f32 v95, v110, v111
    v_pk_fma_f32 v[104:105], v[64:65], v[112:113], v[228:229]
    v_pk_fma_f32 v[106:107], v[66:67], v[114:115], v[230:231]
    v_pk_fma_f32 v[108:109], v[68:69], v[116:117], v[232:233]
    v_pk_fma_f32 v[110:111], v[70:71], v[118:119], v[234:235]
    v_cvt_pk_bf16_f32 v100, v104, v105
    v_cvt_pk_bf16_f32 v101, v106, v107
    v_cvt_pk_bf16_f32 v102, v108, v109
    v_cvt_pk_bf16_f32 v103, v110, v111
    s_waitcnt lgkmcnt(0)
    s_cbranch_scc1 BP_X
NEXT:
    s_cmp_eq_u32 s73, 0
    s_cbranch_scc1 U_1
    s_cmp_eq_u32 s73, 1
    s_cbranch_scc1 U_2
    s_cmp_eq_u32 s73, 2
    s_cbranch_scc1 U_3
    s_branch U_0
EPI:
    s_and_b32 s56, s53, 0x7f
    v_pk_add_f32 v[4:5], v[176:177], v[178:179]
    v_add_f32 v4, v4, v5
    v_lshl_add_u32 v5, s56, 8, v250
    v_mul_f32 v4, s46, v4
    s_and_b32 s56, s53, 0x80
    v_cmp_class_f32_e64 s[64:65], v4, s45
    v_mov_b64 v[176:177], 0
    v_mov_b64 v[178:179], 0
    ds_write_b32 v5, v4
    s_or_b32 s64, s64, s56
    s_cmp_lg_u64 s[64:65], 0
    s_cbranch_scc1 SLOW
EPI_R:
    s_bitcmp1_b32 s52, 6
    s_cbranch_scc1 L_DONE
EPI_C:
    s_bfe_u32 s62, s52, 0x40008
    s_sub_u32 s62, s62, 2
    s_mov_b32 s76, 1
    s_lshr_b32 s56, s52, 12
    s_lshl_b32 s78, 0x20002, s56
    s_sub_u32 s78, s78, 0x10001
    s_mov_b32 s79, s78
    s_cmp_eq_u32 s73, 0
    s_cbranch_scc1 U_1
    s_cmp_eq_u32 s73, 1
    s_cbranch_scc1 U_2
    s_cmp_eq_u32 s73, 2
    s_cbranch_scc1 U_3
    s_branch U_0
PEV:
    s_cmp_eq_u32 s55, 0
    s_cbranch_scc1 P_DR
    ds_read_b32 v254, v253
    s_waitcnt lgkmcnt(0)
ADV:
    v_readfirstlane_b32 s66, v254
    s_mov_b32 s67, 0
    s_and_b32 s56, s66, 63
    s_bfe_u32 s50, s66, 0x40008
    s_cbranch_scc0 AW
    s_lshr_b32 s57, s56, 3
    s_mul_i32 s51, s56, 25600
    s_mul_i32 s57, s57, 52224000
    s_add_u32 s51, s51, s57
    v_lshl_add_u32 v246, s56, 8, v247
    s_add_u32 s51, s51, s49
    s_add_u32 s72, s51, 1024
    s_lshl_b64 s[64:65], s[66:67], s75
    s_or_b64 s[68:69], s[68:69], s[64:65]
    s_add_u32 s75, s75, 16
    s_mov_b32 s55, 0
    s_sub_u32 s50, s50, 3
    s_cbranch_scc1 P_2
P_RET:
    s_cmp_eq_u32 s73, 0
    s_cbranch_scc1 RET_0
    s_cmp_eq_u32 s73, 1
    s_cbranch_scc1 RET_1
    s_cmp_eq_u32 s73, 2
    s_cbranch_scc1 RET_2
    s_branch RET_3
P_DR:
    v_add_u32 v246, 16, v246
P_D2:
    s_mov_b64 exec, 1
    v_mov_b32 v253, 4
    ds_add_rtn_u32 v253, v251, v253 offset:17600
    s_mov_b64 exec, -1
    s_mov_b32 s50, 1
    s_mov_b32 s55, 1
    s_cmp_eq_u32 s73, 0
    s_cbranch_scc1 RET_0
    s_cmp_eq_u32 s73, 1
    s_cbranch_scc1 RET_1
    s_cmp_eq_u32 s73, 2
    s_cbranch_scc1 RET_2
    s_branch RET_3
P_2:
    s_bitcmp1_b32 s66, 6
    s_cbranch_scc0 P_D2
    v_mov_b32 v246, 16896
    s_movk_i32 s50, 0x100
    s_branch P_RET
DRAIN:
    v_rcp_f32 v2, v2
    v_rcp_f32 v3, v3
    v_fma_f32 v0, v0, v2, s44
    v_fmac_f32 v0, v1, v3
    v_cvt_pk_bf16_f32 v0, v0, v0
    s_bitcmp1_b32 s73, 0
    ds_write_b16 v249, v0
    ds_read_b64 v[236:237], v248
    s_waitcnt lgkmcnt(0)
    s_cbranch_scc1 DRAIN1
    v_mfma_f32_4x4x4_16b_bf16 v[176:179], v[236:237], v[160:161], v[176:179] cbsz:4 abid:0
    s_nop 1
    v_mfma_f32_4x4x4_16b_bf16 v[176:179], v[236:237], v[162:163], v[176:179] cbsz:4 abid:1
    s_nop 1
    v_mfma_f32_4x4x4_16b_bf16 v[176:179], v[236:237], v[164:165], v[176:179] cbsz:4 abid:2
    s_nop 1
    v_mfma_f32_4x4x4_16b_bf16 v[176:179], v[236:237], v[166:167], v[176:179] cbsz:4 abid:3
    s_nop 2
    s_branch EPI
DRAIN1:
    v_mfma_f32_4x4x4_16b_bf16 v[176:179], v[236:237], v[168:169], v[176:179] cbsz:4 abid:0
    s_nop 1
    v_mfma_f32_4x4x4_16b_bf16 v[176:179], v[236:237], v[170:171], v[176:179] cbsz:4 abid:1
    s_nop 1
    v_mfma_f32_4x4x4_16b_bf16 v[176:179], v[236:237], v[172:173], v[176:179] cbsz:4 abid:2
    s_nop 1
    v_mfma_f32_4x4x4_16b_bf16 v[176:179], v[236:237], v[174:175], v[176:179] cbsz:4 abid:3
    s_nop 2
    s_branch EPI
L_DONE:
    s_lshl_b32 s56, s48, 11
    s_add_u32 s56, s56, 133376
    v_lshl_add_u32 v0, v251, 1, s56
    s_lshl_b32 s56, s48, 18
    s_waitcnt lgkmcnt(0)
    s_barrier
    ds_read_b128 v[104:107], v0 offset:0
    ds_read_b128 v[108:111], v0 offset:16
    s_waitcnt lgkmcnt(0)
    v_cvt_pk_bf16_f32 v152, v104, v105
    v_cvt_pk_bf16_f32 v153, v106, v107
    v_cvt_pk_bf16_f32 v154, v108, v109
    v_cvt_pk_bf16_f32 v155, v110, v111
    buffer_store_dwordx4 v[152:155], v251, s[28:31], s56 offen nt
L_FIN:
    s_endpgm
AW:
    s_sleep 1
    ds_read_b32 v254, v253
    s_waitcnt lgkmcnt(0)
    s_branch ADV
DRAW_P:
    s_mov_b64 exec, 1
    v_mov_b32 v253, 4
    ds_add_rtn_u32 v253, v251, v253 offset:17600
    s_mov_b64 exec, -1
    s_add_u32 s50, s50, 2
    s_mov_b32 s55, 1
    s_branch DRET_P
BP_X:
    s_cmp_eq_u32 s77, 1
    s_mov_b32 s77, 0
    s_cbranch_scc1 SLOW_W
    s_branch EPI_C
SLOW:
    s_bitcmp1_b32 s53, 6
    s_cbranch_scc1 EPI_R
    s_mov_b32 s74, s52
    s_mov_b32 s52, s53
    s_mov_b32 s77, 1
    ds_write_b32 v5, v176
    s_branch BPF
SLOW_W:
    s_load_dwordx2 s[4:5], s[0:1], 40
    v_lshrrev_b32 v204, 1, v252
    s_waitcnt lgkmcnt(0)
    global_load_dwordx2 v[196:197], v204, s[4:5] offset:0
    global_load_dwordx2 v[198:199], v204, s[4:5] offset:32
    global_load_dwordx2 v[200:201], v204, s[4:5] offset:64
    global_load_dwordx2 v[202:203], v204, s[4:5] offset:96
    s_waitcnt vmcnt(0)
    v_lshlrev_b32 v212, 16, v196
    v_and_b32 v213, 0xffff0000, v196
    v_lshlrev_b32 v214, 16, v197
    v_and_b32 v215, 0xffff0000, v197
    v_lshlrev_b32 v216, 16, v198
    v_and_b32 v217, 0xffff0000, v198
    v_lshlrev_b32 v218, 16, v199
    v_and_b32 v219, 0xffff0000, v199
    v_lshlrev_b32 v220, 16, v200
    v_and_b32 v221, 0xffff0000, v200
    v_lshlrev_b32 v222, 16, v201
    v_and_b32 v223, 0xffff0000, v201
    v_lshlrev_b32 v224, 16, v202
    v_and_b32 v225, 0xffff0000, v202
    v_lshlrev_b32 v226, 16, v203
    v_and_b32 v227, 0xffff0000, v203
    s_mov_b32 s52, s74
    s_and_b32 s56, s53, 63
    s_mov_b32 s57, 0
    s_bfe_u32 s59, s53, 0x40008
    s_lshl4_add_u32 s57, s56, s57
    s_lshl_b32 s57, s57, 4
    s_add_u32 s74, s57, 116992
    s_bitcmp1_b32 s53, 7
    s_cselect_b64 s[66:67], -1, 0
    s_cselect_b32 s59, 13, s59
    v_bfe_u32 v204, v251, 4, 4
    v_mov_b32 v207, v252
    v_mov_b64 v[180:181], 0
    v_mov_b64 v[182:183], 0
    v_mov_b64 v[184:185], 0
    v_mov_b64 v[186:187], 0
    v_mov_b64 v[188:189], 0
    v_mov_b64 v[190:191], 0
    v_mov_b64 v[192:193], 0
    v_mov_b64 v[194:195], 0
    s_lshr_b32 s58, s56, 3
    s_mul_i32 s57, s56, 25600
    s_mul_i32 s58, s58, 52224000
    s_add_u32 s57, s57, s58
    s_add_u32 s57, s57, s49
    s_lshr_b32 s64, s56, 3
    s_mul_i32 s58, s56, 400
    s_mul_i32 s64, s64, 816000
    s_add_u32 s58, s58, s64
SLOW_L:
    v_add_u32 v205, s74, v204
    ds_read_u8 v206, v205
    s_waitcnt lgkmcnt(0)
    v_cndmask_b32_e64 v206, v206, v204, s[66:67]
    v_lshlrev_b32 v205, 1, v206
    buffer_load_dwordx4 v[196:199], v[206:207], s[20:23], s57 idxen offen offset:1024
    buffer_load_dwordx4 v[200:203], v[206:207], s[20:23], s57 idxen offen offset:1088
    buffer_load_ushort v205, v205, s[24:27], s58 offen
    v_cmp_gt_u32 vcc, 200, v206
    v_add_u32 v204, 16, v204
    s_waitcnt vmcnt(0)
    v_mfma_f32_16x16x32_bf16 v[104:107], v[72:75], v[196:199], v[136:139]
    v_mfma_f32_16x16x32_bf16 v[104:107], v[76:79], v[200:203], v[104:107]
    v_mfma_f32_16x16x32_bf16 v[108:111], v[80:83], v[196:199], v[140:143]
    v_mfma_f32_16x16x32_bf16 v[108:111], v[84:87], v[200:203], v[108:111]
    v_mfma_f32_16x16x32_bf16 v[112:115], v[88:91], v[196:199], v[144:147]
    v_mfma_f32_16x16x32_bf16 v[112:115], v[92:95], v[200:203], v[112:115]
    v_mfma_f32_16x16x32_bf16 v[116:119], v[96:99], v[196:199], v[148:151]
    v_mfma_f32_16x16x32_bf16 v[116:119], v[100:103], v[200:203], v[116:119]
    v_lshlrev_b32 v205, 16, v205
    v_cndmask_b32 v205, 0, v205, vcc
    s_nop 7
    v_exp_f32 v104, v104
    v_exp_f32 v105, v105
    v_exp_f32 v106, v106
    v_exp_f32 v107, v107
    v_exp_f32 v108, v108
    v_exp_f32 v109, v109
    v_exp_f32 v110, v110
    v_exp_f32 v111, v111
    v_exp_f32 v112, v112
    v_exp_f32 v113, v113
    v_exp_f32 v114, v114
    v_exp_f32 v115, v115
    v_exp_f32 v116, v116
    v_exp_f32 v117, v117
    v_exp_f32 v118, v118
    v_exp_f32 v119, v119
    v_add_f32 v104, 1.0, v104
    v_add_f32 v105, 1.0, v105
    v_add_f32 v106, 1.0, v106
    v_add_f32 v107, 1.0, v107
    v_add_f32 v108, 1.0, v108
    v_add_f32 v109, 1.0, v109
    v_add_f32 v110, 1.0, v110
    v_add_f32 v111, 1.0, v111
    v_add_f32 v112, 1.0, v112
    v_add_f32 v113, 1.0, v113
    v_add_f32 v114, 1.0, v114
    v_add_f32 v115, 1.0, v115
    v_add_f32 v116, 1.0, v116
    v_add_f32 v117, 1.0, v117
    v_add_f32 v118, 1.0, v118
    v_add_f32 v119, 1.0, v119
    v_rcp_f32 v104, v104
    v_rcp_f32 v105, v105
    v_rcp_f32 v106, v106
    v_rcp_f32 v107, v107
    v_rcp_f32 v108, v108
    v_rcp_f32 v109, v109
    v_rcp_f32 v110, v110
    v_rcp_f32 v111, v111
    v_rcp_f32 v112, v112
    v_rcp_f32 v113, v113
    v_rcp_f32 v114, v114
    v_rcp_f32 v115, v115
    v_rcp_f32 v116, v116
    v_rcp_f32 v117, v117
    v_rcp_f32 v118, v118
    v_rcp_f32 v119, v119
    v_mul_f32 v208, v104, v212
    v_fmac_f32 v208, v105, v213
    v_fmac_f32 v208, v106, v214
    v_fmac_f32 v208, v107, v215
    v_fmac_f32 v208, v108, v216
    v_fmac_f32 v208, v109, v217
    v_fmac_f32 v208, v110, v218
    v_fmac_f32 v208, v111, v219
    v_fmac_f32 v208, v112, v220
    v_fmac_f32 v208, v113, v221
    v_fmac_f32 v208, v114, v222
    v_fmac_f32 v208, v115, v223
    v_fmac_f32 v208, v116, v224
    v_fmac_f32 v208, v117, v225
    v_fmac_f32 v208, v118, v226
    v_fmac_f32 v208, v119, v227
    v_mov_b32 v209, v208
    s_nop 1
    v_permlane32_swap_b32 v208, v209
    v_add_f32 v208, v208, v209
    v_mov_b32 v209, v208
    s_nop 1
    v_permlane16_swap_b32 v208, v209
    v_add_f32 v208, v208, v209
    v_add_f32 v208, s63, v208
    v_mul_f32 v208, v208, v205
    v_lshlrev_b32 v209, 16, v196
    v_and_b32 v210, 0xffff0000, v196
    v_fmac_f32 v180, v208, v209
    v_fmac_f32 v181, v208, v210
    v_lshlrev_b32 v209, 16, v197
    v_and_b32 v210, 0xffff0000, v197
    v_fmac_f32 v182, v208, v209
    v_fmac_f32 v183, v208, v210
    v_lshlrev_b32 v209, 16, v198
    v_and_b32 v210, 0xffff0000, v198
    v_fmac_f32 v184, v208, v209
    v_fmac_f32 v185, v208, v210
    v_lshlrev_b32 v209, 16, v199
    v_and_b32 v210, 0xffff0000, v199
    v_fmac_f32 v186, v208, v209
    v_fmac_f32 v187, v208, v210
    v_lshlrev_b32 v209, 16, v200
    v_and_b32 v210, 0xffff0000, v200
    v_fmac_f32 v188, v208, v209
    v_fmac_f32 v189, v208, v210
    v_lshlrev_b32 v209, 16, v201
    v_and_b32 v210, 0xffff0000, v201
    v_fmac_f32 v190, v208, v209
    v_fmac_f32 v191, v208, v210
    v_lshlrev_b32 v209, 16, v202
    v_and_b32 v210, 0xffff0000, v202
    v_fmac_f32 v192, v208, v209
    v_fmac_f32 v193, v208, v210
    v_lshlrev_b32 v209, 16, v203
    v_and_b32 v210, 0xffff0000, v203
    v_fmac_f32 v194, v208, v209
    v_fmac_f32 v195, v208, v210
    s_sub_u32 s59, s59, 1
    s_cmp_lg_u32 s59, 0
    s_cbranch_scc1 SLOW_L
    v_readfirstlane_b32 s56, v5
    s_nop 1
    v_lshl_add_u32 v208, v252, 1, s56
    ds_add_f32 v208, v180 offset:0
    ds_add_f32 v208, v181 offset:4
    ds_add_f32 v208, v182 offset:8
    ds_add_f32 v208, v183 offset:12
    ds_add_f32 v208, v184 offset:16
    ds_add_f32 v208, v185 offset:20
    ds_add_f32 v208, v186 offset:24
    ds_add_f32 v208, v187 offset:28
    ds_add_f32 v208, v188 offset:128
    ds_add_f32 v208, v189 offset:132
    ds_add_f32 v208, v190 offset:136
    ds_add_f32 v208, v191 offset:140
    ds_add_f32 v208, v192 offset:144
    ds_add_f32 v208, v193 offset:148
    ds_add_f32 v208, v194 offset:152
    ds_add_f32 v208, v195 offset:156
    s_waitcnt lgkmcnt(0)
    s_bitcmp1_b32 s52, 6
    s_cbranch_scc1 L_DONE
    ds_read_b128 v[180:183], v251 offset:0
    ds_read_b128 v[184:187], v251 offset:1024
    ds_read_b128 v[196:199], v251 offset:4096
    ds_read_b128 v[200:203], v251 offset:5120
    ds_read_b128 v[212:215], v251 offset:8192
    ds_read_b128 v[216:219], v251 offset:9216
    ds_read_b128 v[188:191], v251 offset:2048
    ds_read_b128 v[192:195], v251 offset:3072
    ds_read_b128 v[204:207], v251 offset:6144
    ds_read_b128 v[208:211], v251 offset:7168
    ds_read_b128 v[220:223], v251 offset:10240
    ds_read_b128 v[224:227], v251 offset:11264
    ds_read_b128 v[228:231], v251 offset:14336
    ds_read_b128 v[232:235], v251 offset:15360
    s_mov_b32 s77, 2
    s_branch BPF
L_END:
    s_endpgm
.section .rodata,"a"
.p2align 6
.amdhsa_kernel standalone__sequential_behavior_din__recsys_kernel
  .amdhsa_next_free_vgpr 255
  .amdhsa_next_free_sgpr 80
  .amdhsa_accum_offset 256
  .amdhsa_group_segment_fixed_size 0
  .amdhsa_kernarg_size 80
  .amdhsa_user_sgpr_count 2
  .amdhsa_user_sgpr_kernarg_segment_ptr 1
  .amdhsa_system_sgpr_workgroup_id_x 1
.end_amdhsa_kernel
```

```asm
; @launch grid=(256,1,1) block=(512,1,1) lds=153856
.amdgcn_target "amdgcn-amd-amdhsa--gfx950"
.text
.globl standalone__sequential_behavior_din__recsys_kernel
.p2align 8
.type standalone__sequential_behavior_din__recsys_kernel,@function
standalone__sequential_behavior_din__recsys_kernel:
    s_cmpk_ge_u32 s2, 256
    s_cbranch_scc1 L_END
    s_load_dwordx16 s[4:19], s[0:1], 0
    s_setprio 3
    v_lshrrev_b32 v1, 6, v0
    v_and_b32 v176, 63, v0
    v_readfirstlane_b32 s48, v1
    s_getpc_b64 s[40:41]
L_PC:
    s_sub_u32 s56, s48, 5
    s_cmp_ge_u32 s56, 3
    s_cbranch_scc1 P_NC
    s_mov_b32 s42, L_END-L_PC
    s_mov_b32 s43, 0x20000
    v_subrev_u32 v150, 320, v0
    v_lshlrev_b32 v150, 6, v150
    buffer_load_dword v150, v150, s[40:43], 0 offen
P_NC:
    v_and_b32 v2, 31, v0
    v_bfe_u32 v3, v0, 5, 1
    v_cmp_gt_u32 vcc, 25, v2
    v_mul_u32_u24 v4, 400, v3
    v_lshl_add_u32 v179, v2, 4, v4
    v_bfrev_b32 v4, 8
    v_cndmask_b32 v179, v4, v179, vcc
    s_mul_i32 s57, s2, 3200
    s_sub_u32 s26, 6553600, s57
    s_lshr_b32 s59, s48, 2
    s_mul_i32 s71, s48, 800
    s_mul_i32 s59, s59, 816000
    s_add_u32 s71, s71, s59
    s_mov_b32 s27, 0x20000
    s_lshl_b32 s74, s48, 12
    s_lshl_b32 s53, s2, 10
    v_lshlrev_b32 v251, 4, v176
    v_lshlrev_b32 v120, 1, v176
    v_and_b32 v120, 32, v120
    v_xor_b32 v120, v120, v251
    v_xor_b32 v121, 64, v120
    s_mov_b32 s38, 32768
    s_mov_b32 s39, s27
    s_lshl_b32 s58, s48, 18
    s_sub_u32 s34, 2097152, s53
    s_mov_b32 s35, s27
    s_add_u32 m0, s74, 121088
    v_and_b32 v178, 15, v176
    v_lshrrev_b32 v177, 4, v176
    v_lshlrev_b32 v252, 4, v177
    v_mul_u32_u24 v208, 0x80008, v2
    v_lshrrev_b32 v238, 3, v176
    v_add_u32 v208, 0x10000, v208
    v_cmp_gt_u32 vcc, 32, v176
    s_waitcnt lgkmcnt(0)
    s_add_u32 s24, s8, s57
    s_addc_u32 s25, s9, 0
    s_mov_b64 s[36:37], s[10:11]
    buffer_load_dwordx4 v[204:207], v179, s[24:27], s71 offen offset:0 nt
    s_setprio 0
    s_add_u32 s32, s4, s53
    s_addc_u32 s33, s5, 0
    s_load_dword s63, s[16:17], 0
    s_cmp_lg_u32 s48, 0
    s_cbranch_scc1 P_LJ
    v_mov_b32 v146, s12
    v_mov_b32 v147, s13
    v_mov_b32 v148, s14
    v_mov_b32 v149, s15
    v_lshlrev_b32 v4, 2, v2
    v_cndmask_b32 v146, v146, v148, vcc
    v_cndmask_b32 v147, v147, v149, vcc
    v_add_co_u32 v146, vcc, v146, v4
    s_nop 1
    v_addc_co_u32 v147, vcc, 0, v147, vcc
    global_load_dword v146, v[146:147], off
P_LJ:
    buffer_load_dwordx4 v[124:127], v251, s[32:35], s58 offen nt
    buffer_load_dwordx4 v120, s[36:39], s74 offen offset:0 lds
    buffer_load_dwordx4 v121, s[36:39], s74 offen offset:1024 lds
    s_lshl1_add_u32 s54, s74, 17664
    s_mul_i32 s49, s2, 204800
    s_lshl_b32 s57, s48, 9
    v_add_u32 v247, 116992, v238
    v_add_u32 v246, s57, v247
    s_add_u32 s56, s57, 116992
    v_add_u32 v209, 0x20002, v208
    v_add_u32 v210, 0x40004, v208
    v_add_u32 v211, 0x60006, v208
    s_sub_u32 s20, s6, 1024
    s_subb_u32 s21, s7, 0
    s_or_b32 s21, s21, 0x800000
    s_movk_i32 s22, 200
    s_mov_b32 s23, s27
    s_movk_i32 s61, 0x3f80
    v_lshrrev_b32 v216, 1, v251
    v_and_b32 v213, 0x100, v216
    v_mov_b64 v[214:215], -1
    v_lshlrev_b32 v250, 2, v176
    v_bfrev_b32 v2, v238
    v_lshrrev_b32 v2, 28, v2
    v_and_b32 v2, 6, v2
    v_xor_b32 v2, v2, v176
    v_and_b32 v2, 7, v2
    v_mul_u32_u24 v143, 528, v238
    v_lshlrev_b32 v239, 4, v2
    v_lshlrev_b32 v241, 4, v2
    v_lshlrev_b32 v153, 4, v2
    v_lshlrev_b32 v155, 4, v2
    s_add_u32 s28, s18, s53
    s_addc_u32 s29, s19, 0
    s_sub_u32 s30, 2097152, s53
    s_mov_b32 s31, s27
    s_mov_b32 s60, 0xbfb8aa3b
    s_mov_b32 s42, 0x21800000
    s_mov_b32 s46, 0x2b800000
    s_lshr_b32 s59, s48, 2
    s_mul_i32 s51, s48, 51200
    s_mul_i32 s59, s59, 52224000
    s_add_u32 s51, s51, s59
    s_add_u32 s51, s51, s49
    s_add_u32 s72, s51, 1024
    v_bfrev_b32 v2, v178
    v_lshrrev_b32 v2, 28, v2
    v_and_b32 v2, 6, v2
    v_xor_b32 v2, v2, v177
    v_lshl_add_u32 v2, v2, 4, s54
    v_lshl_add_u32 v242, v178, 7, v2
    v_xor_b32 v243, 64, v242
    v_and_b32 v3, 3, v176
    v_bfe_u32 v2, v176, 2, 2
    v_lshlrev_b32 v7, 3, v3
    v_lshl_add_u32 v7, v2, 7, v7
    v_and_b32 v6, 8, v176
    v_lshlrev_b32 v6, 3, v6
    v_lshl_add_u32 v244, v177, 5, v7
    v_xor_b32 v244, v244, v6
    v_add_u32 v244, s54, v244
    v_xor_b32 v245, 32, v244
    s_lshl_b32 s57, s48, 7
    s_add_u32 s57, s57, 150016
    v_lshl_add_u32 v249, v2, 2, v177
    v_lshl_add_u32 v249, v249, 2, v3
    v_lshl_add_u32 v249, v249, 1, s57
    v_lshl_add_u32 v248, v178, 3, s57
    v_and_b32 v6, 0x60, v250
    v_or_b32 v6, v6, v7
    v_lshl_add_u32 v136, v177, 10, v6
    s_mul_i32 s57, s48, 0x1010
    s_and_b32 s57, s57, 0x1060
    v_xor_b32 v144, s57, v136
    v_add_u32 v136, 121088, v136
    v_add_u32 v144, 121088, v144
    v_xor_b32 v137, 32, v136
    v_xor_b32 v138, 64, v136
    v_xor_b32 v139, 96, v136
    s_and_b32 s59, s48, 4
    s_lshl_b32 s59, s59, 4
    v_xor_b32 v140, s59, v136
    v_xor_b32 v141, 32, v140
    s_and_b32 s57, s48, 3
    s_mul_i32 s57, s57, 8448
    s_lshl1_add_u32 s57, s59, s57
    s_add_u32 s57, s57, 83200
    v_mul_u32_u24 v145, 528, v178
    v_add3_u32 v145, v145, v252, s57
    v_lshl_add_u32 v142, s59, 1, v252
    s_mul_i32 s57, s48, 4224
    s_add_u32 s57, s57, 83200
    v_and_b32 v3, 0x70, v251
    v_add3_u32 v143, v143, v3, s57
    v_add_u32 v3, v143, v3
    s_lshl_b32 s57, s48, 11
    v_add_u32 v151, s57, v251
    s_mov_b32 s66, 0x18c00000
    s_mov_b32 s67, 0x1863
    s_mul_i32 s57, s48, 5
    s_lshr_b64 s[66:67], s[66:67], s57
    s_and_b32 s70, s66, 31
    s_bfe_u32 s47, s66, 0x50005
    s_sub_u32 s47, s47, s70
    s_lshl1_add_u32 s70, s70, 16
    s_mul_i32 s71, s70, 400
    buffer_load_dwordx4 v120, s[36:39], s74 offen offset:2048 lds
    buffer_load_dwordx4 v121, s[36:39], s74 offen offset:3072 lds
    s_cmp_eq_u32 s48, 0
    s_waitcnt vmcnt(6) lgkmcnt(0)
    s_cbranch_scc1 P_M0
    s_waitcnt vmcnt(5)
P_M0:
    s_call_b64 s[36:37], CMP
    s_branch P_C
    .p2align 3
CMP:
    v_bcnt_u32_b32 v7, v204, 0
    v_bcnt_u32_b32 v7, v205, v7
    v_bcnt_u32_b32 v7, v206, v7
    v_bcnt_u32_b32 v7, v207, v7
    v_add_u32 v4, s56, v216
    v_mov_b32 v6, v7
    ds_write_b64 v4, v[214:215]
    v_cmp_eq_u16_e64 s[4:5], s61, v204
    v_cmp_eq_u16_sdwa s[6:7], v204, s61 src0_sel:WORD_1 src1_sel:WORD_0
    v_add_u32_dpp v6, v6, v6 row_shr:1 row_mask:0xf bank_mask:0xf bound_ctrl:0
    v_cmp_eq_u16_e64 s[8:9], s61, v205
    v_cmp_eq_u16_sdwa s[10:11], v205, s61 src0_sel:WORD_1 src1_sel:WORD_0
    v_add_u32_dpp v6, v6, v6 row_shr:2 row_mask:0xf bank_mask:0xf bound_ctrl:0
    v_cmp_eq_u16_e64 s[12:13], s61, v206
    v_cmp_eq_u16_sdwa s[14:15], v206, s61 src0_sel:WORD_1 src1_sel:WORD_0
    v_add_u32_dpp v6, v6, v6 row_shr:4 row_mask:0xf bank_mask:0xf bound_ctrl:0
    v_cmp_eq_u16_e64 s[16:17], s61, v207
    v_cmp_eq_u16_sdwa s[18:19], v207, s61 src0_sel:WORD_1 src1_sel:WORD_0
    v_add_u32_dpp v6, v6, v6 row_shr:8 row_mask:0xf bank_mask:0xf bound_ctrl:0
    s_nop 1
    v_add_u32_dpp v6, v6, v6 row_bcast:15 row_mask:0xa bank_mask:0xf
    v_sub_u32 v6, v6, v7
    v_mul_u32_u24 v6, 9363, v6
    v_lshrrev_b32 v6, 16, v6
    v_min_u32 v6, 200, v6
    v_add3_u32 v226, v6, v213, s56
    v_readlane_b32 s59, v6, 31
    v_readlane_b32 s58, v6, 63
    v_addc_co_u32_e64 v227, vcc, 0, v226, s[4:5]
    v_addc_co_u32_e64 v228, vcc, 0, v227, s[6:7]
    v_addc_co_u32_e64 v229, vcc, 0, v228, s[8:9]
    v_addc_co_u32_e64 v230, vcc, 0, v229, s[10:11]
    v_addc_co_u32_e64 v231, vcc, 0, v230, s[12:13]
    v_addc_co_u32_e64 v232, vcc, 0, v231, s[14:15]
    v_addc_co_u32_e64 v233, vcc, 0, v232, s[16:17]
    v_addc_co_u32_e64 v234, vcc, 0, v233, s[18:19]
    s_mov_b64 exec, s[4:5]
    ds_write_b8 v226, v208
    s_mov_b64 exec, s[6:7]
    ds_write_b8_d16_hi v227, v208
    s_mov_b64 exec, s[8:9]
    ds_write_b8 v228, v209
    s_mov_b64 exec, s[10:11]
    ds_write_b8_d16_hi v229, v209
    s_mov_b64 exec, s[12:13]
    ds_write_b8 v230, v210
    s_mov_b64 exec, s[14:15]
    ds_write_b8_d16_hi v231, v210
    s_mov_b64 exec, s[16:17]
    ds_write_b8 v232, v211
    s_mov_b64 exec, s[18:19]
    ds_write_b8_d16_hi v233, v211
    s_mov_b64 exec, -1
    v_sub_u32 v6, v234, v226
    v_mul_u32_u24 v6, 7, v6
    v_cmp_ne_u32 vcc, v6, v7
    s_min_u32 s64, vcc_lo, 1
    s_min_u32 s65, vcc_hi, 1
    s_lshl_b64 s[64:65], s[64:65], 15
    s_or_b32 s57, s59, s64
    s_or_b32 s58, s58, s65
    s_setpc_b64 s[36:37]
P_C:
    ds_read_u8 v238, v246 offset:0
    ds_read_u8 v240, v246 offset:8
    ds_read_u8 v152, v246 offset:16
    ds_read_u8 v154, v246 offset:24
    s_add_u32 m0, s54, 0
    s_waitcnt lgkmcnt(3)
    buffer_load_dwordx4 v[238:239], s[20:23], s72 idxen offen nt lds
    s_waitcnt lgkmcnt(2)
    buffer_load_dwordx4 v[240:241], s[20:23], s51 idxen offen offset:1024 nt lds
    s_add_u32 m0, s54, 2048
    s_waitcnt lgkmcnt(1)
    buffer_load_dwordx4 v[152:153], s[20:23], s72 idxen offen nt lds
    s_waitcnt lgkmcnt(0)
    buffer_load_dwordx4 v[154:155], s[20:23], s51 idxen offen offset:1024 nt lds
    s_lshl_b32 s63, s63, 16
    s_cmp_lg_u32 s48, 0
    s_waitcnt vmcnt(8)
    s_cbranch_scc1 P_SW_J
    v_lshlrev_b32 v148, 16, v146
    v_and_b32 v149, 0xffff0000, v146
    v_mov_b32 v4, -1
    v_mov_b32 v5, 0
    v_mov_b32 v6, 0x240
    v_lshrrev_b32 v0, 1, v251
    ds_write2st64_b32 v250, v4, v5 offset0:66 offset1:67
    s_mov_b32 exec_hi, 0
    v_max3_f32 v2, abs(v148), abs(v149), abs(s63)
    v_ldexp_f32 v148, v148, 40
    v_ldexp_f32 v149, v149, 40
    v_cmp_le_f32 vcc, 0x33800000, v2
    s_mov_b32 exec_lo, 0x55
    v_mul_f32 v148, s42, v148
    v_mul_f32 v149, s42, v149
    s_mov_b32 exec_lo, -1
    ds_write_b32 v250, v6 offset:17408
    s_mov_b32 exec_hi, -1
    s_movk_i32 s56, 0x3ff
    s_cmp_lg_u64 vcc, 0
    s_cmovk_i32 s56, 0x207
    v_mov_b32 v6, 17184
    v_mov_b32 v7, s56
    ds_write_b64 v0, v[148:149] offset:16384
    ds_write_b64 v5, v[6:7] offset:17600
P_SW_J:
    ds_write_b128 v143, v[124:127] offset:256
    ds_write_b128 v143, v[124:127] offset:384
    s_waitcnt vmcnt(4) lgkmcnt(0)
    s_barrier
    ds_read_b64_tr_b16 v[218:219], v144 offset:0
    ds_read_b64_tr_b16 v[220:221], v144 offset:512
    ds_read_b64_tr_b16 v[222:223], v144 offset:16384
    ds_read_b64_tr_b16 v[224:225], v144 offset:16896
    ds_read_b128 v[160:163], v145 offset:256
    ds_read_b128 v[164:167], v145 offset:320
    ds_read_b128 v[104:107], v142 offset:16640
    ds_read_b128 v[108:111], v142 offset:16704
    ds_read_b64_tr_b16 v[40:41], v140 offset:8192
    ds_read_b64_tr_b16 v[42:43], v140 offset:8704
    ds_read_b64_tr_b16 v[44:45], v141 offset:8192
    ds_read_b64_tr_b16 v[46:47], v141 offset:8704
    ds_read_b64_tr_b16 v[48:49], v140 offset:12288
    ds_read_b64_tr_b16 v[50:51], v140 offset:12800
    ds_read_b64_tr_b16 v[52:53], v141 offset:12288
    ds_read_b64_tr_b16 v[54:55], v141 offset:12800
    ds_read_b64_tr_b16 v[56:57], v140 offset:16384
    ds_read_b64_tr_b16 v[58:59], v140 offset:16896
    ds_read_b64_tr_b16 v[60:61], v141 offset:16384
    ds_read_b64_tr_b16 v[62:63], v141 offset:16896
    ds_read_b64_tr_b16 v[64:65], v140 offset:20480
    ds_read_b64_tr_b16 v[66:67], v140 offset:20992
    ds_read_b64_tr_b16 v[68:69], v141 offset:20480
    ds_read_b64_tr_b16 v[70:71], v141 offset:20992
    s_and_b32 s59, s57, 0xff
    s_lshr_b32 s57, s57, 8
    s_add_u32 s59, s59, 15
    s_and_b32 s52, s59, 15
    s_lshl_b32 s52, s52, 12
    s_or_b32 s57, s57, s52
    s_lshr_b32 s59, s59, 4
    s_max_u32 s59, s59, 3
    s_lshl1_add_u32 s52, s48, s57
    s_lshl_b32 s57, s59, 8
    s_or_b32 s52, s52, s57
    s_sub_u32 s50, s59, 3
    s_and_b32 s59, s58, 0xff
    s_lshr_b32 s58, s58, 8
    s_add_u32 s59, s59, 15
    s_and_b32 s74, s59, 15
    s_lshl_b32 s74, s74, 12
    s_or_b32 s58, s58, s74
    s_lshr_b32 s59, s59, 4
    s_max_u32 s59, s59, 2
    s_lshl1_add_u32 s74, s48, s58
    s_lshl_b32 s58, s59, 8
    s_or_b32 s74, s74, s58
    s_or_b32 s74, s74, 1
    v_lshlrev_b32 v24, 16, v124
    v_and_b32 v25, 0xffff0000, v124
    v_lshlrev_b32 v26, 16, v125
    v_and_b32 v27, 0xffff0000, v125
    v_lshlrev_b32 v28, 16, v126
    v_and_b32 v29, 0xffff0000, v126
    v_lshlrev_b32 v30, 16, v127
    v_and_b32 v31, 0xffff0000, v127
    v_mul_f32 v24, s60, v24
    v_mul_f32 v25, s60, v25
    v_mul_f32 v26, s60, v26
    v_mul_f32 v27, s60, v27
    v_mul_f32 v28, s60, v28
    v_mul_f32 v29, s60, v29
    v_mul_f32 v30, s60, v30
    v_mul_f32 v31, s60, v31
    s_waitcnt lgkmcnt(15)
    v_lshlrev_b32 v8, 16, v218
    v_and_b32 v9, 0xffff0000, v218
    v_lshlrev_b32 v16, 16, v222
    v_and_b32 v17, 0xffff0000, v222
    v_lshlrev_b32 v10, 16, v219
    v_and_b32 v11, 0xffff0000, v219
    v_lshlrev_b32 v18, 16, v223
    v_and_b32 v19, 0xffff0000, v223
    v_lshlrev_b32 v12, 16, v220
    v_and_b32 v13, 0xffff0000, v220
    v_lshlrev_b32 v20, 16, v224
    v_and_b32 v21, 0xffff0000, v224
    v_lshlrev_b32 v14, 16, v221
    v_and_b32 v15, 0xffff0000, v221
    v_lshlrev_b32 v22, 16, v225
    v_and_b32 v23, 0xffff0000, v225
    v_xor_b32 v168, 0x80008000, v160
    v_xor_b32 v169, 0x80008000, v161
    v_xor_b32 v170, 0x80008000, v162
    v_xor_b32 v171, 0x80008000, v163
    v_xor_b32 v172, 0x80008000, v164
    v_xor_b32 v173, 0x80008000, v165
    v_xor_b32 v174, 0x80008000, v166
    v_xor_b32 v175, 0x80008000, v167
    s_waitcnt lgkmcnt(12)
    v_mfma_f32_16x16x32_bf16 v[104:107], v[40:43], v[160:163], v[104:107]
    v_mfma_f32_16x16x32_bf16 v[108:111], v[44:47], v[160:163], v[108:111]
    v_add_f32 v112, v8, v16
    v_add_f32 v113, v9, v17
    s_waitcnt lgkmcnt(8)
    v_mfma_f32_16x16x32_bf16 v[104:107], v[48:51], v[164:167], v[104:107]
    v_mfma_f32_16x16x32_bf16 v[108:111], v[52:55], v[164:167], v[108:111]
    v_add_f32 v114, v10, v18
    v_add_f32 v115, v11, v19
    s_waitcnt lgkmcnt(4)
    v_mfma_f32_16x16x32_bf16 v[104:107], v[56:59], v[168:171], v[104:107]
    v_mfma_f32_16x16x32_bf16 v[108:111], v[60:63], v[168:171], v[108:111]
    v_add_f32 v116, v12, v20
    v_add_f32 v117, v13, v21
    s_waitcnt lgkmcnt(0)
    v_mfma_f32_16x16x32_bf16 v[104:107], v[64:67], v[172:175], v[104:107]
    v_mfma_f32_16x16x32_bf16 v[108:111], v[68:71], v[172:175], v[108:111]
    v_add_f32 v118, v14, v22
    v_add_f32 v119, v15, v23
    ds_read_b64_tr_b16 v[72:73], v136 offset:24576
    ds_read_b64_tr_b16 v[74:75], v136 offset:25088
    ds_read_b64_tr_b16 v[76:77], v136 offset:28672
    ds_read_b64_tr_b16 v[78:79], v136 offset:29184
    ds_read_b64_tr_b16 v[80:81], v137 offset:24576
    ds_read_b64_tr_b16 v[82:83], v137 offset:25088
    ds_read_b64_tr_b16 v[84:85], v137 offset:28672
    ds_read_b64_tr_b16 v[86:87], v137 offset:29184
    ds_read_b64_tr_b16 v[88:89], v138 offset:24576
    ds_read_b64_tr_b16 v[90:91], v138 offset:25088
    ds_read_b64_tr_b16 v[92:93], v138 offset:28672
    ds_read_b64_tr_b16 v[94:95], v138 offset:29184
    ds_read_b64_tr_b16 v[96:97], v139 offset:24576
    ds_read_b64_tr_b16 v[98:99], v139 offset:25088
    ds_read_b64_tr_b16 v[100:101], v139 offset:28672
    ds_read_b64_tr_b16 v[102:103], v139 offset:29184
    s_cmp_eq_u32 s47, 0
    s_cbranch_scc1 P_MJ
    s_mul_i32 s71, s70, 102400
    buffer_load_dwordx4 v[180:183], v179, s[24:27], s71 offen offset:0 nt
    buffer_load_dwordx4 v[184:187], v179, s[24:27], s71 offen offset:800 nt
    buffer_load_dwordx4 v[188:191], v179, s[24:27], s71 offen offset:1600 nt
    buffer_load_dwordx4 v[192:195], v179, s[24:27], s71 offen offset:2400 nt
    s_add_u32 s71, s71, 819200
    buffer_load_dwordx4 v[196:199], v179, s[24:27], s71 offen offset:0 nt
    buffer_load_dwordx4 v[200:203], v179, s[24:27], s71 offen offset:800 nt
    buffer_load_dwordx4 v[40:43], v179, s[24:27], s71 offen offset:1600 nt
    buffer_load_dwordx4 v[44:47], v179, s[24:27], s71 offen offset:2400 nt
    s_add_u32 s71, s71, 819200
    buffer_load_dwordx4 v[48:51], v179, s[24:27], s71 offen offset:0 nt
    buffer_load_dwordx4 v[52:55], v179, s[24:27], s71 offen offset:800 nt
    buffer_load_dwordx4 v[56:59], v179, s[24:27], s71 offen offset:1600 nt
    buffer_load_dwordx4 v[60:63], v179, s[24:27], s71 offen offset:2400 nt
P_MJ:
    v_mul_f32 v112, s60, v112
    v_mul_f32 v113, s60, v113
    v_mul_f32 v114, s60, v114
    v_mul_f32 v115, s60, v115
    v_mul_f32 v116, s60, v116
    v_mul_f32 v117, s60, v117
    v_mul_f32 v118, s60, v118
    v_mul_f32 v119, s60, v119
    ds_write_b128 v151, v[112:115] offset:0
    ds_write_b128 v151, v[116:119] offset:1024
    v_mul_f32 v104, s60, v104
    v_mul_f32 v105, s60, v105
    v_mul_f32 v106, s60, v106
    v_mul_f32 v107, s60, v107
    v_mul_f32 v108, s60, v108
    v_mul_f32 v109, s60, v109
    v_mul_f32 v110, s60, v110
    v_mul_f32 v111, s60, v111
    ds_write_b128 v145, v[104:107] offset:256
    ds_write_b128 v145, v[108:111] offset:320
    ds_write_b128 v3, v[24:27] offset:0
    ds_write_b128 v3, v[28:31] offset:16
    ds_read_b128 v[120:123], v252 offset:16384
    ds_read_b128 v[124:127], v252 offset:16448
    ds_read_b128 v[128:131], v252 offset:16512
    ds_read_b128 v[132:135], v252 offset:16576
    ds_read_b32 v150, v252 offset:17604
    s_lshl2_add_u32 s56, s48, 17184
    v_mov_b32 v253, s56
    v_mov_b32 v254, s74
    ds_write_b32 v253, v254
    v_ldexp_f32 v2, s63, 38
    v_add_u32 v250, 133376, v250
    v_mov_b64 v[168:169], 0
    v_mov_b64 v[170:171], 0
    v_mov_b64 v[172:173], 0
    v_mov_b64 v[174:175], 0
    v_readfirstlane_b32 s44, v2
    s_waitcnt lgkmcnt(15)
    v_lshlrev_b32 v8, 16, v72
    v_and_b32 v9, 0xffff0000, v72
    v_lshlrev_b32 v10, 16, v73
    v_and_b32 v11, 0xffff0000, v73
    v_lshlrev_b32 v12, 16, v74
    v_and_b32 v13, 0xffff0000, v74
    v_lshlrev_b32 v14, 16, v75
    v_and_b32 v15, 0xffff0000, v75
    v_lshlrev_b32 v16, 16, v76
    v_and_b32 v17, 0xffff0000, v76
    v_lshlrev_b32 v18, 16, v77
    v_and_b32 v19, 0xffff0000, v77
    v_lshlrev_b32 v20, 16, v78
    v_and_b32 v21, 0xffff0000, v78
    v_lshlrev_b32 v22, 16, v79
    v_and_b32 v23, 0xffff0000, v79
    v_lshlrev_b32 v24, 16, v80
    v_and_b32 v25, 0xffff0000, v80
    v_lshlrev_b32 v26, 16, v81
    v_and_b32 v27, 0xffff0000, v81
    v_lshlrev_b32 v28, 16, v82
    v_and_b32 v29, 0xffff0000, v82
    v_lshlrev_b32 v30, 16, v83
    v_and_b32 v31, 0xffff0000, v83
    v_lshlrev_b32 v32, 16, v84
    v_and_b32 v33, 0xffff0000, v84
    v_lshlrev_b32 v34, 16, v85
    v_and_b32 v35, 0xffff0000, v85
    v_lshlrev_b32 v36, 16, v86
    v_and_b32 v37, 0xffff0000, v86
    v_lshlrev_b32 v38, 16, v87
    v_and_b32 v39, 0xffff0000, v87
    ds_read_u8 v238, v246 offset:32
    ds_read_u8 v240, v246 offset:40
    s_add_u32 m0, s54, 4096
    v_add_u32 v246, 32, v246
    s_mov_b64 s[68:69], 0
    s_mov_b32 s75, 0
    s_movk_i32 s53, 0x1040
    s_mov_b32 s73, 3
    s_mov_b32 s77, 0
    s_mov_b32 s55, 0
    v_mov_b64 v[0:1], 0
    v_mov_b32 v2, 1.0
    v_mov_b32 v3, 1.0
    s_waitcnt lgkmcnt(0)
    s_barrier
    v_readfirstlane_b32 s45, v150
    buffer_load_dwordx4 v[238:239], s[20:23], s72 idxen offen nt lds
    buffer_load_dwordx4 v[240:241], s[20:23], s51 idxen offen offset:1024 nt lds
    s_cmp_eq_u32 s47, 0
    s_cbranch_scc1 P_GO
    s_lshl_b32 s56, s70, 8
    s_add_u32 s56, s56, 116992
    s_waitcnt vmcnt(2)
    v_mov_b64 v[204:205], v[180:181]
    v_mov_b64 v[206:207], v[182:183]
    s_call_b64 s[36:37], CMP
    v_writelane_b32 v212, s57, 0
    v_writelane_b32 v212, s58, 1
    s_add_u32 s56, s56, 512
    v_mov_b64 v[204:205], v[184:185]
    v_mov_b64 v[206:207], v[186:187]
    s_call_b64 s[36:37], CMP
    v_writelane_b32 v212, s57, 2
    v_writelane_b32 v212, s58, 3
    s_add_u32 s56, s56, 512
    v_mov_b64 v[204:205], v[188:189]
    v_mov_b64 v[206:207], v[190:191]
    s_call_b64 s[36:37], CMP
    v_writelane_b32 v212, s57, 4
    v_writelane_b32 v212, s58, 5
    s_add_u32 s56, s56, 512
    v_mov_b64 v[204:205], v[192:193]
    v_mov_b64 v[206:207], v[194:195]
    s_call_b64 s[36:37], CMP
    v_writelane_b32 v212, s57, 6
    v_writelane_b32 v212, s58, 7
    s_add_u32 s56, s56, 512
    v_mov_b64 v[204:205], v[196:197]
    v_mov_b64 v[206:207], v[198:199]
    s_call_b64 s[36:37], CMP
    v_writelane_b32 v212, s57, 8
    v_writelane_b32 v212, s58, 9
    s_add_u32 s56, s56, 512
    v_mov_b64 v[204:205], v[200:201]
    v_mov_b64 v[206:207], v[202:203]
    s_call_b64 s[36:37], CMP
    v_writelane_b32 v212, s57, 10
    v_writelane_b32 v212, s58, 11
    s_add_u32 s56, s56, 512
    v_mov_b64 v[204:205], v[40:41]
    v_mov_b64 v[206:207], v[42:43]
    s_call_b64 s[36:37], CMP
    v_writelane_b32 v212, s57, 12
    v_writelane_b32 v212, s58, 13
    s_add_u32 s56, s56, 512
    v_mov_b64 v[204:205], v[44:45]
    v_mov_b64 v[206:207], v[46:47]
    s_call_b64 s[36:37], CMP
    v_writelane_b32 v212, s57, 14
    v_writelane_b32 v212, s58, 15
    s_add_u32 s56, s56, 512
    v_mov_b64 v[204:205], v[48:49]
    v_mov_b64 v[206:207], v[50:51]
    s_call_b64 s[36:37], CMP
    v_writelane_b32 v212, s57, 16
    v_writelane_b32 v212, s58, 17
    s_add_u32 s56, s56, 512
    v_mov_b64 v[204:205], v[52:53]
    v_mov_b64 v[206:207], v[54:55]
    s_call_b64 s[36:37], CMP
    v_writelane_b32 v212, s57, 18
    v_writelane_b32 v212, s58, 19
    s_add_u32 s56, s56, 512
    v_mov_b64 v[204:205], v[56:57]
    v_mov_b64 v[206:207], v[58:59]
    s_call_b64 s[36:37], CMP
    v_writelane_b32 v212, s57, 20
    v_writelane_b32 v212, s58, 21
    s_add_u32 s56, s56, 512
    v_mov_b64 v[204:205], v[60:61]
    v_mov_b64 v[206:207], v[62:63]
    s_call_b64 s[36:37], CMP
    v_writelane_b32 v212, s57, 22
    v_writelane_b32 v212, s58, 23
LATE_D:
    v_add_u32 v4, s70, v176
    s_lshl_b32 s56, s47, 1
    v_and_b32 v5, 0xff, v212
    v_add_u32 v5, 15, v5
    v_lshrrev_b32 v212, 8, v212
    v_and_b32 v6, 15, v5
    v_lshl_or_b32 v212, v6, 12, v212
    v_lshrrev_b32 v5, 4, v5
    v_max_u32 v5, 2, v5
    v_or_b32 v212, v212, v4
    v_cmp_gt_u32 vcc, 64, v4
    v_lshl_or_b32 v6, v5, 8, v212
    v_lshlrev_b32 v4, 2, v4
    s_bfm_b64 s[66:67], s56, 0
    s_and_b64 exec, s[66:67], vcc
    ds_write_b32 v4, v6 offset:17152
    s_mov_b64 exec, -1
P_GO:
    ds_read_b128 v[180:183], v251 offset:0
    ds_read_b128 v[184:187], v251 offset:1024
    ds_read_b128 v[196:199], v251 offset:4096
    ds_read_b128 v[200:203], v251 offset:5120
    ds_read_b128 v[212:215], v251 offset:8192
    ds_read_b128 v[216:219], v251 offset:9216
    ds_read_b128 v[188:191], v251 offset:2048
    ds_read_b128 v[192:195], v251 offset:3072
    ds_read_b128 v[204:207], v251 offset:6144
    ds_read_b128 v[208:211], v251 offset:7168
    ds_read_b128 v[220:223], v251 offset:10240
    ds_read_b128 v[224:227], v251 offset:11264
    ds_read_b128 v[228:231], v251 offset:14336
    ds_read_b128 v[232:235], v251 offset:15360
    v_lshlrev_b32 v40, 16, v88
    v_and_b32 v41, 0xffff0000, v88
    v_lshlrev_b32 v42, 16, v89
    v_and_b32 v43, 0xffff0000, v89
    v_lshlrev_b32 v44, 16, v90
    v_and_b32 v45, 0xffff0000, v90
    v_lshlrev_b32 v46, 16, v91
    v_and_b32 v47, 0xffff0000, v91
    v_lshlrev_b32 v48, 16, v92
    v_and_b32 v49, 0xffff0000, v92
    v_lshlrev_b32 v50, 16, v93
    v_and_b32 v51, 0xffff0000, v93
    v_lshlrev_b32 v52, 16, v94
    v_and_b32 v53, 0xffff0000, v94
    v_lshlrev_b32 v54, 16, v95
    v_and_b32 v55, 0xffff0000, v95
    v_lshlrev_b32 v56, 16, v96
    v_and_b32 v57, 0xffff0000, v96
    v_lshlrev_b32 v58, 16, v97
    v_and_b32 v59, 0xffff0000, v97
    v_lshlrev_b32 v60, 16, v98
    v_and_b32 v61, 0xffff0000, v98
    v_lshlrev_b32 v62, 16, v99
    v_and_b32 v63, 0xffff0000, v99
    v_lshlrev_b32 v64, 16, v100
    v_and_b32 v65, 0xffff0000, v100
    v_lshlrev_b32 v66, 16, v101
    v_and_b32 v67, 0xffff0000, v101
    v_lshlrev_b32 v68, 16, v102
    v_and_b32 v69, 0xffff0000, v102
    v_lshlrev_b32 v70, 16, v103
    v_and_b32 v71, 0xffff0000, v103
    v_mov_b64 v[176:177], 0
    v_mov_b64 v[178:179], 0
    s_sub_u32 s50, s50, 2
    s_cbranch_scc1 DRAW_P
DRET_P:
    s_waitcnt vmcnt(4)
    ds_read_b128 v[152:155], v242
    ds_read_b128 v[156:159], v243
    s_branch BPF
U_0:
    v_mfma_f32_16x16x32_bf16 v[104:107], v[72:75], v[152:155], v[136:139]
    s_add_u32 m0, s54, 6144
    v_rcp_f32 v2, v2
    v_mfma_f32_16x16x32_bf16 v[104:107], v[76:79], v[156:159], v[104:107]
    s_mov_b32 s73, 0
    v_rcp_f32 v3, v3
    v_mfma_f32_16x16x32_bf16 v[108:111], v[80:83], v[152:155], v[140:143]
    s_sub_u32 s50, s50, 1
    v_fma_f32 v0, v0, v2, s44
    v_fmac_f32 v0, v1, v3
    v_mfma_f32_16x16x32_bf16 v[108:111], v[84:87], v[156:159], v[108:111]
    s_cbranch_scc1 PEV
    v_add_u32 v246, 16, v246
RET_0:
    v_cvt_pk_bf16_f32 v0, v0, v0
    v_mfma_f32_16x16x32_bf16 v[112:115], v[88:91], v[152:155], v[144:147]
    v_exp_f32 v104, v104
    v_mfma_f32_16x16x32_bf16 v[112:115], v[92:95], v[156:159], v[112:115]
    v_exp_f32 v105, v105
    v_mfma_f32_16x16x32_bf16 v[116:119], v[96:99], v[152:155], v[148:151]
    s_sub_u32 s62, s62, 1
    v_exp_f32 v106, v106
    v_mfma_f32_16x16x32_bf16 v[116:119], v[100:103], v[156:159], v[116:119]
    s_waitcnt vmcnt(2)
    v_exp_f32 v107, v107
    ds_write_b16 v249, v0
    ds_read_b64 v[236:237], v248
    ds_read_b64_tr_b16 v[160:161], v244 offset:0
    ds_read_b64_tr_b16 v[162:163], v245 offset:512
    ds_read_b64_tr_b16 v[164:165], v244 offset:1024
    ds_read_b64_tr_b16 v[166:167], v245 offset:1536
    ds_read_u8 v238, v246 offset:0
    ds_read_u8 v240, v246 offset:8
    ds_read_b128 v[152:155], v242 offset:2048
    ds_read_b128 v[156:159], v243 offset:2048
    v_exp_f32 v108, v108
    v_exp_f32 v109, v109
    v_exp_f32 v110, v110
    v_exp_f32 v111, v111
    s_waitcnt lgkmcnt(8)
    v_mfma_f32_4x4x4_16b_bf16 v[176:179], v[236:237], v[168:169], v[176:179] cbsz:4 abid:0
    v_exp_f32 v112, v112
    v_exp_f32 v113, v113
    v_mfma_f32_4x4x4_16b_bf16 v[176:179], v[236:237], v[170:171], v[176:179] cbsz:4 abid:1
    v_exp_f32 v114, v114
    v_exp_f32 v115, v115
    v_mfma_f32_4x4x4_16b_bf16 v[176:179], v[236:237], v[172:173], v[176:179] cbsz:4 abid:2
    v_exp_f32 v116, v116
    v_exp_f32 v117, v117
    v_mfma_f32_4x4x4_16b_bf16 v[176:179], v[236:237], v[174:175], v[176:179] cbsz:4 abid:3
    v_exp_f32 v118, v118
    v_exp_f32 v119, v119
    s_waitcnt lgkmcnt(0)
    buffer_load_dwordx4 v[238:239], s[20:23], s72 idxen offen nt lds
    buffer_load_dwordx4 v[240:241], s[20:23], s51 idxen offen offset:1024 nt lds
    s_cselect_b64 exec, s[78:79], -1
    .p2align 3
    v_pk_fma_f32 v[2:3], v[104:105], s[42:43], s[42:43] op_sel_hi:[1,0,0]
    v_pk_fma_f32 v[0:1], v[120:121], v[106:107], v[120:121]
    v_pk_fma_f32 v[0:1], v[122:123], v[2:3], v[0:1]
    v_pk_fma_f32 v[2:3], v[106:107], v[2:3], v[2:3]
    v_pk_fma_f32 v[0:1], v[108:109], v[0:1], v[0:1]
    v_pk_fma_f32 v[0:1], v[124:125], v[2:3], v[0:1]
    v_pk_fma_f32 v[2:3], v[108:109], v[2:3], v[2:3]
    v_pk_fma_f32 v[0:1], v[110:111], v[0:1], v[0:1]
    v_pk_fma_f32 v[0:1], v[126:127], v[2:3], v[0:1]
    v_pk_fma_f32 v[2:3], v[110:111], v[2:3], v[2:3]
    v_pk_fma_f32 v[0:1], v[112:113], v[0:1], v[0:1]
    v_pk_fma_f32 v[0:1], v[128:129], v[2:3], v[0:1]
    v_pk_fma_f32 v[2:3], v[112:113], v[2:3], v[2:3]
    v_pk_fma_f32 v[0:1], v[114:115], v[0:1], v[0:1]
    v_pk_fma_f32 v[0:1], v[130:131], v[2:3], v[0:1]
    v_pk_fma_f32 v[2:3], v[114:115], v[2:3], v[2:3]
    v_pk_fma_f32 v[0:1], v[116:117], v[0:1], v[0:1]
    v_pk_fma_f32 v[0:1], v[132:133], v[2:3], v[0:1]
    v_pk_fma_f32 v[2:3], v[116:117], v[2:3], v[2:3]
    v_pk_fma_f32 v[0:1], v[118:119], v[0:1], v[0:1]
    v_pk_fma_f32 v[0:1], v[134:135], v[2:3], v[0:1]
    v_pk_fma_f32 v[2:3], v[118:119], v[2:3], v[2:3]
    s_mov_b64 exec, -1
    s_cbranch_scc1 CEV
U_1:
    v_mfma_f32_16x16x32_bf16 v[104:107], v[72:75], v[152:155], v[136:139]
    s_add_u32 m0, s54, 0
    v_rcp_f32 v2, v2
    v_mfma_f32_16x16x32_bf16 v[104:107], v[76:79], v[156:159], v[104:107]
    s_mov_b32 s73, 1
    v_rcp_f32 v3, v3
    v_mfma_f32_16x16x32_bf16 v[108:111], v[80:83], v[152:155], v[140:143]
    s_sub_u32 s50, s50, 1
    v_fma_f32 v0, v0, v2, s44
    v_fmac_f32 v0, v1, v3
    v_mfma_f32_16x16x32_bf16 v[108:111], v[84:87], v[156:159], v[108:111]
    s_cbranch_scc1 PEV
    v_add_u32 v246, 16, v246
RET_1:
    v_cvt_pk_bf16_f32 v0, v0, v0
    v_mfma_f32_16x16x32_bf16 v[112:115], v[88:91], v[152:155], v[144:147]
    v_exp_f32 v104, v104
    v_mfma_f32_16x16x32_bf16 v[112:115], v[92:95], v[156:159], v[112:115]
    v_exp_f32 v105, v105
    v_mfma_f32_16x16x32_bf16 v[116:119], v[96:99], v[152:155], v[148:151]
    s_sub_u32 s62, s62, 1
    v_exp_f32 v106, v106
    v_mfma_f32_16x16x32_bf16 v[116:119], v[100:103], v[156:159], v[116:119]
    s_waitcnt vmcnt(2)
    v_exp_f32 v107, v107
    ds_write_b16 v249, v0
    ds_read_b64 v[236:237], v248
    ds_read_b64_tr_b16 v[168:169], v244 offset:2048
    ds_read_b64_tr_b16 v[170:171], v245 offset:2560
    ds_read_b64_tr_b16 v[172:173], v244 offset:3072
    ds_read_b64_tr_b16 v[174:175], v245 offset:3584
    ds_read_u8 v238, v246 offset:0
    ds_read_u8 v240, v246 offset:8
    ds_read_b128 v[152:155], v242 offset:4096
    ds_read_b128 v[156:159], v243 offset:4096
    v_exp_f32 v108, v108
    v_exp_f32 v109, v109
    v_exp_f32 v110, v110
    v_exp_f32 v111, v111
    s_waitcnt lgkmcnt(8)
    v_mfma_f32_4x4x4_16b_bf16 v[176:179], v[236:237], v[160:161], v[176:179] cbsz:4 abid:0
    v_exp_f32 v112, v112
    v_exp_f32 v113, v113
    v_mfma_f32_4x4x4_16b_bf16 v[176:179], v[236:237], v[162:163], v[176:179] cbsz:4 abid:1
    v_exp_f32 v114, v114
    v_exp_f32 v115, v115
    v_mfma_f32_4x4x4_16b_bf16 v[176:179], v[236:237], v[164:165], v[176:179] cbsz:4 abid:2
    v_exp_f32 v116, v116
    v_exp_f32 v117, v117
    v_mfma_f32_4x4x4_16b_bf16 v[176:179], v[236:237], v[166:167], v[176:179] cbsz:4 abid:3
    v_exp_f32 v118, v118
    v_exp_f32 v119, v119
    s_waitcnt lgkmcnt(0)
    buffer_load_dwordx4 v[238:239], s[20:23], s72 idxen offen nt lds
    buffer_load_dwordx4 v[240:241], s[20:23], s51 idxen offen offset:1024 nt lds
    s_cselect_b64 exec, s[78:79], -1
    .p2align 3
    v_pk_fma_f32 v[2:3], v[104:105], s[42:43], s[42:43] op_sel_hi:[1,0,0]
    v_pk_fma_f32 v[0:1], v[120:121], v[106:107], v[120:121]
    v_pk_fma_f32 v[0:1], v[122:123], v[2:3], v[0:1]
    v_pk_fma_f32 v[2:3], v[106:107], v[2:3], v[2:3]
    v_pk_fma_f32 v[0:1], v[108:109], v[0:1], v[0:1]
    v_pk_fma_f32 v[0:1], v[124:125], v[2:3], v[0:1]
    v_pk_fma_f32 v[2:3], v[108:109], v[2:3], v[2:3]
    v_pk_fma_f32 v[0:1], v[110:111], v[0:1], v[0:1]
    v_pk_fma_f32 v[0:1], v[126:127], v[2:3], v[0:1]
    v_pk_fma_f32 v[2:3], v[110:111], v[2:3], v[2:3]
    v_pk_fma_f32 v[0:1], v[112:113], v[0:1], v[0:1]
    v_pk_fma_f32 v[0:1], v[128:129], v[2:3], v[0:1]
    v_pk_fma_f32 v[2:3], v[112:113], v[2:3], v[2:3]
    v_pk_fma_f32 v[0:1], v[114:115], v[0:1], v[0:1]
    v_pk_fma_f32 v[0:1], v[130:131], v[2:3], v[0:1]
    v_pk_fma_f32 v[2:3], v[114:115], v[2:3], v[2:3]
    v_pk_fma_f32 v[0:1], v[116:117], v[0:1], v[0:1]
    v_pk_fma_f32 v[0:1], v[132:133], v[2:3], v[0:1]
    v_pk_fma_f32 v[2:3], v[116:117], v[2:3], v[2:3]
    v_pk_fma_f32 v[0:1], v[118:119], v[0:1], v[0:1]
    v_pk_fma_f32 v[0:1], v[134:135], v[2:3], v[0:1]
    v_pk_fma_f32 v[2:3], v[118:119], v[2:3], v[2:3]
    s_mov_b64 exec, -1
    s_cbranch_scc1 CEV
U_2:
    v_mfma_f32_16x16x32_bf16 v[104:107], v[72:75], v[152:155], v[136:139]
    s_add_u32 m0, s54, 2048
    v_rcp_f32 v2, v2
    v_mfma_f32_16x16x32_bf16 v[104:107], v[76:79], v[156:159], v[104:107]
    s_mov_b32 s73, 2
    v_rcp_f32 v3, v3
    v_mfma_f32_16x16x32_bf16 v[108:111], v[80:83], v[152:155], v[140:143]
    s_sub_u32 s50, s50, 1
    v_fma_f32 v0, v0, v2, s44
    v_fmac_f32 v0, v1, v3
    v_mfma_f32_16x16x32_bf16 v[108:111], v[84:87], v[156:159], v[108:111]
    s_cbranch_scc1 PEV
    v_add_u32 v246, 16, v246
RET_2:
    v_cvt_pk_bf16_f32 v0, v0, v0
    v_mfma_f32_16x16x32_bf16 v[112:115], v[88:91], v[152:155], v[144:147]
    v_exp_f32 v104, v104
    v_mfma_f32_16x16x32_bf16 v[112:115], v[92:95], v[156:159], v[112:115]
    v_exp_f32 v105, v105
    v_mfma_f32_16x16x32_bf16 v[116:119], v[96:99], v[152:155], v[148:151]
    s_sub_u32 s62, s62, 1
    v_exp_f32 v106, v106
    v_mfma_f32_16x16x32_bf16 v[116:119], v[100:103], v[156:159], v[116:119]
    s_waitcnt vmcnt(2)
    v_exp_f32 v107, v107
    ds_write_b16 v249, v0
    ds_read_b64 v[236:237], v248
    ds_read_b64_tr_b16 v[160:161], v244 offset:4096
    ds_read_b64_tr_b16 v[162:163], v245 offset:4608
    ds_read_b64_tr_b16 v[164:165], v244 offset:5120
    ds_read_b64_tr_b16 v[166:167], v245 offset:5632
    ds_read_u8 v238, v246 offset:0
    ds_read_u8 v240, v246 offset:8
    ds_read_b128 v[152:155], v242 offset:6144
    ds_read_b128 v[156:159], v243 offset:6144
    v_exp_f32 v108, v108
    v_exp_f32 v109, v109
    v_exp_f32 v110, v110
    v_exp_f32 v111, v111
    s_waitcnt lgkmcnt(8)
    v_mfma_f32_4x4x4_16b_bf16 v[176:179], v[236:237], v[168:169], v[176:179] cbsz:4 abid:0
    v_exp_f32 v112, v112
    v_exp_f32 v113, v113
    v_mfma_f32_4x4x4_16b_bf16 v[176:179], v[236:237], v[170:171], v[176:179] cbsz:4 abid:1
    v_exp_f32 v114, v114
    v_exp_f32 v115, v115
    v_mfma_f32_4x4x4_16b_bf16 v[176:179], v[236:237], v[172:173], v[176:179] cbsz:4 abid:2
    v_exp_f32 v116, v116
    v_exp_f32 v117, v117
    v_mfma_f32_4x4x4_16b_bf16 v[176:179], v[236:237], v[174:175], v[176:179] cbsz:4 abid:3
    v_exp_f32 v118, v118
    v_exp_f32 v119, v119
    s_waitcnt lgkmcnt(0)
    buffer_load_dwordx4 v[238:239], s[20:23], s72 idxen offen nt lds
    buffer_load_dwordx4 v[240:241], s[20:23], s51 idxen offen offset:1024 nt lds
    s_cselect_b64 exec, s[78:79], -1
    .p2align 3
    v_pk_fma_f32 v[2:3], v[104:105], s[42:43], s[42:43] op_sel_hi:[1,0,0]
    v_pk_fma_f32 v[0:1], v[120:121], v[106:107], v[120:121]
    v_pk_fma_f32 v[0:1], v[122:123], v[2:3], v[0:1]
    v_pk_fma_f32 v[2:3], v[106:107], v[2:3], v[2:3]
    v_pk_fma_f32 v[0:1], v[108:109], v[0:1], v[0:1]
    v_pk_fma_f32 v[0:1], v[124:125], v[2:3], v[0:1]
    v_pk_fma_f32 v[2:3], v[108:109], v[2:3], v[2:3]
    v_pk_fma_f32 v[0:1], v[110:111], v[0:1], v[0:1]
    v_pk_fma_f32 v[0:1], v[126:127], v[2:3], v[0:1]
    v_pk_fma_f32 v[2:3], v[110:111], v[2:3], v[2:3]
    v_pk_fma_f32 v[0:1], v[112:113], v[0:1], v[0:1]
    v_pk_fma_f32 v[0:1], v[128:129], v[2:3], v[0:1]
    v_pk_fma_f32 v[2:3], v[112:113], v[2:3], v[2:3]
    v_pk_fma_f32 v[0:1], v[114:115], v[0:1], v[0:1]
    v_pk_fma_f32 v[0:1], v[130:131], v[2:3], v[0:1]
    v_pk_fma_f32 v[2:3], v[114:115], v[2:3], v[2:3]
    v_pk_fma_f32 v[0:1], v[116:117], v[0:1], v[0:1]
    v_pk_fma_f32 v[0:1], v[132:133], v[2:3], v[0:1]
    v_pk_fma_f32 v[2:3], v[116:117], v[2:3], v[2:3]
    v_pk_fma_f32 v[0:1], v[118:119], v[0:1], v[0:1]
    v_pk_fma_f32 v[0:1], v[134:135], v[2:3], v[0:1]
    v_pk_fma_f32 v[2:3], v[118:119], v[2:3], v[2:3]
    s_mov_b64 exec, -1
    s_cbranch_scc1 CEV
U_3:
    v_mfma_f32_16x16x32_bf16 v[104:107], v[72:75], v[152:155], v[136:139]
    s_add_u32 m0, s54, 4096
    v_rcp_f32 v2, v2
    v_mfma_f32_16x16x32_bf16 v[104:107], v[76:79], v[156:159], v[104:107]
    s_mov_b32 s73, 3
    v_rcp_f32 v3, v3
    v_mfma_f32_16x16x32_bf16 v[108:111], v[80:83], v[152:155], v[140:143]
    s_sub_u32 s50, s50, 1
    v_fma_f32 v0, v0, v2, s44
    v_fmac_f32 v0, v1, v3
    v_mfma_f32_16x16x32_bf16 v[108:111], v[84:87], v[156:159], v[108:111]
    s_cbranch_scc1 PEV
    v_add_u32 v246, 16, v246
RET_3:
    v_cvt_pk_bf16_f32 v0, v0, v0
    v_mfma_f32_16x16x32_bf16 v[112:115], v[88:91], v[152:155], v[144:147]
    v_exp_f32 v104, v104
    v_mfma_f32_16x16x32_bf16 v[112:115], v[92:95], v[156:159], v[112:115]
    v_exp_f32 v105, v105
    v_mfma_f32_16x16x32_bf16 v[116:119], v[96:99], v[152:155], v[148:151]
    s_sub_u32 s62, s62, 1
    v_exp_f32 v106, v106
    v_mfma_f32_16x16x32_bf16 v[116:119], v[100:103], v[156:159], v[116:119]
    s_waitcnt vmcnt(2)
    v_exp_f32 v107, v107
    ds_write_b16 v249, v0
    ds_read_b64 v[236:237], v248
    ds_read_b64_tr_b16 v[168:169], v244 offset:6144
    ds_read_b64_tr_b16 v[170:171], v245 offset:6656
    ds_read_b64_tr_b16 v[172:173], v244 offset:7168
    ds_read_b64_tr_b16 v[174:175], v245 offset:7680
    ds_read_u8 v238, v246 offset:0
    ds_read_u8 v240, v246 offset:8
    ds_read_b128 v[152:155], v242 offset:0
    ds_read_b128 v[156:159], v243 offset:0
    v_exp_f32 v108, v108
    v_exp_f32 v109, v109
    v_exp_f32 v110, v110
    v_exp_f32 v111, v111
    s_waitcnt lgkmcnt(8)
    v_mfma_f32_4x4x4_16b_bf16 v[176:179], v[236:237], v[160:161], v[176:179] cbsz:4 abid:0
    v_exp_f32 v112, v112
    v_exp_f32 v113, v113
    v_mfma_f32_4x4x4_16b_bf16 v[176:179], v[236:237], v[162:163], v[176:179] cbsz:4 abid:1
    v_exp_f32 v114, v114
    v_exp_f32 v115, v115
    v_mfma_f32_4x4x4_16b_bf16 v[176:179], v[236:237], v[164:165], v[176:179] cbsz:4 abid:2
    v_exp_f32 v116, v116
    v_exp_f32 v117, v117
    v_mfma_f32_4x4x4_16b_bf16 v[176:179], v[236:237], v[166:167], v[176:179] cbsz:4 abid:3
    v_exp_f32 v118, v118
    v_exp_f32 v119, v119
    s_waitcnt lgkmcnt(0)
    buffer_load_dwordx4 v[238:239], s[20:23], s72 idxen offen nt lds
    buffer_load_dwordx4 v[240:241], s[20:23], s51 idxen offen offset:1024 nt lds
    s_cselect_b64 exec, s[78:79], -1
    .p2align 3
    v_pk_fma_f32 v[2:3], v[104:105], s[42:43], s[42:43] op_sel_hi:[1,0,0]
    v_pk_fma_f32 v[0:1], v[120:121], v[106:107], v[120:121]
    v_pk_fma_f32 v[0:1], v[122:123], v[2:3], v[0:1]
    v_pk_fma_f32 v[2:3], v[106:107], v[2:3], v[2:3]
    v_pk_fma_f32 v[0:1], v[108:109], v[0:1], v[0:1]
    v_pk_fma_f32 v[0:1], v[124:125], v[2:3], v[0:1]
    v_pk_fma_f32 v[2:3], v[108:109], v[2:3], v[2:3]
    v_pk_fma_f32 v[0:1], v[110:111], v[0:1], v[0:1]
    v_pk_fma_f32 v[0:1], v[126:127], v[2:3], v[0:1]
    v_pk_fma_f32 v[2:3], v[110:111], v[2:3], v[2:3]
    v_pk_fma_f32 v[0:1], v[112:113], v[0:1], v[0:1]
    v_pk_fma_f32 v[0:1], v[128:129], v[2:3], v[0:1]
    v_pk_fma_f32 v[2:3], v[112:113], v[2:3], v[2:3]
    v_pk_fma_f32 v[0:1], v[114:115], v[0:1], v[0:1]
    v_pk_fma_f32 v[0:1], v[130:131], v[2:3], v[0:1]
    v_pk_fma_f32 v[2:3], v[114:115], v[2:3], v[2:3]
    v_pk_fma_f32 v[0:1], v[116:117], v[0:1], v[0:1]
    v_pk_fma_f32 v[0:1], v[132:133], v[2:3], v[0:1]
    v_pk_fma_f32 v[2:3], v[116:117], v[2:3], v[2:3]
    v_pk_fma_f32 v[0:1], v[118:119], v[0:1], v[0:1]
    v_pk_fma_f32 v[0:1], v[134:135], v[2:3], v[0:1]
    v_pk_fma_f32 v[2:3], v[118:119], v[2:3], v[2:3]
    s_mov_b64 exec, -1
    s_cbranch_scc0 U_0
CEV:
    s_cmp_eq_u32 s76, 0
    s_cbranch_scc1 EPI
    s_mov_b32 s53, s52
    s_and_b32 s52, s68, 0xffff
    s_lshr_b64 s[68:69], s[68:69], 16
    s_sub_u32 s75, s75, 16
    s_bitcmp1_b32 s52, 6
    s_cbranch_scc1 DRAIN
BPF:
    s_and_b32 s57, s52, 63
    s_mul_i32 s57, s57, 528
    s_add_u32 s57, s57, 83200
    v_lshl_add_u32 v6, v252, 1, s57
    v_add_u32 v7, s57, v252
    ds_read_b128 v[104:107], v6 offset:0
    ds_read_b128 v[108:111], v6 offset:16
    ds_read_b128 v[144:147], v251 offset:12288
    ds_read_b128 v[148:151], v251 offset:13312
    ds_read_b128 v[112:115], v6 offset:128
    ds_read_b128 v[116:119], v6 offset:144
    s_mov_b32 s62, 0
    s_mov_b32 s76, 0
    s_mov_b64 s[78:79], -1
    s_cmp_lg_u32 s77, 0
    s_waitcnt lgkmcnt(4)
    .p2align 3
    v_pk_fma_f32 v[136:137], v[8:9], v[104:105], v[180:181]
    v_pk_fma_f32 v[138:139], v[10:11], v[106:107], v[182:183]
    v_pk_fma_f32 v[140:141], v[12:13], v[108:109], v[184:185]
    v_pk_fma_f32 v[142:143], v[14:15], v[110:111], v[186:187]
    v_cvt_pk_bf16_f32 v72, v136, v137
    v_cvt_pk_bf16_f32 v73, v138, v139
    v_cvt_pk_bf16_f32 v74, v140, v141
    v_cvt_pk_bf16_f32 v75, v142, v143
    v_pk_fma_f32 v[136:137], v[24:25], v[104:105], v[196:197]
    v_pk_fma_f32 v[138:139], v[26:27], v[106:107], v[198:199]
    v_pk_fma_f32 v[140:141], v[28:29], v[108:109], v[200:201]
    v_pk_fma_f32 v[142:143], v[30:31], v[110:111], v[202:203]
    v_cvt_pk_bf16_f32 v80, v136, v137
    v_cvt_pk_bf16_f32 v81, v138, v139
    v_cvt_pk_bf16_f32 v82, v140, v141
    v_cvt_pk_bf16_f32 v83, v142, v143
    v_pk_fma_f32 v[136:137], v[40:41], v[104:105], v[212:213]
    v_pk_fma_f32 v[138:139], v[42:43], v[106:107], v[214:215]
    v_pk_fma_f32 v[140:141], v[44:45], v[108:109], v[216:217]
    v_pk_fma_f32 v[142:143], v[46:47], v[110:111], v[218:219]
    v_cvt_pk_bf16_f32 v88, v136, v137
    v_cvt_pk_bf16_f32 v89, v138, v139
    v_cvt_pk_bf16_f32 v90, v140, v141
    v_cvt_pk_bf16_f32 v91, v142, v143
    s_waitcnt lgkmcnt(0)
    .p2align 3
    v_pk_fma_f32 v[144:145], v[56:57], v[104:105], v[144:145]
    v_pk_fma_f32 v[146:147], v[58:59], v[106:107], v[146:147]
    v_pk_fma_f32 v[148:149], v[60:61], v[108:109], v[148:149]
    v_pk_fma_f32 v[150:151], v[62:63], v[110:111], v[150:151]
    v_cvt_pk_bf16_f32 v96, v144, v145
    v_cvt_pk_bf16_f32 v97, v146, v147
    v_cvt_pk_bf16_f32 v98, v148, v149
    v_cvt_pk_bf16_f32 v99, v150, v151
    ds_read_b128 v[136:139], v7 offset:256
    ds_read_b128 v[140:143], v7 offset:320
    ds_read_b128 v[144:147], v7 offset:384
    ds_read_b128 v[148:151], v7 offset:448
    v_pk_fma_f32 v[104:105], v[16:17], v[112:113], v[188:189]
    v_pk_fma_f32 v[106:107], v[18:19], v[114:115], v[190:191]
    v_pk_fma_f32 v[108:109], v[20:21], v[116:117], v[192:193]
    v_pk_fma_f32 v[110:111], v[22:23], v[118:119], v[194:195]
    v_cvt_pk_bf16_f32 v76, v104, v105
    v_cvt_pk_bf16_f32 v77, v106, v107
    v_cvt_pk_bf16_f32 v78, v108, v109
    v_cvt_pk_bf16_f32 v79, v110, v111
    v_pk_fma_f32 v[104:105], v[32:33], v[112:113], v[204:205]
    v_pk_fma_f32 v[106:107], v[34:35], v[114:115], v[206:207]
    v_pk_fma_f32 v[108:109], v[36:37], v[116:117], v[208:209]
    v_pk_fma_f32 v[110:111], v[38:39], v[118:119], v[210:211]
    v_cvt_pk_bf16_f32 v84, v104, v105
    v_cvt_pk_bf16_f32 v85, v106, v107
    v_cvt_pk_bf16_f32 v86, v108, v109
    v_cvt_pk_bf16_f32 v87, v110, v111
    v_pk_fma_f32 v[104:105], v[48:49], v[112:113], v[220:221]
    v_pk_fma_f32 v[106:107], v[50:51], v[114:115], v[222:223]
    v_pk_fma_f32 v[108:109], v[52:53], v[116:117], v[224:225]
    v_pk_fma_f32 v[110:111], v[54:55], v[118:119], v[226:227]
    v_cvt_pk_bf16_f32 v92, v104, v105
    v_cvt_pk_bf16_f32 v93, v106, v107
    v_cvt_pk_bf16_f32 v94, v108, v109
    v_cvt_pk_bf16_f32 v95, v110, v111
    v_pk_fma_f32 v[104:105], v[64:65], v[112:113], v[228:229]
    v_pk_fma_f32 v[106:107], v[66:67], v[114:115], v[230:231]
    v_pk_fma_f32 v[108:109], v[68:69], v[116:117], v[232:233]
    v_pk_fma_f32 v[110:111], v[70:71], v[118:119], v[234:235]
    v_cvt_pk_bf16_f32 v100, v104, v105
    v_cvt_pk_bf16_f32 v101, v106, v107
    v_cvt_pk_bf16_f32 v102, v108, v109
    v_cvt_pk_bf16_f32 v103, v110, v111
    s_waitcnt lgkmcnt(0)
    s_cbranch_scc1 BP_X
NEXT:
    s_cmp_eq_u32 s73, 0
    s_cbranch_scc1 U_1
    s_cmp_eq_u32 s73, 1
    s_cbranch_scc1 U_2
    s_cmp_eq_u32 s73, 2
    s_cbranch_scc1 U_3
    s_branch U_0
EPI:
    s_and_b32 s56, s53, 0x7f
    v_pk_add_f32 v[4:5], v[176:177], v[178:179]
    v_add_f32 v4, v4, v5
    v_lshl_add_u32 v5, s56, 8, v250
    v_mul_f32 v4, s46, v4
    s_and_b32 s56, s53, 0x80
    v_cmp_class_f32_e64 s[64:65], v4, s45
    v_mov_b64 v[176:177], 0
    v_mov_b64 v[178:179], 0
    ds_write_b32 v5, v4
    s_or_b32 s64, s64, s56
    s_cmp_lg_u64 s[64:65], 0
    s_cbranch_scc1 SLOW
EPI_R:
    s_bitcmp1_b32 s52, 6
    s_cbranch_scc1 L_DONE
EPI_C:
    s_bfe_u32 s62, s52, 0x40008
    s_sub_u32 s62, s62, 2
    s_mov_b32 s76, 1
    s_lshr_b32 s56, s52, 12
    s_lshl_b32 s78, 0x20002, s56
    s_sub_u32 s78, s78, 0x10001
    s_mov_b32 s79, s78
    s_cmp_eq_u32 s73, 0
    s_cbranch_scc1 U_1
    s_cmp_eq_u32 s73, 1
    s_cbranch_scc1 U_2
    s_cmp_eq_u32 s73, 2
    s_cbranch_scc1 U_3
    s_branch U_0
PEV:
    s_cmp_eq_u32 s55, 0
    s_cbranch_scc1 P_DR
    ds_read_b32 v254, v253
    s_waitcnt lgkmcnt(0)
ADV:
    v_readfirstlane_b32 s66, v254
    s_mov_b32 s67, 0
    s_and_b32 s56, s66, 63
    s_bfe_u32 s50, s66, 0x40008
    s_cbranch_scc0 AW
    s_lshr_b32 s57, s56, 3
    s_mul_i32 s51, s56, 25600
    s_mul_i32 s57, s57, 52224000
    s_add_u32 s51, s51, s57
    v_lshl_add_u32 v246, s56, 8, v247
    s_add_u32 s51, s51, s49
    s_add_u32 s72, s51, 1024
    s_lshl_b64 s[64:65], s[66:67], s75
    s_or_b64 s[68:69], s[68:69], s[64:65]
    s_add_u32 s75, s75, 16
    s_mov_b32 s55, 0
    s_sub_u32 s50, s50, 3
    s_cbranch_scc1 P_2
P_RET:
    s_cmp_eq_u32 s73, 0
    s_cbranch_scc1 RET_0
    s_cmp_eq_u32 s73, 1
    s_cbranch_scc1 RET_1
    s_cmp_eq_u32 s73, 2
    s_cbranch_scc1 RET_2
    s_branch RET_3
P_DR:
    v_add_u32 v246, 16, v246
P_D2:
    s_mov_b64 exec, 1
    v_mov_b32 v253, 4
    ds_add_rtn_u32 v253, v251, v253 offset:17600
    s_mov_b64 exec, -1
    s_mov_b32 s50, 1
    s_mov_b32 s55, 1
    s_cmp_eq_u32 s73, 0
    s_cbranch_scc1 RET_0
    s_cmp_eq_u32 s73, 1
    s_cbranch_scc1 RET_1
    s_cmp_eq_u32 s73, 2
    s_cbranch_scc1 RET_2
    s_branch RET_3
P_2:
    s_bitcmp1_b32 s66, 6
    s_cbranch_scc0 P_D2
    v_mov_b32 v246, 16896
    s_movk_i32 s50, 0x100
    s_branch P_RET
DRAIN:
    v_rcp_f32 v2, v2
    v_rcp_f32 v3, v3
    v_fma_f32 v0, v0, v2, s44
    v_fmac_f32 v0, v1, v3
    v_cvt_pk_bf16_f32 v0, v0, v0
    s_bitcmp1_b32 s73, 0
    ds_write_b16 v249, v0
    ds_read_b64 v[236:237], v248
    s_waitcnt lgkmcnt(0)
    s_cbranch_scc1 DRAIN1
    v_mfma_f32_4x4x4_16b_bf16 v[176:179], v[236:237], v[160:161], v[176:179] cbsz:4 abid:0
    s_nop 1
    v_mfma_f32_4x4x4_16b_bf16 v[176:179], v[236:237], v[162:163], v[176:179] cbsz:4 abid:1
    s_nop 1
    v_mfma_f32_4x4x4_16b_bf16 v[176:179], v[236:237], v[164:165], v[176:179] cbsz:4 abid:2
    s_nop 1
    v_mfma_f32_4x4x4_16b_bf16 v[176:179], v[236:237], v[166:167], v[176:179] cbsz:4 abid:3
    s_nop 2
    s_branch EPI
DRAIN1:
    v_mfma_f32_4x4x4_16b_bf16 v[176:179], v[236:237], v[168:169], v[176:179] cbsz:4 abid:0
    s_nop 1
    v_mfma_f32_4x4x4_16b_bf16 v[176:179], v[236:237], v[170:171], v[176:179] cbsz:4 abid:1
    s_nop 1
    v_mfma_f32_4x4x4_16b_bf16 v[176:179], v[236:237], v[172:173], v[176:179] cbsz:4 abid:2
    s_nop 1
    v_mfma_f32_4x4x4_16b_bf16 v[176:179], v[236:237], v[174:175], v[176:179] cbsz:4 abid:3
    s_nop 2
    s_branch EPI
L_DONE:
    s_lshl_b32 s56, s48, 11
    s_add_u32 s56, s56, 133376
    v_lshl_add_u32 v0, v251, 1, s56
    s_lshl_b32 s56, s48, 18
    s_waitcnt lgkmcnt(0)
    s_barrier
    ds_read_b128 v[104:107], v0 offset:0
    ds_read_b128 v[108:111], v0 offset:16
    s_waitcnt lgkmcnt(0)
    v_cvt_pk_bf16_f32 v152, v104, v105
    v_cvt_pk_bf16_f32 v153, v106, v107
    v_cvt_pk_bf16_f32 v154, v108, v109
    v_cvt_pk_bf16_f32 v155, v110, v111
    buffer_store_dwordx4 v[152:155], v251, s[28:31], s56 offen nt
L_FIN:
    s_endpgm
AW:
    s_sleep 1
    ds_read_b32 v254, v253
    s_waitcnt lgkmcnt(0)
    s_branch ADV
DRAW_P:
    s_mov_b64 exec, 1
    v_mov_b32 v253, 4
    ds_add_rtn_u32 v253, v251, v253 offset:17600
    s_mov_b64 exec, -1
    s_add_u32 s50, s50, 2
    s_mov_b32 s55, 1
    s_branch DRET_P
BP_X:
    s_cmp_eq_u32 s77, 1
    s_mov_b32 s77, 0
    s_cbranch_scc1 SLOW_W
    s_branch EPI_C
SLOW:
    s_bitcmp1_b32 s53, 6
    s_cbranch_scc1 EPI_R
    s_mov_b32 s74, s52
    s_mov_b32 s52, s53
    s_mov_b32 s77, 1
    ds_write_b32 v5, v176
    s_branch BPF
SLOW_W:
    s_load_dwordx2 s[4:5], s[0:1], 40
    v_lshrrev_b32 v204, 1, v252
    s_waitcnt lgkmcnt(0)
    global_load_dwordx2 v[196:197], v204, s[4:5] offset:0
    global_load_dwordx2 v[198:199], v204, s[4:5] offset:32
    global_load_dwordx2 v[200:201], v204, s[4:5] offset:64
    global_load_dwordx2 v[202:203], v204, s[4:5] offset:96
    s_waitcnt vmcnt(0)
    v_lshlrev_b32 v212, 16, v196
    v_and_b32 v213, 0xffff0000, v196
    v_lshlrev_b32 v214, 16, v197
    v_and_b32 v215, 0xffff0000, v197
    v_lshlrev_b32 v216, 16, v198
    v_and_b32 v217, 0xffff0000, v198
    v_lshlrev_b32 v218, 16, v199
    v_and_b32 v219, 0xffff0000, v199
    v_lshlrev_b32 v220, 16, v200
    v_and_b32 v221, 0xffff0000, v200
    v_lshlrev_b32 v222, 16, v201
    v_and_b32 v223, 0xffff0000, v201
    v_lshlrev_b32 v224, 16, v202
    v_and_b32 v225, 0xffff0000, v202
    v_lshlrev_b32 v226, 16, v203
    v_and_b32 v227, 0xffff0000, v203
    s_mov_b32 s52, s74
    s_and_b32 s56, s53, 63
    s_mov_b32 s57, 0
    s_bfe_u32 s59, s53, 0x40008
    s_lshl4_add_u32 s57, s56, s57
    s_lshl_b32 s57, s57, 4
    s_add_u32 s74, s57, 116992
    s_bitcmp1_b32 s53, 7
    s_cselect_b64 s[66:67], -1, 0
    s_cselect_b32 s59, 13, s59
    v_bfe_u32 v204, v251, 4, 4
    v_mov_b32 v207, v252
    v_mov_b64 v[180:181], 0
    v_mov_b64 v[182:183], 0
    v_mov_b64 v[184:185], 0
    v_mov_b64 v[186:187], 0
    v_mov_b64 v[188:189], 0
    v_mov_b64 v[190:191], 0
    v_mov_b64 v[192:193], 0
    v_mov_b64 v[194:195], 0
    s_lshr_b32 s58, s56, 3
    s_mul_i32 s57, s56, 25600
    s_mul_i32 s58, s58, 52224000
    s_add_u32 s57, s57, s58
    s_add_u32 s57, s57, s49
    s_lshr_b32 s64, s56, 3
    s_mul_i32 s58, s56, 400
    s_mul_i32 s64, s64, 816000
    s_add_u32 s58, s58, s64
SLOW_L:
    v_add_u32 v205, s74, v204
    ds_read_u8 v206, v205
    s_waitcnt lgkmcnt(0)
    v_cndmask_b32_e64 v206, v206, v204, s[66:67]
    v_lshlrev_b32 v205, 1, v206
    buffer_load_dwordx4 v[196:199], v[206:207], s[20:23], s57 idxen offen offset:1024
    buffer_load_dwordx4 v[200:203], v[206:207], s[20:23], s57 idxen offen offset:1088
    buffer_load_ushort v205, v205, s[24:27], s58 offen
    v_cmp_gt_u32 vcc, 200, v206
    v_add_u32 v204, 16, v204
    s_waitcnt vmcnt(0)
    v_mfma_f32_16x16x32_bf16 v[104:107], v[72:75], v[196:199], v[136:139]
    v_mfma_f32_16x16x32_bf16 v[104:107], v[76:79], v[200:203], v[104:107]
    v_mfma_f32_16x16x32_bf16 v[108:111], v[80:83], v[196:199], v[140:143]
    v_mfma_f32_16x16x32_bf16 v[108:111], v[84:87], v[200:203], v[108:111]
    v_mfma_f32_16x16x32_bf16 v[112:115], v[88:91], v[196:199], v[144:147]
    v_mfma_f32_16x16x32_bf16 v[112:115], v[92:95], v[200:203], v[112:115]
    v_mfma_f32_16x16x32_bf16 v[116:119], v[96:99], v[196:199], v[148:151]
    v_mfma_f32_16x16x32_bf16 v[116:119], v[100:103], v[200:203], v[116:119]
    v_lshlrev_b32 v205, 16, v205
    v_cndmask_b32 v205, 0, v205, vcc
    s_nop 7
    v_exp_f32 v104, v104
    v_exp_f32 v105, v105
    v_exp_f32 v106, v106
    v_exp_f32 v107, v107
    v_exp_f32 v108, v108
    v_exp_f32 v109, v109
    v_exp_f32 v110, v110
    v_exp_f32 v111, v111
    v_exp_f32 v112, v112
    v_exp_f32 v113, v113
    v_exp_f32 v114, v114
    v_exp_f32 v115, v115
    v_exp_f32 v116, v116
    v_exp_f32 v117, v117
    v_exp_f32 v118, v118
    v_exp_f32 v119, v119
    v_add_f32 v104, 1.0, v104
    v_add_f32 v105, 1.0, v105
    v_add_f32 v106, 1.0, v106
    v_add_f32 v107, 1.0, v107
    v_add_f32 v108, 1.0, v108
    v_add_f32 v109, 1.0, v109
    v_add_f32 v110, 1.0, v110
    v_add_f32 v111, 1.0, v111
    v_add_f32 v112, 1.0, v112
    v_add_f32 v113, 1.0, v113
    v_add_f32 v114, 1.0, v114
    v_add_f32 v115, 1.0, v115
    v_add_f32 v116, 1.0, v116
    v_add_f32 v117, 1.0, v117
    v_add_f32 v118, 1.0, v118
    v_add_f32 v119, 1.0, v119
    v_rcp_f32 v104, v104
    v_rcp_f32 v105, v105
    v_rcp_f32 v106, v106
    v_rcp_f32 v107, v107
    v_rcp_f32 v108, v108
    v_rcp_f32 v109, v109
    v_rcp_f32 v110, v110
    v_rcp_f32 v111, v111
    v_rcp_f32 v112, v112
    v_rcp_f32 v113, v113
    v_rcp_f32 v114, v114
    v_rcp_f32 v115, v115
    v_rcp_f32 v116, v116
    v_rcp_f32 v117, v117
    v_rcp_f32 v118, v118
    v_rcp_f32 v119, v119
    v_mul_f32 v208, v104, v212
    v_fmac_f32 v208, v105, v213
    v_fmac_f32 v208, v106, v214
    v_fmac_f32 v208, v107, v215
    v_fmac_f32 v208, v108, v216
    v_fmac_f32 v208, v109, v217
    v_fmac_f32 v208, v110, v218
    v_fmac_f32 v208, v111, v219
    v_fmac_f32 v208, v112, v220
    v_fmac_f32 v208, v113, v221
    v_fmac_f32 v208, v114, v222
    v_fmac_f32 v208, v115, v223
    v_fmac_f32 v208, v116, v224
    v_fmac_f32 v208, v117, v225
    v_fmac_f32 v208, v118, v226
    v_fmac_f32 v208, v119, v227
    v_mov_b32 v209, v208
    s_nop 1
    v_permlane32_swap_b32 v208, v209
    v_add_f32 v208, v208, v209
    v_mov_b32 v209, v208
    s_nop 1
    v_permlane16_swap_b32 v208, v209
    v_add_f32 v208, v208, v209
    v_add_f32 v208, s63, v208
    v_mul_f32 v208, v208, v205
    v_lshlrev_b32 v209, 16, v196
    v_and_b32 v210, 0xffff0000, v196
    v_fmac_f32 v180, v208, v209
    v_fmac_f32 v181, v208, v210
    v_lshlrev_b32 v209, 16, v197
    v_and_b32 v210, 0xffff0000, v197
    v_fmac_f32 v182, v208, v209
    v_fmac_f32 v183, v208, v210
    v_lshlrev_b32 v209, 16, v198
    v_and_b32 v210, 0xffff0000, v198
    v_fmac_f32 v184, v208, v209
    v_fmac_f32 v185, v208, v210
    v_lshlrev_b32 v209, 16, v199
    v_and_b32 v210, 0xffff0000, v199
    v_fmac_f32 v186, v208, v209
    v_fmac_f32 v187, v208, v210
    v_lshlrev_b32 v209, 16, v200
    v_and_b32 v210, 0xffff0000, v200
    v_fmac_f32 v188, v208, v209
    v_fmac_f32 v189, v208, v210
    v_lshlrev_b32 v209, 16, v201
    v_and_b32 v210, 0xffff0000, v201
    v_fmac_f32 v190, v208, v209
    v_fmac_f32 v191, v208, v210
    v_lshlrev_b32 v209, 16, v202
    v_and_b32 v210, 0xffff0000, v202
    v_fmac_f32 v192, v208, v209
    v_fmac_f32 v193, v208, v210
    v_lshlrev_b32 v209, 16, v203
    v_and_b32 v210, 0xffff0000, v203
    v_fmac_f32 v194, v208, v209
    v_fmac_f32 v195, v208, v210
    s_sub_u32 s59, s59, 1
    s_cmp_lg_u32 s59, 0
    s_cbranch_scc1 SLOW_L
    v_readfirstlane_b32 s56, v5
    s_nop 1
    v_lshl_add_u32 v208, v252, 1, s56
    ds_add_f32 v208, v180 offset:0
    ds_add_f32 v208, v181 offset:4
    ds_add_f32 v208, v182 offset:8
    ds_add_f32 v208, v183 offset:12
    ds_add_f32 v208, v184 offset:16
    ds_add_f32 v208, v185 offset:20
    ds_add_f32 v208, v186 offset:24
    ds_add_f32 v208, v187 offset:28
    ds_add_f32 v208, v188 offset:128
    ds_add_f32 v208, v189 offset:132
    ds_add_f32 v208, v190 offset:136
    ds_add_f32 v208, v191 offset:140
    ds_add_f32 v208, v192 offset:144
    ds_add_f32 v208, v193 offset:148
    ds_add_f32 v208, v194 offset:152
    ds_add_f32 v208, v195 offset:156
    s_waitcnt lgkmcnt(0)
    s_bitcmp1_b32 s52, 6
    s_cbranch_scc1 L_DONE
    ds_read_b128 v[180:183], v251 offset:0
    ds_read_b128 v[184:187], v251 offset:1024
    ds_read_b128 v[196:199], v251 offset:4096
    ds_read_b128 v[200:203], v251 offset:5120
    ds_read_b128 v[212:215], v251 offset:8192
    ds_read_b128 v[216:219], v251 offset:9216
    ds_read_b128 v[188:191], v251 offset:2048
    ds_read_b128 v[192:195], v251 offset:3072
    ds_read_b128 v[204:207], v251 offset:6144
    ds_read_b128 v[208:211], v251 offset:7168
    ds_read_b128 v[220:223], v251 offset:10240
    ds_read_b128 v[224:227], v251 offset:11264
    ds_read_b128 v[228:231], v251 offset:14336
    ds_read_b128 v[232:235], v251 offset:15360
    s_mov_b32 s77, 2
    s_branch BPF
L_END:
    s_endpgm
.section .rodata,"a"
.p2align 6
.amdhsa_kernel standalone__sequential_behavior_din__recsys_kernel
  .amdhsa_next_free_vgpr 255
  .amdhsa_next_free_sgpr 80
  .amdhsa_accum_offset 256
  .amdhsa_group_segment_fixed_size 0
  .amdhsa_kernarg_size 80
  .amdhsa_user_sgpr_count 2
  .amdhsa_user_sgpr_kernarg_segment_ptr 1
  .amdhsa_system_sgpr_workgroup_id_x 1
.end_amdhsa_kernel
```
